```python
import torch

def _softmax(x, axis=-1):
    return torch.softmax(x, dim=axis)
def _gelu(x):
    return torch.nn.functional.gelu(x, approximate="tanh")
def _silu(x):
    return torch.nn.functional.silu(x)
def _sigmoid(x):
    return torch.sigmoid(x)
def _layernorm(x, axis=-1, eps=1e-5):
    m = x.mean(dim=axis, keepdim=True)
    v = x.var(dim=axis, keepdim=True, unbiased=False)
    return (x - m) / torch.sqrt(v + eps)
def _scatter_add(tgt, idx, src, axis=0):
    return tgt.clone().index_add_(axis, idx, src)
def _segment_sum(src, seg, n):
    out = torch.zeros((n,) + src.shape[1:], dtype=src.dtype)
    return out.index_add_(0, seg, src)
def _pad(x, pw):
    flat = tuple(v for pair in reversed(pw) for v in pair)
    return torch.nn.functional.pad(x, flat)

kernel_name = 'standalone__gqa_block_cached__near_ridge'

def setup_inputs():

    _w = (lambda a: (lambda t: t.to(torch.bfloat16) if t.is_floating_point() else t)(torch.as_tensor(a)))
    B, Sq, D = 16, 144, 512
    Hq, Hkv, Sk, Dh = 32, 32, 1024, 128
    assert Hq % Hkv == 0, (Hq, Hkv)
    return {
        "x": _w((lambda *s: torch.randn(*s, dtype=torch.bfloat16) * 0.8)(B, Sq, D)),
        "k_cache": _w((lambda *s: torch.randn(*s, dtype=torch.bfloat16) * 0.8)(B, Hkv, Sk, Dh)),
        "v_cache": _w((lambda *s: torch.randn(*s, dtype=torch.bfloat16) * 0.05)(B, Hkv, Sk, Dh)),
        "wq": _w((lambda *s: torch.randn(*s, dtype=torch.bfloat16) * 0.8)(D, Hq * Dh) * (D ** -0.5)),
        "wo": _w((lambda *s: torch.randn(*s, dtype=torch.bfloat16) * 0.05)(Hq * Dh, D) * ((Hq * Dh) ** -0.5)),
    }

def reference(x, k_cache, v_cache, wq, wo):
    B, Sq, D = x.shape
    Hq, Dh = 32, 128
    Hkv = k_cache.shape[1]
    rep = Hq // Hkv
    q = (lambda x, *d: x.permute(*d))((x @ wq).reshape(B, Sq, Hq, Dh), 0, 2, 1, 3)
    k = (lambda x, n, axis: torch.repeat_interleave(x, n, dim=axis))(k_cache, rep, axis=1)
    v = (lambda x, n, axis: torch.repeat_interleave(x, n, dim=axis))(v_cache, rep, axis=1)
    scores = torch.einsum("bhqd,bhkd->bhqk", q, k) * (Dh ** -0.5)
    p = _softmax(scores, axis=-1)
    o = torch.einsum("bhqk,bhkd->bhqd", p, v)
    return (lambda x, *d: x.permute(*d))(o, 0, 2, 1, 3).reshape(B, Sq, Hq * Dh) @ wo
```

```asm
; @launch grid=(256,1,1) block=(256,1,1) lds=163840
.amdgcn_target "amdgcn-amd-amdhsa--gfx950"
.text
.globl standalone__gqa_block_cached__near_ridge_kernel
.p2align 8
.type standalone__gqa_block_cached__near_ridge_kernel,@function
standalone__gqa_block_cached__near_ridge_kernel:
    s_cmp_ge_u32 s2, 256
    s_cbranch_scc1 L_done
    s_load_dwordx16 s[4:19], s[0:1], 0
    s_getpc_b64 s[96:97]
L_pc:
    s_sub_u32 s96, s96, L_pc-standalone__gqa_block_cached__near_ridge_kernel
    s_subb_u32 s97, s97, 0
    v_lshrrev_b32 v1, 2, v0
    v_cmp_lt_u32 vcc, 127, v0
    v_lshlrev_b32 v1, 7, v1
    v_mov_b32 v2, 256
    v_mov_b32 v3, L_helper-standalone__gqa_block_cached__near_ridge_kernel-4096
    v_cndmask_b32 v2, v2, v3, vcc
    v_add3_u32 v2, v1, v2, s96
    v_cmp_gt_u32 vcc, s96, v2
    v_mov_b32 v3, s97
    s_nop 0
    v_addc_co_u32 v3, vcc, 0, v3, vcc
    global_load_dword a200, v[2:3], off
    v_lshrrev_b32 v10, 6, v0
    v_and_b32 v0, 63, v0
    v_readfirstlane_b32 s52, v10
    s_and_b32 s56, s2, 1
    s_lshl_b32 s56, s56, 3
    s_bfe_u32 s57, s2, 0x30003
    s_add_u32 s53, s56, s57
    s_bfe_u32 s54, s2, 0x20001
    s_bfe_u32 s55, s2, 0x20006
    s_lshl_b32 s56, s53, 5
    s_lshl_b32 s57, s54, 3
    s_add_u32 s56, s56, s57
    s_add_u32 s71, s56, s55
    s_add_u32 s84, s55, s53
    s_lshl_b32 s84, s84, 1
    s_and_b32 s84, s84, 7
    v_lshrrev_b32 v10, 4, v0
    v_and_b32 v11, 1, v10
    v_lshlrev_b32 v11, 17, v11
    v_lshrrev_b32 v6, 1, v10
    v_lshl_add_u32 v11, v6, 15, v11
    v_and_b32 v6, 15, v0
    v_lshl_add_u32 v6, v6, 4, v11
    v_add_u32 v7, 7136, v6
    v_add_u32 v8, 14272, v6
    v_add_u32 v9, 21408, v6
    s_and_b32 s65, s71, 31
    s_lshl_b32 s65, s65, 8
    s_lshl_b32 s56, s84, 19
    s_add_u32 s65, s65, s56
    s_and_b32 s56, s52, 1
    s_lshl_b32 s56, s56, 16
    s_add_u32 s65, s65, s56
    s_lshr_b32 s56, s52, 1
    s_lshl_b32 s56, s56, 10
    s_add_u32 s65, s65, s56
    s_mul_i32 s79, s52, 4224
    s_add_u32 s79, s79, 50688
    v_lshrrev_b32 v22, 3, v0
    v_lshlrev_b32 v22, 10, v22
    v_and_b32 v11, 7, v0
    v_xor_b32 v11, v11, v10
    v_lshl_add_u32 v22, v11, 4, v22
    v_xor_b32 v23, 64, v22
    v_add_u32 v23, 7168, v23
    v_add_u32 v24, 14336, v22
    v_add_u32 v25, 14336, v23
    s_mul_i32 s85, s53, 147456
    s_mul_i32 s56, s52, 49152
    s_add_u32 s85, s85, s56
    s_lshl_b32 s84, s84, 7
    s_mul_i32 s67, s52, 6144
    s_add_u32 s67, s67, 118272
    s_waitcnt lgkmcnt(0)
    s_mov_b32 s20, s4
    s_mov_b32 s21, s5
    s_mov_b32 s22, 2359296
    s_mov_b32 s23, 0x20000
    s_mov_b32 s32, s10
    s_mov_b32 s33, s11
    s_mov_b32 s34, 4194304
    s_mov_b32 s35, 0x20000
    s_add_u32 m0, s79, 0
    s_mov_b32 s57, s65
    buffer_load_dwordx4 v6, s[32:35], s57 offen offset:0 lds
    buffer_load_dwordx4 v7, s[32:35], s57 offen offset:1056 lds
    buffer_load_dwordx4 v8, s[32:35], s57 offen offset:2112 lds
    buffer_load_dwordx4 v9, s[32:35], s57 offen offset:3168 lds
    s_add_u32 s65, s65, 262144
    s_and_b32 s65, s65, 0x3fffff
    s_cmp_eq_u32 s52, 3
    s_cbranch_scc1 L_px0
    s_add_u32 m0, s67, 0
    s_add_u32 s57, s85, s84
    buffer_load_dwordx4 v22, s[20:23], s57 offen offset:0 lds
    buffer_load_dwordx4 v23, s[20:23], s57 offen offset:1024 lds
    buffer_load_dwordx4 v24, s[20:23], s57 offen offset:2048 lds
    buffer_load_dwordx4 v25, s[20:23], s57 offen offset:3072 lds
    s_add_u32 m0, s67, 4096
    s_add_u32 s57, s57, 32768
    buffer_load_dwordx4 v22, s[20:23], s57 offen offset:0 lds
    buffer_load_dwordx4 v23, s[20:23], s57 offen offset:1024 lds
    s_add_u32 s84, s84, 128
    s_and_b32 s84, s84, 1023
L_px0:
    s_add_u32 m0, s79, 16896
    s_mov_b32 s57, s65
    buffer_load_dwordx4 v6, s[32:35], s57 offen offset:0 lds
    buffer_load_dwordx4 v7, s[32:35], s57 offen offset:1056 lds
    buffer_load_dwordx4 v8, s[32:35], s57 offen offset:2112 lds
    buffer_load_dwordx4 v9, s[32:35], s57 offen offset:3168 lds
    s_add_u32 s65, s65, 262144
    s_and_b32 s65, s65, 0x3fffff
    s_sub_u32 s24, s6, 96
    s_subb_u32 s25, s7, 0
    s_mov_b32 s26, 134217824
    s_mov_b32 s27, 0x20000
    s_sub_u32 s28, s8, 96
    s_subb_u32 s29, s9, 0
    s_mov_b32 s30, 134217824
    s_mov_b32 s31, 0x20000
    s_sub_u32 s36, s12, 96
    s_subb_u32 s37, s13, 0
    s_mov_b32 s38, 4194400
    s_mov_b32 s39, 0x20000
    s_mov_b32 s44, s14
    s_mov_b32 s45, s15
    s_mov_b32 s46, 2359296
    s_mov_b32 s47, 0x20000
    s_mov_b32 s48, s16
    s_mov_b32 s49, s17
    s_mov_b32 s50, 256
    s_mov_b32 s51, 0x20000
    s_mov_b32 s40, s18
    s_mov_b32 s41, s19
    s_mov_b32 s42, 37797888
    s_mov_b32 s43, 0x20000
    v_lshlrev_b32 v5, 4, v0
    v_bfe_u32 v10, v0, 2, 3
    v_mul_u32_u24 v10, 1056, v10
    v_lshrrev_b32 v11, 5, v0
    v_lshl_add_u32 v10, v11, 8, v10
    v_and_b32 v11, 3, v0
    v_lshl_add_u32 v1, v11, 3, v10
    v_mov_b32 v14, 0x3e0293ee
    v_mov_b32 v15, 0x3e0293ee
    s_cmp_eq_u32 s52, 3
    s_cbranch_scc1 L_helper
    v_lshrrev_b32 v11, 4, v0
    s_lshl_b32 s56, s53, 2
    s_add_u32 s57, s56, s54
    s_lshl_b32 s73, s57, 2
    s_lshl_b32 s57, s57, 7
    s_lshl_b32 s58, s52, 4
    s_add_u32 s58, s58, 37748736
    s_add_u32 s69, s57, s58
    s_add_u32 s57, s56, s55
    s_lshl_b32 s74, s57, 4
    s_lshl_b32 s56, s55, 2
    s_add_u32 s75, s69, s56
    s_add_u32 s76, s75, 8192
    s_mul_i32 s76, s73, 384
    s_lshl_b32 s57, s52, 7
    s_add_u32 s76, s76, s57
    s_add_u32 s76, s76, 19922944
    s_mul_i32 s89, s55, 384
    s_add_u32 s89, s89, s76
    s_add_u32 s76, s76, s56
    s_add_u32 s56, s54, 0
    s_and_b32 s56, s56, 3
    s_lshl_b32 s59, s53, 2
    s_add_u32 s56, s56, s59
    s_lshl_b32 s56, s56, 2
    s_add_u32 s56, s56, s55
    s_mul_i32 s56, s56, 3
    s_add_u32 s56, s56, s52
    s_mul_i32 s56, s56, 12288
    s_add_u32 s4, s56, 0
    s_add_u32 s56, s54, 0
    s_and_b32 s56, s56, 3
    s_lshl_b32 s59, s53, 2
    s_add_u32 s56, s56, s59
    s_lshl_b32 s56, s56, 2
    s_add_u32 s56, s56, s55
    s_mul_i32 s56, s56, 3
    s_add_u32 s56, s56, s52
    s_mul_i32 s56, s56, 12288
    s_add_u32 s5, s56, 4096
    s_add_u32 s56, s54, 0
    s_and_b32 s56, s56, 3
    s_lshl_b32 s59, s53, 2
    s_add_u32 s56, s56, s59
    s_lshl_b32 s56, s56, 2
    s_add_u32 s56, s56, s55
    s_mul_i32 s56, s56, 3
    s_add_u32 s56, s56, s52
    s_mul_i32 s56, s56, 12288
    s_add_u32 s6, s56, 8192
    s_lshl_b32 s56, s74, 4
    s_add_u32 s56, s56, s58
    s_add_u32 s56, s56, 16384
    s_lshl_b32 s57, s54, 6
    s_add_u32 s70, s56, s57
    s_add_u32 s57, s54, 1
    v_add_u32 v16, s57, v0
    v_and_b32 v16, 3, v16
    v_lshlrev_b32 v16, 6, v16
    v_lshlrev_b32 v17, 2, v0
    v_sub_u32 v16, v16, v17
    s_add_u32 s56, s56, 8
    s_add_u32 s14, s56, 16384
    v_add_u32 v16, s56, v16
    s_mul_i32 s14, s74, 96
    s_lshl_b32 s56, s52, 7
    s_add_u32 s14, s14, s56
    s_add_u32 s14, s14, 20971528
    s_add_u32 s56, s54, 1
    s_and_b32 s56, s56, 3
    s_lshl_b32 s59, s53, 2
    s_add_u32 s56, s56, s59
    s_lshl_b32 s56, s56, 2
    s_add_u32 s56, s56, s55
    s_mul_i32 s56, s56, 3
    s_add_u32 s56, s56, s52
    s_mul_i32 s56, s56, 12288
    s_add_u32 s7, s56, 8192
    s_add_u32 s56, s54, 2
    s_and_b32 s56, s56, 3
    s_lshl_b32 s59, s53, 2
    s_add_u32 s56, s56, s59
    s_lshl_b32 s56, s56, 2
    s_add_u32 s56, s56, s55
    s_mul_i32 s56, s56, 3
    s_add_u32 s56, s56, s52
    s_mul_i32 s56, s56, 12288
    s_add_u32 s8, s56, 4096
    s_add_u32 s56, s54, 3
    s_and_b32 s56, s56, 3
    s_lshl_b32 s59, s53, 2
    s_add_u32 s56, s56, s59
    s_lshl_b32 s56, s56, 2
    s_add_u32 s56, s56, s55
    s_mul_i32 s56, s56, 3
    s_add_u32 s56, s56, s52
    s_mul_i32 s56, s56, 12288
    s_add_u32 s9, s56, 0
    s_mul_i32 s56, s53, 144
    s_mul_i32 s57, s52, 48
    s_add_u32 s56, s56, s57
    s_lshl_b32 s56, s56, 10
    s_lshl_b32 s57, s53, 1
    s_lshr_b32 s57, 2045222521, s57
    s_add_u32 s57, s57, s55
    s_and_b32 s57, s57, 3
    s_lshl_b32 s57, s57, 8
    s_add_u32 s56, s56, s57
    s_lshl_b32 s57, s54, 6
    s_add_u32 s10, s56, s57
    s_add_u32 s56, s73, s55
    s_mul_i32 s68, s56, 36864
    s_mul_i32 s57, s52, 12288
    s_add_u32 s68, s68, s57
    v_bfe_u32 v10, v0, 1, 3
    v_xor_b32 v10, v10, v11
    v_lshlrev_b32 v10, 4, v10
    v_and_b32 v20, 15, v0
    v_lshl_add_u32 v10, v20, 7, v10
    v_add_u32 v20, s67, v10
    v_xor_b32 v10, 64, v10
    v_add_u32 v21, s67, v10
    v_and_b32 v10, 7, v0
    v_mul_u32_u24 v10, 1056, v10
    v_bfe_u32 v4, v0, 3, 1
    v_lshl_add_u32 v10, v4, 8, v10
    v_lshl_add_u32 v10, v11, 4, v10
    v_add_u32 v2, 8448, v10
    v_mov_b32 v4, v2
    v_add_u32 v3, 50688, v1
    v_mov_b32 v10, 0x3f803f80
    v_accvgpr_write_b32 a168, v10
    v_accvgpr_write_b32 a169, v10
    v_accvgpr_write_b32 a170, v10
    v_accvgpr_write_b32 a171, v10
    s_add_u32 m0, s79, 33792
    s_mov_b32 s57, s65
    buffer_load_dwordx4 v6, s[32:35], s57 offen offset:0 lds
    buffer_load_dwordx4 v7, s[32:35], s57 offen offset:1056 lds
    buffer_load_dwordx4 v8, s[32:35], s57 offen offset:2112 lds
    buffer_load_dwordx4 v9, s[32:35], s57 offen offset:3168 lds
    s_add_u32 s65, s65, 262144
    s_and_b32 s65, s65, 0x3fffff
    s_add_u32 m0, s67, 18432
    s_add_u32 s57, s85, s84
    buffer_load_dwordx4 v22, s[20:23], s57 offen offset:0 lds
    buffer_load_dwordx4 v23, s[20:23], s57 offen offset:1024 lds
    buffer_load_dwordx4 v24, s[20:23], s57 offen offset:2048 lds
    buffer_load_dwordx4 v25, s[20:23], s57 offen offset:3072 lds
    s_add_u32 m0, s67, 22528
    s_add_u32 s57, s57, 32768
    buffer_load_dwordx4 v22, s[20:23], s57 offen offset:0 lds
    buffer_load_dwordx4 v23, s[20:23], s57 offen offset:1024 lds
    s_add_u32 s84, s84, 128
    s_and_b32 s84, s84, 1023
    s_waitcnt vmcnt(10)
    s_barrier
    ds_read_b128 a[96:99], v20 offset:0
    ds_read_b128 a[100:103], v20 offset:2048
    ds_read_b128 a[104:107], v20 offset:4096
    ds_read_b64_tr_b16 a[0:1], v3 offset:0
    ds_read_b64_tr_b16 a[2:3], v3 offset:512
    ds_read_b64_tr_b16 a[4:5], v3 offset:32
    ds_read_b64_tr_b16 a[6:7], v3 offset:544
    ds_read_b64_tr_b16 a[8:9], v3 offset:64
    ds_read_b64_tr_b16 a[10:11], v3 offset:576
    ds_read_b64_tr_b16 a[12:13], v3 offset:96
    ds_read_b64_tr_b16 a[14:15], v3 offset:608
    ds_read_b64_tr_b16 a[16:17], v3 offset:128
    ds_read_b64_tr_b16 a[18:19], v3 offset:640
    ds_read_b64_tr_b16 a[20:21], v3 offset:160
    ds_read_b64_tr_b16 a[22:23], v3 offset:672
    ds_read_b64_tr_b16 a[24:25], v3 offset:192
    ds_read_b64_tr_b16 a[26:27], v3 offset:704
    ds_read_b64_tr_b16 a[28:29], v3 offset:224
    ds_read_b64_tr_b16 a[30:31], v3 offset:736
    ds_read_b64_tr_b16 a[32:33], v3 offset:8448
    ds_read_b64_tr_b16 a[34:35], v3 offset:8960
    ds_read_b64_tr_b16 a[36:37], v3 offset:8480
    ds_read_b64_tr_b16 a[38:39], v3 offset:8992
    ds_read_b64_tr_b16 a[40:41], v3 offset:8512
    ds_read_b64_tr_b16 a[42:43], v3 offset:9024
    ds_read_b64_tr_b16 a[44:45], v3 offset:8544
    ds_read_b64_tr_b16 a[46:47], v3 offset:9056
    s_waitcnt lgkmcnt(0)
    v_mfma_f32_16x16x32_bf16 v[116:119], a[0:3], a[96:99], 0
    s_add_u32 m0, s79, 50688
    ds_read_b128 a[108:111], v21 offset:0
    v_mfma_f32_16x16x32_bf16 v[148:151], a[0:3], a[100:103], 0
    s_mov_b32 s57, s65
    ds_read_b128 a[112:115], v21 offset:2048
    v_mfma_f32_16x16x32_bf16 v[180:183], a[0:3], a[104:107], 0
    buffer_load_dwordx4 v6, s[32:35], s57 offen offset:0 lds
    v_mfma_f32_16x16x32_bf16 v[120:123], a[4:7], a[96:99], 0
    ds_read_b128 a[116:119], v21 offset:4096
    v_mfma_f32_16x16x32_bf16 v[152:155], a[4:7], a[100:103], 0
    buffer_load_dwordx4 v7, s[32:35], s57 offen offset:1056 lds
    v_mfma_f32_16x16x32_bf16 v[184:187], a[4:7], a[104:107], 0
    ds_read_b64_tr_b16 a[48:49], v3 offset:16896
    v_mfma_f32_16x16x32_bf16 v[124:127], a[8:11], a[96:99], 0
    buffer_load_dwordx4 v8, s[32:35], s57 offen offset:2112 lds
    v_mfma_f32_16x16x32_bf16 v[156:159], a[8:11], a[100:103], 0
    ds_read_b64_tr_b16 a[50:51], v3 offset:17408
    v_mfma_f32_16x16x32_bf16 v[188:191], a[8:11], a[104:107], 0
    buffer_load_dwordx4 v9, s[32:35], s57 offen offset:3168 lds
    v_mfma_f32_16x16x32_bf16 v[128:131], a[12:15], a[96:99], 0
    ds_read_b64_tr_b16 a[52:53], v3 offset:16928
    v_mfma_f32_16x16x32_bf16 v[160:163], a[12:15], a[100:103], 0
    s_add_u32 s65, s65, 262144
    ds_read_b64_tr_b16 a[54:55], v3 offset:17440
    v_mfma_f32_16x16x32_bf16 v[192:195], a[12:15], a[104:107], 0
    s_and_b32 s65, s65, 0x3fffff
    ds_read_b64_tr_b16 a[56:57], v3 offset:16960
    v_mfma_f32_16x16x32_bf16 v[132:135], a[16:19], a[96:99], 0
    ds_read_b64_tr_b16 a[58:59], v3 offset:17472
    v_mfma_f32_16x16x32_bf16 v[164:167], a[16:19], a[100:103], 0
    ds_read_b64_tr_b16 a[60:61], v3 offset:16992
    v_mfma_f32_16x16x32_bf16 v[196:199], a[16:19], a[104:107], 0
    ds_read_b64_tr_b16 a[62:63], v3 offset:17504
    v_mfma_f32_16x16x32_bf16 v[136:139], a[20:23], a[96:99], 0
    ds_read_b64_tr_b16 a[64:65], v3 offset:17024
    v_mfma_f32_16x16x32_bf16 v[168:171], a[20:23], a[100:103], 0
    ds_read_b64_tr_b16 a[66:67], v3 offset:17536
    v_mfma_f32_16x16x32_bf16 v[200:203], a[20:23], a[104:107], 0
    ds_read_b64_tr_b16 a[68:69], v3 offset:17056
    v_mfma_f32_16x16x32_bf16 v[140:143], a[24:27], a[96:99], 0
    ds_read_b64_tr_b16 a[70:71], v3 offset:17568
    v_mfma_f32_16x16x32_bf16 v[172:175], a[24:27], a[100:103], 0
    ds_read_b64_tr_b16 a[72:73], v3 offset:17088
    v_mfma_f32_16x16x32_bf16 v[204:207], a[24:27], a[104:107], 0
    ds_read_b64_tr_b16 a[74:75], v3 offset:17600
    v_mfma_f32_16x16x32_bf16 v[144:147], a[28:31], a[96:99], 0
    ds_read_b64_tr_b16 a[76:77], v3 offset:17120
    v_mfma_f32_16x16x32_bf16 v[176:179], a[28:31], a[100:103], 0
    ds_read_b64_tr_b16 a[78:79], v3 offset:17632
    v_mfma_f32_16x16x32_bf16 v[208:211], a[28:31], a[104:107], 0
    ds_read_b64_tr_b16 a[80:81], v3 offset:25344
    v_mfma_f32_16x16x32_bf16 a[120:123], a[32:35], a[96:99], 0
    ds_read_b64_tr_b16 a[82:83], v3 offset:25856
    v_mfma_f32_16x16x32_bf16 a[136:139], a[32:35], a[100:103], 0
    ds_read_b64_tr_b16 a[84:85], v3 offset:25376
    v_mfma_f32_16x16x32_bf16 a[152:155], a[32:35], a[104:107], 0
    ds_read_b64_tr_b16 a[86:87], v3 offset:25888
    v_mfma_f32_16x16x32_bf16 a[124:127], a[36:39], a[96:99], 0
    ds_read_b64_tr_b16 a[88:89], v3 offset:25408
    v_mfma_f32_16x16x32_bf16 a[140:143], a[36:39], a[100:103], 0
    ds_read_b64_tr_b16 a[90:91], v3 offset:25920
    v_mfma_f32_16x16x32_bf16 a[156:159], a[36:39], a[104:107], 0
    ds_read_b64_tr_b16 a[92:93], v3 offset:25440
    v_mfma_f32_16x16x32_bf16 a[128:131], a[40:43], a[96:99], 0
    ds_read_b64_tr_b16 a[94:95], v3 offset:25952
    v_mfma_f32_16x16x32_bf16 a[144:147], a[40:43], a[100:103], 0
    v_mfma_f32_16x16x32_bf16 a[160:163], a[40:43], a[104:107], 0
    v_mfma_f32_16x16x32_bf16 a[132:135], a[44:47], a[96:99], 0
    v_mfma_f32_16x16x32_bf16 a[148:151], a[44:47], a[100:103], 0
    v_mfma_f32_16x16x32_bf16 a[164:167], a[44:47], a[104:107], 0
    s_lshr_b32 s56, s2, 3
    s_mul_i32 s56, s56, 3
    s_add_u32 s56, s56, s52
    v_mul_u32_u24 v10, 12288, v0
    s_lshl_b32 s56, s56, 7
    s_add_u32 s56, s56, standalone__gqa_block_cached__near_ridge_kernel-standalone__gqa_block_cached__near_ridge_kernel
    v_add_u32 v10, s56, v10
    v_min_u32 v10, L_done-standalone__gqa_block_cached__near_ridge_kernel, v10
    v_mov_b32 v11, s97
    v_add_co_u32 v10, vcc, s96, v10
    s_nop 1
    v_addc_co_u32 v11, vcc, 0, v11, vcc
    global_load_dword a172, v[10:11], off
    s_mov_b64 exec, 1
    v_mov_b32 v28, 0
    v_mov_b32 v29, 0
    v_mov_b32 v30, 0
    v_mov_b32 v31, 0
    buffer_store_dword v28, off, s[40:43], s75 sc1
    buffer_store_dwordx4 v[28:31], off, s[40:43], s89 sc1
    s_mov_b64 exec, -1
    s_mov_b64 exec, 15
    buffer_load_dword v17, v16, s[40:43], 0 offen sc1
    s_mov_b64 exec, -1
    s_waitcnt vmcnt(8) lgkmcnt(0)
    s_barrier
    v_mfma_f32_16x16x32_bf16 v[116:119], a[48:51], a[108:111], v[116:119]
    s_add_u32 m0, s67, 0
    ds_read_b128 a[96:99], v20 offset:18432
    v_mfma_f32_16x16x32_bf16 v[148:151], a[48:51], a[112:115], v[148:151]
    s_add_u32 s57, s85, s84
    ds_read_b128 a[100:103], v20 offset:20480
    v_mfma_f32_16x16x32_bf16 v[180:183], a[48:51], a[116:119], v[180:183]
    buffer_load_dwordx4 v22, s[20:23], s57 offen offset:0 lds
    v_mfma_f32_16x16x32_bf16 v[120:123], a[52:55], a[108:111], v[120:123]
    ds_read_b128 a[104:107], v20 offset:22528
    v_mfma_f32_16x16x32_bf16 v[152:155], a[52:55], a[112:115], v[152:155]
    buffer_load_dwordx4 v23, s[20:23], s57 offen offset:1024 lds
    v_mfma_f32_16x16x32_bf16 v[184:187], a[52:55], a[116:119], v[184:187]
    ds_read_b64_tr_b16 a[0:1], v3 offset:33792
    v_mfma_f32_16x16x32_bf16 v[124:127], a[56:59], a[108:111], v[124:127]
    buffer_load_dwordx4 v24, s[20:23], s57 offen offset:2048 lds
    v_mfma_f32_16x16x32_bf16 v[156:159], a[56:59], a[112:115], v[156:159]
    ds_read_b64_tr_b16 a[2:3], v3 offset:34304
    v_mfma_f32_16x16x32_bf16 v[188:191], a[56:59], a[116:119], v[188:191]
    buffer_load_dwordx4 v25, s[20:23], s57 offen offset:3072 lds
    v_mfma_f32_16x16x32_bf16 v[128:131], a[60:63], a[108:111], v[128:131]
    ds_read_b64_tr_b16 a[4:5], v3 offset:33824
    v_mfma_f32_16x16x32_bf16 v[160:163], a[60:63], a[112:115], v[160:163]
    s_add_u32 m0, s67, 4096
    ds_read_b64_tr_b16 a[6:7], v3 offset:34336
    v_mfma_f32_16x16x32_bf16 v[192:195], a[60:63], a[116:119], v[192:195]
    s_add_u32 s57, s57, 32768
    ds_read_b64_tr_b16 a[8:9], v3 offset:33856
    v_mfma_f32_16x16x32_bf16 v[132:135], a[64:67], a[108:111], v[132:135]
    buffer_load_dwordx4 v22, s[20:23], s57 offen offset:0 lds
    v_mfma_f32_16x16x32_bf16 v[164:167], a[64:67], a[112:115], v[164:167]
    ds_read_b64_tr_b16 a[10:11], v3 offset:34368
    v_mfma_f32_16x16x32_bf16 v[196:199], a[64:67], a[116:119], v[196:199]
    buffer_load_dwordx4 v23, s[20:23], s57 offen offset:1024 lds
    v_mfma_f32_16x16x32_bf16 v[136:139], a[68:71], a[108:111], v[136:139]
    ds_read_b64_tr_b16 a[12:13], v3 offset:33888
    v_mfma_f32_16x16x32_bf16 v[168:171], a[68:71], a[112:115], v[168:171]
    s_add_u32 s84, s84, 128
    ds_read_b64_tr_b16 a[14:15], v3 offset:34400
    v_mfma_f32_16x16x32_bf16 v[200:203], a[68:71], a[116:119], v[200:203]
    s_and_b32 s84, s84, 1023
    ds_read_b64_tr_b16 a[16:17], v3 offset:33920
    v_mfma_f32_16x16x32_bf16 v[140:143], a[72:75], a[108:111], v[140:143]
    s_add_u32 m0, s79, 0
    ds_read_b64_tr_b16 a[18:19], v3 offset:34432
    v_mfma_f32_16x16x32_bf16 v[172:175], a[72:75], a[112:115], v[172:175]
    s_mov_b32 s57, s65
    ds_read_b64_tr_b16 a[20:21], v3 offset:33952
    v_mfma_f32_16x16x32_bf16 v[204:207], a[72:75], a[116:119], v[204:207]
    buffer_load_dwordx4 v6, s[32:35], s57 offen offset:0 lds
    v_mfma_f32_16x16x32_bf16 v[144:147], a[76:79], a[108:111], v[144:147]
    ds_read_b64_tr_b16 a[22:23], v3 offset:34464
    v_mfma_f32_16x16x32_bf16 v[176:179], a[76:79], a[112:115], v[176:179]
    buffer_load_dwordx4 v7, s[32:35], s57 offen offset:1056 lds
    v_mfma_f32_16x16x32_bf16 v[208:211], a[76:79], a[116:119], v[208:211]
    ds_read_b64_tr_b16 a[24:25], v3 offset:33984
    v_mfma_f32_16x16x32_bf16 a[120:123], a[80:83], a[108:111], a[120:123]
    buffer_load_dwordx4 v8, s[32:35], s57 offen offset:2112 lds
    v_mfma_f32_16x16x32_bf16 a[136:139], a[80:83], a[112:115], a[136:139]
    ds_read_b64_tr_b16 a[26:27], v3 offset:34496
    v_mfma_f32_16x16x32_bf16 a[152:155], a[80:83], a[116:119], a[152:155]
    buffer_load_dwordx4 v9, s[32:35], s57 offen offset:3168 lds
    v_mfma_f32_16x16x32_bf16 a[124:127], a[84:87], a[108:111], a[124:127]
    ds_read_b64_tr_b16 a[28:29], v3 offset:34016
    v_mfma_f32_16x16x32_bf16 a[140:143], a[84:87], a[112:115], a[140:143]
    s_add_u32 s65, s65, 262144
    ds_read_b64_tr_b16 a[30:31], v3 offset:34528
    v_mfma_f32_16x16x32_bf16 a[156:159], a[84:87], a[116:119], a[156:159]
    s_and_b32 s65, s65, 0x3fffff
    ds_read_b64_tr_b16 a[32:33], v3 offset:42240
    v_mfma_f32_16x16x32_bf16 a[128:131], a[88:91], a[108:111], a[128:131]
    s_add_u32 m0, s79, 16896
    ds_read_b64_tr_b16 a[34:35], v3 offset:42752
    v_mfma_f32_16x16x32_bf16 a[144:147], a[88:91], a[112:115], a[144:147]
    s_mov_b32 s57, s65
    ds_read_b64_tr_b16 a[36:37], v3 offset:42272
    v_mfma_f32_16x16x32_bf16 a[160:163], a[88:91], a[116:119], a[160:163]
    buffer_load_dwordx4 v6, s[32:35], s57 offen offset:0 lds
    v_mfma_f32_16x16x32_bf16 a[132:135], a[92:95], a[108:111], a[132:135]
    ds_read_b64_tr_b16 a[38:39], v3 offset:42784
    v_mfma_f32_16x16x32_bf16 a[148:151], a[92:95], a[112:115], a[148:151]
    buffer_load_dwordx4 v7, s[32:35], s57 offen offset:1056 lds
    v_mfma_f32_16x16x32_bf16 a[164:167], a[92:95], a[116:119], a[164:167]
    ds_read_b64_tr_b16 a[40:41], v3 offset:42304
    buffer_load_dwordx4 v8, s[32:35], s57 offen offset:2112 lds
    ds_read_b64_tr_b16 a[42:43], v3 offset:42816
    buffer_load_dwordx4 v9, s[32:35], s57 offen offset:3168 lds
    ds_read_b64_tr_b16 a[44:45], v3 offset:42336
    s_add_u32 s65, s65, 262144
    ds_read_b64_tr_b16 a[46:47], v3 offset:42848
    s_and_b32 s65, s65, 0x3fffff
    s_waitcnt vmcnt(18) lgkmcnt(0)
    s_barrier
    v_mfma_f32_16x16x32_bf16 v[116:119], a[0:3], a[96:99], v[116:119]
    s_add_u32 m0, s79, 33792
    ds_read_b128 a[108:111], v21 offset:18432
    v_mfma_f32_16x16x32_bf16 v[148:151], a[0:3], a[100:103], v[148:151]
    s_mov_b32 s57, s65
    ds_read_b128 a[112:115], v21 offset:20480
    v_mfma_f32_16x16x32_bf16 v[180:183], a[0:3], a[104:107], v[180:183]
    buffer_load_dwordx4 v6, s[32:35], s57 offen offset:0 lds
    v_mfma_f32_16x16x32_bf16 v[120:123], a[4:7], a[96:99], v[120:123]
    ds_read_b128 a[116:119], v21 offset:22528
    v_mfma_f32_16x16x32_bf16 v[152:155], a[4:7], a[100:103], v[152:155]
    buffer_load_dwordx4 v7, s[32:35], s57 offen offset:1056 lds
    v_mfma_f32_16x16x32_bf16 v[184:187], a[4:7], a[104:107], v[184:187]
    ds_read_b64_tr_b16 a[48:49], v3 offset:50688
    v_mfma_f32_16x16x32_bf16 v[124:127], a[8:11], a[96:99], v[124:127]
    buffer_load_dwordx4 v8, s[32:35], s57 offen offset:2112 lds
    v_mfma_f32_16x16x32_bf16 v[156:159], a[8:11], a[100:103], v[156:159]
    ds_read_b64_tr_b16 a[50:51], v3 offset:51200
    v_mfma_f32_16x16x32_bf16 v[188:191], a[8:11], a[104:107], v[188:191]
    buffer_load_dwordx4 v9, s[32:35], s57 offen offset:3168 lds
    v_mfma_f32_16x16x32_bf16 v[128:131], a[12:15], a[96:99], v[128:131]
    ds_read_b64_tr_b16 a[52:53], v3 offset:50720
    v_mfma_f32_16x16x32_bf16 v[160:163], a[12:15], a[100:103], v[160:163]
    s_add_u32 s65, s65, 262144
    ds_read_b64_tr_b16 a[54:55], v3 offset:51232
    v_mfma_f32_16x16x32_bf16 v[192:195], a[12:15], a[104:107], v[192:195]
    s_and_b32 s65, s65, 0x3fffff
    ds_read_b64_tr_b16 a[56:57], v3 offset:50752
    v_mfma_f32_16x16x32_bf16 v[132:135], a[16:19], a[96:99], v[132:135]
    ds_read_b64_tr_b16 a[58:59], v3 offset:51264
    v_mfma_f32_16x16x32_bf16 v[164:167], a[16:19], a[100:103], v[164:167]
    ds_read_b64_tr_b16 a[60:61], v3 offset:50784
    v_mfma_f32_16x16x32_bf16 v[196:199], a[16:19], a[104:107], v[196:199]
    ds_read_b64_tr_b16 a[62:63], v3 offset:51296
    v_mfma_f32_16x16x32_bf16 v[136:139], a[20:23], a[96:99], v[136:139]
    ds_read_b64_tr_b16 a[64:65], v3 offset:50816
    v_mfma_f32_16x16x32_bf16 v[168:171], a[20:23], a[100:103], v[168:171]
    ds_read_b64_tr_b16 a[66:67], v3 offset:51328
    v_mfma_f32_16x16x32_bf16 v[200:203], a[20:23], a[104:107], v[200:203]
    ds_read_b64_tr_b16 a[68:69], v3 offset:50848
    v_mfma_f32_16x16x32_bf16 v[140:143], a[24:27], a[96:99], v[140:143]
    ds_read_b64_tr_b16 a[70:71], v3 offset:51360
    v_mfma_f32_16x16x32_bf16 v[172:175], a[24:27], a[100:103], v[172:175]
    ds_read_b64_tr_b16 a[72:73], v3 offset:50880
    v_mfma_f32_16x16x32_bf16 v[204:207], a[24:27], a[104:107], v[204:207]
    ds_read_b64_tr_b16 a[74:75], v3 offset:51392
    v_mfma_f32_16x16x32_bf16 v[144:147], a[28:31], a[96:99], v[144:147]
    ds_read_b64_tr_b16 a[76:77], v3 offset:50912
    v_mfma_f32_16x16x32_bf16 v[176:179], a[28:31], a[100:103], v[176:179]
    ds_read_b64_tr_b16 a[78:79], v3 offset:51424
    v_mfma_f32_16x16x32_bf16 v[208:211], a[28:31], a[104:107], v[208:211]
    ds_read_b64_tr_b16 a[80:81], v3 offset:59136
    v_mfma_f32_16x16x32_bf16 a[120:123], a[32:35], a[96:99], a[120:123]
    ds_read_b64_tr_b16 a[82:83], v3 offset:59648
    v_mfma_f32_16x16x32_bf16 a[136:139], a[32:35], a[100:103], a[136:139]
    ds_read_b64_tr_b16 a[84:85], v3 offset:59168
    v_mfma_f32_16x16x32_bf16 a[152:155], a[32:35], a[104:107], a[152:155]
    ds_read_b64_tr_b16 a[86:87], v3 offset:59680
    v_mfma_f32_16x16x32_bf16 a[124:127], a[36:39], a[96:99], a[124:127]
    ds_read_b64_tr_b16 a[88:89], v3 offset:59200
    v_mfma_f32_16x16x32_bf16 a[140:143], a[36:39], a[100:103], a[140:143]
    ds_read_b64_tr_b16 a[90:91], v3 offset:59712
    v_mfma_f32_16x16x32_bf16 a[156:159], a[36:39], a[104:107], a[156:159]
    ds_read_b64_tr_b16 a[92:93], v3 offset:59232
    v_mfma_f32_16x16x32_bf16 a[128:131], a[40:43], a[96:99], a[128:131]
    ds_read_b64_tr_b16 a[94:95], v3 offset:59744
    v_mfma_f32_16x16x32_bf16 a[144:147], a[40:43], a[100:103], a[144:147]
    v_mfma_f32_16x16x32_bf16 a[160:163], a[40:43], a[104:107], a[160:163]
    v_mfma_f32_16x16x32_bf16 a[132:135], a[44:47], a[96:99], a[132:135]
    v_mfma_f32_16x16x32_bf16 a[148:151], a[44:47], a[100:103], a[148:151]
    v_mfma_f32_16x16x32_bf16 a[164:167], a[44:47], a[104:107], a[164:167]
    s_waitcnt vmcnt(8) lgkmcnt(0)
    s_barrier
    v_mfma_f32_16x16x32_bf16 v[116:119], a[48:51], a[108:111], v[116:119]
    s_add_u32 m0, s67, 18432
    ds_read_b128 a[96:99], v20 offset:0
    v_mfma_f32_16x16x32_bf16 v[148:151], a[48:51], a[112:115], v[148:151]
    s_add_u32 s57, s85, s84
    ds_read_b128 a[100:103], v20 offset:2048
    v_mfma_f32_16x16x32_bf16 v[180:183], a[48:51], a[116:119], v[180:183]
    buffer_load_dwordx4 v22, s[20:23], s57 offen offset:0 lds
    v_mfma_f32_16x16x32_bf16 v[120:123], a[52:55], a[108:111], v[120:123]
    ds_read_b128 a[104:107], v20 offset:4096
    v_mfma_f32_16x16x32_bf16 v[152:155], a[52:55], a[112:115], v[152:155]
    buffer_load_dwordx4 v23, s[20:23], s57 offen offset:1024 lds
    v_mfma_f32_16x16x32_bf16 v[184:187], a[52:55], a[116:119], v[184:187]
    ds_read_b64_tr_b16 a[0:1], v3 offset:0
    v_mfma_f32_16x16x32_bf16 v[124:127], a[56:59], a[108:111], v[124:127]
    buffer_load_dwordx4 v24, s[20:23], s57 offen offset:2048 lds
    v_mfma_f32_16x16x32_bf16 v[156:159], a[56:59], a[112:115], v[156:159]
    ds_read_b64_tr_b16 a[2:3], v3 offset:512
    v_mfma_f32_16x16x32_bf16 v[188:191], a[56:59], a[116:119], v[188:191]
    buffer_load_dwordx4 v25, s[20:23], s57 offen offset:3072 lds
    v_mfma_f32_16x16x32_bf16 v[128:131], a[60:63], a[108:111], v[128:131]
    ds_read_b64_tr_b16 a[4:5], v3 offset:32
    v_mfma_f32_16x16x32_bf16 v[160:163], a[60:63], a[112:115], v[160:163]
    s_add_u32 m0, s67, 22528
    ds_read_b64_tr_b16 a[6:7], v3 offset:544
    v_mfma_f32_16x16x32_bf16 v[192:195], a[60:63], a[116:119], v[192:195]
    s_add_u32 s57, s57, 32768
    ds_read_b64_tr_b16 a[8:9], v3 offset:64
    v_mfma_f32_16x16x32_bf16 v[132:135], a[64:67], a[108:111], v[132:135]
    buffer_load_dwordx4 v22, s[20:23], s57 offen offset:0 lds
    v_mfma_f32_16x16x32_bf16 v[164:167], a[64:67], a[112:115], v[164:167]
    ds_read_b64_tr_b16 a[10:11], v3 offset:576
    v_mfma_f32_16x16x32_bf16 v[196:199], a[64:67], a[116:119], v[196:199]
    buffer_load_dwordx4 v23, s[20:23], s57 offen offset:1024 lds
    v_mfma_f32_16x16x32_bf16 v[136:139], a[68:71], a[108:111], v[136:139]
    ds_read_b64_tr_b16 a[12:13], v3 offset:96
    v_mfma_f32_16x16x32_bf16 v[168:171], a[68:71], a[112:115], v[168:171]
    s_add_u32 s84, s84, 128
    ds_read_b64_tr_b16 a[14:15], v3 offset:608
    v_mfma_f32_16x16x32_bf16 v[200:203], a[68:71], a[116:119], v[200:203]
    s_and_b32 s84, s84, 1023
    ds_read_b64_tr_b16 a[16:17], v3 offset:128
    v_mfma_f32_16x16x32_bf16 v[140:143], a[72:75], a[108:111], v[140:143]
    s_add_u32 m0, s79, 50688
    ds_read_b64_tr_b16 a[18:19], v3 offset:640
    v_mfma_f32_16x16x32_bf16 v[172:175], a[72:75], a[112:115], v[172:175]
    s_mov_b32 s57, s65
    ds_read_b64_tr_b16 a[20:21], v3 offset:160
    v_mfma_f32_16x16x32_bf16 v[204:207], a[72:75], a[116:119], v[204:207]
    buffer_load_dwordx4 v6, s[32:35], s57 offen offset:0 lds
    v_mfma_f32_16x16x32_bf16 v[144:147], a[76:79], a[108:111], v[144:147]
    ds_read_b64_tr_b16 a[22:23], v3 offset:672
    v_mfma_f32_16x16x32_bf16 v[176:179], a[76:79], a[112:115], v[176:179]
    buffer_load_dwordx4 v7, s[32:35], s57 offen offset:1056 lds
    v_mfma_f32_16x16x32_bf16 v[208:211], a[76:79], a[116:119], v[208:211]
    ds_read_b64_tr_b16 a[24:25], v3 offset:192
    v_mfma_f32_16x16x32_bf16 a[120:123], a[80:83], a[108:111], a[120:123]
    buffer_load_dwordx4 v8, s[32:35], s57 offen offset:2112 lds
    v_mfma_f32_16x16x32_bf16 a[136:139], a[80:83], a[112:115], a[136:139]
    ds_read_b64_tr_b16 a[26:27], v3 offset:704
    v_mfma_f32_16x16x32_bf16 a[152:155], a[80:83], a[116:119], a[152:155]
    buffer_load_dwordx4 v9, s[32:35], s57 offen offset:3168 lds
    v_mfma_f32_16x16x32_bf16 a[124:127], a[84:87], a[108:111], a[124:127]
    ds_read_b64_tr_b16 a[28:29], v3 offset:224
    v_mfma_f32_16x16x32_bf16 a[140:143], a[84:87], a[112:115], a[140:143]
    s_add_u32 s65, s65, 262144
    ds_read_b64_tr_b16 a[30:31], v3 offset:736
    v_mfma_f32_16x16x32_bf16 a[156:159], a[84:87], a[116:119], a[156:159]
    s_and_b32 s65, s65, 0x3fffff
    ds_read_b64_tr_b16 a[32:33], v3 offset:8448
    ds_read_b64_tr_b16 a[34:35], v3 offset:8960
    v_mfma_f32_16x16x32_bf16 a[128:131], a[88:91], a[108:111], a[128:131]
    ds_read_b64_tr_b16 a[36:37], v3 offset:8480
    ds_read_b64_tr_b16 a[38:39], v3 offset:8992
    v_mfma_f32_16x16x32_bf16 a[144:147], a[88:91], a[112:115], a[144:147]
    ds_read_b64_tr_b16 a[40:41], v3 offset:8512
    ds_read_b64_tr_b16 a[42:43], v3 offset:9024
    v_mfma_f32_16x16x32_bf16 a[160:163], a[88:91], a[116:119], a[160:163]
    ds_read_b64_tr_b16 a[44:45], v3 offset:8544
    ds_read_b64_tr_b16 a[46:47], v3 offset:9056
    v_mfma_f32_16x16x32_bf16 a[132:135], a[92:95], a[108:111], a[132:135]
    v_mfma_f32_16x16x32_bf16 a[148:151], a[92:95], a[112:115], a[148:151]
    v_mfma_f32_16x16x32_bf16 a[164:167], a[92:95], a[116:119], a[164:167]
    s_waitcnt vmcnt(14) lgkmcnt(0)
    s_barrier
    v_add_u32 v17, 1, v17
    s_mov_b64 exec, 15
    buffer_store_dword v17, v16, s[40:43], 0 offen sc1
    s_mov_b64 exec, -1
    v_readlane_b32 s11, v17, 0
    v_readlane_b32 s12, v17, 1
    v_readlane_b32 s13, v17, 2
    v_readlane_b32 s63, v17, 3
    v_mfma_f32_16x16x32_bf16 v[116:119], a[0:3], a[96:99], v[116:119]
    s_add_u32 m0, s79, 0
    ds_read_b128 a[108:111], v21 offset:0
    v_mfma_f32_16x16x32_bf16 v[148:151], a[0:3], a[100:103], v[148:151]
    s_mov_b32 s57, s65
    ds_read_b128 a[112:115], v21 offset:2048
    v_mfma_f32_16x16x32_bf16 v[180:183], a[0:3], a[104:107], v[180:183]
    buffer_load_dwordx4 v6, s[32:35], s57 offen offset:0 lds
    v_mfma_f32_16x16x32_bf16 v[120:123], a[4:7], a[96:99], v[120:123]
    ds_read_b128 a[116:119], v21 offset:4096
    v_mfma_f32_16x16x32_bf16 v[152:155], a[4:7], a[100:103], v[152:155]
    buffer_load_dwordx4 v7, s[32:35], s57 offen offset:1056 lds
    v_mfma_f32_16x16x32_bf16 v[184:187], a[4:7], a[104:107], v[184:187]
    ds_read_b64_tr_b16 a[48:49], v3 offset:16896
    v_mfma_f32_16x16x32_bf16 v[124:127], a[8:11], a[96:99], v[124:127]
    buffer_load_dwordx4 v8, s[32:35], s57 offen offset:2112 lds
    v_mfma_f32_16x16x32_bf16 v[156:159], a[8:11], a[100:103], v[156:159]
    ds_read_b64_tr_b16 a[50:51], v3 offset:17408
    v_mfma_f32_16x16x32_bf16 v[188:191], a[8:11], a[104:107], v[188:191]
    buffer_load_dwordx4 v9, s[32:35], s57 offen offset:3168 lds
    v_mfma_f32_16x16x32_bf16 v[128:131], a[12:15], a[96:99], v[128:131]
    ds_read_b64_tr_b16 a[52:53], v3 offset:16928
    v_mfma_f32_16x16x32_bf16 v[160:163], a[12:15], a[100:103], v[160:163]
    s_add_u32 s65, s65, 262144
    ds_read_b64_tr_b16 a[54:55], v3 offset:17440
    v_mfma_f32_16x16x32_bf16 v[192:195], a[12:15], a[104:107], v[192:195]
    s_and_b32 s65, s65, 0x3fffff
    ds_read_b64_tr_b16 a[56:57], v3 offset:16960
    v_mfma_f32_16x16x32_bf16 v[132:135], a[16:19], a[96:99], v[132:135]
    ds_read_b64_tr_b16 a[58:59], v3 offset:17472
    v_mfma_f32_16x16x32_bf16 v[164:167], a[16:19], a[100:103], v[164:167]
    ds_read_b64_tr_b16 a[60:61], v3 offset:16992
    v_mfma_f32_16x16x32_bf16 v[196:199], a[16:19], a[104:107], v[196:199]
    ds_read_b64_tr_b16 a[62:63], v3 offset:17504
    v_mfma_f32_16x16x32_bf16 v[136:139], a[20:23], a[96:99], v[136:139]
    ds_read_b64_tr_b16 a[64:65], v3 offset:17024
    v_mfma_f32_16x16x32_bf16 v[168:171], a[20:23], a[100:103], v[168:171]
    ds_read_b64_tr_b16 a[66:67], v3 offset:17536
    v_mfma_f32_16x16x32_bf16 v[200:203], a[20:23], a[104:107], v[200:203]
    ds_read_b64_tr_b16 a[68:69], v3 offset:17056
    v_mfma_f32_16x16x32_bf16 v[140:143], a[24:27], a[96:99], v[140:143]
    ds_read_b64_tr_b16 a[70:71], v3 offset:17568
    v_mfma_f32_16x16x32_bf16 v[172:175], a[24:27], a[100:103], v[172:175]
    ds_read_b64_tr_b16 a[72:73], v3 offset:17088
    v_mfma_f32_16x16x32_bf16 v[204:207], a[24:27], a[104:107], v[204:207]
    ds_read_b64_tr_b16 a[74:75], v3 offset:17600
    v_mfma_f32_16x16x32_bf16 v[144:147], a[28:31], a[96:99], v[144:147]
    ds_read_b64_tr_b16 a[76:77], v3 offset:17120
    v_mfma_f32_16x16x32_bf16 v[176:179], a[28:31], a[100:103], v[176:179]
    ds_read_b64_tr_b16 a[78:79], v3 offset:17632
    v_mfma_f32_16x16x32_bf16 v[208:211], a[28:31], a[104:107], v[208:211]
    ds_read_b64_tr_b16 a[80:81], v3 offset:25344
    v_mfma_f32_16x16x32_bf16 a[120:123], a[32:35], a[96:99], a[120:123]
    ds_read_b64_tr_b16 a[82:83], v3 offset:25856
    v_mfma_f32_16x16x32_bf16 a[136:139], a[32:35], a[100:103], a[136:139]
    ds_read_b64_tr_b16 a[84:85], v3 offset:25376
    v_mfma_f32_16x16x32_bf16 a[152:155], a[32:35], a[104:107], a[152:155]
    ds_read_b64_tr_b16 a[86:87], v3 offset:25888
    v_mfma_f32_16x16x32_bf16 a[124:127], a[36:39], a[96:99], a[124:127]
    ds_read_b64_tr_b16 a[88:89], v3 offset:25408
    v_mfma_f32_16x16x32_bf16 a[140:143], a[36:39], a[100:103], a[140:143]
    ds_read_b64_tr_b16 a[90:91], v3 offset:25920
    v_mfma_f32_16x16x32_bf16 a[156:159], a[36:39], a[104:107], a[156:159]
    ds_read_b64_tr_b16 a[92:93], v3 offset:25440
    v_mfma_f32_16x16x32_bf16 a[128:131], a[40:43], a[96:99], a[128:131]
    ds_read_b64_tr_b16 a[94:95], v3 offset:25952
    v_mfma_f32_16x16x32_bf16 a[144:147], a[40:43], a[100:103], a[144:147]
    v_mfma_f32_16x16x32_bf16 a[160:163], a[40:43], a[104:107], a[160:163]
    v_mfma_f32_16x16x32_bf16 a[132:135], a[44:47], a[96:99], a[132:135]
    v_mfma_f32_16x16x32_bf16 a[148:151], a[44:47], a[100:103], a[148:151]
    v_mfma_f32_16x16x32_bf16 a[164:167], a[44:47], a[104:107], a[164:167]
    s_waitcnt vmcnt(9) lgkmcnt(0)
    s_barrier
    v_mfma_f32_16x16x32_bf16 v[116:119], a[48:51], a[108:111], v[116:119]
    s_add_u32 m0, s67, 0
    ds_read_b128 a[96:99], v20 offset:18432
    v_mfma_f32_16x16x32_bf16 v[148:151], a[48:51], a[112:115], v[148:151]
    s_add_u32 s57, s85, s84
    ds_read_b128 a[100:103], v20 offset:20480
    v_mfma_f32_16x16x32_bf16 v[180:183], a[48:51], a[116:119], v[180:183]
    buffer_load_dwordx4 v22, s[20:23], s57 offen offset:0 lds
    v_mfma_f32_16x16x32_bf16 v[120:123], a[52:55], a[108:111], v[120:123]
    ds_read_b128 a[104:107], v20 offset:22528
    v_mfma_f32_16x16x32_bf16 v[152:155], a[52:55], a[112:115], v[152:155]
    buffer_load_dwordx4 v23, s[20:23], s57 offen offset:1024 lds
    v_mfma_f32_16x16x32_bf16 v[184:187], a[52:55], a[116:119], v[184:187]
    ds_read_b64_tr_b16 a[0:1], v3 offset:33792
    v_mfma_f32_16x16x32_bf16 v[124:127], a[56:59], a[108:111], v[124:127]
    buffer_load_dwordx4 v24, s[20:23], s57 offen offset:2048 lds
    v_mfma_f32_16x16x32_bf16 v[156:159], a[56:59], a[112:115], v[156:159]
    ds_read_b64_tr_b16 a[2:3], v3 offset:34304
    v_mfma_f32_16x16x32_bf16 v[188:191], a[56:59], a[116:119], v[188:191]
    buffer_load_dwordx4 v25, s[20:23], s57 offen offset:3072 lds
    v_mfma_f32_16x16x32_bf16 v[128:131], a[60:63], a[108:111], v[128:131]
    ds_read_b64_tr_b16 a[4:5], v3 offset:33824
    v_mfma_f32_16x16x32_bf16 v[160:163], a[60:63], a[112:115], v[160:163]
    s_add_u32 m0, s67, 4096
    ds_read_b64_tr_b16 a[6:7], v3 offset:34336
    v_mfma_f32_16x16x32_bf16 v[192:195], a[60:63], a[116:119], v[192:195]
    s_add_u32 s57, s57, 32768
    ds_read_b64_tr_b16 a[8:9], v3 offset:33856
    v_mfma_f32_16x16x32_bf16 v[132:135], a[64:67], a[108:111], v[132:135]
    buffer_load_dwordx4 v22, s[20:23], s57 offen offset:0 lds
    v_mfma_f32_16x16x32_bf16 v[164:167], a[64:67], a[112:115], v[164:167]
    ds_read_b64_tr_b16 a[10:11], v3 offset:34368
    v_mfma_f32_16x16x32_bf16 v[196:199], a[64:67], a[116:119], v[196:199]
    buffer_load_dwordx4 v23, s[20:23], s57 offen offset:1024 lds
    v_mfma_f32_16x16x32_bf16 v[136:139], a[68:71], a[108:111], v[136:139]
    ds_read_b64_tr_b16 a[12:13], v3 offset:33888
    v_mfma_f32_16x16x32_bf16 v[168:171], a[68:71], a[112:115], v[168:171]
    s_add_u32 s84, s84, 128
    ds_read_b64_tr_b16 a[14:15], v3 offset:34400
    v_mfma_f32_16x16x32_bf16 v[200:203], a[68:71], a[116:119], v[200:203]
    s_and_b32 s84, s84, 1023
    ds_read_b64_tr_b16 a[16:17], v3 offset:33920
    v_mfma_f32_16x16x32_bf16 v[140:143], a[72:75], a[108:111], v[140:143]
    s_add_u32 m0, s79, 16896
    ds_read_b64_tr_b16 a[18:19], v3 offset:34432
    v_mfma_f32_16x16x32_bf16 v[172:175], a[72:75], a[112:115], v[172:175]
    s_mov_b32 s57, s65
    ds_read_b64_tr_b16 a[20:21], v3 offset:33952
    v_mfma_f32_16x16x32_bf16 v[204:207], a[72:75], a[116:119], v[204:207]
    buffer_load_dwordx4 v6, s[32:35], s57 offen offset:0 lds
    v_mfma_f32_16x16x32_bf16 v[144:147], a[76:79], a[108:111], v[144:147]
    ds_read_b64_tr_b16 a[22:23], v3 offset:34464
    v_mfma_f32_16x16x32_bf16 v[176:179], a[76:79], a[112:115], v[176:179]
    buffer_load_dwordx4 v7, s[32:35], s57 offen offset:1056 lds
    v_mfma_f32_16x16x32_bf16 v[208:211], a[76:79], a[116:119], v[208:211]
    ds_read_b64_tr_b16 a[24:25], v3 offset:33984
    v_mfma_f32_16x16x32_bf16 a[120:123], a[80:83], a[108:111], a[120:123]
    buffer_load_dwordx4 v8, s[32:35], s57 offen offset:2112 lds
    v_mfma_f32_16x16x32_bf16 a[136:139], a[80:83], a[112:115], a[136:139]
    ds_read_b64_tr_b16 a[26:27], v3 offset:34496
    v_mfma_f32_16x16x32_bf16 a[152:155], a[80:83], a[116:119], a[152:155]
    buffer_load_dwordx4 v9, s[32:35], s57 offen offset:3168 lds
    v_mfma_f32_16x16x32_bf16 a[124:127], a[84:87], a[108:111], a[124:127]
    ds_read_b64_tr_b16 a[28:29], v3 offset:34016
    v_mfma_f32_16x16x32_bf16 a[140:143], a[84:87], a[112:115], a[140:143]
    s_add_u32 s65, s65, 262144
    ds_read_b64_tr_b16 a[30:31], v3 offset:34528
    v_mfma_f32_16x16x32_bf16 a[156:159], a[84:87], a[116:119], a[156:159]
    s_and_b32 s65, s65, 0x3fffff
    ds_read_b64_tr_b16 a[32:33], v3 offset:42240
    ds_read_b64_tr_b16 a[34:35], v3 offset:42752
    v_mfma_f32_16x16x32_bf16 a[128:131], a[88:91], a[108:111], a[128:131]
    ds_read_b64_tr_b16 a[36:37], v3 offset:42272
    ds_read_b64_tr_b16 a[38:39], v3 offset:42784
    v_mfma_f32_16x16x32_bf16 a[144:147], a[88:91], a[112:115], a[144:147]
    ds_read_b64_tr_b16 a[40:41], v3 offset:42304
    ds_read_b64_tr_b16 a[42:43], v3 offset:42816
    v_mfma_f32_16x16x32_bf16 a[160:163], a[88:91], a[116:119], a[160:163]
    ds_read_b64_tr_b16 a[44:45], v3 offset:42336
    ds_read_b64_tr_b16 a[46:47], v3 offset:42848
    v_mfma_f32_16x16x32_bf16 a[132:135], a[92:95], a[108:111], a[132:135]
    v_mfma_f32_16x16x32_bf16 a[148:151], a[92:95], a[112:115], a[148:151]
    v_mfma_f32_16x16x32_bf16 a[164:167], a[92:95], a[116:119], a[164:167]
    s_waitcnt vmcnt(15) lgkmcnt(0)
    s_barrier
    v_mfma_f32_16x16x32_bf16 v[116:119], a[0:3], a[96:99], v[116:119]
    s_add_u32 m0, s79, 33792
    ds_read_b128 a[108:111], v21 offset:18432
    v_mfma_f32_16x16x32_bf16 v[148:151], a[0:3], a[100:103], v[148:151]
    s_mov_b32 s57, s65
    ds_read_b128 a[112:115], v21 offset:20480
    v_mfma_f32_16x16x32_bf16 v[180:183], a[0:3], a[104:107], v[180:183]
    buffer_load_dwordx4 v6, s[32:35], s57 offen offset:0 lds
    v_mfma_f32_16x16x32_bf16 v[120:123], a[4:7], a[96:99], v[120:123]
    ds_read_b128 a[116:119], v21 offset:22528
    v_mfma_f32_16x16x32_bf16 v[152:155], a[4:7], a[100:103], v[152:155]
    buffer_load_dwordx4 v7, s[32:35], s57 offen offset:1056 lds
    v_mfma_f32_16x16x32_bf16 v[184:187], a[4:7], a[104:107], v[184:187]
    ds_read_b64_tr_b16 a[48:49], v3 offset:50688
    v_mfma_f32_16x16x32_bf16 v[124:127], a[8:11], a[96:99], v[124:127]
    buffer_load_dwordx4 v8, s[32:35], s57 offen offset:2112 lds
    v_mfma_f32_16x16x32_bf16 v[156:159], a[8:11], a[100:103], v[156:159]
    ds_read_b64_tr_b16 a[50:51], v3 offset:51200
    v_mfma_f32_16x16x32_bf16 v[188:191], a[8:11], a[104:107], v[188:191]
    buffer_load_dwordx4 v9, s[32:35], s57 offen offset:3168 lds
    v_mfma_f32_16x16x32_bf16 v[128:131], a[12:15], a[96:99], v[128:131]
    ds_read_b64_tr_b16 a[52:53], v3 offset:50720
    v_mfma_f32_16x16x32_bf16 v[160:163], a[12:15], a[100:103], v[160:163]
    s_add_u32 s65, s65, 262144
    ds_read_b64_tr_b16 a[54:55], v3 offset:51232
    v_mfma_f32_16x16x32_bf16 v[192:195], a[12:15], a[104:107], v[192:195]
    s_and_b32 s65, s65, 0x3fffff
    ds_read_b64_tr_b16 a[56:57], v3 offset:50752
    v_mfma_f32_16x16x32_bf16 v[132:135], a[16:19], a[96:99], v[132:135]
    ds_read_b64_tr_b16 a[58:59], v3 offset:51264
    v_mfma_f32_16x16x32_bf16 v[164:167], a[16:19], a[100:103], v[164:167]
    ds_read_b64_tr_b16 a[60:61], v3 offset:50784
    v_mfma_f32_16x16x32_bf16 v[196:199], a[16:19], a[104:107], v[196:199]
    ds_read_b64_tr_b16 a[62:63], v3 offset:51296
    v_mfma_f32_16x16x32_bf16 v[136:139], a[20:23], a[96:99], v[136:139]
    ds_read_b64_tr_b16 a[64:65], v3 offset:50816
    v_mfma_f32_16x16x32_bf16 v[168:171], a[20:23], a[100:103], v[168:171]
    ds_read_b64_tr_b16 a[66:67], v3 offset:51328
    v_mfma_f32_16x16x32_bf16 v[200:203], a[20:23], a[104:107], v[200:203]
    ds_read_b64_tr_b16 a[68:69], v3 offset:50848
    v_mfma_f32_16x16x32_bf16 v[140:143], a[24:27], a[96:99], v[140:143]
    ds_read_b64_tr_b16 a[70:71], v3 offset:51360
    v_mfma_f32_16x16x32_bf16 v[172:175], a[24:27], a[100:103], v[172:175]
    ds_read_b64_tr_b16 a[72:73], v3 offset:50880
    v_mfma_f32_16x16x32_bf16 v[204:207], a[24:27], a[104:107], v[204:207]
    ds_read_b64_tr_b16 a[74:75], v3 offset:51392
    v_mfma_f32_16x16x32_bf16 v[144:147], a[28:31], a[96:99], v[144:147]
    ds_read_b64_tr_b16 a[76:77], v3 offset:50912
    v_mfma_f32_16x16x32_bf16 v[176:179], a[28:31], a[100:103], v[176:179]
    ds_read_b64_tr_b16 a[78:79], v3 offset:51424
    v_mfma_f32_16x16x32_bf16 v[208:211], a[28:31], a[104:107], v[208:211]
    ds_read_b64_tr_b16 a[80:81], v3 offset:59136
    v_mfma_f32_16x16x32_bf16 a[120:123], a[32:35], a[96:99], a[120:123]
    ds_read_b64_tr_b16 a[82:83], v3 offset:59648
    v_mfma_f32_16x16x32_bf16 a[136:139], a[32:35], a[100:103], a[136:139]
    ds_read_b64_tr_b16 a[84:85], v3 offset:59168
    v_mfma_f32_16x16x32_bf16 a[152:155], a[32:35], a[104:107], a[152:155]
    ds_read_b64_tr_b16 a[86:87], v3 offset:59680
    v_mfma_f32_16x16x32_bf16 a[124:127], a[36:39], a[96:99], a[124:127]
    ds_read_b64_tr_b16 a[88:89], v3 offset:59200
    v_mfma_f32_16x16x32_bf16 a[140:143], a[36:39], a[100:103], a[140:143]
    ds_read_b64_tr_b16 a[90:91], v3 offset:59712
    v_mfma_f32_16x16x32_bf16 a[156:159], a[36:39], a[104:107], a[156:159]
    ds_read_b64_tr_b16 a[92:93], v3 offset:59232
    v_mfma_f32_16x16x32_bf16 a[128:131], a[40:43], a[96:99], a[128:131]
    ds_read_b64_tr_b16 a[94:95], v3 offset:59744
    v_mfma_f32_16x16x32_bf16 a[144:147], a[40:43], a[100:103], a[144:147]
    v_mfma_f32_16x16x32_bf16 a[160:163], a[40:43], a[104:107], a[160:163]
    v_mfma_f32_16x16x32_bf16 a[132:135], a[44:47], a[96:99], a[132:135]
    v_mfma_f32_16x16x32_bf16 a[148:151], a[44:47], a[100:103], a[148:151]
    v_mfma_f32_16x16x32_bf16 a[164:167], a[44:47], a[104:107], a[164:167]
    s_waitcnt vmcnt(8) lgkmcnt(0)
    s_barrier
    v_mfma_f32_16x16x32_bf16 v[116:119], a[48:51], a[108:111], v[116:119]
    s_add_u32 m0, s67, 18432
    ds_read_b128 a[96:99], v20 offset:0
    v_mfma_f32_16x16x32_bf16 v[148:151], a[48:51], a[112:115], v[148:151]
    s_add_u32 s57, s85, s84
    ds_read_b128 a[100:103], v20 offset:2048
    v_mfma_f32_16x16x32_bf16 v[180:183], a[48:51], a[116:119], v[180:183]
    buffer_load_dwordx4 v22, s[20:23], s57 offen offset:0 lds
    v_mfma_f32_16x16x32_bf16 v[120:123], a[52:55], a[108:111], v[120:123]
    ds_read_b128 a[104:107], v20 offset:4096
    v_mfma_f32_16x16x32_bf16 v[152:155], a[52:55], a[112:115], v[152:155]
    buffer_load_dwordx4 v23, s[20:23], s57 offen offset:1024 lds
    v_mfma_f32_16x16x32_bf16 v[184:187], a[52:55], a[116:119], v[184:187]
    ds_read_b64_tr_b16 a[0:1], v3 offset:0
    v_mfma_f32_16x16x32_bf16 v[124:127], a[56:59], a[108:111], v[124:127]
    buffer_load_dwordx4 v24, s[20:23], s57 offen offset:2048 lds
    v_mfma_f32_16x16x32_bf16 v[156:159], a[56:59], a[112:115], v[156:159]
    ds_read_b64_tr_b16 a[2:3], v3 offset:512
    v_mfma_f32_16x16x32_bf16 v[188:191], a[56:59], a[116:119], v[188:191]
    buffer_load_dwordx4 v25, s[20:23], s57 offen offset:3072 lds
    v_mfma_f32_16x16x32_bf16 v[128:131], a[60:63], a[108:111], v[128:131]
    ds_read_b64_tr_b16 a[4:5], v3 offset:32
    v_mfma_f32_16x16x32_bf16 v[160:163], a[60:63], a[112:115], v[160:163]
    s_add_u32 m0, s67, 22528
    ds_read_b64_tr_b16 a[6:7], v3 offset:544
    v_mfma_f32_16x16x32_bf16 v[192:195], a[60:63], a[116:119], v[192:195]
    s_add_u32 s57, s57, 32768
    ds_read_b64_tr_b16 a[8:9], v3 offset:64
    v_mfma_f32_16x16x32_bf16 v[132:135], a[64:67], a[108:111], v[132:135]
    buffer_load_dwordx4 v22, s[20:23], s57 offen offset:0 lds
    v_mfma_f32_16x16x32_bf16 v[164:167], a[64:67], a[112:115], v[164:167]
    ds_read_b64_tr_b16 a[10:11], v3 offset:576
    v_mfma_f32_16x16x32_bf16 v[196:199], a[64:67], a[116:119], v[196:199]
    buffer_load_dwordx4 v23, s[20:23], s57 offen offset:1024 lds
    v_mfma_f32_16x16x32_bf16 v[136:139], a[68:71], a[108:111], v[136:139]
    ds_read_b64_tr_b16 a[12:13], v3 offset:96
    v_mfma_f32_16x16x32_bf16 v[168:171], a[68:71], a[112:115], v[168:171]
    s_add_u32 s84, s84, 128
    ds_read_b64_tr_b16 a[14:15], v3 offset:608
    v_mfma_f32_16x16x32_bf16 v[200:203], a[68:71], a[116:119], v[200:203]
    s_and_b32 s84, s84, 1023
    ds_read_b64_tr_b16 a[16:17], v3 offset:128
    v_mfma_f32_16x16x32_bf16 v[140:143], a[72:75], a[108:111], v[140:143]
    s_add_u32 m0, s79, 50688
    ds_read_b64_tr_b16 a[18:19], v3 offset:640
    v_mfma_f32_16x16x32_bf16 v[172:175], a[72:75], a[112:115], v[172:175]
    s_mov_b32 s57, s65
    ds_read_b64_tr_b16 a[20:21], v3 offset:160
    v_mfma_f32_16x16x32_bf16 v[204:207], a[72:75], a[116:119], v[204:207]
    buffer_load_dwordx4 v6, s[32:35], s57 offen offset:0 lds
    v_mfma_f32_16x16x32_bf16 v[144:147], a[76:79], a[108:111], v[144:147]
    ds_read_b64_tr_b16 a[22:23], v3 offset:672
    v_mfma_f32_16x16x32_bf16 v[176:179], a[76:79], a[112:115], v[176:179]
    buffer_load_dwordx4 v7, s[32:35], s57 offen offset:1056 lds
    v_mfma_f32_16x16x32_bf16 v[208:211], a[76:79], a[116:119], v[208:211]
    ds_read_b64_tr_b16 a[24:25], v3 offset:192
    v_mfma_f32_16x16x32_bf16 a[120:123], a[80:83], a[108:111], a[120:123]
    buffer_load_dwordx4 v8, s[32:35], s57 offen offset:2112 lds
    v_mfma_f32_16x16x32_bf16 a[136:139], a[80:83], a[112:115], a[136:139]
    ds_read_b64_tr_b16 a[26:27], v3 offset:704
    v_mfma_f32_16x16x32_bf16 a[152:155], a[80:83], a[116:119], a[152:155]
    buffer_load_dwordx4 v9, s[32:35], s57 offen offset:3168 lds
    v_mfma_f32_16x16x32_bf16 a[124:127], a[84:87], a[108:111], a[124:127]
    ds_read_b64_tr_b16 a[28:29], v3 offset:224
    v_mfma_f32_16x16x32_bf16 a[140:143], a[84:87], a[112:115], a[140:143]
    s_add_u32 s65, s65, 262144
    ds_read_b64_tr_b16 a[30:31], v3 offset:736
    v_mfma_f32_16x16x32_bf16 a[156:159], a[84:87], a[116:119], a[156:159]
    s_and_b32 s65, s65, 0x3fffff
    ds_read_b64_tr_b16 a[32:33], v3 offset:8448
    ds_read_b64_tr_b16 a[34:35], v3 offset:8960
    v_mfma_f32_16x16x32_bf16 a[128:131], a[88:91], a[108:111], a[128:131]
    ds_read_b64_tr_b16 a[36:37], v3 offset:8480
    ds_read_b64_tr_b16 a[38:39], v3 offset:8992
    v_mfma_f32_16x16x32_bf16 a[144:147], a[88:91], a[112:115], a[144:147]
    ds_read_b64_tr_b16 a[40:41], v3 offset:8512
    ds_read_b64_tr_b16 a[42:43], v3 offset:9024
    v_mfma_f32_16x16x32_bf16 a[160:163], a[88:91], a[116:119], a[160:163]
    ds_read_b64_tr_b16 a[44:45], v3 offset:8544
    ds_read_b64_tr_b16 a[46:47], v3 offset:9056
    v_mfma_f32_16x16x32_bf16 a[132:135], a[92:95], a[108:111], a[132:135]
    v_mfma_f32_16x16x32_bf16 a[148:151], a[92:95], a[112:115], a[148:151]
    v_mfma_f32_16x16x32_bf16 a[164:167], a[92:95], a[116:119], a[164:167]
    s_waitcnt vmcnt(14) lgkmcnt(0)
    s_barrier
    v_mfma_f32_16x16x32_bf16 v[116:119], a[0:3], a[96:99], v[116:119]
    s_add_u32 m0, s79, 0
    ds_read_b128 a[108:111], v21 offset:0
    v_mfma_f32_16x16x32_bf16 v[148:151], a[0:3], a[100:103], v[148:151]
    s_mov_b32 s57, s65
    ds_read_b128 a[112:115], v21 offset:2048
    v_mfma_f32_16x16x32_bf16 v[180:183], a[0:3], a[104:107], v[180:183]
    buffer_load_dwordx4 v6, s[32:35], s57 offen offset:0 lds
    v_mfma_f32_16x16x32_bf16 v[120:123], a[4:7], a[96:99], v[120:123]
    ds_read_b128 a[116:119], v21 offset:4096
    v_mfma_f32_16x16x32_bf16 v[152:155], a[4:7], a[100:103], v[152:155]
    buffer_load_dwordx4 v7, s[32:35], s57 offen offset:1056 lds
    v_mfma_f32_16x16x32_bf16 v[184:187], a[4:7], a[104:107], v[184:187]
    ds_read_b64_tr_b16 a[48:49], v3 offset:16896
    v_mfma_f32_16x16x32_bf16 v[124:127], a[8:11], a[96:99], v[124:127]
    buffer_load_dwordx4 v8, s[32:35], s57 offen offset:2112 lds
    v_mfma_f32_16x16x32_bf16 v[156:159], a[8:11], a[100:103], v[156:159]
    ds_read_b64_tr_b16 a[50:51], v3 offset:17408
    v_mfma_f32_16x16x32_bf16 v[188:191], a[8:11], a[104:107], v[188:191]
    buffer_load_dwordx4 v9, s[32:35], s57 offen offset:3168 lds
    v_mfma_f32_16x16x32_bf16 v[128:131], a[12:15], a[96:99], v[128:131]
    ds_read_b64_tr_b16 a[52:53], v3 offset:16928
    v_mfma_f32_16x16x32_bf16 v[160:163], a[12:15], a[100:103], v[160:163]
    s_add_u32 s65, s65, 262144
    ds_read_b64_tr_b16 a[54:55], v3 offset:17440
    v_mfma_f32_16x16x32_bf16 v[192:195], a[12:15], a[104:107], v[192:195]
    s_and_b32 s65, s65, 0x3fffff
    ds_read_b64_tr_b16 a[56:57], v3 offset:16960
    v_mfma_f32_16x16x32_bf16 v[132:135], a[16:19], a[96:99], v[132:135]
    ds_read_b64_tr_b16 a[58:59], v3 offset:17472
    v_mfma_f32_16x16x32_bf16 v[164:167], a[16:19], a[100:103], v[164:167]
    ds_read_b64_tr_b16 a[60:61], v3 offset:16992
    v_mfma_f32_16x16x32_bf16 v[196:199], a[16:19], a[104:107], v[196:199]
    ds_read_b64_tr_b16 a[62:63], v3 offset:17504
    v_mfma_f32_16x16x32_bf16 v[136:139], a[20:23], a[96:99], v[136:139]
    ds_read_b64_tr_b16 a[64:65], v3 offset:17024
    v_mfma_f32_16x16x32_bf16 v[168:171], a[20:23], a[100:103], v[168:171]
    ds_read_b64_tr_b16 a[66:67], v3 offset:17536
    v_mfma_f32_16x16x32_bf16 v[200:203], a[20:23], a[104:107], v[200:203]
    ds_read_b64_tr_b16 a[68:69], v3 offset:17056
    v_mfma_f32_16x16x32_bf16 v[140:143], a[24:27], a[96:99], v[140:143]
    ds_read_b64_tr_b16 a[70:71], v3 offset:17568
    v_mfma_f32_16x16x32_bf16 v[172:175], a[24:27], a[100:103], v[172:175]
    ds_read_b64_tr_b16 a[72:73], v3 offset:17088
    v_mfma_f32_16x16x32_bf16 v[204:207], a[24:27], a[104:107], v[204:207]
    ds_read_b64_tr_b16 a[74:75], v3 offset:17600
    v_mfma_f32_16x16x32_bf16 v[144:147], a[28:31], a[96:99], v[144:147]
    ds_read_b64_tr_b16 a[76:77], v3 offset:17120
    v_mfma_f32_16x16x32_bf16 v[176:179], a[28:31], a[100:103], v[176:179]
    ds_read_b64_tr_b16 a[78:79], v3 offset:17632
    v_mfma_f32_16x16x32_bf16 v[208:211], a[28:31], a[104:107], v[208:211]
    ds_read_b64_tr_b16 a[80:81], v3 offset:25344
    v_mfma_f32_16x16x32_bf16 a[120:123], a[32:35], a[96:99], a[120:123]
    ds_read_b64_tr_b16 a[82:83], v3 offset:25856
    v_mfma_f32_16x16x32_bf16 a[136:139], a[32:35], a[100:103], a[136:139]
    ds_read_b64_tr_b16 a[84:85], v3 offset:25376
    v_mfma_f32_16x16x32_bf16 a[152:155], a[32:35], a[104:107], a[152:155]
    ds_read_b64_tr_b16 a[86:87], v3 offset:25888
    v_mfma_f32_16x16x32_bf16 a[124:127], a[36:39], a[96:99], a[124:127]
    ds_read_b64_tr_b16 a[88:89], v3 offset:25408
    v_mfma_f32_16x16x32_bf16 a[140:143], a[36:39], a[100:103], a[140:143]
    ds_read_b64_tr_b16 a[90:91], v3 offset:25920
    v_mfma_f32_16x16x32_bf16 a[156:159], a[36:39], a[104:107], a[156:159]
    ds_read_b64_tr_b16 a[92:93], v3 offset:25440
    v_mfma_f32_16x16x32_bf16 a[128:131], a[40:43], a[96:99], a[128:131]
    ds_read_b64_tr_b16 a[94:95], v3 offset:25952
    v_mfma_f32_16x16x32_bf16 a[144:147], a[40:43], a[100:103], a[144:147]
    v_mfma_f32_16x16x32_bf16 a[160:163], a[40:43], a[104:107], a[160:163]
    v_mfma_f32_16x16x32_bf16 a[132:135], a[44:47], a[96:99], a[132:135]
    v_mfma_f32_16x16x32_bf16 a[148:151], a[44:47], a[100:103], a[148:151]
    v_mfma_f32_16x16x32_bf16 a[164:167], a[44:47], a[104:107], a[164:167]
    s_waitcnt vmcnt(8) lgkmcnt(0)
    s_barrier
    v_mfma_f32_16x16x32_bf16 v[116:119], a[48:51], a[108:111], v[116:119]
    s_add_u32 m0, s67, 0
    ds_read_b128 a[96:99], v20 offset:18432
    v_mfma_f32_16x16x32_bf16 v[148:151], a[48:51], a[112:115], v[148:151]
    s_add_u32 s57, s85, s84
    ds_read_b128 a[100:103], v20 offset:20480
    v_mfma_f32_16x16x32_bf16 v[180:183], a[48:51], a[116:119], v[180:183]
    buffer_load_dwordx4 v22, s[20:23], s57 offen offset:0 lds
    v_mfma_f32_16x16x32_bf16 v[120:123], a[52:55], a[108:111], v[120:123]
    ds_read_b128 a[104:107], v20 offset:22528
    v_mfma_f32_16x16x32_bf16 v[152:155], a[52:55], a[112:115], v[152:155]
    buffer_load_dwordx4 v23, s[20:23], s57 offen offset:1024 lds
    v_mfma_f32_16x16x32_bf16 v[184:187], a[52:55], a[116:119], v[184:187]
    ds_read_b64_tr_b16 a[0:1], v3 offset:33792
    v_mfma_f32_16x16x32_bf16 v[124:127], a[56:59], a[108:111], v[124:127]
    buffer_load_dwordx4 v24, s[20:23], s57 offen offset:2048 lds
    v_mfma_f32_16x16x32_bf16 v[156:159], a[56:59], a[112:115], v[156:159]
    ds_read_b64_tr_b16 a[2:3], v3 offset:34304
    v_mfma_f32_16x16x32_bf16 v[188:191], a[56:59], a[116:119], v[188:191]
    buffer_load_dwordx4 v25, s[20:23], s57 offen offset:3072 lds
    v_mfma_f32_16x16x32_bf16 v[128:131], a[60:63], a[108:111], v[128:131]
    ds_read_b64_tr_b16 a[4:5], v3 offset:33824
    v_mfma_f32_16x16x32_bf16 v[160:163], a[60:63], a[112:115], v[160:163]
    s_add_u32 m0, s67, 4096
    ds_read_b64_tr_b16 a[6:7], v3 offset:34336
    v_mfma_f32_16x16x32_bf16 v[192:195], a[60:63], a[116:119], v[192:195]
    s_add_u32 s57, s57, 32768
    ds_read_b64_tr_b16 a[8:9], v3 offset:33856
    v_mfma_f32_16x16x32_bf16 v[132:135], a[64:67], a[108:111], v[132:135]
    buffer_load_dwordx4 v22, s[20:23], s57 offen offset:0 lds
    v_mfma_f32_16x16x32_bf16 v[164:167], a[64:67], a[112:115], v[164:167]
    ds_read_b64_tr_b16 a[10:11], v3 offset:34368
    v_mfma_f32_16x16x32_bf16 v[196:199], a[64:67], a[116:119], v[196:199]
    buffer_load_dwordx4 v23, s[20:23], s57 offen offset:1024 lds
    v_mfma_f32_16x16x32_bf16 v[136:139], a[68:71], a[108:111], v[136:139]
    ds_read_b64_tr_b16 a[12:13], v3 offset:33888
    v_mfma_f32_16x16x32_bf16 v[168:171], a[68:71], a[112:115], v[168:171]
    s_add_u32 s84, s84, 128
    ds_read_b64_tr_b16 a[14:15], v3 offset:34400
    v_mfma_f32_16x16x32_bf16 v[200:203], a[68:71], a[116:119], v[200:203]
    s_and_b32 s84, s84, 1023
    ds_read_b64_tr_b16 a[16:17], v3 offset:33920
    v_mfma_f32_16x16x32_bf16 v[140:143], a[72:75], a[108:111], v[140:143]
    s_add_u32 m0, s79, 16896
    ds_read_b64_tr_b16 a[18:19], v3 offset:34432
    v_mfma_f32_16x16x32_bf16 v[172:175], a[72:75], a[112:115], v[172:175]
    s_mov_b32 s57, s65
    ds_read_b64_tr_b16 a[20:21], v3 offset:33952
    v_mfma_f32_16x16x32_bf16 v[204:207], a[72:75], a[116:119], v[204:207]
    buffer_load_dwordx4 v6, s[32:35], s57 offen offset:0 lds
    v_mfma_f32_16x16x32_bf16 v[144:147], a[76:79], a[108:111], v[144:147]
    ds_read_b64_tr_b16 a[22:23], v3 offset:34464
    v_mfma_f32_16x16x32_bf16 v[176:179], a[76:79], a[112:115], v[176:179]
    buffer_load_dwordx4 v7, s[32:35], s57 offen offset:1056 lds
    v_mfma_f32_16x16x32_bf16 v[208:211], a[76:79], a[116:119], v[208:211]
    ds_read_b64_tr_b16 a[24:25], v3 offset:33984
    v_mfma_f32_16x16x32_bf16 a[120:123], a[80:83], a[108:111], a[120:123]
    buffer_load_dwordx4 v8, s[32:35], s57 offen offset:2112 lds
    v_mfma_f32_16x16x32_bf16 a[136:139], a[80:83], a[112:115], a[136:139]
    ds_read_b64_tr_b16 a[26:27], v3 offset:34496
    v_mfma_f32_16x16x32_bf16 a[152:155], a[80:83], a[116:119], a[152:155]
    buffer_load_dwordx4 v9, s[32:35], s57 offen offset:3168 lds
    v_mfma_f32_16x16x32_bf16 a[124:127], a[84:87], a[108:111], a[124:127]
    ds_read_b64_tr_b16 a[28:29], v3 offset:34016
    v_mfma_f32_16x16x32_bf16 a[140:143], a[84:87], a[112:115], a[140:143]
    s_add_u32 s65, s65, 262144
    ds_read_b64_tr_b16 a[30:31], v3 offset:34528
    v_mfma_f32_16x16x32_bf16 a[156:159], a[84:87], a[116:119], a[156:159]
    s_and_b32 s65, s65, 0x3fffff
    ds_read_b64_tr_b16 a[32:33], v3 offset:42240
    ds_read_b64_tr_b16 a[34:35], v3 offset:42752
    v_mfma_f32_16x16x32_bf16 a[128:131], a[88:91], a[108:111], a[128:131]
    ds_read_b64_tr_b16 a[36:37], v3 offset:42272
    ds_read_b64_tr_b16 a[38:39], v3 offset:42784
    v_mfma_f32_16x16x32_bf16 a[144:147], a[88:91], a[112:115], a[144:147]
    ds_read_b64_tr_b16 a[40:41], v3 offset:42304
    ds_read_b64_tr_b16 a[42:43], v3 offset:42816
    v_mfma_f32_16x16x32_bf16 a[160:163], a[88:91], a[116:119], a[160:163]
    ds_read_b64_tr_b16 a[44:45], v3 offset:42336
    ds_read_b64_tr_b16 a[46:47], v3 offset:42848
    v_mfma_f32_16x16x32_bf16 a[132:135], a[92:95], a[108:111], a[132:135]
    v_mfma_f32_16x16x32_bf16 a[148:151], a[92:95], a[112:115], a[148:151]
    v_mfma_f32_16x16x32_bf16 a[164:167], a[92:95], a[116:119], a[164:167]
    s_waitcnt vmcnt(14) lgkmcnt(0)
    s_barrier
    v_mfma_f32_16x16x32_bf16 v[116:119], a[0:3], a[96:99], v[116:119]
    s_add_u32 m0, s79, 33792
    ds_read_b128 a[108:111], v21 offset:18432
    v_mfma_f32_16x16x32_bf16 v[148:151], a[0:3], a[100:103], v[148:151]
    s_mov_b32 s57, s65
    ds_read_b128 a[112:115], v21 offset:20480
    v_mfma_f32_16x16x32_bf16 v[180:183], a[0:3], a[104:107], v[180:183]
    buffer_load_dwordx4 v6, s[32:35], s57 offen offset:0 lds
    v_mfma_f32_16x16x32_bf16 v[120:123], a[4:7], a[96:99], v[120:123]
    ds_read_b128 a[116:119], v21 offset:22528
    v_mfma_f32_16x16x32_bf16 v[152:155], a[4:7], a[100:103], v[152:155]
    buffer_load_dwordx4 v7, s[32:35], s57 offen offset:1056 lds
    v_mfma_f32_16x16x32_bf16 v[184:187], a[4:7], a[104:107], v[184:187]
    ds_read_b64_tr_b16 a[48:49], v3 offset:50688
    v_mfma_f32_16x16x32_bf16 v[124:127], a[8:11], a[96:99], v[124:127]
    buffer_load_dwordx4 v8, s[32:35], s57 offen offset:2112 lds
    v_mfma_f32_16x16x32_bf16 v[156:159], a[8:11], a[100:103], v[156:159]
    ds_read_b64_tr_b16 a[50:51], v3 offset:51200
    v_mfma_f32_16x16x32_bf16 v[188:191], a[8:11], a[104:107], v[188:191]
    buffer_load_dwordx4 v9, s[32:35], s57 offen offset:3168 lds
    v_mfma_f32_16x16x32_bf16 v[128:131], a[12:15], a[96:99], v[128:131]
    ds_read_b64_tr_b16 a[52:53], v3 offset:50720
    v_mfma_f32_16x16x32_bf16 v[160:163], a[12:15], a[100:103], v[160:163]
    s_add_u32 s65, s65, 262144
    ds_read_b64_tr_b16 a[54:55], v3 offset:51232
    v_mfma_f32_16x16x32_bf16 v[192:195], a[12:15], a[104:107], v[192:195]
    s_and_b32 s65, s65, 0x3fffff
    ds_read_b64_tr_b16 a[56:57], v3 offset:50752
    v_mfma_f32_16x16x32_bf16 v[132:135], a[16:19], a[96:99], v[132:135]
    ds_read_b64_tr_b16 a[58:59], v3 offset:51264
    v_mfma_f32_16x16x32_bf16 v[164:167], a[16:19], a[100:103], v[164:167]
    ds_read_b64_tr_b16 a[60:61], v3 offset:50784
    v_mfma_f32_16x16x32_bf16 v[196:199], a[16:19], a[104:107], v[196:199]
    ds_read_b64_tr_b16 a[62:63], v3 offset:51296
    v_mfma_f32_16x16x32_bf16 v[136:139], a[20:23], a[96:99], v[136:139]
    ds_read_b64_tr_b16 a[64:65], v3 offset:50816
    v_mfma_f32_16x16x32_bf16 v[168:171], a[20:23], a[100:103], v[168:171]
    ds_read_b64_tr_b16 a[66:67], v3 offset:51328
    v_mfma_f32_16x16x32_bf16 v[200:203], a[20:23], a[104:107], v[200:203]
    ds_read_b64_tr_b16 a[68:69], v3 offset:50848
    v_mfma_f32_16x16x32_bf16 v[140:143], a[24:27], a[96:99], v[140:143]
    ds_read_b64_tr_b16 a[70:71], v3 offset:51360
    v_mfma_f32_16x16x32_bf16 v[172:175], a[24:27], a[100:103], v[172:175]
    ds_read_b64_tr_b16 a[72:73], v3 offset:50880
    v_mfma_f32_16x16x32_bf16 v[204:207], a[24:27], a[104:107], v[204:207]
    ds_read_b64_tr_b16 a[74:75], v3 offset:51392
    v_mfma_f32_16x16x32_bf16 v[144:147], a[28:31], a[96:99], v[144:147]
    ds_read_b64_tr_b16 a[76:77], v3 offset:50912
    v_mfma_f32_16x16x32_bf16 v[176:179], a[28:31], a[100:103], v[176:179]
    ds_read_b64_tr_b16 a[78:79], v3 offset:51424
    v_mfma_f32_16x16x32_bf16 v[208:211], a[28:31], a[104:107], v[208:211]
    ds_read_b64_tr_b16 a[80:81], v3 offset:59136
    v_mfma_f32_16x16x32_bf16 a[120:123], a[32:35], a[96:99], a[120:123]
    ds_read_b64_tr_b16 a[82:83], v3 offset:59648
    v_mfma_f32_16x16x32_bf16 a[136:139], a[32:35], a[100:103], a[136:139]
    ds_read_b64_tr_b16 a[84:85], v3 offset:59168
    v_mfma_f32_16x16x32_bf16 a[152:155], a[32:35], a[104:107], a[152:155]
    ds_read_b64_tr_b16 a[86:87], v3 offset:59680
    v_mfma_f32_16x16x32_bf16 a[124:127], a[36:39], a[96:99], a[124:127]
    ds_read_b64_tr_b16 a[88:89], v3 offset:59200
    v_mfma_f32_16x16x32_bf16 a[140:143], a[36:39], a[100:103], a[140:143]
    ds_read_b64_tr_b16 a[90:91], v3 offset:59712
    v_mfma_f32_16x16x32_bf16 a[156:159], a[36:39], a[104:107], a[156:159]
    ds_read_b64_tr_b16 a[92:93], v3 offset:59232
    v_mfma_f32_16x16x32_bf16 a[128:131], a[40:43], a[96:99], a[128:131]
    ds_read_b64_tr_b16 a[94:95], v3 offset:59744
    v_mfma_f32_16x16x32_bf16 a[144:147], a[40:43], a[100:103], a[144:147]
    v_mfma_f32_16x16x32_bf16 a[160:163], a[40:43], a[104:107], a[160:163]
    v_mfma_f32_16x16x32_bf16 a[132:135], a[44:47], a[96:99], a[132:135]
    v_mfma_f32_16x16x32_bf16 a[148:151], a[44:47], a[100:103], a[148:151]
    v_mfma_f32_16x16x32_bf16 a[164:167], a[44:47], a[104:107], a[164:167]
    s_waitcnt vmcnt(8) lgkmcnt(0)
    s_barrier
    v_mfma_f32_16x16x32_bf16 v[116:119], a[48:51], a[108:111], v[116:119]
    s_add_u32 m0, s67, 18432
    ds_read_b128 a[96:99], v20 offset:0
    v_mfma_f32_16x16x32_bf16 v[148:151], a[48:51], a[112:115], v[148:151]
    s_add_u32 s57, s85, s84
    ds_read_b128 a[100:103], v20 offset:2048
    v_mfma_f32_16x16x32_bf16 v[180:183], a[48:51], a[116:119], v[180:183]
    buffer_load_dwordx4 v22, s[20:23], s57 offen offset:0 lds
    v_mfma_f32_16x16x32_bf16 v[120:123], a[52:55], a[108:111], v[120:123]
    ds_read_b128 a[104:107], v20 offset:4096
    v_mfma_f32_16x16x32_bf16 v[152:155], a[52:55], a[112:115], v[152:155]
    buffer_load_dwordx4 v23, s[20:23], s57 offen offset:1024 lds
    v_mfma_f32_16x16x32_bf16 v[184:187], a[52:55], a[116:119], v[184:187]
    ds_read_b64_tr_b16 a[0:1], v3 offset:0
    v_mfma_f32_16x16x32_bf16 v[124:127], a[56:59], a[108:111], v[124:127]
    buffer_load_dwordx4 v24, s[20:23], s57 offen offset:2048 lds
    v_mfma_f32_16x16x32_bf16 v[156:159], a[56:59], a[112:115], v[156:159]
    ds_read_b64_tr_b16 a[2:3], v3 offset:512
    v_mfma_f32_16x16x32_bf16 v[188:191], a[56:59], a[116:119], v[188:191]
    buffer_load_dwordx4 v25, s[20:23], s57 offen offset:3072 lds
    v_mfma_f32_16x16x32_bf16 v[128:131], a[60:63], a[108:111], v[128:131]
    ds_read_b64_tr_b16 a[4:5], v3 offset:32
    v_mfma_f32_16x16x32_bf16 v[160:163], a[60:63], a[112:115], v[160:163]
    s_add_u32 m0, s67, 22528
    ds_read_b64_tr_b16 a[6:7], v3 offset:544
    v_mfma_f32_16x16x32_bf16 v[192:195], a[60:63], a[116:119], v[192:195]
    s_add_u32 s57, s57, 32768
    ds_read_b64_tr_b16 a[8:9], v3 offset:64
    v_mfma_f32_16x16x32_bf16 v[132:135], a[64:67], a[108:111], v[132:135]
    buffer_load_dwordx4 v22, s[20:23], s57 offen offset:0 lds
    v_mfma_f32_16x16x32_bf16 v[164:167], a[64:67], a[112:115], v[164:167]
    ds_read_b64_tr_b16 a[10:11], v3 offset:576
    v_mfma_f32_16x16x32_bf16 v[196:199], a[64:67], a[116:119], v[196:199]
    buffer_load_dwordx4 v23, s[20:23], s57 offen offset:1024 lds
    v_mfma_f32_16x16x32_bf16 v[136:139], a[68:71], a[108:111], v[136:139]
    ds_read_b64_tr_b16 a[12:13], v3 offset:96
    v_mfma_f32_16x16x32_bf16 v[168:171], a[68:71], a[112:115], v[168:171]
    s_add_u32 s84, s84, 128
    ds_read_b64_tr_b16 a[14:15], v3 offset:608
    v_mfma_f32_16x16x32_bf16 v[200:203], a[68:71], a[116:119], v[200:203]
    s_and_b32 s84, s84, 1023
    ds_read_b64_tr_b16 a[16:17], v3 offset:128
    v_mfma_f32_16x16x32_bf16 v[140:143], a[72:75], a[108:111], v[140:143]
    s_add_u32 m0, s79, 50688
    ds_read_b64_tr_b16 a[18:19], v3 offset:640
    v_mfma_f32_16x16x32_bf16 v[172:175], a[72:75], a[112:115], v[172:175]
    s_mov_b32 s57, s65
    ds_read_b64_tr_b16 a[20:21], v3 offset:160
    v_mfma_f32_16x16x32_bf16 v[204:207], a[72:75], a[116:119], v[204:207]
    buffer_load_dwordx4 v6, s[32:35], s57 offen offset:0 lds
    v_mfma_f32_16x16x32_bf16 v[144:147], a[76:79], a[108:111], v[144:147]
    ds_read_b64_tr_b16 a[22:23], v3 offset:672
    v_mfma_f32_16x16x32_bf16 v[176:179], a[76:79], a[112:115], v[176:179]
    buffer_load_dwordx4 v7, s[32:35], s57 offen offset:1056 lds
    v_mfma_f32_16x16x32_bf16 v[208:211], a[76:79], a[116:119], v[208:211]
    ds_read_b64_tr_b16 a[24:25], v3 offset:192
    v_mfma_f32_16x16x32_bf16 a[120:123], a[80:83], a[108:111], a[120:123]
    buffer_load_dwordx4 v8, s[32:35], s57 offen offset:2112 lds
    v_mfma_f32_16x16x32_bf16 a[136:139], a[80:83], a[112:115], a[136:139]
    ds_read_b64_tr_b16 a[26:27], v3 offset:704
    v_mfma_f32_16x16x32_bf16 a[152:155], a[80:83], a[116:119], a[152:155]
    buffer_load_dwordx4 v9, s[32:35], s57 offen offset:3168 lds
    v_mfma_f32_16x16x32_bf16 a[124:127], a[84:87], a[108:111], a[124:127]
    ds_read_b64_tr_b16 a[28:29], v3 offset:224
    v_mfma_f32_16x16x32_bf16 a[140:143], a[84:87], a[112:115], a[140:143]
    s_add_u32 s65, s65, 262144
    ds_read_b64_tr_b16 a[30:31], v3 offset:736
    v_mfma_f32_16x16x32_bf16 a[156:159], a[84:87], a[116:119], a[156:159]
    s_and_b32 s65, s65, 0x3fffff
    ds_read_b64_tr_b16 a[32:33], v3 offset:8448
    ds_read_b64_tr_b16 a[34:35], v3 offset:8960
    v_mfma_f32_16x16x32_bf16 a[128:131], a[88:91], a[108:111], a[128:131]
    ds_read_b64_tr_b16 a[36:37], v3 offset:8480
    ds_read_b64_tr_b16 a[38:39], v3 offset:8992
    v_mfma_f32_16x16x32_bf16 a[144:147], a[88:91], a[112:115], a[144:147]
    ds_read_b64_tr_b16 a[40:41], v3 offset:8512
    ds_read_b64_tr_b16 a[42:43], v3 offset:9024
    v_mfma_f32_16x16x32_bf16 a[160:163], a[88:91], a[116:119], a[160:163]
    ds_read_b64_tr_b16 a[44:45], v3 offset:8544
    ds_read_b64_tr_b16 a[46:47], v3 offset:9056
    v_mfma_f32_16x16x32_bf16 a[132:135], a[92:95], a[108:111], a[132:135]
    v_mfma_f32_16x16x32_bf16 a[148:151], a[92:95], a[112:115], a[148:151]
    v_mfma_f32_16x16x32_bf16 a[164:167], a[92:95], a[116:119], a[164:167]
    s_waitcnt vmcnt(14) lgkmcnt(0)
    s_barrier
    v_mfma_f32_16x16x32_bf16 v[116:119], a[0:3], a[96:99], v[116:119]
    ds_read_b128 a[108:111], v21 offset:0
    v_mfma_f32_16x16x32_bf16 v[148:151], a[0:3], a[100:103], v[148:151]
    ds_read_b128 a[112:115], v21 offset:2048
    v_mfma_f32_16x16x32_bf16 v[180:183], a[0:3], a[104:107], v[180:183]
    ds_read_b128 a[116:119], v21 offset:4096
    v_mfma_f32_16x16x32_bf16 v[120:123], a[4:7], a[96:99], v[120:123]
    ds_read_b64_tr_b16 a[48:49], v3 offset:16896
    v_mfma_f32_16x16x32_bf16 v[152:155], a[4:7], a[100:103], v[152:155]
    ds_read_b64_tr_b16 a[50:51], v3 offset:17408
    v_mfma_f32_16x16x32_bf16 v[184:187], a[4:7], a[104:107], v[184:187]
    ds_read_b64_tr_b16 a[52:53], v3 offset:16928
    v_mfma_f32_16x16x32_bf16 v[124:127], a[8:11], a[96:99], v[124:127]
    ds_read_b64_tr_b16 a[54:55], v3 offset:17440
    v_mfma_f32_16x16x32_bf16 v[156:159], a[8:11], a[100:103], v[156:159]
    ds_read_b64_tr_b16 a[56:57], v3 offset:16960
    v_mfma_f32_16x16x32_bf16 v[188:191], a[8:11], a[104:107], v[188:191]
    ds_read_b64_tr_b16 a[58:59], v3 offset:17472
    v_mfma_f32_16x16x32_bf16 v[128:131], a[12:15], a[96:99], v[128:131]
    ds_read_b64_tr_b16 a[60:61], v3 offset:16992
    v_mfma_f32_16x16x32_bf16 v[160:163], a[12:15], a[100:103], v[160:163]
    ds_read_b64_tr_b16 a[62:63], v3 offset:17504
    v_mfma_f32_16x16x32_bf16 v[192:195], a[12:15], a[104:107], v[192:195]
    ds_read_b64_tr_b16 a[64:65], v3 offset:17024
    v_mfma_f32_16x16x32_bf16 v[132:135], a[16:19], a[96:99], v[132:135]
    ds_read_b64_tr_b16 a[66:67], v3 offset:17536
    v_mfma_f32_16x16x32_bf16 v[164:167], a[16:19], a[100:103], v[164:167]
    ds_read_b64_tr_b16 a[68:69], v3 offset:17056
    v_mfma_f32_16x16x32_bf16 v[196:199], a[16:19], a[104:107], v[196:199]
    ds_read_b64_tr_b16 a[70:71], v3 offset:17568
    v_mfma_f32_16x16x32_bf16 v[136:139], a[20:23], a[96:99], v[136:139]
    ds_read_b64_tr_b16 a[72:73], v3 offset:17088
    v_mfma_f32_16x16x32_bf16 v[168:171], a[20:23], a[100:103], v[168:171]
    ds_read_b64_tr_b16 a[74:75], v3 offset:17600
    v_mfma_f32_16x16x32_bf16 v[200:203], a[20:23], a[104:107], v[200:203]
    ds_read_b64_tr_b16 a[76:77], v3 offset:17120
    v_mfma_f32_16x16x32_bf16 v[140:143], a[24:27], a[96:99], v[140:143]
    ds_read_b64_tr_b16 a[78:79], v3 offset:17632
    v_mfma_f32_16x16x32_bf16 v[172:175], a[24:27], a[100:103], v[172:175]
    ds_read_b64_tr_b16 a[80:81], v3 offset:25344
    v_mfma_f32_16x16x32_bf16 v[204:207], a[24:27], a[104:107], v[204:207]
    ds_read_b64_tr_b16 a[82:83], v3 offset:25856
    v_mfma_f32_16x16x32_bf16 v[144:147], a[28:31], a[96:99], v[144:147]
    ds_read_b64_tr_b16 a[84:85], v3 offset:25376
    v_mfma_f32_16x16x32_bf16 v[176:179], a[28:31], a[100:103], v[176:179]
    ds_read_b64_tr_b16 a[86:87], v3 offset:25888
    v_mfma_f32_16x16x32_bf16 v[208:211], a[28:31], a[104:107], v[208:211]
    ds_read_b64_tr_b16 a[88:89], v3 offset:25408
    v_mfma_f32_16x16x32_bf16 a[120:123], a[32:35], a[96:99], a[120:123]
    ds_read_b64_tr_b16 a[90:91], v3 offset:25920
    v_mfma_f32_16x16x32_bf16 a[136:139], a[32:35], a[100:103], a[136:139]
    ds_read_b64_tr_b16 a[92:93], v3 offset:25440
    v_mfma_f32_16x16x32_bf16 a[152:155], a[32:35], a[104:107], a[152:155]
    ds_read_b64_tr_b16 a[94:95], v3 offset:25952
    v_mfma_f32_16x16x32_bf16 a[124:127], a[36:39], a[96:99], a[124:127]
    v_mfma_f32_16x16x32_bf16 a[140:143], a[36:39], a[100:103], a[140:143]
    v_mfma_f32_16x16x32_bf16 a[156:159], a[36:39], a[104:107], a[156:159]
    v_mfma_f32_16x16x32_bf16 a[128:131], a[40:43], a[96:99], a[128:131]
    v_mfma_f32_16x16x32_bf16 a[144:147], a[40:43], a[100:103], a[144:147]
    v_mfma_f32_16x16x32_bf16 a[160:163], a[40:43], a[104:107], a[160:163]
    v_mfma_f32_16x16x32_bf16 a[132:135], a[44:47], a[96:99], a[132:135]
    v_mfma_f32_16x16x32_bf16 a[148:151], a[44:47], a[100:103], a[148:151]
    v_mfma_f32_16x16x32_bf16 a[164:167], a[44:47], a[104:107], a[164:167]
    s_waitcnt vmcnt(4) lgkmcnt(0)
    s_barrier
    v_mfma_f32_16x16x32_bf16 v[116:119], a[48:51], a[108:111], v[116:119]
    ds_read_b128 a[96:99], v20 offset:18432
    v_mfma_f32_16x16x32_bf16 v[148:151], a[48:51], a[112:115], v[148:151]
    ds_read_b128 a[100:103], v20 offset:20480
    v_mfma_f32_16x16x32_bf16 v[180:183], a[48:51], a[116:119], v[180:183]
    ds_read_b128 a[104:107], v20 offset:22528
    v_mfma_f32_16x16x32_bf16 v[120:123], a[52:55], a[108:111], v[120:123]
    ds_read_b64_tr_b16 a[0:1], v3 offset:33792
    v_mfma_f32_16x16x32_bf16 v[152:155], a[52:55], a[112:115], v[152:155]
    ds_read_b64_tr_b16 a[2:3], v3 offset:34304
    v_mfma_f32_16x16x32_bf16 v[184:187], a[52:55], a[116:119], v[184:187]
    ds_read_b64_tr_b16 a[4:5], v3 offset:33824
    v_mfma_f32_16x16x32_bf16 v[124:127], a[56:59], a[108:111], v[124:127]
    ds_read_b64_tr_b16 a[6:7], v3 offset:34336
    v_mfma_f32_16x16x32_bf16 v[156:159], a[56:59], a[112:115], v[156:159]
    ds_read_b64_tr_b16 a[8:9], v3 offset:33856
    v_mfma_f32_16x16x32_bf16 v[188:191], a[56:59], a[116:119], v[188:191]
    ds_read_b64_tr_b16 a[10:11], v3 offset:34368
    v_mfma_f32_16x16x32_bf16 v[128:131], a[60:63], a[108:111], v[128:131]
    ds_read_b64_tr_b16 a[12:13], v3 offset:33888
    v_mfma_f32_16x16x32_bf16 v[160:163], a[60:63], a[112:115], v[160:163]
    ds_read_b64_tr_b16 a[14:15], v3 offset:34400
    v_mfma_f32_16x16x32_bf16 v[192:195], a[60:63], a[116:119], v[192:195]
    ds_read_b64_tr_b16 a[16:17], v3 offset:33920
    v_mfma_f32_16x16x32_bf16 v[132:135], a[64:67], a[108:111], v[132:135]
    ds_read_b64_tr_b16 a[18:19], v3 offset:34432
    v_mfma_f32_16x16x32_bf16 v[164:167], a[64:67], a[112:115], v[164:167]
    ds_read_b64_tr_b16 a[20:21], v3 offset:33952
    v_mfma_f32_16x16x32_bf16 v[196:199], a[64:67], a[116:119], v[196:199]
    ds_read_b64_tr_b16 a[22:23], v3 offset:34464
    v_mfma_f32_16x16x32_bf16 v[136:139], a[68:71], a[108:111], v[136:139]
    ds_read_b64_tr_b16 a[24:25], v3 offset:33984
    v_mfma_f32_16x16x32_bf16 v[168:171], a[68:71], a[112:115], v[168:171]
    ds_read_b64_tr_b16 a[26:27], v3 offset:34496
    v_mfma_f32_16x16x32_bf16 v[200:203], a[68:71], a[116:119], v[200:203]
    ds_read_b64_tr_b16 a[28:29], v3 offset:34016
    v_mfma_f32_16x16x32_bf16 v[140:143], a[72:75], a[108:111], v[140:143]
    ds_read_b64_tr_b16 a[30:31], v3 offset:34528
    v_mfma_f32_16x16x32_bf16 v[172:175], a[72:75], a[112:115], v[172:175]
    ds_read_b64_tr_b16 a[32:33], v3 offset:42240
    v_mfma_f32_16x16x32_bf16 v[204:207], a[72:75], a[116:119], v[204:207]
    ds_read_b64_tr_b16 a[34:35], v3 offset:42752
    v_mfma_f32_16x16x32_bf16 v[144:147], a[76:79], a[108:111], v[144:147]
    ds_read_b64_tr_b16 a[36:37], v3 offset:42272
    v_mfma_f32_16x16x32_bf16 v[176:179], a[76:79], a[112:115], v[176:179]
    ds_read_b64_tr_b16 a[38:39], v3 offset:42784
    v_mfma_f32_16x16x32_bf16 v[208:211], a[76:79], a[116:119], v[208:211]
    ds_read_b64_tr_b16 a[40:41], v3 offset:42304
    v_mfma_f32_16x16x32_bf16 a[120:123], a[80:83], a[108:111], a[120:123]
    ds_read_b64_tr_b16 a[42:43], v3 offset:42816
    v_mfma_f32_16x16x32_bf16 a[136:139], a[80:83], a[112:115], a[136:139]
    ds_read_b64_tr_b16 a[44:45], v3 offset:42336
    v_mfma_f32_16x16x32_bf16 a[152:155], a[80:83], a[116:119], a[152:155]
    ds_read_b64_tr_b16 a[46:47], v3 offset:42848
    v_mfma_f32_16x16x32_bf16 a[124:127], a[84:87], a[108:111], a[124:127]
    v_mfma_f32_16x16x32_bf16 a[140:143], a[84:87], a[112:115], a[140:143]
    v_mfma_f32_16x16x32_bf16 a[156:159], a[84:87], a[116:119], a[156:159]
    v_mfma_f32_16x16x32_bf16 a[128:131], a[88:91], a[108:111], a[128:131]
    v_mfma_f32_16x16x32_bf16 a[144:147], a[88:91], a[112:115], a[144:147]
    v_mfma_f32_16x16x32_bf16 a[160:163], a[88:91], a[116:119], a[160:163]
    v_mfma_f32_16x16x32_bf16 a[132:135], a[92:95], a[108:111], a[132:135]
    v_mfma_f32_16x16x32_bf16 a[148:151], a[92:95], a[112:115], a[148:151]
    v_mfma_f32_16x16x32_bf16 a[164:167], a[92:95], a[116:119], a[164:167]
    s_waitcnt vmcnt(0) lgkmcnt(0)
    s_barrier
    v_mfma_f32_16x16x32_bf16 v[116:119], a[0:3], a[96:99], v[116:119]
    ds_read_b128 a[108:111], v21 offset:18432
    v_mfma_f32_16x16x32_bf16 v[148:151], a[0:3], a[100:103], v[148:151]
    ds_read_b128 a[112:115], v21 offset:20480
    v_mfma_f32_16x16x32_bf16 v[180:183], a[0:3], a[104:107], v[180:183]
    ds_read_b128 a[116:119], v21 offset:22528
    v_mfma_f32_16x16x32_bf16 v[120:123], a[4:7], a[96:99], v[120:123]
    ds_read_b64_tr_b16 a[48:49], v3 offset:50688
    v_mfma_f32_16x16x32_bf16 v[152:155], a[4:7], a[100:103], v[152:155]
    ds_read_b64_tr_b16 a[50:51], v3 offset:51200
    v_mfma_f32_16x16x32_bf16 v[184:187], a[4:7], a[104:107], v[184:187]
    ds_read_b64_tr_b16 a[52:53], v3 offset:50720
    v_mfma_f32_16x16x32_bf16 v[124:127], a[8:11], a[96:99], v[124:127]
    ds_read_b64_tr_b16 a[54:55], v3 offset:51232
    v_mfma_f32_16x16x32_bf16 v[156:159], a[8:11], a[100:103], v[156:159]
    ds_read_b64_tr_b16 a[56:57], v3 offset:50752
    v_mfma_f32_16x16x32_bf16 v[188:191], a[8:11], a[104:107], v[188:191]
    ds_read_b64_tr_b16 a[58:59], v3 offset:51264
    v_mfma_f32_16x16x32_bf16 v[128:131], a[12:15], a[96:99], v[128:131]
    ds_read_b64_tr_b16 a[60:61], v3 offset:50784
    v_mfma_f32_16x16x32_bf16 v[160:163], a[12:15], a[100:103], v[160:163]
    ds_read_b64_tr_b16 a[62:63], v3 offset:51296
    v_mfma_f32_16x16x32_bf16 v[192:195], a[12:15], a[104:107], v[192:195]
    ds_read_b64_tr_b16 a[64:65], v3 offset:50816
    v_mfma_f32_16x16x32_bf16 v[132:135], a[16:19], a[96:99], v[132:135]
    ds_read_b64_tr_b16 a[66:67], v3 offset:51328
    v_mfma_f32_16x16x32_bf16 v[164:167], a[16:19], a[100:103], v[164:167]
    ds_read_b64_tr_b16 a[68:69], v3 offset:50848
    v_mfma_f32_16x16x32_bf16 v[196:199], a[16:19], a[104:107], v[196:199]
    ds_read_b64_tr_b16 a[70:71], v3 offset:51360
    v_mfma_f32_16x16x32_bf16 v[136:139], a[20:23], a[96:99], v[136:139]
    ds_read_b64_tr_b16 a[72:73], v3 offset:50880
    v_mfma_f32_16x16x32_bf16 v[168:171], a[20:23], a[100:103], v[168:171]
    ds_read_b64_tr_b16 a[74:75], v3 offset:51392
    v_mfma_f32_16x16x32_bf16 v[200:203], a[20:23], a[104:107], v[200:203]
    ds_read_b64_tr_b16 a[76:77], v3 offset:50912
    v_mfma_f32_16x16x32_bf16 v[140:143], a[24:27], a[96:99], v[140:143]
    ds_read_b64_tr_b16 a[78:79], v3 offset:51424
    v_mfma_f32_16x16x32_bf16 v[172:175], a[24:27], a[100:103], v[172:175]
    ds_read_b64_tr_b16 a[80:81], v3 offset:59136
    v_mfma_f32_16x16x32_bf16 v[204:207], a[24:27], a[104:107], v[204:207]
    ds_read_b64_tr_b16 a[82:83], v3 offset:59648
    v_mfma_f32_16x16x32_bf16 v[144:147], a[28:31], a[96:99], v[144:147]
    ds_read_b64_tr_b16 a[84:85], v3 offset:59168
    v_mfma_f32_16x16x32_bf16 v[176:179], a[28:31], a[100:103], v[176:179]
    ds_read_b64_tr_b16 a[86:87], v3 offset:59680
    v_mfma_f32_16x16x32_bf16 v[208:211], a[28:31], a[104:107], v[208:211]
    ds_read_b64_tr_b16 a[88:89], v3 offset:59200
    v_mfma_f32_16x16x32_bf16 a[120:123], a[32:35], a[96:99], a[120:123]
    ds_read_b64_tr_b16 a[90:91], v3 offset:59712
    v_mfma_f32_16x16x32_bf16 a[136:139], a[32:35], a[100:103], a[136:139]
    ds_read_b64_tr_b16 a[92:93], v3 offset:59232
    v_mfma_f32_16x16x32_bf16 a[152:155], a[32:35], a[104:107], a[152:155]
    ds_read_b64_tr_b16 a[94:95], v3 offset:59744
    v_mfma_f32_16x16x32_bf16 a[124:127], a[36:39], a[96:99], a[124:127]
    v_mfma_f32_16x16x32_bf16 a[140:143], a[36:39], a[100:103], a[140:143]
    v_mfma_f32_16x16x32_bf16 a[156:159], a[36:39], a[104:107], a[156:159]
    v_mfma_f32_16x16x32_bf16 a[128:131], a[40:43], a[96:99], a[128:131]
    v_mfma_f32_16x16x32_bf16 a[144:147], a[40:43], a[100:103], a[144:147]
    v_mfma_f32_16x16x32_bf16 a[160:163], a[40:43], a[104:107], a[160:163]
    v_mfma_f32_16x16x32_bf16 a[132:135], a[44:47], a[96:99], a[132:135]
    v_mfma_f32_16x16x32_bf16 a[148:151], a[44:47], a[100:103], a[148:151]
    v_mfma_f32_16x16x32_bf16 a[164:167], a[44:47], a[104:107], a[164:167]
    s_cmp_lg_u32 s52, 0
    s_cbranch_scc1 L_noat
    s_mov_b64 exec, 1
    v_mov_b32 v10, 1
    buffer_atomic_add v10, off, s[48:51], 0
    s_mov_b64 exec, -1
L_noat:
    s_waitcnt lgkmcnt(0)
    s_barrier
    v_mfma_f32_16x16x32_bf16 v[116:119], a[48:51], a[108:111], v[116:119]
    ds_read_b128 a[192:195], v4 offset:0
    v_mfma_f32_16x16x32_bf16 v[148:151], a[48:51], a[112:115], v[148:151]
    ds_read_b128 a[196:199], v4 offset:64
    v_mfma_f32_16x16x32_bf16 v[180:183], a[48:51], a[116:119], v[180:183]
    ds_read_b128 a[200:203], v4 offset:128
    v_mfma_f32_16x16x32_bf16 v[120:123], a[52:55], a[108:111], v[120:123]
    ds_read_b128 a[204:207], v4 offset:192
    v_mfma_f32_16x16x32_bf16 v[152:155], a[52:55], a[112:115], v[152:155]
    ds_read_b128 a[208:211], v4 offset:512
    v_mfma_f32_16x16x32_bf16 v[184:187], a[52:55], a[116:119], v[184:187]
    ds_read_b128 a[212:215], v4 offset:576
    v_mfma_f32_16x16x32_bf16 v[124:127], a[56:59], a[108:111], v[124:127]
    ds_read_b128 a[216:219], v4 offset:640
    v_mfma_f32_16x16x32_bf16 v[156:159], a[56:59], a[112:115], v[156:159]
    ds_read_b128 a[220:223], v4 offset:704
    v_mfma_f32_16x16x32_bf16 v[188:191], a[56:59], a[116:119], v[188:191]
    v_mfma_f32_16x16x32_bf16 v[128:131], a[60:63], a[108:111], v[128:131]
    v_mfma_f32_16x16x32_bf16 v[160:163], a[60:63], a[112:115], v[160:163]
    v_mfma_f32_16x16x32_bf16 v[192:195], a[60:63], a[116:119], v[192:195]
    v_mfma_f32_16x16x32_bf16 v[132:135], a[64:67], a[108:111], v[132:135]
    v_mfma_f32_16x16x32_bf16 v[164:167], a[64:67], a[112:115], v[164:167]
    v_mfma_f32_16x16x32_bf16 v[196:199], a[64:67], a[116:119], v[196:199]
    v_mfma_f32_16x16x32_bf16 v[136:139], a[68:71], a[108:111], v[136:139]
    v_mfma_f32_16x16x32_bf16 v[168:171], a[68:71], a[112:115], v[168:171]
    v_mfma_f32_16x16x32_bf16 v[200:203], a[68:71], a[116:119], v[200:203]
    v_mfma_f32_16x16x32_bf16 v[140:143], a[72:75], a[108:111], v[140:143]
    v_mfma_f32_16x16x32_bf16 v[172:175], a[72:75], a[112:115], v[172:175]
    v_mfma_f32_16x16x32_bf16 v[204:207], a[72:75], a[116:119], v[204:207]
    v_mfma_f32_16x16x32_bf16 v[144:147], a[76:79], a[108:111], v[144:147]
    v_mfma_f32_16x16x32_bf16 v[176:179], a[76:79], a[112:115], v[176:179]
    v_mfma_f32_16x16x32_bf16 v[208:211], a[76:79], a[116:119], v[208:211]
    v_mfma_f32_16x16x32_bf16 a[120:123], a[80:83], a[108:111], a[120:123]
    v_mfma_f32_16x16x32_bf16 a[136:139], a[80:83], a[112:115], a[136:139]
    v_mfma_f32_16x16x32_bf16 a[152:155], a[80:83], a[116:119], a[152:155]
    v_mfma_f32_16x16x32_bf16 a[124:127], a[84:87], a[108:111], a[124:127]
    v_mfma_f32_16x16x32_bf16 a[140:143], a[84:87], a[112:115], a[140:143]
    v_mfma_f32_16x16x32_bf16 a[156:159], a[84:87], a[116:119], a[156:159]
    v_mfma_f32_16x16x32_bf16 a[128:131], a[88:91], a[108:111], a[128:131]
    v_mfma_f32_16x16x32_bf16 a[144:147], a[88:91], a[112:115], a[144:147]
    v_mfma_f32_16x16x32_bf16 a[160:163], a[88:91], a[116:119], a[160:163]
    v_mfma_f32_16x16x32_bf16 a[132:135], a[92:95], a[108:111], a[132:135]
    v_mfma_f32_16x16x32_bf16 a[148:151], a[92:95], a[112:115], a[148:151]
    v_mfma_f32_16x16x32_bf16 a[164:167], a[92:95], a[116:119], a[164:167]
    s_nop 7
    v_pk_mul_f32 v[116:117], v[116:117], v[14:15]
    v_pk_mul_f32 v[118:119], v[118:119], v[14:15]
    v_pk_mul_f32 v[120:121], v[120:121], v[14:15]
    v_pk_mul_f32 v[122:123], v[122:123], v[14:15]
    v_cvt_pk_bf16_f32 v68, v116, v117
    v_cvt_pk_bf16_f32 v69, v118, v119
    v_cvt_pk_bf16_f32 v70, v120, v121
    v_cvt_pk_bf16_f32 v71, v122, v123
    v_pk_mul_f32 v[124:125], v[124:125], v[14:15]
    v_pk_mul_f32 v[126:127], v[126:127], v[14:15]
    v_pk_mul_f32 v[128:129], v[128:129], v[14:15]
    v_pk_mul_f32 v[130:131], v[130:131], v[14:15]
    v_cvt_pk_bf16_f32 v72, v124, v125
    v_cvt_pk_bf16_f32 v73, v126, v127
    v_cvt_pk_bf16_f32 v74, v128, v129
    v_cvt_pk_bf16_f32 v75, v130, v131
    v_pk_mul_f32 v[132:133], v[132:133], v[14:15]
    v_pk_mul_f32 v[134:135], v[134:135], v[14:15]
    v_pk_mul_f32 v[136:137], v[136:137], v[14:15]
    v_pk_mul_f32 v[138:139], v[138:139], v[14:15]
    v_cvt_pk_bf16_f32 v76, v132, v133
    v_cvt_pk_bf16_f32 v77, v134, v135
    v_cvt_pk_bf16_f32 v78, v136, v137
    v_cvt_pk_bf16_f32 v79, v138, v139
    v_pk_mul_f32 v[140:141], v[140:141], v[14:15]
    v_pk_mul_f32 v[142:143], v[142:143], v[14:15]
    v_pk_mul_f32 v[144:145], v[144:145], v[14:15]
    v_pk_mul_f32 v[146:147], v[146:147], v[14:15]
    v_cvt_pk_bf16_f32 v80, v140, v141
    v_cvt_pk_bf16_f32 v81, v142, v143
    v_cvt_pk_bf16_f32 v82, v144, v145
    v_cvt_pk_bf16_f32 v83, v146, v147
    s_nop 1
    v_permlane32_swap_b32 v68, v70
    v_permlane32_swap_b32 v69, v71
    v_permlane32_swap_b32 v72, v74
    v_permlane32_swap_b32 v73, v75
    v_permlane32_swap_b32 v76, v78
    v_permlane32_swap_b32 v77, v79
    v_permlane32_swap_b32 v80, v82
    v_permlane32_swap_b32 v81, v83
    v_permlane16_swap_b32 v68, v70
    v_permlane16_swap_b32 v69, v71
    v_permlane16_swap_b32 v72, v74
    v_permlane16_swap_b32 v73, v75
    v_permlane16_swap_b32 v76, v78
    v_permlane16_swap_b32 v77, v79
    v_permlane16_swap_b32 v80, v82
    v_permlane16_swap_b32 v81, v83
    s_nop 1
    v_pk_mul_f32 v[148:149], v[148:149], v[14:15]
    v_pk_mul_f32 v[150:151], v[150:151], v[14:15]
    v_pk_mul_f32 v[152:153], v[152:153], v[14:15]
    v_pk_mul_f32 v[154:155], v[154:155], v[14:15]
    v_cvt_pk_bf16_f32 v84, v148, v149
    v_cvt_pk_bf16_f32 v85, v150, v151
    v_cvt_pk_bf16_f32 v86, v152, v153
    v_cvt_pk_bf16_f32 v87, v154, v155
    v_pk_mul_f32 v[156:157], v[156:157], v[14:15]
    v_pk_mul_f32 v[158:159], v[158:159], v[14:15]
    v_pk_mul_f32 v[160:161], v[160:161], v[14:15]
    v_pk_mul_f32 v[162:163], v[162:163], v[14:15]
    v_cvt_pk_bf16_f32 v88, v156, v157
    v_cvt_pk_bf16_f32 v89, v158, v159
    v_cvt_pk_bf16_f32 v90, v160, v161
    v_cvt_pk_bf16_f32 v91, v162, v163
    v_pk_mul_f32 v[164:165], v[164:165], v[14:15]
    v_pk_mul_f32 v[166:167], v[166:167], v[14:15]
    v_pk_mul_f32 v[168:169], v[168:169], v[14:15]
    v_pk_mul_f32 v[170:171], v[170:171], v[14:15]
    v_cvt_pk_bf16_f32 v92, v164, v165
    v_cvt_pk_bf16_f32 v93, v166, v167
    v_cvt_pk_bf16_f32 v94, v168, v169
    v_cvt_pk_bf16_f32 v95, v170, v171
    v_pk_mul_f32 v[172:173], v[172:173], v[14:15]
    v_pk_mul_f32 v[174:175], v[174:175], v[14:15]
    v_pk_mul_f32 v[176:177], v[176:177], v[14:15]
    v_pk_mul_f32 v[178:179], v[178:179], v[14:15]
    v_cvt_pk_bf16_f32 v96, v172, v173
    v_cvt_pk_bf16_f32 v97, v174, v175
    v_cvt_pk_bf16_f32 v98, v176, v177
    v_cvt_pk_bf16_f32 v99, v178, v179
    s_nop 1
    v_permlane32_swap_b32 v84, v86
    v_permlane32_swap_b32 v85, v87
    v_permlane32_swap_b32 v88, v90
    v_permlane32_swap_b32 v89, v91
    v_permlane32_swap_b32 v92, v94
    v_permlane32_swap_b32 v93, v95
    v_permlane32_swap_b32 v96, v98
    v_permlane32_swap_b32 v97, v99
    v_permlane16_swap_b32 v84, v86
    v_permlane16_swap_b32 v85, v87
    v_permlane16_swap_b32 v88, v90
    v_permlane16_swap_b32 v89, v91
    v_permlane16_swap_b32 v92, v94
    v_permlane16_swap_b32 v93, v95
    v_permlane16_swap_b32 v96, v98
    v_permlane16_swap_b32 v97, v99
    s_nop 1
    v_pk_mul_f32 v[180:181], v[180:181], v[14:15]
    v_pk_mul_f32 v[182:183], v[182:183], v[14:15]
    v_pk_mul_f32 v[184:185], v[184:185], v[14:15]
    v_pk_mul_f32 v[186:187], v[186:187], v[14:15]
    v_cvt_pk_bf16_f32 v100, v180, v181
    v_cvt_pk_bf16_f32 v101, v182, v183
    v_cvt_pk_bf16_f32 v102, v184, v185
    v_cvt_pk_bf16_f32 v103, v186, v187
    v_pk_mul_f32 v[188:189], v[188:189], v[14:15]
    v_pk_mul_f32 v[190:191], v[190:191], v[14:15]
    v_pk_mul_f32 v[192:193], v[192:193], v[14:15]
    v_pk_mul_f32 v[194:195], v[194:195], v[14:15]
    v_cvt_pk_bf16_f32 v104, v188, v189
    v_cvt_pk_bf16_f32 v105, v190, v191
    v_cvt_pk_bf16_f32 v106, v192, v193
    v_cvt_pk_bf16_f32 v107, v194, v195
    v_pk_mul_f32 v[196:197], v[196:197], v[14:15]
    v_pk_mul_f32 v[198:199], v[198:199], v[14:15]
    v_pk_mul_f32 v[200:201], v[200:201], v[14:15]
    v_pk_mul_f32 v[202:203], v[202:203], v[14:15]
    v_cvt_pk_bf16_f32 v108, v196, v197
    v_cvt_pk_bf16_f32 v109, v198, v199
    v_cvt_pk_bf16_f32 v110, v200, v201
    v_cvt_pk_bf16_f32 v111, v202, v203
    v_pk_mul_f32 v[204:205], v[204:205], v[14:15]
    v_pk_mul_f32 v[206:207], v[206:207], v[14:15]
    v_pk_mul_f32 v[208:209], v[208:209], v[14:15]
    v_pk_mul_f32 v[210:211], v[210:211], v[14:15]
    v_cvt_pk_bf16_f32 v112, v204, v205
    v_cvt_pk_bf16_f32 v113, v206, v207
    v_cvt_pk_bf16_f32 v114, v208, v209
    v_cvt_pk_bf16_f32 v115, v210, v211
    s_nop 1
    v_permlane32_swap_b32 v100, v102
    v_permlane32_swap_b32 v101, v103
    v_permlane32_swap_b32 v104, v106
    v_permlane32_swap_b32 v105, v107
    v_permlane32_swap_b32 v108, v110
    v_permlane32_swap_b32 v109, v111
    v_permlane32_swap_b32 v112, v114
    v_permlane32_swap_b32 v113, v115
    v_permlane16_swap_b32 v100, v102
    v_permlane16_swap_b32 v101, v103
    v_permlane16_swap_b32 v104, v106
    v_permlane16_swap_b32 v105, v107
    v_permlane16_swap_b32 v108, v110
    v_permlane16_swap_b32 v109, v111
    v_permlane16_swap_b32 v112, v114
    v_permlane16_swap_b32 v113, v115
    s_nop 1
    s_mov_b32 s60, 16896
    s_mov_b32 s61, 118272
    v_add_u32 v3, 16896, v1
    v_add_u32 v4, 16896, v2
    s_waitcnt lgkmcnt(0)
    s_barrier
    v_mfma_f32_16x16x32_bf16 v[32:35], a[192:195], v[68:71], 0
    ds_read_b64_tr_b16 a[224:225], v3 offset:0
    ds_read_b64_tr_b16 a[226:227], v3 offset:512
    v_mfma_f32_16x16x32_bf16 v[32:35], a[196:199], v[72:75], v[32:35]
    ds_read_b64_tr_b16 a[228:229], v3 offset:32
    ds_read_b64_tr_b16 a[230:231], v3 offset:544
    v_mfma_f32_16x16x32_bf16 v[32:35], a[200:203], v[76:79], v[32:35]
    ds_read_b64_tr_b16 a[232:233], v3 offset:64
    ds_read_b64_tr_b16 a[234:235], v3 offset:576
    v_mfma_f32_16x16x32_bf16 v[32:35], a[204:207], v[80:83], v[32:35]
    ds_read_b64_tr_b16 a[236:237], v3 offset:96
    ds_read_b64_tr_b16 a[238:239], v3 offset:608
    v_mfma_f32_16x16x32_bf16 v[36:39], a[208:211], v[68:71], 0
    ds_read_b64_tr_b16 a[240:241], v3 offset:128
    ds_read_b64_tr_b16 a[242:243], v3 offset:640
    v_mfma_f32_16x16x32_bf16 v[36:39], a[212:215], v[72:75], v[36:39]
    ds_read_b64_tr_b16 a[244:245], v3 offset:160
    ds_read_b64_tr_b16 a[246:247], v3 offset:672
    v_mfma_f32_16x16x32_bf16 v[36:39], a[216:219], v[76:79], v[36:39]
    ds_read_b64_tr_b16 a[248:249], v3 offset:192
    ds_read_b64_tr_b16 a[250:251], v3 offset:704
    v_mfma_f32_16x16x32_bf16 v[36:39], a[220:223], v[80:83], v[36:39]
    v_exp_f32 v32, v32
    v_mfma_f32_16x16x32_bf16 v[40:43], a[192:195], v[84:87], 0
    v_exp_f32 v33, v33
    v_mfma_f32_16x16x32_bf16 v[40:43], a[196:199], v[88:91], v[40:43]
    v_exp_f32 v34, v34
    v_mfma_f32_16x16x32_bf16 v[40:43], a[200:203], v[92:95], v[40:43]
    v_exp_f32 v35, v35
    v_mfma_f32_16x16x32_bf16 v[40:43], a[204:207], v[96:99], v[40:43]
    v_exp_f32 v36, v36
    v_mfma_f32_16x16x32_bf16 v[44:47], a[208:211], v[84:87], 0
    v_exp_f32 v37, v37
    v_mfma_f32_16x16x32_bf16 v[44:47], a[212:215], v[88:91], v[44:47]
    v_exp_f32 v38, v38
    v_mfma_f32_16x16x32_bf16 v[44:47], a[216:219], v[92:95], v[44:47]
    v_exp_f32 v39, v39
    v_mfma_f32_16x16x32_bf16 v[44:47], a[220:223], v[96:99], v[44:47]
    ds_read_b64_tr_b16 a[252:253], v3 offset:224
    ds_read_b64_tr_b16 a[254:255], v3 offset:736
    v_mfma_f32_16x16x32_bf16 v[48:51], a[192:195], v[100:103], 0
    v_cvt_pk_bf16_f32 v56, v32, v33
    v_cvt_pk_bf16_f32 v57, v34, v35
    v_mfma_f32_16x16x32_bf16 v[48:51], a[196:199], v[104:107], v[48:51]
    v_cvt_pk_bf16_f32 v58, v36, v37
    v_cvt_pk_bf16_f32 v59, v38, v39
    v_mfma_f32_16x16x32_bf16 v[48:51], a[200:203], v[108:111], v[48:51]
    v_exp_f32 v40, v40
    v_mfma_f32_16x16x32_bf16 v[48:51], a[204:207], v[112:115], v[48:51]
    v_exp_f32 v41, v41
    v_mfma_f32_16x16x32_bf16 v[52:55], a[208:211], v[100:103], 0
    v_exp_f32 v42, v42
    v_mfma_f32_16x16x32_bf16 v[52:55], a[212:215], v[104:107], v[52:55]
    v_exp_f32 v43, v43
    v_mfma_f32_16x16x32_bf16 v[52:55], a[216:219], v[108:111], v[52:55]
    v_exp_f32 v44, v44
    v_mfma_f32_16x16x32_bf16 v[52:55], a[220:223], v[112:115], v[52:55]
    s_waitcnt lgkmcnt(0)
    v_exp_f32 v45, v45
    v_mfma_f32_16x16x32_bf16 v[116:119], a[224:227], v[56:59], 0
    v_exp_f32 v46, v46
    v_mfma_f32_16x16x32_bf16 v[120:123], a[228:231], v[56:59], 0
    v_exp_f32 v47, v47
    v_mfma_f32_16x16x32_bf16 v[124:127], a[232:235], v[56:59], 0
    v_cvt_pk_bf16_f32 v60, v40, v41
    v_cvt_pk_bf16_f32 v61, v42, v43
    v_mfma_f32_16x16x32_bf16 v[128:131], a[236:239], v[56:59], 0
    v_cvt_pk_bf16_f32 v62, v44, v45
    v_cvt_pk_bf16_f32 v63, v46, v47
    v_mfma_f32_16x16x32_bf16 v[132:135], a[240:243], v[56:59], 0
    v_exp_f32 v48, v48
    v_mfma_f32_16x16x32_bf16 v[136:139], a[244:247], v[56:59], 0
    v_exp_f32 v49, v49
    v_mfma_f32_16x16x32_bf16 v[140:143], a[248:251], v[56:59], 0
    v_exp_f32 v50, v50
    v_mfma_f32_16x16x32_bf16 v[144:147], a[252:255], v[56:59], 0
    v_exp_f32 v51, v51
    v_mfma_f32_16x16x32_bf16 v[20:23], a[168:171], v[56:59], 0
    v_exp_f32 v52, v52
    v_mfma_f32_16x16x32_bf16 v[148:151], a[224:227], v[60:63], 0
    v_exp_f32 v53, v53
    v_mfma_f32_16x16x32_bf16 v[152:155], a[228:231], v[60:63], 0
    v_exp_f32 v54, v54
    v_mfma_f32_16x16x32_bf16 v[156:159], a[232:235], v[60:63], 0
    v_exp_f32 v55, v55
    v_mfma_f32_16x16x32_bf16 v[160:163], a[236:239], v[60:63], 0
    v_cvt_pk_bf16_f32 v64, v48, v49
    v_cvt_pk_bf16_f32 v65, v50, v51
    v_mfma_f32_16x16x32_bf16 v[164:167], a[240:243], v[60:63], 0
    v_cvt_pk_bf16_f32 v66, v52, v53
    v_cvt_pk_bf16_f32 v67, v54, v55
    v_mfma_f32_16x16x32_bf16 v[168:171], a[244:247], v[60:63], 0
    s_add_u32 s60, s60, 16896
    ds_read_b128 a[192:195], v4 offset:0
    v_mfma_f32_16x16x32_bf16 v[172:175], a[248:251], v[60:63], 0
    s_cmp_ge_u32 s60, s61
    ds_read_b128 a[196:199], v4 offset:64
    v_mfma_f32_16x16x32_bf16 v[176:179], a[252:255], v[60:63], 0
    s_cselect_b32 s60, 0, s60
    ds_read_b128 a[200:203], v4 offset:128
    v_mfma_f32_16x16x32_bf16 v[24:27], a[168:171], v[60:63], 0
    s_sub_u32 s62, s62, 1
    ds_read_b128 a[204:207], v4 offset:192
    v_mfma_f32_16x16x32_bf16 v[180:183], a[224:227], v[64:67], 0
    ds_read_b128 a[208:211], v4 offset:512
    v_mfma_f32_16x16x32_bf16 v[184:187], a[228:231], v[64:67], 0
    ds_read_b128 a[212:215], v4 offset:576
    v_mfma_f32_16x16x32_bf16 v[188:191], a[232:235], v[64:67], 0
    ds_read_b128 a[216:219], v4 offset:640
    v_mfma_f32_16x16x32_bf16 v[192:195], a[236:239], v[64:67], 0
    ds_read_b128 a[220:223], v4 offset:704
    v_mfma_f32_16x16x32_bf16 v[196:199], a[240:243], v[64:67], 0
    v_add_u32 v3, s60, v1
    v_add_u32 v4, s60, v2
    v_mfma_f32_16x16x32_bf16 v[200:203], a[244:247], v[64:67], 0
    v_mfma_f32_16x16x32_bf16 v[204:207], a[248:251], v[64:67], 0
    v_mfma_f32_16x16x32_bf16 v[208:211], a[252:255], v[64:67], 0
    s_cmp_lg_u32 s62, 0
    v_mfma_f32_16x16x32_bf16 v[28:31], a[168:171], v[64:67], 0
    s_waitcnt lgkmcnt(0)
    s_barrier
    s_mov_b32 s62, 25
    .p2align 3
L_c_loop0:
    v_mfma_f32_16x16x32_bf16 v[32:35], a[192:195], v[68:71], 0
    ds_read_b64_tr_b16 a[224:225], v3 offset:0
    ds_read_b64_tr_b16 a[226:227], v3 offset:512
    v_mfma_f32_16x16x32_bf16 v[32:35], a[196:199], v[72:75], v[32:35]
    ds_read_b64_tr_b16 a[228:229], v3 offset:32
    ds_read_b64_tr_b16 a[230:231], v3 offset:544
    v_mfma_f32_16x16x32_bf16 v[32:35], a[200:203], v[76:79], v[32:35]
    ds_read_b64_tr_b16 a[232:233], v3 offset:64
    ds_read_b64_tr_b16 a[234:235], v3 offset:576
    v_mfma_f32_16x16x32_bf16 v[32:35], a[204:207], v[80:83], v[32:35]
    ds_read_b64_tr_b16 a[236:237], v3 offset:96
    ds_read_b64_tr_b16 a[238:239], v3 offset:608
    v_mfma_f32_16x16x32_bf16 v[36:39], a[208:211], v[68:71], 0
    ds_read_b64_tr_b16 a[240:241], v3 offset:128
    ds_read_b64_tr_b16 a[242:243], v3 offset:640
    v_mfma_f32_16x16x32_bf16 v[36:39], a[212:215], v[72:75], v[36:39]
    ds_read_b64_tr_b16 a[244:245], v3 offset:160
    ds_read_b64_tr_b16 a[246:247], v3 offset:672
    v_mfma_f32_16x16x32_bf16 v[36:39], a[216:219], v[76:79], v[36:39]
    ds_read_b64_tr_b16 a[248:249], v3 offset:192
    ds_read_b64_tr_b16 a[250:251], v3 offset:704
    v_mfma_f32_16x16x32_bf16 v[36:39], a[220:223], v[80:83], v[36:39]
    v_exp_f32 v32, v32
    v_mfma_f32_16x16x32_bf16 v[40:43], a[192:195], v[84:87], 0
    v_exp_f32 v33, v33
    v_mfma_f32_16x16x32_bf16 v[40:43], a[196:199], v[88:91], v[40:43]
    v_exp_f32 v34, v34
    v_mfma_f32_16x16x32_bf16 v[40:43], a[200:203], v[92:95], v[40:43]
    v_exp_f32 v35, v35
    v_mfma_f32_16x16x32_bf16 v[40:43], a[204:207], v[96:99], v[40:43]
    v_exp_f32 v36, v36
    v_mfma_f32_16x16x32_bf16 v[44:47], a[208:211], v[84:87], 0
    v_exp_f32 v37, v37
    v_mfma_f32_16x16x32_bf16 v[44:47], a[212:215], v[88:91], v[44:47]
    v_exp_f32 v38, v38
    v_mfma_f32_16x16x32_bf16 v[44:47], a[216:219], v[92:95], v[44:47]
    v_exp_f32 v39, v39
    v_mfma_f32_16x16x32_bf16 v[44:47], a[220:223], v[96:99], v[44:47]
    ds_read_b64_tr_b16 a[252:253], v3 offset:224
    ds_read_b64_tr_b16 a[254:255], v3 offset:736
    v_mfma_f32_16x16x32_bf16 v[48:51], a[192:195], v[100:103], 0
    v_cvt_pk_bf16_f32 v56, v32, v33
    v_cvt_pk_bf16_f32 v57, v34, v35
    v_mfma_f32_16x16x32_bf16 v[48:51], a[196:199], v[104:107], v[48:51]
    v_cvt_pk_bf16_f32 v58, v36, v37
    v_cvt_pk_bf16_f32 v59, v38, v39
    v_mfma_f32_16x16x32_bf16 v[48:51], a[200:203], v[108:111], v[48:51]
    v_exp_f32 v40, v40
    v_mfma_f32_16x16x32_bf16 v[48:51], a[204:207], v[112:115], v[48:51]
    v_exp_f32 v41, v41
    v_mfma_f32_16x16x32_bf16 v[52:55], a[208:211], v[100:103], 0
    v_exp_f32 v42, v42
    v_mfma_f32_16x16x32_bf16 v[52:55], a[212:215], v[104:107], v[52:55]
    v_exp_f32 v43, v43
    v_mfma_f32_16x16x32_bf16 v[52:55], a[216:219], v[108:111], v[52:55]
    v_exp_f32 v44, v44
    v_mfma_f32_16x16x32_bf16 v[52:55], a[220:223], v[112:115], v[52:55]
    s_waitcnt lgkmcnt(0)
    v_exp_f32 v45, v45
    v_mfma_f32_16x16x32_bf16 v[116:119], a[224:227], v[56:59], v[116:119]
    v_exp_f32 v46, v46
    v_mfma_f32_16x16x32_bf16 v[120:123], a[228:231], v[56:59], v[120:123]
    v_exp_f32 v47, v47
    v_mfma_f32_16x16x32_bf16 v[124:127], a[232:235], v[56:59], v[124:127]
    v_cvt_pk_bf16_f32 v60, v40, v41
    v_cvt_pk_bf16_f32 v61, v42, v43
    v_mfma_f32_16x16x32_bf16 v[128:131], a[236:239], v[56:59], v[128:131]
    v_cvt_pk_bf16_f32 v62, v44, v45
    v_cvt_pk_bf16_f32 v63, v46, v47
    v_mfma_f32_16x16x32_bf16 v[132:135], a[240:243], v[56:59], v[132:135]
    v_exp_f32 v48, v48
    v_mfma_f32_16x16x32_bf16 v[136:139], a[244:247], v[56:59], v[136:139]
    v_exp_f32 v49, v49
    v_mfma_f32_16x16x32_bf16 v[140:143], a[248:251], v[56:59], v[140:143]
    v_exp_f32 v50, v50
    v_mfma_f32_16x16x32_bf16 v[144:147], a[252:255], v[56:59], v[144:147]
    v_exp_f32 v51, v51
    v_mfma_f32_16x16x32_bf16 v[20:23], a[168:171], v[56:59], v[20:23]
    v_exp_f32 v52, v52
    v_mfma_f32_16x16x32_bf16 v[148:151], a[224:227], v[60:63], v[148:151]
    v_exp_f32 v53, v53
    v_mfma_f32_16x16x32_bf16 v[152:155], a[228:231], v[60:63], v[152:155]
    v_exp_f32 v54, v54
    v_mfma_f32_16x16x32_bf16 v[156:159], a[232:235], v[60:63], v[156:159]
    v_exp_f32 v55, v55
    v_mfma_f32_16x16x32_bf16 v[160:163], a[236:239], v[60:63], v[160:163]
    v_cvt_pk_bf16_f32 v64, v48, v49
    v_cvt_pk_bf16_f32 v65, v50, v51
    v_mfma_f32_16x16x32_bf16 v[164:167], a[240:243], v[60:63], v[164:167]
    v_cvt_pk_bf16_f32 v66, v52, v53
    v_cvt_pk_bf16_f32 v67, v54, v55
    v_mfma_f32_16x16x32_bf16 v[168:171], a[244:247], v[60:63], v[168:171]
    s_add_u32 s60, s60, 16896
    ds_read_b128 a[192:195], v4 offset:0
    v_mfma_f32_16x16x32_bf16 v[172:175], a[248:251], v[60:63], v[172:175]
    s_cmp_ge_u32 s60, s61
    ds_read_b128 a[196:199], v4 offset:64
    v_mfma_f32_16x16x32_bf16 v[176:179], a[252:255], v[60:63], v[176:179]
    s_cselect_b32 s60, 0, s60
    ds_read_b128 a[200:203], v4 offset:128
    v_mfma_f32_16x16x32_bf16 v[24:27], a[168:171], v[60:63], v[24:27]
    s_sub_u32 s62, s62, 1
    ds_read_b128 a[204:207], v4 offset:192
    v_mfma_f32_16x16x32_bf16 v[180:183], a[224:227], v[64:67], v[180:183]
    ds_read_b128 a[208:211], v4 offset:512
    v_mfma_f32_16x16x32_bf16 v[184:187], a[228:231], v[64:67], v[184:187]
    ds_read_b128 a[212:215], v4 offset:576
    v_mfma_f32_16x16x32_bf16 v[188:191], a[232:235], v[64:67], v[188:191]
    ds_read_b128 a[216:219], v4 offset:640
    v_mfma_f32_16x16x32_bf16 v[192:195], a[236:239], v[64:67], v[192:195]
    ds_read_b128 a[220:223], v4 offset:704
    v_mfma_f32_16x16x32_bf16 v[196:199], a[240:243], v[64:67], v[196:199]
    v_add_u32 v3, s60, v1
    v_add_u32 v4, s60, v2
    v_mfma_f32_16x16x32_bf16 v[200:203], a[244:247], v[64:67], v[200:203]
    v_mfma_f32_16x16x32_bf16 v[204:207], a[248:251], v[64:67], v[204:207]
    v_mfma_f32_16x16x32_bf16 v[208:211], a[252:255], v[64:67], v[208:211]
    s_cmp_lg_u32 s62, 0
    v_mfma_f32_16x16x32_bf16 v[28:31], a[168:171], v[64:67], v[28:31]
    s_waitcnt lgkmcnt(0)
    s_barrier
    s_cbranch_scc1 L_c_loop0
    s_mov_b32 s61, 67584
    s_mov_b32 s62, 6
    .p2align 3
L_c_loop1:
    v_mfma_f32_16x16x32_bf16 v[32:35], a[192:195], v[68:71], 0
    ds_read_b64_tr_b16 a[224:225], v3 offset:0
    ds_read_b64_tr_b16 a[226:227], v3 offset:512
    v_mfma_f32_16x16x32_bf16 v[32:35], a[196:199], v[72:75], v[32:35]
    ds_read_b64_tr_b16 a[228:229], v3 offset:32
    ds_read_b64_tr_b16 a[230:231], v3 offset:544
    v_mfma_f32_16x16x32_bf16 v[32:35], a[200:203], v[76:79], v[32:35]
    ds_read_b64_tr_b16 a[232:233], v3 offset:64
    ds_read_b64_tr_b16 a[234:235], v3 offset:576
    v_mfma_f32_16x16x32_bf16 v[32:35], a[204:207], v[80:83], v[32:35]
    ds_read_b64_tr_b16 a[236:237], v3 offset:96
    ds_read_b64_tr_b16 a[238:239], v3 offset:608
    v_mfma_f32_16x16x32_bf16 v[36:39], a[208:211], v[68:71], 0
    ds_read_b64_tr_b16 a[240:241], v3 offset:128
    ds_read_b64_tr_b16 a[242:243], v3 offset:640
    v_mfma_f32_16x16x32_bf16 v[36:39], a[212:215], v[72:75], v[36:39]
    ds_read_b64_tr_b16 a[244:245], v3 offset:160
    ds_read_b64_tr_b16 a[246:247], v3 offset:672
    v_mfma_f32_16x16x32_bf16 v[36:39], a[216:219], v[76:79], v[36:39]
    ds_read_b64_tr_b16 a[248:249], v3 offset:192
    ds_read_b64_tr_b16 a[250:251], v3 offset:704
    v_mfma_f32_16x16x32_bf16 v[36:39], a[220:223], v[80:83], v[36:39]
    v_exp_f32 v32, v32
    v_mfma_f32_16x16x32_bf16 v[40:43], a[192:195], v[84:87], 0
    v_exp_f32 v33, v33
    v_mfma_f32_16x16x32_bf16 v[40:43], a[196:199], v[88:91], v[40:43]
    v_exp_f32 v34, v34
    v_mfma_f32_16x16x32_bf16 v[40:43], a[200:203], v[92:95], v[40:43]
    v_exp_f32 v35, v35
    v_mfma_f32_16x16x32_bf16 v[40:43], a[204:207], v[96:99], v[40:43]
    v_exp_f32 v36, v36
    v_mfma_f32_16x16x32_bf16 v[44:47], a[208:211], v[84:87], 0
    v_exp_f32 v37, v37
    v_mfma_f32_16x16x32_bf16 v[44:47], a[212:215], v[88:91], v[44:47]
    v_exp_f32 v38, v38
    v_mfma_f32_16x16x32_bf16 v[44:47], a[216:219], v[92:95], v[44:47]
    v_exp_f32 v39, v39
    v_mfma_f32_16x16x32_bf16 v[44:47], a[220:223], v[96:99], v[44:47]
    ds_read_b64_tr_b16 a[252:253], v3 offset:224
    ds_read_b64_tr_b16 a[254:255], v3 offset:736
    v_mfma_f32_16x16x32_bf16 v[48:51], a[192:195], v[100:103], 0
    v_cvt_pk_bf16_f32 v56, v32, v33
    v_cvt_pk_bf16_f32 v57, v34, v35
    v_mfma_f32_16x16x32_bf16 v[48:51], a[196:199], v[104:107], v[48:51]
    v_cvt_pk_bf16_f32 v58, v36, v37
    v_cvt_pk_bf16_f32 v59, v38, v39
    v_mfma_f32_16x16x32_bf16 v[48:51], a[200:203], v[108:111], v[48:51]
    v_exp_f32 v40, v40
    v_mfma_f32_16x16x32_bf16 v[48:51], a[204:207], v[112:115], v[48:51]
    v_exp_f32 v41, v41
    v_mfma_f32_16x16x32_bf16 v[52:55], a[208:211], v[100:103], 0
    v_exp_f32 v42, v42
    v_mfma_f32_16x16x32_bf16 v[52:55], a[212:215], v[104:107], v[52:55]
    v_exp_f32 v43, v43
    v_mfma_f32_16x16x32_bf16 v[52:55], a[216:219], v[108:111], v[52:55]
    v_exp_f32 v44, v44
    v_mfma_f32_16x16x32_bf16 v[52:55], a[220:223], v[112:115], v[52:55]
    s_waitcnt lgkmcnt(0)
    v_exp_f32 v45, v45
    v_mfma_f32_16x16x32_bf16 v[116:119], a[224:227], v[56:59], v[116:119]
    v_exp_f32 v46, v46
    v_mfma_f32_16x16x32_bf16 v[120:123], a[228:231], v[56:59], v[120:123]
    v_exp_f32 v47, v47
    v_mfma_f32_16x16x32_bf16 v[124:127], a[232:235], v[56:59], v[124:127]
    v_cvt_pk_bf16_f32 v60, v40, v41
    v_cvt_pk_bf16_f32 v61, v42, v43
    v_mfma_f32_16x16x32_bf16 v[128:131], a[236:239], v[56:59], v[128:131]
    v_cvt_pk_bf16_f32 v62, v44, v45
    v_cvt_pk_bf16_f32 v63, v46, v47
    v_mfma_f32_16x16x32_bf16 v[132:135], a[240:243], v[56:59], v[132:135]
    v_exp_f32 v48, v48
    v_mfma_f32_16x16x32_bf16 v[136:139], a[244:247], v[56:59], v[136:139]
    v_exp_f32 v49, v49
    v_mfma_f32_16x16x32_bf16 v[140:143], a[248:251], v[56:59], v[140:143]
    v_exp_f32 v50, v50
    v_mfma_f32_16x16x32_bf16 v[144:147], a[252:255], v[56:59], v[144:147]
    v_exp_f32 v51, v51
    v_mfma_f32_16x16x32_bf16 v[20:23], a[168:171], v[56:59], v[20:23]
    v_exp_f32 v52, v52
    v_mfma_f32_16x16x32_bf16 v[148:151], a[224:227], v[60:63], v[148:151]
    v_exp_f32 v53, v53
    v_mfma_f32_16x16x32_bf16 v[152:155], a[228:231], v[60:63], v[152:155]
    v_exp_f32 v54, v54
    v_mfma_f32_16x16x32_bf16 v[156:159], a[232:235], v[60:63], v[156:159]
    v_exp_f32 v55, v55
    v_mfma_f32_16x16x32_bf16 v[160:163], a[236:239], v[60:63], v[160:163]
    v_cvt_pk_bf16_f32 v64, v48, v49
    v_cvt_pk_bf16_f32 v65, v50, v51
    v_mfma_f32_16x16x32_bf16 v[164:167], a[240:243], v[60:63], v[164:167]
    v_cvt_pk_bf16_f32 v66, v52, v53
    v_cvt_pk_bf16_f32 v67, v54, v55
    v_mfma_f32_16x16x32_bf16 v[168:171], a[244:247], v[60:63], v[168:171]
    s_add_u32 s60, s60, 16896
    ds_read_b128 a[192:195], v4 offset:0
    v_mfma_f32_16x16x32_bf16 v[172:175], a[248:251], v[60:63], v[172:175]
    s_cmp_ge_u32 s60, s61
    ds_read_b128 a[196:199], v4 offset:64
    v_mfma_f32_16x16x32_bf16 v[176:179], a[252:255], v[60:63], v[176:179]
    s_cselect_b32 s60, 0, s60
    ds_read_b128 a[200:203], v4 offset:128
    v_mfma_f32_16x16x32_bf16 v[24:27], a[168:171], v[60:63], v[24:27]
    s_sub_u32 s62, s62, 1
    ds_read_b128 a[204:207], v4 offset:192
    v_mfma_f32_16x16x32_bf16 v[180:183], a[224:227], v[64:67], v[180:183]
    ds_read_b128 a[208:211], v4 offset:512
    v_mfma_f32_16x16x32_bf16 v[184:187], a[228:231], v[64:67], v[184:187]
    ds_read_b128 a[212:215], v4 offset:576
    v_mfma_f32_16x16x32_bf16 v[188:191], a[232:235], v[64:67], v[188:191]
    ds_read_b128 a[216:219], v4 offset:640
    v_mfma_f32_16x16x32_bf16 v[192:195], a[236:239], v[64:67], v[192:195]
    ds_read_b128 a[220:223], v4 offset:704
    v_mfma_f32_16x16x32_bf16 v[196:199], a[240:243], v[64:67], v[196:199]
    v_add_u32 v3, s60, v1
    v_add_u32 v4, s60, v2
    v_mfma_f32_16x16x32_bf16 v[200:203], a[244:247], v[64:67], v[200:203]
    v_mfma_f32_16x16x32_bf16 v[204:207], a[248:251], v[64:67], v[204:207]
    v_mfma_f32_16x16x32_bf16 v[208:211], a[252:255], v[64:67], v[208:211]
    s_cmp_lg_u32 s62, 0
    v_mfma_f32_16x16x32_bf16 v[28:31], a[168:171], v[64:67], v[28:31]
    s_waitcnt lgkmcnt(0)
    s_barrier
    s_cbranch_scc1 L_c_loop1
L_trans:
    s_nop 7
    s_mov_b32 s56, 0x35800000
    s_mov_b32 s57, 0x16000000
    v_subrev_u32 v10, s56, v20
    v_subrev_u32 v11, s56, v24
    v_subrev_u32 v6, s56, v28
    v_max3_u32 v10, v10, v11, v6
    v_cmp_lt_u32 vcc, s57, v10
    s_nop 1
    s_cbranch_vccnz L_fb0
L_fbret0:
    s_mul_i32 s56, s52, 6144
    s_add_u32 s56, s56, 136704
    v_add_u32 v6, s56, v5
    ds_read_b128 v[76:79], v6 offset:0
    ds_read_b128 v[80:83], v6 offset:1024
    ds_read_b128 v[92:95], v6 offset:2048
    ds_read_b128 v[96:99], v6 offset:3072
    ds_read_b128 v[108:111], v6 offset:4096
    ds_read_b128 v[112:115], v6 offset:5120
    v_rcp_f32 v10, v20
    s_nop 0
    v_pk_mul_f32 v[116:117], v[116:117], v[10:11] op_sel_hi:[1,0]
    v_pk_mul_f32 v[118:119], v[118:119], v[10:11] op_sel_hi:[1,0]
    v_pk_mul_f32 v[120:121], v[120:121], v[10:11] op_sel_hi:[1,0]
    v_pk_mul_f32 v[122:123], v[122:123], v[10:11] op_sel_hi:[1,0]
    v_cvt_pk_bf16_f32 v16, v116, v117
    v_cvt_pk_bf16_f32 v17, v118, v119
    v_cvt_pk_bf16_f32 v18, v120, v121
    v_cvt_pk_bf16_f32 v19, v122, v123
    v_pk_mul_f32 v[124:125], v[124:125], v[10:11] op_sel_hi:[1,0]
    v_pk_mul_f32 v[126:127], v[126:127], v[10:11] op_sel_hi:[1,0]
    v_pk_mul_f32 v[128:129], v[128:129], v[10:11] op_sel_hi:[1,0]
    v_pk_mul_f32 v[130:131], v[130:131], v[10:11] op_sel_hi:[1,0]
    v_cvt_pk_bf16_f32 v212, v124, v125
    v_cvt_pk_bf16_f32 v213, v126, v127
    v_cvt_pk_bf16_f32 v214, v128, v129
    v_cvt_pk_bf16_f32 v215, v130, v131
    v_pk_mul_f32 v[132:133], v[132:133], v[10:11] op_sel_hi:[1,0]
    v_pk_mul_f32 v[134:135], v[134:135], v[10:11] op_sel_hi:[1,0]
    v_pk_mul_f32 v[136:137], v[136:137], v[10:11] op_sel_hi:[1,0]
    v_pk_mul_f32 v[138:139], v[138:139], v[10:11] op_sel_hi:[1,0]
    v_cvt_pk_bf16_f32 v216, v132, v133
    v_cvt_pk_bf16_f32 v217, v134, v135
    v_cvt_pk_bf16_f32 v218, v136, v137
    v_cvt_pk_bf16_f32 v219, v138, v139
    v_pk_mul_f32 v[140:141], v[140:141], v[10:11] op_sel_hi:[1,0]
    v_pk_mul_f32 v[142:143], v[142:143], v[10:11] op_sel_hi:[1,0]
    v_pk_mul_f32 v[144:145], v[144:145], v[10:11] op_sel_hi:[1,0]
    v_pk_mul_f32 v[146:147], v[146:147], v[10:11] op_sel_hi:[1,0]
    v_cvt_pk_bf16_f32 v220, v140, v141
    v_cvt_pk_bf16_f32 v221, v142, v143
    v_cvt_pk_bf16_f32 v222, v144, v145
    v_cvt_pk_bf16_f32 v223, v146, v147
    v_rcp_f32 v10, v24
    s_nop 0
    v_pk_mul_f32 v[148:149], v[148:149], v[10:11] op_sel_hi:[1,0]
    v_pk_mul_f32 v[150:151], v[150:151], v[10:11] op_sel_hi:[1,0]
    v_pk_mul_f32 v[152:153], v[152:153], v[10:11] op_sel_hi:[1,0]
    v_pk_mul_f32 v[154:155], v[154:155], v[10:11] op_sel_hi:[1,0]
    v_cvt_pk_bf16_f32 v224, v148, v149
    v_cvt_pk_bf16_f32 v225, v150, v151
    v_cvt_pk_bf16_f32 v226, v152, v153
    v_cvt_pk_bf16_f32 v227, v154, v155
    v_pk_mul_f32 v[156:157], v[156:157], v[10:11] op_sel_hi:[1,0]
    v_pk_mul_f32 v[158:159], v[158:159], v[10:11] op_sel_hi:[1,0]
    v_pk_mul_f32 v[160:161], v[160:161], v[10:11] op_sel_hi:[1,0]
    v_pk_mul_f32 v[162:163], v[162:163], v[10:11] op_sel_hi:[1,0]
    v_cvt_pk_bf16_f32 v228, v156, v157
    v_cvt_pk_bf16_f32 v229, v158, v159
    v_cvt_pk_bf16_f32 v230, v160, v161
    v_cvt_pk_bf16_f32 v231, v162, v163
    v_pk_mul_f32 v[164:165], v[164:165], v[10:11] op_sel_hi:[1,0]
    v_pk_mul_f32 v[166:167], v[166:167], v[10:11] op_sel_hi:[1,0]
    v_pk_mul_f32 v[168:169], v[168:169], v[10:11] op_sel_hi:[1,0]
    v_pk_mul_f32 v[170:171], v[170:171], v[10:11] op_sel_hi:[1,0]
    v_cvt_pk_bf16_f32 v232, v164, v165
    v_cvt_pk_bf16_f32 v233, v166, v167
    v_cvt_pk_bf16_f32 v234, v168, v169
    v_cvt_pk_bf16_f32 v235, v170, v171
    v_pk_mul_f32 v[172:173], v[172:173], v[10:11] op_sel_hi:[1,0]
    v_pk_mul_f32 v[174:175], v[174:175], v[10:11] op_sel_hi:[1,0]
    v_pk_mul_f32 v[176:177], v[176:177], v[10:11] op_sel_hi:[1,0]
    v_pk_mul_f32 v[178:179], v[178:179], v[10:11] op_sel_hi:[1,0]
    v_cvt_pk_bf16_f32 v236, v172, v173
    v_cvt_pk_bf16_f32 v237, v174, v175
    v_cvt_pk_bf16_f32 v238, v176, v177
    v_cvt_pk_bf16_f32 v239, v178, v179
    v_rcp_f32 v10, v28
    s_nop 0
    v_pk_mul_f32 v[180:181], v[180:181], v[10:11] op_sel_hi:[1,0]
    v_pk_mul_f32 v[182:183], v[182:183], v[10:11] op_sel_hi:[1,0]
    v_pk_mul_f32 v[184:185], v[184:185], v[10:11] op_sel_hi:[1,0]
    v_pk_mul_f32 v[186:187], v[186:187], v[10:11] op_sel_hi:[1,0]
    v_cvt_pk_bf16_f32 v240, v180, v181
    v_cvt_pk_bf16_f32 v241, v182, v183
    v_cvt_pk_bf16_f32 v242, v184, v185
    v_cvt_pk_bf16_f32 v243, v186, v187
    v_pk_mul_f32 v[188:189], v[188:189], v[10:11] op_sel_hi:[1,0]
    v_pk_mul_f32 v[190:191], v[190:191], v[10:11] op_sel_hi:[1,0]
    v_pk_mul_f32 v[192:193], v[192:193], v[10:11] op_sel_hi:[1,0]
    v_pk_mul_f32 v[194:195], v[194:195], v[10:11] op_sel_hi:[1,0]
    v_cvt_pk_bf16_f32 v244, v188, v189
    v_cvt_pk_bf16_f32 v245, v190, v191
    v_cvt_pk_bf16_f32 v246, v192, v193
    v_cvt_pk_bf16_f32 v247, v194, v195
    v_pk_mul_f32 v[196:197], v[196:197], v[10:11] op_sel_hi:[1,0]
    v_pk_mul_f32 v[198:199], v[198:199], v[10:11] op_sel_hi:[1,0]
    v_pk_mul_f32 v[200:201], v[200:201], v[10:11] op_sel_hi:[1,0]
    v_pk_mul_f32 v[202:203], v[202:203], v[10:11] op_sel_hi:[1,0]
    v_cvt_pk_bf16_f32 v248, v196, v197
    v_cvt_pk_bf16_f32 v249, v198, v199
    v_cvt_pk_bf16_f32 v250, v200, v201
    v_cvt_pk_bf16_f32 v251, v202, v203
    v_pk_mul_f32 v[204:205], v[204:205], v[10:11] op_sel_hi:[1,0]
    v_pk_mul_f32 v[206:207], v[206:207], v[10:11] op_sel_hi:[1,0]
    v_pk_mul_f32 v[208:209], v[208:209], v[10:11] op_sel_hi:[1,0]
    v_pk_mul_f32 v[210:211], v[210:211], v[10:11] op_sel_hi:[1,0]
    v_cvt_pk_bf16_f32 v252, v204, v205
    v_cvt_pk_bf16_f32 v253, v206, v207
    v_cvt_pk_bf16_f32 v254, v208, v209
    v_cvt_pk_bf16_f32 v255, v210, v211
    v_accvgpr_read_b32 v32, a120
    v_accvgpr_read_b32 v33, a121
    v_accvgpr_read_b32 v34, a122
    v_accvgpr_read_b32 v35, a123
    v_accvgpr_read_b32 v36, a124
    v_accvgpr_read_b32 v37, a125
    v_accvgpr_read_b32 v38, a126
    v_accvgpr_read_b32 v39, a127
    v_accvgpr_read_b32 v40, a128
    v_accvgpr_read_b32 v41, a129
    v_accvgpr_read_b32 v42, a130
    v_accvgpr_read_b32 v43, a131
    v_accvgpr_read_b32 v44, a132
    v_accvgpr_read_b32 v45, a133
    v_accvgpr_read_b32 v46, a134
    v_accvgpr_read_b32 v47, a135
    v_pk_mul_f32 v[32:33], v[32:33], v[14:15]
    v_pk_mul_f32 v[34:35], v[34:35], v[14:15]
    v_pk_mul_f32 v[36:37], v[36:37], v[14:15]
    v_pk_mul_f32 v[38:39], v[38:39], v[14:15]
    v_cvt_pk_bf16_f32 v68, v32, v33
    v_cvt_pk_bf16_f32 v69, v34, v35
    v_cvt_pk_bf16_f32 v70, v36, v37
    v_cvt_pk_bf16_f32 v71, v38, v39
    v_pk_mul_f32 v[40:41], v[40:41], v[14:15]
    v_pk_mul_f32 v[42:43], v[42:43], v[14:15]
    v_pk_mul_f32 v[44:45], v[44:45], v[14:15]
    v_pk_mul_f32 v[46:47], v[46:47], v[14:15]
    v_cvt_pk_bf16_f32 v72, v40, v41
    v_cvt_pk_bf16_f32 v73, v42, v43
    v_cvt_pk_bf16_f32 v74, v44, v45
    v_cvt_pk_bf16_f32 v75, v46, v47
    s_nop 1
    v_permlane32_swap_b32 v68, v70
    v_permlane32_swap_b32 v69, v71
    v_permlane32_swap_b32 v72, v74
    v_permlane32_swap_b32 v73, v75
    v_permlane16_swap_b32 v68, v70
    v_permlane16_swap_b32 v69, v71
    v_permlane16_swap_b32 v72, v74
    v_permlane16_swap_b32 v73, v75
    s_nop 1
    v_accvgpr_read_b32 v32, a136
    v_accvgpr_read_b32 v33, a137
    v_accvgpr_read_b32 v34, a138
    v_accvgpr_read_b32 v35, a139
    v_accvgpr_read_b32 v36, a140
    v_accvgpr_read_b32 v37, a141
    v_accvgpr_read_b32 v38, a142
    v_accvgpr_read_b32 v39, a143
    v_accvgpr_read_b32 v40, a144
    v_accvgpr_read_b32 v41, a145
    v_accvgpr_read_b32 v42, a146
    v_accvgpr_read_b32 v43, a147
    v_accvgpr_read_b32 v44, a148
    v_accvgpr_read_b32 v45, a149
    v_accvgpr_read_b32 v46, a150
    v_accvgpr_read_b32 v47, a151
    v_pk_mul_f32 v[32:33], v[32:33], v[14:15]
    v_pk_mul_f32 v[34:35], v[34:35], v[14:15]
    v_pk_mul_f32 v[36:37], v[36:37], v[14:15]
    v_pk_mul_f32 v[38:39], v[38:39], v[14:15]
    v_cvt_pk_bf16_f32 v84, v32, v33
    v_cvt_pk_bf16_f32 v85, v34, v35
    v_cvt_pk_bf16_f32 v86, v36, v37
    v_cvt_pk_bf16_f32 v87, v38, v39
    v_pk_mul_f32 v[40:41], v[40:41], v[14:15]
    v_pk_mul_f32 v[42:43], v[42:43], v[14:15]
    v_pk_mul_f32 v[44:45], v[44:45], v[14:15]
    v_pk_mul_f32 v[46:47], v[46:47], v[14:15]
    v_cvt_pk_bf16_f32 v88, v40, v41
    v_cvt_pk_bf16_f32 v89, v42, v43
    v_cvt_pk_bf16_f32 v90, v44, v45
    v_cvt_pk_bf16_f32 v91, v46, v47
    s_nop 1
    v_permlane32_swap_b32 v84, v86
    v_permlane32_swap_b32 v85, v87
    v_permlane32_swap_b32 v88, v90
    v_permlane32_swap_b32 v89, v91
    v_permlane16_swap_b32 v84, v86
    v_permlane16_swap_b32 v85, v87
    v_permlane16_swap_b32 v88, v90
    v_permlane16_swap_b32 v89, v91
    s_nop 1
    v_accvgpr_read_b32 v32, a152
    v_accvgpr_read_b32 v33, a153
    v_accvgpr_read_b32 v34, a154
    v_accvgpr_read_b32 v35, a155
    v_accvgpr_read_b32 v36, a156
    v_accvgpr_read_b32 v37, a157
    v_accvgpr_read_b32 v38, a158
    v_accvgpr_read_b32 v39, a159
    v_accvgpr_read_b32 v40, a160
    v_accvgpr_read_b32 v41, a161
    v_accvgpr_read_b32 v42, a162
    v_accvgpr_read_b32 v43, a163
    v_accvgpr_read_b32 v44, a164
    v_accvgpr_read_b32 v45, a165
    v_accvgpr_read_b32 v46, a166
    v_accvgpr_read_b32 v47, a167
    v_pk_mul_f32 v[32:33], v[32:33], v[14:15]
    v_pk_mul_f32 v[34:35], v[34:35], v[14:15]
    v_pk_mul_f32 v[36:37], v[36:37], v[14:15]
    v_pk_mul_f32 v[38:39], v[38:39], v[14:15]
    v_cvt_pk_bf16_f32 v100, v32, v33
    v_cvt_pk_bf16_f32 v101, v34, v35
    v_cvt_pk_bf16_f32 v102, v36, v37
    v_cvt_pk_bf16_f32 v103, v38, v39
    v_pk_mul_f32 v[40:41], v[40:41], v[14:15]
    v_pk_mul_f32 v[42:43], v[42:43], v[14:15]
    v_pk_mul_f32 v[44:45], v[44:45], v[14:15]
    v_pk_mul_f32 v[46:47], v[46:47], v[14:15]
    v_cvt_pk_bf16_f32 v104, v40, v41
    v_cvt_pk_bf16_f32 v105, v42, v43
    v_cvt_pk_bf16_f32 v106, v44, v45
    v_cvt_pk_bf16_f32 v107, v46, v47
    s_nop 1
    v_permlane32_swap_b32 v100, v102
    v_permlane32_swap_b32 v101, v103
    v_permlane32_swap_b32 v104, v106
    v_permlane32_swap_b32 v105, v107
    v_permlane16_swap_b32 v100, v102
    v_permlane16_swap_b32 v101, v103
    v_permlane16_swap_b32 v104, v106
    v_permlane16_swap_b32 v105, v107
    s_nop 1
    v_bfe_u32 v10, v0, 2, 2
    v_lshrrev_b32 v11, 4, v0
    v_cmp_eq_u32 vcc, v10, v11
    v_and_b32 v10, 1, v0
    v_lshlrev_b32 v10, 4, v10
    v_mov_b32 v11, 0x3f80
    v_lshlrev_b32 v11, v10, v11
    v_cndmask_b32 v11, 0, v11, vcc
    v_and_b32 v10, 2, v0
    v_cmp_eq_u32 vcc, 0, v10
    s_nop 1
    v_cndmask_b32 v14, 0, v11, vcc
    v_sub_u32 v15, v11, v14
    s_mul_i32 s56, s52, 24576
    s_add_u32 s56, s56, 67584
    s_waitcnt lgkmcnt(0)
    v_add_u32 v6, s56, v5
    s_waitcnt lgkmcnt(0)
    v_mfma_f32_16x16x32_bf16 v[32:35], a[192:195], v[68:71], 0
    ds_read_b64_tr_b16 a[224:225], v3 offset:0
    ds_read_b64_tr_b16 a[226:227], v3 offset:512
    v_mfma_f32_16x16x32_bf16 v[32:35], a[196:199], v[72:75], v[32:35]
    ds_read_b64_tr_b16 a[228:229], v3 offset:32
    ds_read_b64_tr_b16 a[230:231], v3 offset:544
    v_mfma_f32_16x16x32_bf16 v[32:35], a[200:203], v[76:79], v[32:35]
    ds_read_b64_tr_b16 a[232:233], v3 offset:64
    ds_read_b64_tr_b16 a[234:235], v3 offset:576
    v_mfma_f32_16x16x32_bf16 v[32:35], a[204:207], v[80:83], v[32:35]
    ds_read_b64_tr_b16 a[236:237], v3 offset:96
    ds_read_b64_tr_b16 a[238:239], v3 offset:608
    v_mfma_f32_16x16x32_bf16 v[36:39], a[208:211], v[68:71], 0
    ds_read_b64_tr_b16 a[240:241], v3 offset:128
    ds_read_b64_tr_b16 a[242:243], v3 offset:640
    v_mfma_f32_16x16x32_bf16 v[36:39], a[212:215], v[72:75], v[36:39]
    ds_read_b64_tr_b16 a[244:245], v3 offset:160
    ds_read_b64_tr_b16 a[246:247], v3 offset:672
    v_mfma_f32_16x16x32_bf16 v[36:39], a[216:219], v[76:79], v[36:39]
    ds_read_b64_tr_b16 a[248:249], v3 offset:192
    ds_read_b64_tr_b16 a[250:251], v3 offset:704
    v_mfma_f32_16x16x32_bf16 v[36:39], a[220:223], v[80:83], v[36:39]
    v_exp_f32 v32, v32
    v_mfma_f32_16x16x32_bf16 v[40:43], a[192:195], v[84:87], 0
    v_exp_f32 v33, v33
    v_mfma_f32_16x16x32_bf16 v[40:43], a[196:199], v[88:91], v[40:43]
    v_exp_f32 v34, v34
    v_mfma_f32_16x16x32_bf16 v[40:43], a[200:203], v[92:95], v[40:43]
    v_exp_f32 v35, v35
    v_mfma_f32_16x16x32_bf16 v[40:43], a[204:207], v[96:99], v[40:43]
    v_exp_f32 v36, v36
    v_mfma_f32_16x16x32_bf16 v[44:47], a[208:211], v[84:87], 0
    v_exp_f32 v37, v37
    v_mfma_f32_16x16x32_bf16 v[44:47], a[212:215], v[88:91], v[44:47]
    v_exp_f32 v38, v38
    v_mfma_f32_16x16x32_bf16 v[44:47], a[216:219], v[92:95], v[44:47]
    v_exp_f32 v39, v39
    v_mfma_f32_16x16x32_bf16 v[44:47], a[220:223], v[96:99], v[44:47]
    ds_read_b64_tr_b16 a[252:253], v3 offset:224
    ds_read_b64_tr_b16 a[254:255], v3 offset:736
    v_mfma_f32_16x16x32_bf16 v[48:51], a[192:195], v[100:103], 0
    v_cvt_pk_bf16_f32 v56, v32, v33
    v_cvt_pk_bf16_f32 v57, v34, v35
    v_mfma_f32_16x16x32_bf16 v[48:51], a[196:199], v[104:107], v[48:51]
    v_cvt_pk_bf16_f32 v58, v36, v37
    v_cvt_pk_bf16_f32 v59, v38, v39
    v_mfma_f32_16x16x32_bf16 v[48:51], a[200:203], v[108:111], v[48:51]
    v_exp_f32 v40, v40
    v_mfma_f32_16x16x32_bf16 v[48:51], a[204:207], v[112:115], v[48:51]
    v_exp_f32 v41, v41
    v_mfma_f32_16x16x32_bf16 v[52:55], a[208:211], v[100:103], 0
    v_exp_f32 v42, v42
    v_mfma_f32_16x16x32_bf16 v[52:55], a[212:215], v[104:107], v[52:55]
    v_exp_f32 v43, v43
    v_mfma_f32_16x16x32_bf16 v[52:55], a[216:219], v[108:111], v[52:55]
    v_exp_f32 v44, v44
    v_mfma_f32_16x16x32_bf16 v[52:55], a[220:223], v[112:115], v[52:55]
    s_waitcnt lgkmcnt(0)
    v_exp_f32 v45, v45
    v_mfma_f32_16x16x32_bf16 v[116:119], a[224:227], v[56:59], 0
    v_exp_f32 v46, v46
    v_mfma_f32_16x16x32_bf16 v[120:123], a[228:231], v[56:59], 0
    v_exp_f32 v47, v47
    v_mfma_f32_16x16x32_bf16 v[124:127], a[232:235], v[56:59], 0
    v_cvt_pk_bf16_f32 v60, v40, v41
    v_cvt_pk_bf16_f32 v61, v42, v43
    v_mfma_f32_16x16x32_bf16 v[128:131], a[236:239], v[56:59], 0
    v_cvt_pk_bf16_f32 v62, v44, v45
    v_cvt_pk_bf16_f32 v63, v46, v47
    v_mfma_f32_16x16x32_bf16 v[132:135], a[240:243], v[56:59], 0
    v_exp_f32 v48, v48
    v_mfma_f32_16x16x32_bf16 v[136:139], a[244:247], v[56:59], 0
    v_exp_f32 v49, v49
    v_mfma_f32_16x16x32_bf16 v[140:143], a[248:251], v[56:59], 0
    v_exp_f32 v50, v50
    v_mfma_f32_16x16x32_bf16 v[144:147], a[252:255], v[56:59], 0
    v_exp_f32 v51, v51
    v_mfma_f32_16x16x32_bf16 v[20:23], a[168:171], v[56:59], 0
    v_exp_f32 v52, v52
    v_mfma_f32_16x16x32_bf16 v[148:151], a[224:227], v[60:63], 0
    v_exp_f32 v53, v53
    v_mfma_f32_16x16x32_bf16 v[152:155], a[228:231], v[60:63], 0
    v_exp_f32 v54, v54
    v_mfma_f32_16x16x32_bf16 v[156:159], a[232:235], v[60:63], 0
    v_exp_f32 v55, v55
    v_mfma_f32_16x16x32_bf16 v[160:163], a[236:239], v[60:63], 0
    v_cvt_pk_bf16_f32 v64, v48, v49
    v_cvt_pk_bf16_f32 v65, v50, v51
    v_mfma_f32_16x16x32_bf16 v[164:167], a[240:243], v[60:63], 0
    v_cvt_pk_bf16_f32 v66, v52, v53
    v_cvt_pk_bf16_f32 v67, v54, v55
    v_mfma_f32_16x16x32_bf16 v[168:171], a[244:247], v[60:63], 0
    s_add_u32 s60, s60, 16896
    ds_read_b128 a[192:195], v4 offset:0
    v_mfma_f32_16x16x32_bf16 v[172:175], a[248:251], v[60:63], 0
    s_cmp_ge_u32 s60, s61
    ds_read_b128 a[196:199], v4 offset:64
    v_mfma_f32_16x16x32_bf16 v[176:179], a[252:255], v[60:63], 0
    s_cselect_b32 s60, 0, s60
    ds_read_b128 a[200:203], v4 offset:128
    v_mfma_f32_16x16x32_bf16 v[24:27], a[168:171], v[60:63], 0
    s_sub_u32 s62, s62, 1
    ds_read_b128 a[204:207], v4 offset:192
    s_add_u32 s57, s68, 0
    v_mfma_f32_16x16x32_bf16 v[180:183], a[224:227], v[64:67], 0
    ds_read_b128 a[208:211], v4 offset:512
    buffer_store_dwordx4 v[16:19], v5, s[40:43], s57 offen offset:0 sc1
    v_mfma_f32_16x16x32_bf16 v[184:187], a[228:231], v[64:67], 0
    ds_read_b128 a[212:215], v4 offset:576
    buffer_store_dwordx4 v[212:215], v5, s[40:43], s57 offen offset:1024 sc1
    v_mfma_f32_16x16x32_bf16 v[188:191], a[232:235], v[64:67], 0
    ds_read_b128 a[216:219], v4 offset:640
    buffer_store_dwordx4 v[216:219], v5, s[40:43], s57 offen offset:2048 sc1
    v_mfma_f32_16x16x32_bf16 v[192:195], a[236:239], v[64:67], 0
    ds_read_b128 a[220:223], v4 offset:704
    buffer_store_dwordx4 v[220:223], v5, s[40:43], s57 offen offset:3072 sc1
    v_mfma_f32_16x16x32_bf16 v[196:199], a[240:243], v[64:67], 0
    v_add_u32 v3, s60, v1
    v_add_u32 v4, s60, v2
    s_add_u32 s57, s68, 4096
    v_mfma_f32_16x16x32_bf16 v[200:203], a[244:247], v[64:67], 0
    buffer_store_dwordx4 v[224:227], v5, s[40:43], s57 offen offset:0 sc1
    v_mfma_f32_16x16x32_bf16 v[204:207], a[248:251], v[64:67], 0
    buffer_store_dwordx4 v[228:231], v5, s[40:43], s57 offen offset:1024 sc1
    v_mfma_f32_16x16x32_bf16 v[208:211], a[252:255], v[64:67], 0
    s_cmp_lg_u32 s62, 0
    v_mfma_f32_16x16x32_bf16 v[28:31], a[168:171], v[64:67], 0
    s_waitcnt lgkmcnt(0)
    s_barrier
    v_mfma_f32_16x16x32_bf16 v[32:35], a[192:195], v[68:71], 0
    ds_read_b64_tr_b16 a[224:225], v3 offset:0
    ds_read_b64_tr_b16 a[226:227], v3 offset:512
    v_mfma_f32_16x16x32_bf16 v[32:35], a[196:199], v[72:75], v[32:35]
    ds_read_b64_tr_b16 a[228:229], v3 offset:32
    ds_read_b64_tr_b16 a[230:231], v3 offset:544
    v_mfma_f32_16x16x32_bf16 v[32:35], a[200:203], v[76:79], v[32:35]
    ds_read_b64_tr_b16 a[232:233], v3 offset:64
    ds_read_b64_tr_b16 a[234:235], v3 offset:576
    v_mfma_f32_16x16x32_bf16 v[32:35], a[204:207], v[80:83], v[32:35]
    ds_read_b64_tr_b16 a[236:237], v3 offset:96
    ds_read_b64_tr_b16 a[238:239], v3 offset:608
    v_mfma_f32_16x16x32_bf16 v[36:39], a[208:211], v[68:71], 0
    ds_read_b64_tr_b16 a[240:241], v3 offset:128
    ds_read_b64_tr_b16 a[242:243], v3 offset:640
    v_mfma_f32_16x16x32_bf16 v[36:39], a[212:215], v[72:75], v[36:39]
    ds_read_b64_tr_b16 a[244:245], v3 offset:160
    ds_read_b64_tr_b16 a[246:247], v3 offset:672
    v_mfma_f32_16x16x32_bf16 v[36:39], a[216:219], v[76:79], v[36:39]
    ds_read_b64_tr_b16 a[248:249], v3 offset:192
    ds_read_b64_tr_b16 a[250:251], v3 offset:704
    v_mfma_f32_16x16x32_bf16 v[36:39], a[220:223], v[80:83], v[36:39]
    v_exp_f32 v32, v32
    v_mfma_f32_16x16x32_bf16 v[40:43], a[192:195], v[84:87], 0
    v_exp_f32 v33, v33
    v_mfma_f32_16x16x32_bf16 v[40:43], a[196:199], v[88:91], v[40:43]
    v_exp_f32 v34, v34
    v_mfma_f32_16x16x32_bf16 v[40:43], a[200:203], v[92:95], v[40:43]
    v_exp_f32 v35, v35
    v_mfma_f32_16x16x32_bf16 v[40:43], a[204:207], v[96:99], v[40:43]
    v_exp_f32 v36, v36
    v_mfma_f32_16x16x32_bf16 v[44:47], a[208:211], v[84:87], 0
    v_exp_f32 v37, v37
    v_mfma_f32_16x16x32_bf16 v[44:47], a[212:215], v[88:91], v[44:47]
    v_exp_f32 v38, v38
    v_mfma_f32_16x16x32_bf16 v[44:47], a[216:219], v[92:95], v[44:47]
    v_exp_f32 v39, v39
    v_mfma_f32_16x16x32_bf16 v[44:47], a[220:223], v[96:99], v[44:47]
    ds_read_b64_tr_b16 a[252:253], v3 offset:224
    ds_read_b64_tr_b16 a[254:255], v3 offset:736
    v_mfma_f32_16x16x32_bf16 v[48:51], a[192:195], v[100:103], 0
    v_cvt_pk_bf16_f32 v56, v32, v33
    v_cvt_pk_bf16_f32 v57, v34, v35
    v_mfma_f32_16x16x32_bf16 v[48:51], a[196:199], v[104:107], v[48:51]
    v_cvt_pk_bf16_f32 v58, v36, v37
    v_cvt_pk_bf16_f32 v59, v38, v39
    v_mfma_f32_16x16x32_bf16 v[48:51], a[200:203], v[108:111], v[48:51]
    v_exp_f32 v40, v40
    v_mfma_f32_16x16x32_bf16 v[48:51], a[204:207], v[112:115], v[48:51]
    v_exp_f32 v41, v41
    v_mfma_f32_16x16x32_bf16 v[52:55], a[208:211], v[100:103], 0
    v_exp_f32 v42, v42
    v_mfma_f32_16x16x32_bf16 v[52:55], a[212:215], v[104:107], v[52:55]
    v_exp_f32 v43, v43
    v_mfma_f32_16x16x32_bf16 v[52:55], a[216:219], v[108:111], v[52:55]
    v_exp_f32 v44, v44
    v_mfma_f32_16x16x32_bf16 v[52:55], a[220:223], v[112:115], v[52:55]
    s_waitcnt lgkmcnt(0)
    v_exp_f32 v45, v45
    v_mfma_f32_16x16x32_bf16 v[116:119], a[224:227], v[56:59], v[116:119]
    v_exp_f32 v46, v46
    v_mfma_f32_16x16x32_bf16 v[120:123], a[228:231], v[56:59], v[120:123]
    v_exp_f32 v47, v47
    v_mfma_f32_16x16x32_bf16 v[124:127], a[232:235], v[56:59], v[124:127]
    v_cvt_pk_bf16_f32 v60, v40, v41
    v_cvt_pk_bf16_f32 v61, v42, v43
    v_mfma_f32_16x16x32_bf16 v[128:131], a[236:239], v[56:59], v[128:131]
    v_cvt_pk_bf16_f32 v62, v44, v45
    v_cvt_pk_bf16_f32 v63, v46, v47
    v_mfma_f32_16x16x32_bf16 v[132:135], a[240:243], v[56:59], v[132:135]
    v_exp_f32 v48, v48
    v_mfma_f32_16x16x32_bf16 v[136:139], a[244:247], v[56:59], v[136:139]
    v_exp_f32 v49, v49
    v_mfma_f32_16x16x32_bf16 v[140:143], a[248:251], v[56:59], v[140:143]
    v_exp_f32 v50, v50
    v_mfma_f32_16x16x32_bf16 v[144:147], a[252:255], v[56:59], v[144:147]
    v_exp_f32 v51, v51
    v_mfma_f32_16x16x32_bf16 v[20:23], a[168:171], v[56:59], v[20:23]
    v_exp_f32 v52, v52
    v_mfma_f32_16x16x32_bf16 v[148:151], a[224:227], v[60:63], v[148:151]
    v_exp_f32 v53, v53
    v_mfma_f32_16x16x32_bf16 v[152:155], a[228:231], v[60:63], v[152:155]
    v_exp_f32 v54, v54
    v_mfma_f32_16x16x32_bf16 v[156:159], a[232:235], v[60:63], v[156:159]
    v_exp_f32 v55, v55
    v_mfma_f32_16x16x32_bf16 v[160:163], a[236:239], v[60:63], v[160:163]
    v_cvt_pk_bf16_f32 v64, v48, v49
    v_cvt_pk_bf16_f32 v65, v50, v51
    v_mfma_f32_16x16x32_bf16 v[164:167], a[240:243], v[60:63], v[164:167]
    v_cvt_pk_bf16_f32 v66, v52, v53
    v_cvt_pk_bf16_f32 v67, v54, v55
    v_mfma_f32_16x16x32_bf16 v[168:171], a[244:247], v[60:63], v[168:171]
    s_add_u32 s60, s60, 16896
    ds_read_b128 a[192:195], v4 offset:0
    v_mfma_f32_16x16x32_bf16 v[172:175], a[248:251], v[60:63], v[172:175]
    s_cmp_ge_u32 s60, s61
    ds_read_b128 a[196:199], v4 offset:64
    v_mfma_f32_16x16x32_bf16 v[176:179], a[252:255], v[60:63], v[176:179]
    s_cselect_b32 s60, 0, s60
    ds_read_b128 a[200:203], v4 offset:128
    v_mfma_f32_16x16x32_bf16 v[24:27], a[168:171], v[60:63], v[24:27]
    s_sub_u32 s62, s62, 1
    ds_read_b128 a[204:207], v4 offset:192
    s_add_u32 s57, s68, 4096
    v_mfma_f32_16x16x32_bf16 v[180:183], a[224:227], v[64:67], v[180:183]
    ds_read_b128 a[208:211], v4 offset:512
    buffer_store_dwordx4 v[232:235], v5, s[40:43], s57 offen offset:2048 sc1
    v_mfma_f32_16x16x32_bf16 v[184:187], a[228:231], v[64:67], v[184:187]
    ds_read_b128 a[212:215], v4 offset:576
    buffer_store_dwordx4 v[236:239], v5, s[40:43], s57 offen offset:3072 sc1
    s_add_u32 s57, s68, 8192
    v_mfma_f32_16x16x32_bf16 v[188:191], a[232:235], v[64:67], v[188:191]
    ds_read_b128 a[216:219], v4 offset:640
    buffer_store_dwordx4 v[240:243], v5, s[40:43], s57 offen offset:0 sc1
    v_mfma_f32_16x16x32_bf16 v[192:195], a[236:239], v[64:67], v[192:195]
    ds_read_b128 a[220:223], v4 offset:704
    buffer_store_dwordx4 v[244:247], v5, s[40:43], s57 offen offset:1024 sc1
    v_mfma_f32_16x16x32_bf16 v[196:199], a[240:243], v[64:67], v[196:199]
    v_add_u32 v3, s60, v1
    v_add_u32 v4, s60, v2
    v_mfma_f32_16x16x32_bf16 v[200:203], a[244:247], v[64:67], v[200:203]
    buffer_store_dwordx4 v[248:251], v5, s[40:43], s57 offen offset:2048 sc1
    v_mfma_f32_16x16x32_bf16 v[204:207], a[248:251], v[64:67], v[204:207]
    buffer_store_dwordx4 v[252:255], v5, s[40:43], s57 offen offset:3072 sc1
    v_mfma_f32_16x16x32_bf16 v[208:211], a[252:255], v[64:67], v[208:211]
    s_cmp_lg_u32 s62, 0
    v_mfma_f32_16x16x32_bf16 v[28:31], a[168:171], v[64:67], v[28:31]
    s_waitcnt lgkmcnt(0)
    s_barrier
    v_mfma_f32_16x16x32_bf16 v[32:35], a[192:195], v[68:71], 0
    ds_read_b64_tr_b16 a[224:225], v3 offset:0
    ds_read_b64_tr_b16 a[226:227], v3 offset:512
    v_mfma_f32_16x16x32_bf16 v[32:35], a[196:199], v[72:75], v[32:35]
    ds_read_b64_tr_b16 a[228:229], v3 offset:32
    ds_read_b64_tr_b16 a[230:231], v3 offset:544
    v_mfma_f32_16x16x32_bf16 v[32:35], a[200:203], v[76:79], v[32:35]
    ds_read_b64_tr_b16 a[232:233], v3 offset:64
    ds_read_b64_tr_b16 a[234:235], v3 offset:576
    v_mfma_f32_16x16x32_bf16 v[32:35], a[204:207], v[80:83], v[32:35]
    ds_read_b64_tr_b16 a[236:237], v3 offset:96
    ds_read_b64_tr_b16 a[238:239], v3 offset:608
    v_mfma_f32_16x16x32_bf16 v[36:39], a[208:211], v[68:71], 0
    ds_read_b64_tr_b16 a[240:241], v3 offset:128
    ds_read_b64_tr_b16 a[242:243], v3 offset:640
    v_mfma_f32_16x16x32_bf16 v[36:39], a[212:215], v[72:75], v[36:39]
    ds_read_b64_tr_b16 a[244:245], v3 offset:160
    ds_read_b64_tr_b16 a[246:247], v3 offset:672
    v_mfma_f32_16x16x32_bf16 v[36:39], a[216:219], v[76:79], v[36:39]
    ds_read_b64_tr_b16 a[248:249], v3 offset:192
    ds_read_b64_tr_b16 a[250:251], v3 offset:704
    v_mfma_f32_16x16x32_bf16 v[36:39], a[220:223], v[80:83], v[36:39]
    v_exp_f32 v32, v32
    v_mfma_f32_16x16x32_bf16 v[40:43], a[192:195], v[84:87], 0
    v_exp_f32 v33, v33
    v_mfma_f32_16x16x32_bf16 v[40:43], a[196:199], v[88:91], v[40:43]
    v_exp_f32 v34, v34
    v_mfma_f32_16x16x32_bf16 v[40:43], a[200:203], v[92:95], v[40:43]
    v_exp_f32 v35, v35
    v_mfma_f32_16x16x32_bf16 v[40:43], a[204:207], v[96:99], v[40:43]
    v_exp_f32 v36, v36
    v_mfma_f32_16x16x32_bf16 v[44:47], a[208:211], v[84:87], 0
    v_exp_f32 v37, v37
    v_mfma_f32_16x16x32_bf16 v[44:47], a[212:215], v[88:91], v[44:47]
    v_exp_f32 v38, v38
    v_mfma_f32_16x16x32_bf16 v[44:47], a[216:219], v[92:95], v[44:47]
    v_exp_f32 v39, v39
    v_mfma_f32_16x16x32_bf16 v[44:47], a[220:223], v[96:99], v[44:47]
    ds_read_b64_tr_b16 a[252:253], v3 offset:224
    ds_read_b64_tr_b16 a[254:255], v3 offset:736
    v_mfma_f32_16x16x32_bf16 v[48:51], a[192:195], v[100:103], 0
    v_cvt_pk_bf16_f32 v56, v32, v33
    v_cvt_pk_bf16_f32 v57, v34, v35
    v_mfma_f32_16x16x32_bf16 v[48:51], a[196:199], v[104:107], v[48:51]
    v_cvt_pk_bf16_f32 v58, v36, v37
    v_cvt_pk_bf16_f32 v59, v38, v39
    v_mfma_f32_16x16x32_bf16 v[48:51], a[200:203], v[108:111], v[48:51]
    v_exp_f32 v40, v40
    v_mfma_f32_16x16x32_bf16 v[48:51], a[204:207], v[112:115], v[48:51]
    v_exp_f32 v41, v41
    v_mfma_f32_16x16x32_bf16 v[52:55], a[208:211], v[100:103], 0
    v_exp_f32 v42, v42
    v_mfma_f32_16x16x32_bf16 v[52:55], a[212:215], v[104:107], v[52:55]
    v_exp_f32 v43, v43
    v_mfma_f32_16x16x32_bf16 v[52:55], a[216:219], v[108:111], v[52:55]
    v_exp_f32 v44, v44
    v_mfma_f32_16x16x32_bf16 v[52:55], a[220:223], v[112:115], v[52:55]
    s_waitcnt lgkmcnt(0)
    v_exp_f32 v45, v45
    v_mfma_f32_16x16x32_bf16 v[116:119], a[224:227], v[56:59], v[116:119]
    v_exp_f32 v46, v46
    v_mfma_f32_16x16x32_bf16 v[120:123], a[228:231], v[56:59], v[120:123]
    v_exp_f32 v47, v47
    v_mfma_f32_16x16x32_bf16 v[124:127], a[232:235], v[56:59], v[124:127]
    v_cvt_pk_bf16_f32 v60, v40, v41
    v_cvt_pk_bf16_f32 v61, v42, v43
    v_mfma_f32_16x16x32_bf16 v[128:131], a[236:239], v[56:59], v[128:131]
    v_cvt_pk_bf16_f32 v62, v44, v45
    v_cvt_pk_bf16_f32 v63, v46, v47
    v_mfma_f32_16x16x32_bf16 v[132:135], a[240:243], v[56:59], v[132:135]
    v_exp_f32 v48, v48
    v_mfma_f32_16x16x32_bf16 v[136:139], a[244:247], v[56:59], v[136:139]
    v_exp_f32 v49, v49
    v_mfma_f32_16x16x32_bf16 v[140:143], a[248:251], v[56:59], v[140:143]
    v_exp_f32 v50, v50
    v_mfma_f32_16x16x32_bf16 v[144:147], a[252:255], v[56:59], v[144:147]
    v_exp_f32 v51, v51
    v_mfma_f32_16x16x32_bf16 v[20:23], a[168:171], v[56:59], v[20:23]
    v_exp_f32 v52, v52
    v_mfma_f32_16x16x32_bf16 v[148:151], a[224:227], v[60:63], v[148:151]
    v_exp_f32 v53, v53
    v_mfma_f32_16x16x32_bf16 v[152:155], a[228:231], v[60:63], v[152:155]
    v_exp_f32 v54, v54
    v_mfma_f32_16x16x32_bf16 v[156:159], a[232:235], v[60:63], v[156:159]
    v_exp_f32 v55, v55
    v_mfma_f32_16x16x32_bf16 v[160:163], a[236:239], v[60:63], v[160:163]
    v_cvt_pk_bf16_f32 v64, v48, v49
    v_cvt_pk_bf16_f32 v65, v50, v51
    v_mfma_f32_16x16x32_bf16 v[164:167], a[240:243], v[60:63], v[164:167]
    v_cvt_pk_bf16_f32 v66, v52, v53
    v_cvt_pk_bf16_f32 v67, v54, v55
    v_mfma_f32_16x16x32_bf16 v[168:171], a[244:247], v[60:63], v[168:171]
    s_add_u32 s60, s60, 16896
    ds_read_b128 a[192:195], v4 offset:0
    v_mfma_f32_16x16x32_bf16 v[172:175], a[248:251], v[60:63], v[172:175]
    s_cmp_ge_u32 s60, s61
    ds_read_b128 a[196:199], v4 offset:64
    v_mfma_f32_16x16x32_bf16 v[176:179], a[252:255], v[60:63], v[176:179]
    s_cselect_b32 s60, 0, s60
    ds_read_b128 a[200:203], v4 offset:128
    v_mfma_f32_16x16x32_bf16 v[24:27], a[168:171], v[60:63], v[24:27]
    s_sub_u32 s62, s62, 1
    ds_read_b128 a[204:207], v4 offset:192
    v_mfma_f32_16x16x32_bf16 v[180:183], a[224:227], v[64:67], v[180:183]
    ds_read_b128 a[208:211], v4 offset:512
    v_mfma_f32_16x16x32_bf16 v[184:187], a[228:231], v[64:67], v[184:187]
    ds_read_b128 a[212:215], v4 offset:576
    v_mfma_f32_16x16x32_bf16 v[188:191], a[232:235], v[64:67], v[188:191]
    ds_read_b128 a[216:219], v4 offset:640
    v_mfma_f32_16x16x32_bf16 v[192:195], a[236:239], v[64:67], v[192:195]
    ds_read_b128 a[220:223], v4 offset:704
    v_mfma_f32_16x16x32_bf16 v[196:199], a[240:243], v[64:67], v[196:199]
    v_add_u32 v3, s60, v1
    v_add_u32 v4, s60, v2
    v_mfma_f32_16x16x32_bf16 v[200:203], a[244:247], v[64:67], v[200:203]
    s_waitcnt vmcnt(0)
    s_mov_b64 exec, 1
    v_mov_b32 v11, 1
    buffer_store_dword v11, off, s[40:43], s75 sc1
    s_mov_b64 exec, -1
    v_mfma_f32_16x16x32_bf16 v[204:207], a[248:251], v[64:67], v[204:207]
    v_mfma_f32_16x16x32_bf16 v[208:211], a[252:255], v[64:67], v[208:211]
    s_cmp_lg_u32 s62, 0
    v_mfma_f32_16x16x32_bf16 v[28:31], a[168:171], v[64:67], v[28:31]
    s_waitcnt lgkmcnt(0)
    s_barrier
    s_mov_b32 s62, 19
    .p2align 3
L_c_loop2:
    v_mfma_f32_16x16x32_bf16 v[32:35], a[192:195], v[68:71], 0
    ds_read_b64_tr_b16 a[224:225], v3 offset:0
    ds_read_b64_tr_b16 a[226:227], v3 offset:512
    v_mfma_f32_16x16x32_bf16 v[32:35], a[196:199], v[72:75], v[32:35]
    ds_read_b64_tr_b16 a[228:229], v3 offset:32
    ds_read_b64_tr_b16 a[230:231], v3 offset:544
    v_mfma_f32_16x16x32_bf16 v[32:35], a[200:203], v[76:79], v[32:35]
    ds_read_b64_tr_b16 a[232:233], v3 offset:64
    ds_read_b64_tr_b16 a[234:235], v3 offset:576
    v_mfma_f32_16x16x32_bf16 v[32:35], a[204:207], v[80:83], v[32:35]
    ds_read_b64_tr_b16 a[236:237], v3 offset:96
    ds_read_b64_tr_b16 a[238:239], v3 offset:608
    v_mfma_f32_16x16x32_bf16 v[36:39], a[208:211], v[68:71], 0
    ds_read_b64_tr_b16 a[240:241], v3 offset:128
    ds_read_b64_tr_b16 a[242:243], v3 offset:640
    v_mfma_f32_16x16x32_bf16 v[36:39], a[212:215], v[72:75], v[36:39]
    ds_read_b64_tr_b16 a[244:245], v3 offset:160
    ds_read_b64_tr_b16 a[246:247], v3 offset:672
    v_mfma_f32_16x16x32_bf16 v[36:39], a[216:219], v[76:79], v[36:39]
    ds_read_b64_tr_b16 a[248:249], v3 offset:192
    ds_read_b64_tr_b16 a[250:251], v3 offset:704
    v_mfma_f32_16x16x32_bf16 v[36:39], a[220:223], v[80:83], v[36:39]
    v_exp_f32 v32, v32
    v_mfma_f32_16x16x32_bf16 v[40:43], a[192:195], v[84:87], 0
    v_exp_f32 v33, v33
    v_mfma_f32_16x16x32_bf16 v[40:43], a[196:199], v[88:91], v[40:43]
    v_exp_f32 v34, v34
    v_mfma_f32_16x16x32_bf16 v[40:43], a[200:203], v[92:95], v[40:43]
    v_exp_f32 v35, v35
    v_mfma_f32_16x16x32_bf16 v[40:43], a[204:207], v[96:99], v[40:43]
    v_exp_f32 v36, v36
    v_mfma_f32_16x16x32_bf16 v[44:47], a[208:211], v[84:87], 0
    v_exp_f32 v37, v37
    v_mfma_f32_16x16x32_bf16 v[44:47], a[212:215], v[88:91], v[44:47]
    v_exp_f32 v38, v38
    v_mfma_f32_16x16x32_bf16 v[44:47], a[216:219], v[92:95], v[44:47]
    v_exp_f32 v39, v39
    v_mfma_f32_16x16x32_bf16 v[44:47], a[220:223], v[96:99], v[44:47]
    ds_read_b64_tr_b16 a[252:253], v3 offset:224
    ds_read_b64_tr_b16 a[254:255], v3 offset:736
    v_mfma_f32_16x16x32_bf16 v[48:51], a[192:195], v[100:103], 0
    v_cvt_pk_bf16_f32 v56, v32, v33
    v_cvt_pk_bf16_f32 v57, v34, v35
    v_mfma_f32_16x16x32_bf16 v[48:51], a[196:199], v[104:107], v[48:51]
    v_cvt_pk_bf16_f32 v58, v36, v37
    v_cvt_pk_bf16_f32 v59, v38, v39
    v_mfma_f32_16x16x32_bf16 v[48:51], a[200:203], v[108:111], v[48:51]
    v_exp_f32 v40, v40
    v_mfma_f32_16x16x32_bf16 v[48:51], a[204:207], v[112:115], v[48:51]
    v_exp_f32 v41, v41
    v_mfma_f32_16x16x32_bf16 v[52:55], a[208:211], v[100:103], 0
    v_exp_f32 v42, v42
    v_mfma_f32_16x16x32_bf16 v[52:55], a[212:215], v[104:107], v[52:55]
    v_exp_f32 v43, v43
    v_mfma_f32_16x16x32_bf16 v[52:55], a[216:219], v[108:111], v[52:55]
    v_exp_f32 v44, v44
    v_mfma_f32_16x16x32_bf16 v[52:55], a[220:223], v[112:115], v[52:55]
    s_waitcnt lgkmcnt(0)
    v_exp_f32 v45, v45
    v_mfma_f32_16x16x32_bf16 v[116:119], a[224:227], v[56:59], v[116:119]
    v_exp_f32 v46, v46
    v_mfma_f32_16x16x32_bf16 v[120:123], a[228:231], v[56:59], v[120:123]
    v_exp_f32 v47, v47
    v_mfma_f32_16x16x32_bf16 v[124:127], a[232:235], v[56:59], v[124:127]
    v_cvt_pk_bf16_f32 v60, v40, v41
    v_cvt_pk_bf16_f32 v61, v42, v43
    v_mfma_f32_16x16x32_bf16 v[128:131], a[236:239], v[56:59], v[128:131]
    v_cvt_pk_bf16_f32 v62, v44, v45
    v_cvt_pk_bf16_f32 v63, v46, v47
    v_mfma_f32_16x16x32_bf16 v[132:135], a[240:243], v[56:59], v[132:135]
    v_exp_f32 v48, v48
    v_mfma_f32_16x16x32_bf16 v[136:139], a[244:247], v[56:59], v[136:139]
    v_exp_f32 v49, v49
    v_mfma_f32_16x16x32_bf16 v[140:143], a[248:251], v[56:59], v[140:143]
    v_exp_f32 v50, v50
    v_mfma_f32_16x16x32_bf16 v[144:147], a[252:255], v[56:59], v[144:147]
    v_exp_f32 v51, v51
    v_mfma_f32_16x16x32_bf16 v[20:23], a[168:171], v[56:59], v[20:23]
    v_exp_f32 v52, v52
    v_mfma_f32_16x16x32_bf16 v[148:151], a[224:227], v[60:63], v[148:151]
    v_exp_f32 v53, v53
    v_mfma_f32_16x16x32_bf16 v[152:155], a[228:231], v[60:63], v[152:155]
    v_exp_f32 v54, v54
    v_mfma_f32_16x16x32_bf16 v[156:159], a[232:235], v[60:63], v[156:159]
    v_exp_f32 v55, v55
    v_mfma_f32_16x16x32_bf16 v[160:163], a[236:239], v[60:63], v[160:163]
    v_cvt_pk_bf16_f32 v64, v48, v49
    v_cvt_pk_bf16_f32 v65, v50, v51
    v_mfma_f32_16x16x32_bf16 v[164:167], a[240:243], v[60:63], v[164:167]
    v_cvt_pk_bf16_f32 v66, v52, v53
    v_cvt_pk_bf16_f32 v67, v54, v55
    v_mfma_f32_16x16x32_bf16 v[168:171], a[244:247], v[60:63], v[168:171]
    s_add_u32 s60, s60, 16896
    ds_read_b128 a[192:195], v4 offset:0
    v_mfma_f32_16x16x32_bf16 v[172:175], a[248:251], v[60:63], v[172:175]
    s_cmp_ge_u32 s60, s61
    ds_read_b128 a[196:199], v4 offset:64
    v_mfma_f32_16x16x32_bf16 v[176:179], a[252:255], v[60:63], v[176:179]
    s_cselect_b32 s60, 0, s60
    ds_read_b128 a[200:203], v4 offset:128
    v_mfma_f32_16x16x32_bf16 v[24:27], a[168:171], v[60:63], v[24:27]
    s_sub_u32 s62, s62, 1
    ds_read_b128 a[204:207], v4 offset:192
    v_mfma_f32_16x16x32_bf16 v[180:183], a[224:227], v[64:67], v[180:183]
    ds_read_b128 a[208:211], v4 offset:512
    v_mfma_f32_16x16x32_bf16 v[184:187], a[228:231], v[64:67], v[184:187]
    ds_read_b128 a[212:215], v4 offset:576
    v_mfma_f32_16x16x32_bf16 v[188:191], a[232:235], v[64:67], v[188:191]
    ds_read_b128 a[216:219], v4 offset:640
    v_mfma_f32_16x16x32_bf16 v[192:195], a[236:239], v[64:67], v[192:195]
    ds_read_b128 a[220:223], v4 offset:704
    v_mfma_f32_16x16x32_bf16 v[196:199], a[240:243], v[64:67], v[196:199]
    v_add_u32 v3, s60, v1
    v_add_u32 v4, s60, v2
    v_mfma_f32_16x16x32_bf16 v[200:203], a[244:247], v[64:67], v[200:203]
    v_mfma_f32_16x16x32_bf16 v[204:207], a[248:251], v[64:67], v[204:207]
    v_mfma_f32_16x16x32_bf16 v[208:211], a[252:255], v[64:67], v[208:211]
    s_cmp_lg_u32 s62, 0
    v_mfma_f32_16x16x32_bf16 v[28:31], a[168:171], v[64:67], v[28:31]
    s_waitcnt lgkmcnt(0)
    s_barrier
    s_cbranch_scc1 L_c_loop2
    v_mfma_f32_16x16x32_bf16 v[32:35], a[192:195], v[68:71], 0
    ds_read_b64_tr_b16 a[224:225], v3 offset:0
    ds_read_b64_tr_b16 a[226:227], v3 offset:512
    v_mfma_f32_16x16x32_bf16 v[32:35], a[196:199], v[72:75], v[32:35]
    ds_read_b64_tr_b16 a[228:229], v3 offset:32
    ds_read_b64_tr_b16 a[230:231], v3 offset:544
    v_mfma_f32_16x16x32_bf16 v[32:35], a[200:203], v[76:79], v[32:35]
    ds_read_b64_tr_b16 a[232:233], v3 offset:64
    ds_read_b64_tr_b16 a[234:235], v3 offset:576
    v_mfma_f32_16x16x32_bf16 v[32:35], a[204:207], v[80:83], v[32:35]
    ds_read_b64_tr_b16 a[236:237], v3 offset:96
    ds_read_b64_tr_b16 a[238:239], v3 offset:608
    v_mfma_f32_16x16x32_bf16 v[36:39], a[208:211], v[68:71], 0
    ds_read_b64_tr_b16 a[240:241], v3 offset:128
    ds_read_b64_tr_b16 a[242:243], v3 offset:640
    v_mfma_f32_16x16x32_bf16 v[36:39], a[212:215], v[72:75], v[36:39]
    ds_read_b64_tr_b16 a[244:245], v3 offset:160
    ds_read_b64_tr_b16 a[246:247], v3 offset:672
    v_mfma_f32_16x16x32_bf16 v[36:39], a[216:219], v[76:79], v[36:39]
    ds_read_b64_tr_b16 a[248:249], v3 offset:192
    ds_read_b64_tr_b16 a[250:251], v3 offset:704
    v_mfma_f32_16x16x32_bf16 v[36:39], a[220:223], v[80:83], v[36:39]
    v_exp_f32 v32, v32
    v_mfma_f32_16x16x32_bf16 v[40:43], a[192:195], v[84:87], 0
    v_exp_f32 v33, v33
    v_mfma_f32_16x16x32_bf16 v[40:43], a[196:199], v[88:91], v[40:43]
    v_exp_f32 v34, v34
    v_mfma_f32_16x16x32_bf16 v[40:43], a[200:203], v[92:95], v[40:43]
    v_exp_f32 v35, v35
    v_mfma_f32_16x16x32_bf16 v[40:43], a[204:207], v[96:99], v[40:43]
    v_exp_f32 v36, v36
    v_mfma_f32_16x16x32_bf16 v[44:47], a[208:211], v[84:87], 0
    v_exp_f32 v37, v37
    v_mfma_f32_16x16x32_bf16 v[44:47], a[212:215], v[88:91], v[44:47]
    v_exp_f32 v38, v38
    v_mfma_f32_16x16x32_bf16 v[44:47], a[216:219], v[92:95], v[44:47]
    v_exp_f32 v39, v39
    v_mfma_f32_16x16x32_bf16 v[44:47], a[220:223], v[96:99], v[44:47]
    ds_read_b64_tr_b16 a[252:253], v3 offset:224
    ds_read_b64_tr_b16 a[254:255], v3 offset:736
    v_mfma_f32_16x16x32_bf16 v[48:51], a[192:195], v[100:103], 0
    v_cvt_pk_bf16_f32 v56, v32, v33
    v_cvt_pk_bf16_f32 v57, v34, v35
    v_mfma_f32_16x16x32_bf16 v[48:51], a[196:199], v[104:107], v[48:51]
    v_cvt_pk_bf16_f32 v58, v36, v37
    v_cvt_pk_bf16_f32 v59, v38, v39
    v_mfma_f32_16x16x32_bf16 v[48:51], a[200:203], v[108:111], v[48:51]
    v_exp_f32 v40, v40
    v_mfma_f32_16x16x32_bf16 v[48:51], a[204:207], v[112:115], v[48:51]
    v_exp_f32 v41, v41
    v_mfma_f32_16x16x32_bf16 v[52:55], a[208:211], v[100:103], 0
    v_exp_f32 v42, v42
    v_mfma_f32_16x16x32_bf16 v[52:55], a[212:215], v[104:107], v[52:55]
    v_exp_f32 v43, v43
    v_mfma_f32_16x16x32_bf16 v[52:55], a[216:219], v[108:111], v[52:55]
    v_exp_f32 v44, v44
    v_mfma_f32_16x16x32_bf16 v[52:55], a[220:223], v[112:115], v[52:55]
    s_waitcnt lgkmcnt(0)
    v_exp_f32 v45, v45
    v_mfma_f32_16x16x32_bf16 v[116:119], a[224:227], v[56:59], v[116:119]
    v_exp_f32 v46, v46
    v_mfma_f32_16x16x32_bf16 v[120:123], a[228:231], v[56:59], v[120:123]
    v_exp_f32 v47, v47
    v_mfma_f32_16x16x32_bf16 v[124:127], a[232:235], v[56:59], v[124:127]
    v_cvt_pk_bf16_f32 v60, v40, v41
    v_cvt_pk_bf16_f32 v61, v42, v43
    v_mfma_f32_16x16x32_bf16 v[128:131], a[236:239], v[56:59], v[128:131]
    v_cvt_pk_bf16_f32 v62, v44, v45
    v_cvt_pk_bf16_f32 v63, v46, v47
    v_mfma_f32_16x16x32_bf16 v[132:135], a[240:243], v[56:59], v[132:135]
    v_exp_f32 v48, v48
    v_mfma_f32_16x16x32_bf16 v[136:139], a[244:247], v[56:59], v[136:139]
    v_exp_f32 v49, v49
    v_mfma_f32_16x16x32_bf16 v[140:143], a[248:251], v[56:59], v[140:143]
    v_exp_f32 v50, v50
    v_mfma_f32_16x16x32_bf16 v[144:147], a[252:255], v[56:59], v[144:147]
    v_exp_f32 v51, v51
    v_mfma_f32_16x16x32_bf16 v[20:23], a[168:171], v[56:59], v[20:23]
    v_exp_f32 v52, v52
    v_mfma_f32_16x16x32_bf16 v[148:151], a[224:227], v[60:63], v[148:151]
    v_exp_f32 v53, v53
    v_mfma_f32_16x16x32_bf16 v[152:155], a[228:231], v[60:63], v[152:155]
    v_exp_f32 v54, v54
    v_mfma_f32_16x16x32_bf16 v[156:159], a[232:235], v[60:63], v[156:159]
    v_exp_f32 v55, v55
    v_mfma_f32_16x16x32_bf16 v[160:163], a[236:239], v[60:63], v[160:163]
    v_cvt_pk_bf16_f32 v64, v48, v49
    v_cvt_pk_bf16_f32 v65, v50, v51
    v_mfma_f32_16x16x32_bf16 v[164:167], a[240:243], v[60:63], v[164:167]
    v_cvt_pk_bf16_f32 v66, v52, v53
    v_cvt_pk_bf16_f32 v67, v54, v55
    v_mfma_f32_16x16x32_bf16 v[168:171], a[244:247], v[60:63], v[168:171]
    s_add_u32 s60, s60, 16896
    ds_read_b128 a[192:195], v4 offset:0
    ds_read_b128 a[8:11], v6 offset:2048
    v_mfma_f32_16x16x32_bf16 v[172:175], a[248:251], v[60:63], v[172:175]
    s_cmp_ge_u32 s60, s61
    ds_read_b128 a[196:199], v4 offset:64
    ds_read_b128 a[32:35], v6 offset:8192
    v_mfma_f32_16x16x32_bf16 v[176:179], a[252:255], v[60:63], v[176:179]
    s_cselect_b32 s60, 0, s60
    ds_read_b128 a[200:203], v4 offset:128
    ds_read_b128 a[36:39], v6 offset:9216
    v_mfma_f32_16x16x32_bf16 v[24:27], a[168:171], v[60:63], v[24:27]
    s_sub_u32 s62, s62, 1
    ds_read_b128 a[204:207], v4 offset:192
    ds_read_b128 a[40:43], v6 offset:10240
    v_mfma_f32_16x16x32_bf16 v[180:183], a[224:227], v[64:67], v[180:183]
    ds_read_b128 a[208:211], v4 offset:512
    ds_read_b128 a[64:67], v6 offset:16384
    v_mfma_f32_16x16x32_bf16 v[184:187], a[228:231], v[64:67], v[184:187]
    ds_read_b128 a[212:215], v4 offset:576
    ds_read_b128 a[68:71], v6 offset:17408
    v_mfma_f32_16x16x32_bf16 v[188:191], a[232:235], v[64:67], v[188:191]
    ds_read_b128 a[216:219], v4 offset:640
    ds_read_b128 a[72:75], v6 offset:18432
    v_mfma_f32_16x16x32_bf16 v[192:195], a[236:239], v[64:67], v[192:195]
    ds_read_b128 a[220:223], v4 offset:704
    v_mfma_f32_16x16x32_bf16 v[196:199], a[240:243], v[64:67], v[196:199]
    v_add_u32 v3, s60, v1
    v_add_u32 v4, s60, v2
    v_mfma_f32_16x16x32_bf16 v[200:203], a[244:247], v[64:67], v[200:203]
    ds_read_b128 a[0:3], v6 offset:0
    v_mfma_f32_16x16x32_bf16 v[204:207], a[248:251], v[64:67], v[204:207]
    ds_read_b128 a[4:7], v6 offset:1024
    v_mfma_f32_16x16x32_bf16 v[208:211], a[252:255], v[64:67], v[208:211]
    s_cmp_lg_u32 s62, 0
    v_mfma_f32_16x16x32_bf16 v[28:31], a[168:171], v[64:67], v[28:31]
    s_waitcnt lgkmcnt(0)
    s_barrier
    v_mfma_f32_16x16x32_bf16 v[32:35], a[192:195], v[68:71], 0
    ds_read_b64_tr_b16 a[224:225], v3 offset:0
    ds_read_b64_tr_b16 a[226:227], v3 offset:512
    v_mfma_f32_16x16x32_bf16 v[32:35], a[196:199], v[72:75], v[32:35]
    ds_read_b64_tr_b16 a[228:229], v3 offset:32
    ds_read_b64_tr_b16 a[230:231], v3 offset:544
    v_mfma_f32_16x16x32_bf16 v[32:35], a[200:203], v[76:79], v[32:35]
    ds_read_b64_tr_b16 a[232:233], v3 offset:64
    ds_read_b64_tr_b16 a[234:235], v3 offset:576
    v_mfma_f32_16x16x32_bf16 v[32:35], a[204:207], v[80:83], v[32:35]
    ds_read_b64_tr_b16 a[236:237], v3 offset:96
    ds_read_b64_tr_b16 a[238:239], v3 offset:608
    v_mfma_f32_16x16x32_bf16 v[36:39], a[208:211], v[68:71], 0
    ds_read_b64_tr_b16 a[240:241], v3 offset:128
    ds_read_b64_tr_b16 a[242:243], v3 offset:640
    v_mfma_f32_16x16x32_bf16 v[36:39], a[212:215], v[72:75], v[36:39]
    ds_read_b64_tr_b16 a[244:245], v3 offset:160
    ds_read_b64_tr_b16 a[246:247], v3 offset:672
    v_mfma_f32_16x16x32_bf16 v[36:39], a[216:219], v[76:79], v[36:39]
    ds_read_b64_tr_b16 a[248:249], v3 offset:192
    ds_read_b64_tr_b16 a[250:251], v3 offset:704
    v_mfma_f32_16x16x32_bf16 v[36:39], a[220:223], v[80:83], v[36:39]
    v_exp_f32 v32, v32
    v_mfma_f32_16x16x32_bf16 v[40:43], a[192:195], v[84:87], 0
    v_exp_f32 v33, v33
    v_mfma_f32_16x16x32_bf16 v[40:43], a[196:199], v[88:91], v[40:43]
    v_exp_f32 v34, v34
    v_mfma_f32_16x16x32_bf16 v[40:43], a[200:203], v[92:95], v[40:43]
    v_exp_f32 v35, v35
    v_mfma_f32_16x16x32_bf16 v[40:43], a[204:207], v[96:99], v[40:43]
    v_exp_f32 v36, v36
    v_mfma_f32_16x16x32_bf16 v[44:47], a[208:211], v[84:87], 0
    v_exp_f32 v37, v37
    v_mfma_f32_16x16x32_bf16 v[44:47], a[212:215], v[88:91], v[44:47]
    v_exp_f32 v38, v38
    v_mfma_f32_16x16x32_bf16 v[44:47], a[216:219], v[92:95], v[44:47]
    v_exp_f32 v39, v39
    v_mfma_f32_16x16x32_bf16 v[44:47], a[220:223], v[96:99], v[44:47]
    ds_read_b64_tr_b16 a[252:253], v3 offset:224
    ds_read_b64_tr_b16 a[254:255], v3 offset:736
    v_mfma_f32_16x16x32_bf16 v[48:51], a[192:195], v[100:103], 0
    v_cvt_pk_bf16_f32 v56, v32, v33
    v_cvt_pk_bf16_f32 v57, v34, v35
    v_mfma_f32_16x16x32_bf16 v[48:51], a[196:199], v[104:107], v[48:51]
    v_cvt_pk_bf16_f32 v58, v36, v37
    v_cvt_pk_bf16_f32 v59, v38, v39
    v_mfma_f32_16x16x32_bf16 v[48:51], a[200:203], v[108:111], v[48:51]
    v_exp_f32 v40, v40
    v_mfma_f32_16x16x32_bf16 v[48:51], a[204:207], v[112:115], v[48:51]
    v_exp_f32 v41, v41
    v_mfma_f32_16x16x32_bf16 v[52:55], a[208:211], v[100:103], 0
    v_exp_f32 v42, v42
    v_mfma_f32_16x16x32_bf16 v[52:55], a[212:215], v[104:107], v[52:55]
    v_exp_f32 v43, v43
    v_mfma_f32_16x16x32_bf16 v[52:55], a[216:219], v[108:111], v[52:55]
    v_exp_f32 v44, v44
    v_mfma_f32_16x16x32_bf16 v[52:55], a[220:223], v[112:115], v[52:55]
    s_waitcnt lgkmcnt(0)
    v_exp_f32 v45, v45
    v_mfma_f32_16x16x32_bf16 v[116:119], a[224:227], v[56:59], v[116:119]
    v_exp_f32 v46, v46
    v_mfma_f32_16x16x32_bf16 v[120:123], a[228:231], v[56:59], v[120:123]
    v_exp_f32 v47, v47
    v_mfma_f32_16x16x32_bf16 v[124:127], a[232:235], v[56:59], v[124:127]
    v_cvt_pk_bf16_f32 v60, v40, v41
    v_cvt_pk_bf16_f32 v61, v42, v43
    v_mfma_f32_16x16x32_bf16 v[128:131], a[236:239], v[56:59], v[128:131]
    v_cvt_pk_bf16_f32 v62, v44, v45
    v_cvt_pk_bf16_f32 v63, v46, v47
    v_mfma_f32_16x16x32_bf16 v[132:135], a[240:243], v[56:59], v[132:135]
    v_exp_f32 v48, v48
    v_mfma_f32_16x16x32_bf16 v[136:139], a[244:247], v[56:59], v[136:139]
    v_exp_f32 v49, v49
    v_mfma_f32_16x16x32_bf16 v[140:143], a[248:251], v[56:59], v[140:143]
    v_exp_f32 v50, v50
    v_mfma_f32_16x16x32_bf16 v[144:147], a[252:255], v[56:59], v[144:147]
    v_exp_f32 v51, v51
    v_mfma_f32_16x16x32_bf16 v[20:23], a[168:171], v[56:59], v[20:23]
    v_exp_f32 v52, v52
    v_mfma_f32_16x16x32_bf16 v[148:151], a[224:227], v[60:63], v[148:151]
    v_exp_f32 v53, v53
    v_mfma_f32_16x16x32_bf16 v[152:155], a[228:231], v[60:63], v[152:155]
    v_exp_f32 v54, v54
    v_mfma_f32_16x16x32_bf16 v[156:159], a[232:235], v[60:63], v[156:159]
    v_exp_f32 v55, v55
    v_mfma_f32_16x16x32_bf16 v[160:163], a[236:239], v[60:63], v[160:163]
    v_cvt_pk_bf16_f32 v64, v48, v49
    v_cvt_pk_bf16_f32 v65, v50, v51
    v_mfma_f32_16x16x32_bf16 v[164:167], a[240:243], v[60:63], v[164:167]
    v_cvt_pk_bf16_f32 v66, v52, v53
    v_cvt_pk_bf16_f32 v67, v54, v55
    v_mfma_f32_16x16x32_bf16 v[168:171], a[244:247], v[60:63], v[168:171]
    s_add_u32 s60, s60, 16896
    ds_read_b128 a[192:195], v4 offset:0
    ds_read_b128 a[20:23], v6 offset:5120
    v_mfma_f32_16x16x32_bf16 v[172:175], a[248:251], v[60:63], v[172:175]
    s_cmp_ge_u32 s60, s61
    ds_read_b128 a[196:199], v4 offset:64
    ds_read_b128 a[44:47], v6 offset:11264
    v_mfma_f32_16x16x32_bf16 v[176:179], a[252:255], v[60:63], v[176:179]
    s_cselect_b32 s60, 0, s60
    ds_read_b128 a[200:203], v4 offset:128
    ds_read_b128 a[48:51], v6 offset:12288
    v_mfma_f32_16x16x32_bf16 v[24:27], a[168:171], v[60:63], v[24:27]
    s_sub_u32 s62, s62, 1
    ds_read_b128 a[204:207], v4 offset:192
    ds_read_b128 a[52:55], v6 offset:13312
    v_mfma_f32_16x16x32_bf16 v[180:183], a[224:227], v[64:67], v[180:183]
    ds_read_b128 a[208:211], v4 offset:512
    ds_read_b128 a[76:79], v6 offset:19456
    v_mfma_f32_16x16x32_bf16 v[184:187], a[228:231], v[64:67], v[184:187]
    ds_read_b128 a[212:215], v4 offset:576
    ds_read_b128 a[80:83], v6 offset:20480
    v_mfma_f32_16x16x32_bf16 v[188:191], a[232:235], v[64:67], v[188:191]
    ds_read_b128 a[216:219], v4 offset:640
    ds_read_b128 a[84:87], v6 offset:21504
    v_mfma_f32_16x16x32_bf16 v[192:195], a[236:239], v[64:67], v[192:195]
    ds_read_b128 a[220:223], v4 offset:704
    v_mfma_f32_16x16x32_bf16 v[196:199], a[240:243], v[64:67], v[196:199]
    v_add_u32 v3, s60, v1
    v_add_u32 v4, s60, v2
    v_mfma_f32_16x16x32_bf16 v[200:203], a[244:247], v[64:67], v[200:203]
    ds_read_b128 a[12:15], v6 offset:3072
    v_mfma_f32_16x16x32_bf16 v[204:207], a[248:251], v[64:67], v[204:207]
    ds_read_b128 a[16:19], v6 offset:4096
    v_mfma_f32_16x16x32_bf16 v[208:211], a[252:255], v[64:67], v[208:211]
    s_cmp_lg_u32 s62, 0
    v_mfma_f32_16x16x32_bf16 v[28:31], a[168:171], v[64:67], v[28:31]
    s_waitcnt lgkmcnt(0)
    s_barrier
    v_mfma_f32_16x16x32_bf16 v[32:35], a[192:195], v[68:71], 0
    ds_read_b64_tr_b16 a[224:225], v3 offset:0
    ds_read_b64_tr_b16 a[226:227], v3 offset:512
    v_mfma_f32_16x16x32_bf16 v[32:35], a[196:199], v[72:75], v[32:35]
    ds_read_b64_tr_b16 a[228:229], v3 offset:32
    ds_read_b64_tr_b16 a[230:231], v3 offset:544
    v_mfma_f32_16x16x32_bf16 v[32:35], a[200:203], v[76:79], v[32:35]
    ds_read_b64_tr_b16 a[232:233], v3 offset:64
    ds_read_b64_tr_b16 a[234:235], v3 offset:576
    v_mfma_f32_16x16x32_bf16 v[32:35], a[204:207], v[80:83], v[32:35]
    ds_read_b64_tr_b16 a[236:237], v3 offset:96
    ds_read_b64_tr_b16 a[238:239], v3 offset:608
    v_mfma_f32_16x16x32_bf16 v[36:39], a[208:211], v[68:71], 0
    ds_read_b64_tr_b16 a[240:241], v3 offset:128
    ds_read_b64_tr_b16 a[242:243], v3 offset:640
    v_mfma_f32_16x16x32_bf16 v[36:39], a[212:215], v[72:75], v[36:39]
    ds_read_b64_tr_b16 a[244:245], v3 offset:160
    ds_read_b64_tr_b16 a[246:247], v3 offset:672
    v_mfma_f32_16x16x32_bf16 v[36:39], a[216:219], v[76:79], v[36:39]
    ds_read_b64_tr_b16 a[248:249], v3 offset:192
    ds_read_b64_tr_b16 a[250:251], v3 offset:704
    v_mfma_f32_16x16x32_bf16 v[36:39], a[220:223], v[80:83], v[36:39]
    v_exp_f32 v32, v32
    v_mfma_f32_16x16x32_bf16 v[40:43], a[192:195], v[84:87], 0
    v_exp_f32 v33, v33
    v_mfma_f32_16x16x32_bf16 v[40:43], a[196:199], v[88:91], v[40:43]
    v_exp_f32 v34, v34
    v_mfma_f32_16x16x32_bf16 v[40:43], a[200:203], v[92:95], v[40:43]
    v_exp_f32 v35, v35
    v_mfma_f32_16x16x32_bf16 v[40:43], a[204:207], v[96:99], v[40:43]
    v_exp_f32 v36, v36
    v_mfma_f32_16x16x32_bf16 v[44:47], a[208:211], v[84:87], 0
    v_exp_f32 v37, v37
    v_mfma_f32_16x16x32_bf16 v[44:47], a[212:215], v[88:91], v[44:47]
    v_exp_f32 v38, v38
    v_mfma_f32_16x16x32_bf16 v[44:47], a[216:219], v[92:95], v[44:47]
    v_exp_f32 v39, v39
    v_mfma_f32_16x16x32_bf16 v[44:47], a[220:223], v[96:99], v[44:47]
    ds_read_b64_tr_b16 a[252:253], v3 offset:224
    ds_read_b64_tr_b16 a[254:255], v3 offset:736
    v_mfma_f32_16x16x32_bf16 v[48:51], a[192:195], v[100:103], 0
    v_cvt_pk_bf16_f32 v56, v32, v33
    v_cvt_pk_bf16_f32 v57, v34, v35
    v_mfma_f32_16x16x32_bf16 v[48:51], a[196:199], v[104:107], v[48:51]
    v_cvt_pk_bf16_f32 v58, v36, v37
    v_cvt_pk_bf16_f32 v59, v38, v39
    v_mfma_f32_16x16x32_bf16 v[48:51], a[200:203], v[108:111], v[48:51]
    v_exp_f32 v40, v40
    v_mfma_f32_16x16x32_bf16 v[48:51], a[204:207], v[112:115], v[48:51]
    v_exp_f32 v41, v41
    v_mfma_f32_16x16x32_bf16 v[52:55], a[208:211], v[100:103], 0
    v_exp_f32 v42, v42
    v_mfma_f32_16x16x32_bf16 v[52:55], a[212:215], v[104:107], v[52:55]
    v_exp_f32 v43, v43
    v_mfma_f32_16x16x32_bf16 v[52:55], a[216:219], v[108:111], v[52:55]
    v_exp_f32 v44, v44
    v_mfma_f32_16x16x32_bf16 v[52:55], a[220:223], v[112:115], v[52:55]
    s_waitcnt lgkmcnt(0)
    v_exp_f32 v45, v45
    v_mfma_f32_16x16x32_bf16 v[116:119], a[224:227], v[56:59], v[116:119]
    v_exp_f32 v46, v46
    v_mfma_f32_16x16x32_bf16 v[120:123], a[228:231], v[56:59], v[120:123]
    v_exp_f32 v47, v47
    v_mfma_f32_16x16x32_bf16 v[124:127], a[232:235], v[56:59], v[124:127]
    v_cvt_pk_bf16_f32 v60, v40, v41
    v_cvt_pk_bf16_f32 v61, v42, v43
    v_mfma_f32_16x16x32_bf16 v[128:131], a[236:239], v[56:59], v[128:131]
    v_cvt_pk_bf16_f32 v62, v44, v45
    v_cvt_pk_bf16_f32 v63, v46, v47
    v_mfma_f32_16x16x32_bf16 v[132:135], a[240:243], v[56:59], v[132:135]
    v_exp_f32 v48, v48
    v_mfma_f32_16x16x32_bf16 v[136:139], a[244:247], v[56:59], v[136:139]
    v_exp_f32 v49, v49
    v_mfma_f32_16x16x32_bf16 v[140:143], a[248:251], v[56:59], v[140:143]
    v_exp_f32 v50, v50
    v_mfma_f32_16x16x32_bf16 v[144:147], a[252:255], v[56:59], v[144:147]
    v_exp_f32 v51, v51
    v_mfma_f32_16x16x32_bf16 v[20:23], a[168:171], v[56:59], v[20:23]
    v_exp_f32 v52, v52
    v_mfma_f32_16x16x32_bf16 v[148:151], a[224:227], v[60:63], v[148:151]
    v_exp_f32 v53, v53
    v_mfma_f32_16x16x32_bf16 v[152:155], a[228:231], v[60:63], v[152:155]
    v_exp_f32 v54, v54
    v_mfma_f32_16x16x32_bf16 v[156:159], a[232:235], v[60:63], v[156:159]
    v_exp_f32 v55, v55
    v_mfma_f32_16x16x32_bf16 v[160:163], a[236:239], v[60:63], v[160:163]
    v_cvt_pk_bf16_f32 v64, v48, v49
    v_cvt_pk_bf16_f32 v65, v50, v51
    v_mfma_f32_16x16x32_bf16 v[164:167], a[240:243], v[60:63], v[164:167]
    v_cvt_pk_bf16_f32 v66, v52, v53
    v_cvt_pk_bf16_f32 v67, v54, v55
    v_mfma_f32_16x16x32_bf16 v[168:171], a[244:247], v[60:63], v[168:171]
    s_add_u32 s60, s60, 16896
    ds_read_b128 a[192:195], v4 offset:0
    ds_read_b128 a[56:59], v6 offset:14336
    v_mfma_f32_16x16x32_bf16 v[172:175], a[248:251], v[60:63], v[172:175]
    s_cmp_ge_u32 s60, s61
    ds_read_b128 a[196:199], v4 offset:64
    ds_read_b128 a[60:63], v6 offset:15360
    v_mfma_f32_16x16x32_bf16 v[176:179], a[252:255], v[60:63], v[176:179]
    s_cselect_b32 s60, 0, s60
    ds_read_b128 a[200:203], v4 offset:128
    ds_read_b128 a[88:91], v6 offset:22528
    v_mfma_f32_16x16x32_bf16 v[24:27], a[168:171], v[60:63], v[24:27]
    s_sub_u32 s62, s62, 1
    ds_read_b128 a[204:207], v4 offset:192
    ds_read_b128 a[92:95], v6 offset:23552
    v_mfma_f32_16x16x32_bf16 v[180:183], a[224:227], v[64:67], v[180:183]
    ds_read_b128 a[208:211], v4 offset:512
    v_mfma_f32_16x16x32_bf16 v[184:187], a[228:231], v[64:67], v[184:187]
    ds_read_b128 a[212:215], v4 offset:576
    v_mfma_f32_16x16x32_bf16 v[188:191], a[232:235], v[64:67], v[188:191]
    ds_read_b128 a[216:219], v4 offset:640
    v_mfma_f32_16x16x32_bf16 v[192:195], a[236:239], v[64:67], v[192:195]
    ds_read_b128 a[220:223], v4 offset:704
    v_mfma_f32_16x16x32_bf16 v[196:199], a[240:243], v[64:67], v[196:199]
    v_add_u32 v3, s60, v1
    v_add_u32 v4, s60, v2
    v_mfma_f32_16x16x32_bf16 v[200:203], a[244:247], v[64:67], v[200:203]
    ds_read_b128 a[24:27], v6 offset:6144
    v_mfma_f32_16x16x32_bf16 v[204:207], a[248:251], v[64:67], v[204:207]
    ds_read_b128 a[28:31], v6 offset:7168
    v_mfma_f32_16x16x32_bf16 v[208:211], a[252:255], v[64:67], v[208:211]
    s_cmp_lg_u32 s62, 0
    v_mfma_f32_16x16x32_bf16 v[28:31], a[168:171], v[64:67], v[28:31]
    s_waitcnt lgkmcnt(0)
    s_barrier
    s_mov_b32 s62, 6
    .p2align 3
L_c_loop3:
    v_mfma_f32_16x16x32_bf16 v[32:35], a[192:195], v[68:71], 0
    ds_read_b64_tr_b16 a[224:225], v3 offset:0
    ds_read_b64_tr_b16 a[226:227], v3 offset:512
    v_mfma_f32_16x16x32_bf16 v[32:35], a[196:199], v[72:75], v[32:35]
    ds_read_b64_tr_b16 a[228:229], v3 offset:32
    ds_read_b64_tr_b16 a[230:231], v3 offset:544
    v_mfma_f32_16x16x32_bf16 v[32:35], a[200:203], v[76:79], v[32:35]
    ds_read_b64_tr_b16 a[232:233], v3 offset:64
    ds_read_b64_tr_b16 a[234:235], v3 offset:576
    v_mfma_f32_16x16x32_bf16 v[32:35], a[204:207], v[80:83], v[32:35]
    ds_read_b64_tr_b16 a[236:237], v3 offset:96
    ds_read_b64_tr_b16 a[238:239], v3 offset:608
    v_mfma_f32_16x16x32_bf16 v[36:39], a[208:211], v[68:71], 0
    ds_read_b64_tr_b16 a[240:241], v3 offset:128
    ds_read_b64_tr_b16 a[242:243], v3 offset:640
    v_mfma_f32_16x16x32_bf16 v[36:39], a[212:215], v[72:75], v[36:39]
    ds_read_b64_tr_b16 a[244:245], v3 offset:160
    ds_read_b64_tr_b16 a[246:247], v3 offset:672
    v_mfma_f32_16x16x32_bf16 v[36:39], a[216:219], v[76:79], v[36:39]
    ds_read_b64_tr_b16 a[248:249], v3 offset:192
    ds_read_b64_tr_b16 a[250:251], v3 offset:704
    v_mfma_f32_16x16x32_bf16 v[36:39], a[220:223], v[80:83], v[36:39]
    v_exp_f32 v32, v32
    v_mfma_f32_16x16x32_bf16 v[40:43], a[192:195], v[84:87], 0
    v_exp_f32 v33, v33
    v_mfma_f32_16x16x32_bf16 v[40:43], a[196:199], v[88:91], v[40:43]
    v_exp_f32 v34, v34
    v_mfma_f32_16x16x32_bf16 v[40:43], a[200:203], v[92:95], v[40:43]
    v_exp_f32 v35, v35
    v_mfma_f32_16x16x32_bf16 v[40:43], a[204:207], v[96:99], v[40:43]
    v_exp_f32 v36, v36
    v_mfma_f32_16x16x32_bf16 v[44:47], a[208:211], v[84:87], 0
    v_exp_f32 v37, v37
    v_mfma_f32_16x16x32_bf16 v[44:47], a[212:215], v[88:91], v[44:47]
    v_exp_f32 v38, v38
    v_mfma_f32_16x16x32_bf16 v[44:47], a[216:219], v[92:95], v[44:47]
    v_exp_f32 v39, v39
    v_mfma_f32_16x16x32_bf16 v[44:47], a[220:223], v[96:99], v[44:47]
    ds_read_b64_tr_b16 a[252:253], v3 offset:224
    ds_read_b64_tr_b16 a[254:255], v3 offset:736
    v_mfma_f32_16x16x32_bf16 v[48:51], a[192:195], v[100:103], 0
    v_cvt_pk_bf16_f32 v56, v32, v33
    v_cvt_pk_bf16_f32 v57, v34, v35
    v_mfma_f32_16x16x32_bf16 v[48:51], a[196:199], v[104:107], v[48:51]
    v_cvt_pk_bf16_f32 v58, v36, v37
    v_cvt_pk_bf16_f32 v59, v38, v39
    v_mfma_f32_16x16x32_bf16 v[48:51], a[200:203], v[108:111], v[48:51]
    v_exp_f32 v40, v40
    v_mfma_f32_16x16x32_bf16 v[48:51], a[204:207], v[112:115], v[48:51]
    v_exp_f32 v41, v41
    v_mfma_f32_16x16x32_bf16 v[52:55], a[208:211], v[100:103], 0
    v_exp_f32 v42, v42
    v_mfma_f32_16x16x32_bf16 v[52:55], a[212:215], v[104:107], v[52:55]
    v_exp_f32 v43, v43
    v_mfma_f32_16x16x32_bf16 v[52:55], a[216:219], v[108:111], v[52:55]
    v_exp_f32 v44, v44
    v_mfma_f32_16x16x32_bf16 v[52:55], a[220:223], v[112:115], v[52:55]
    s_waitcnt lgkmcnt(0)
    v_exp_f32 v45, v45
    v_mfma_f32_16x16x32_bf16 v[116:119], a[224:227], v[56:59], v[116:119]
    v_exp_f32 v46, v46
    v_mfma_f32_16x16x32_bf16 v[120:123], a[228:231], v[56:59], v[120:123]
    v_exp_f32 v47, v47
    v_mfma_f32_16x16x32_bf16 v[124:127], a[232:235], v[56:59], v[124:127]
    v_cvt_pk_bf16_f32 v60, v40, v41
    v_cvt_pk_bf16_f32 v61, v42, v43
    v_mfma_f32_16x16x32_bf16 v[128:131], a[236:239], v[56:59], v[128:131]
    v_cvt_pk_bf16_f32 v62, v44, v45
    v_cvt_pk_bf16_f32 v63, v46, v47
    v_mfma_f32_16x16x32_bf16 v[132:135], a[240:243], v[56:59], v[132:135]
    v_exp_f32 v48, v48
    v_mfma_f32_16x16x32_bf16 v[136:139], a[244:247], v[56:59], v[136:139]
    v_exp_f32 v49, v49
    v_mfma_f32_16x16x32_bf16 v[140:143], a[248:251], v[56:59], v[140:143]
    v_exp_f32 v50, v50
    v_mfma_f32_16x16x32_bf16 v[144:147], a[252:255], v[56:59], v[144:147]
    v_exp_f32 v51, v51
    v_mfma_f32_16x16x32_bf16 v[20:23], a[168:171], v[56:59], v[20:23]
    v_exp_f32 v52, v52
    v_mfma_f32_16x16x32_bf16 v[148:151], a[224:227], v[60:63], v[148:151]
    v_exp_f32 v53, v53
    v_mfma_f32_16x16x32_bf16 v[152:155], a[228:231], v[60:63], v[152:155]
    v_exp_f32 v54, v54
    v_mfma_f32_16x16x32_bf16 v[156:159], a[232:235], v[60:63], v[156:159]
    v_exp_f32 v55, v55
    v_mfma_f32_16x16x32_bf16 v[160:163], a[236:239], v[60:63], v[160:163]
    v_cvt_pk_bf16_f32 v64, v48, v49
    v_cvt_pk_bf16_f32 v65, v50, v51
    v_mfma_f32_16x16x32_bf16 v[164:167], a[240:243], v[60:63], v[164:167]
    v_cvt_pk_bf16_f32 v66, v52, v53
    v_cvt_pk_bf16_f32 v67, v54, v55
    v_mfma_f32_16x16x32_bf16 v[168:171], a[244:247], v[60:63], v[168:171]
    s_add_u32 s60, s60, 16896
    ds_read_b128 a[192:195], v4 offset:0
    v_mfma_f32_16x16x32_bf16 v[172:175], a[248:251], v[60:63], v[172:175]
    s_cmp_ge_u32 s60, s61
    ds_read_b128 a[196:199], v4 offset:64
    v_mfma_f32_16x16x32_bf16 v[176:179], a[252:255], v[60:63], v[176:179]
    s_cselect_b32 s60, 0, s60
    ds_read_b128 a[200:203], v4 offset:128
    v_mfma_f32_16x16x32_bf16 v[24:27], a[168:171], v[60:63], v[24:27]
    s_sub_u32 s62, s62, 1
    ds_read_b128 a[204:207], v4 offset:192
    v_mfma_f32_16x16x32_bf16 v[180:183], a[224:227], v[64:67], v[180:183]
    ds_read_b128 a[208:211], v4 offset:512
    v_mfma_f32_16x16x32_bf16 v[184:187], a[228:231], v[64:67], v[184:187]
    ds_read_b128 a[212:215], v4 offset:576
    v_mfma_f32_16x16x32_bf16 v[188:191], a[232:235], v[64:67], v[188:191]
    ds_read_b128 a[216:219], v4 offset:640
    v_mfma_f32_16x16x32_bf16 v[192:195], a[236:239], v[64:67], v[192:195]
    ds_read_b128 a[220:223], v4 offset:704
    v_mfma_f32_16x16x32_bf16 v[196:199], a[240:243], v[64:67], v[196:199]
    v_add_u32 v3, s60, v1
    v_add_u32 v4, s60, v2
    v_mfma_f32_16x16x32_bf16 v[200:203], a[244:247], v[64:67], v[200:203]
    v_mfma_f32_16x16x32_bf16 v[204:207], a[248:251], v[64:67], v[204:207]
    v_mfma_f32_16x16x32_bf16 v[208:211], a[252:255], v[64:67], v[208:211]
    s_cmp_lg_u32 s62, 0
    v_mfma_f32_16x16x32_bf16 v[28:31], a[168:171], v[64:67], v[28:31]
    s_waitcnt lgkmcnt(0)
    s_barrier
    s_cbranch_scc1 L_c_loop3
    v_mfma_f32_16x16x32_bf16 v[32:35], a[192:195], v[68:71], 0
    ds_read_b64_tr_b16 a[224:225], v3 offset:0
    ds_read_b64_tr_b16 a[226:227], v3 offset:512
    v_mfma_f32_16x16x32_bf16 v[32:35], a[196:199], v[72:75], v[32:35]
    s_mov_b32 s69, s89
    ds_read_b64_tr_b16 a[228:229], v3 offset:32
    ds_read_b64_tr_b16 a[230:231], v3 offset:544
    v_mfma_f32_16x16x32_bf16 v[32:35], a[200:203], v[76:79], v[32:35]
    s_lshl_b32 s56, 1, s55
    ds_read_b64_tr_b16 a[232:233], v3 offset:64
    ds_read_b64_tr_b16 a[234:235], v3 offset:576
    v_mfma_f32_16x16x32_bf16 v[32:35], a[204:207], v[80:83], v[32:35]
    s_andn2_b32 s80, 15, s56
    ds_read_b64_tr_b16 a[236:237], v3 offset:96
    ds_read_b64_tr_b16 a[238:239], v3 offset:608
    v_mfma_f32_16x16x32_bf16 v[36:39], a[208:211], v[68:71], 0
    s_mov_b32 s82, 0
    ds_read_b64_tr_b16 a[240:241], v3 offset:128
    ds_read_b64_tr_b16 a[242:243], v3 offset:640
    v_mfma_f32_16x16x32_bf16 v[36:39], a[212:215], v[72:75], v[36:39]
    s_add_u32 s56, s73, 256
    ds_read_b64_tr_b16 a[244:245], v3 offset:160
    ds_read_b64_tr_b16 a[246:247], v3 offset:672
    v_mfma_f32_16x16x32_bf16 v[36:39], a[216:219], v[76:79], v[36:39]
    s_mul_i32 s86, s56, 36864
    ds_read_b64_tr_b16 a[248:249], v3 offset:192
    ds_read_b64_tr_b16 a[250:251], v3 offset:704
    v_mfma_f32_16x16x32_bf16 v[36:39], a[220:223], v[80:83], v[36:39]
    s_mul_i32 s56, s52, 12288
    v_exp_f32 v32, v32
    v_mfma_f32_16x16x32_bf16 v[40:43], a[192:195], v[84:87], 0
    s_add_u32 s86, s86, s56
    v_exp_f32 v33, v33
    v_mfma_f32_16x16x32_bf16 v[40:43], a[196:199], v[88:91], v[40:43]
    s_add_u32 s68, s68, 9437184
    v_exp_f32 v34, v34
    v_mfma_f32_16x16x32_bf16 v[40:43], a[200:203], v[92:95], v[40:43]
    s_mov_b64 s[20:21], s[40:41]
    v_exp_f32 v35, v35
    v_mfma_f32_16x16x32_bf16 v[40:43], a[204:207], v[96:99], v[40:43]
    s_mov_b32 s78, 0
    v_exp_f32 v36, v36
    v_mfma_f32_16x16x32_bf16 v[44:47], a[208:211], v[84:87], 0
    s_mov_b32 s87, 0
    v_exp_f32 v37, v37
    v_mfma_f32_16x16x32_bf16 v[44:47], a[212:215], v[88:91], v[44:47]
    s_mov_b32 s88, 0
    v_exp_f32 v38, v38
    v_mfma_f32_16x16x32_bf16 v[44:47], a[216:219], v[92:95], v[44:47]
    v_exp_f32 v39, v39
    v_mfma_f32_16x16x32_bf16 v[44:47], a[220:223], v[96:99], v[44:47]
    ds_read_b64_tr_b16 a[252:253], v3 offset:224
    ds_read_b64_tr_b16 a[254:255], v3 offset:736
    v_mfma_f32_16x16x32_bf16 v[48:51], a[192:195], v[100:103], 0
    v_cvt_pk_bf16_f32 v56, v32, v33
    v_cvt_pk_bf16_f32 v57, v34, v35
    v_mfma_f32_16x16x32_bf16 v[48:51], a[196:199], v[104:107], v[48:51]
    v_cvt_pk_bf16_f32 v58, v36, v37
    v_cvt_pk_bf16_f32 v59, v38, v39
    v_mfma_f32_16x16x32_bf16 v[48:51], a[200:203], v[108:111], v[48:51]
    v_exp_f32 v40, v40
    v_mfma_f32_16x16x32_bf16 v[48:51], a[204:207], v[112:115], v[48:51]
    v_exp_f32 v41, v41
    v_mfma_f32_16x16x32_bf16 v[52:55], a[208:211], v[100:103], 0
    v_exp_f32 v42, v42
    v_mfma_f32_16x16x32_bf16 v[52:55], a[212:215], v[104:107], v[52:55]
    v_exp_f32 v43, v43
    v_mfma_f32_16x16x32_bf16 v[52:55], a[216:219], v[108:111], v[52:55]
    v_exp_f32 v44, v44
    v_mfma_f32_16x16x32_bf16 v[52:55], a[220:223], v[112:115], v[52:55]
    s_waitcnt lgkmcnt(0)
    v_exp_f32 v45, v45
    v_mfma_f32_16x16x32_bf16 v[116:119], a[224:227], v[56:59], v[116:119]
    v_exp_f32 v46, v46
    v_mfma_f32_16x16x32_bf16 v[120:123], a[228:231], v[56:59], v[120:123]
    v_exp_f32 v47, v47
    v_mfma_f32_16x16x32_bf16 v[124:127], a[232:235], v[56:59], v[124:127]
    v_cvt_pk_bf16_f32 v60, v40, v41
    v_cvt_pk_bf16_f32 v61, v42, v43
    v_mfma_f32_16x16x32_bf16 v[128:131], a[236:239], v[56:59], v[128:131]
    v_cvt_pk_bf16_f32 v62, v44, v45
    v_cvt_pk_bf16_f32 v63, v46, v47
    v_mfma_f32_16x16x32_bf16 v[132:135], a[240:243], v[56:59], v[132:135]
    v_exp_f32 v48, v48
    v_mfma_f32_16x16x32_bf16 v[136:139], a[244:247], v[56:59], v[136:139]
    v_exp_f32 v49, v49
    v_mfma_f32_16x16x32_bf16 v[140:143], a[248:251], v[56:59], v[140:143]
    v_exp_f32 v50, v50
    v_mfma_f32_16x16x32_bf16 v[144:147], a[252:255], v[56:59], v[144:147]
    v_exp_f32 v51, v51
    v_mfma_f32_16x16x32_bf16 v[20:23], a[168:171], v[56:59], v[20:23]
    v_exp_f32 v52, v52
    v_mfma_f32_16x16x32_bf16 v[148:151], a[224:227], v[60:63], v[148:151]
    v_exp_f32 v53, v53
    v_mfma_f32_16x16x32_bf16 v[152:155], a[228:231], v[60:63], v[152:155]
    v_exp_f32 v54, v54
    v_mfma_f32_16x16x32_bf16 v[156:159], a[232:235], v[60:63], v[156:159]
    v_exp_f32 v55, v55
    v_mfma_f32_16x16x32_bf16 v[160:163], a[236:239], v[60:63], v[160:163]
    v_cvt_pk_bf16_f32 v64, v48, v49
    v_cvt_pk_bf16_f32 v65, v50, v51
    v_mfma_f32_16x16x32_bf16 v[164:167], a[240:243], v[60:63], v[164:167]
    v_cvt_pk_bf16_f32 v66, v52, v53
    v_cvt_pk_bf16_f32 v67, v54, v55
    v_mfma_f32_16x16x32_bf16 v[168:171], a[244:247], v[60:63], v[168:171]
    s_add_u32 s60, s60, 16896
    ds_read_b128 a[192:195], v4 offset:0
    v_mfma_f32_16x16x32_bf16 v[172:175], a[248:251], v[60:63], v[172:175]
    s_cmp_ge_u32 s60, s61
    ds_read_b128 a[196:199], v4 offset:64
    v_mfma_f32_16x16x32_bf16 v[176:179], a[252:255], v[60:63], v[176:179]
    s_cselect_b32 s60, 0, s60
    ds_read_b128 a[200:203], v4 offset:128
    v_mfma_f32_16x16x32_bf16 v[24:27], a[168:171], v[60:63], v[24:27]
    s_sub_u32 s62, s62, 1
    ds_read_b128 a[204:207], v4 offset:192
    v_mfma_f32_16x16x32_bf16 v[180:183], a[224:227], v[64:67], v[180:183]
    ds_read_b128 a[208:211], v4 offset:512
    v_mfma_f32_16x16x32_bf16 v[184:187], a[228:231], v[64:67], v[184:187]
    ds_read_b128 a[212:215], v4 offset:576
    v_mfma_f32_16x16x32_bf16 v[188:191], a[232:235], v[64:67], v[188:191]
    ds_read_b128 a[216:219], v4 offset:640
    v_mfma_f32_16x16x32_bf16 v[192:195], a[236:239], v[64:67], v[192:195]
    ds_read_b128 a[220:223], v4 offset:704
    v_mfma_f32_16x16x32_bf16 v[196:199], a[240:243], v[64:67], v[196:199]
    v_add_u32 v3, s60, v1
    v_add_u32 v4, s60, v2
    v_mfma_f32_16x16x32_bf16 v[200:203], a[244:247], v[64:67], v[200:203]
    buffer_load_dwordx4 v[6:9], off, s[40:43], s69 sc1
    v_mfma_f32_16x16x32_bf16 v[204:207], a[248:251], v[64:67], v[204:207]
    v_mul_u32_u24 v2, 384, v0
    v_mfma_f32_16x16x32_bf16 v[208:211], a[252:255], v[64:67], v[208:211]
    s_cmp_lg_u32 s62, 0
    v_mfma_f32_16x16x32_bf16 v[28:31], a[168:171], v[64:67], v[28:31]
    s_waitcnt lgkmcnt(0)
    s_barrier
L_tail:
    v_add_u32 v4, 141312, v1
    s_nop 0
    s_mov_b32 s56, 0x35800000
    s_mov_b32 s57, 0x16000000
    v_subrev_u32 v10, s56, v20
    v_subrev_u32 v11, s56, v24
    v_subrev_u32 v32, s56, v28
    v_max3_u32 v10, v10, v11, v32
    v_cmp_lt_u32 vcc, s57, v10
    s_nop 1
    s_cbranch_vccnz L_fb1
L_fbret1:
    ds_read_b64_tr_b16 a[232:233], v4 offset:64
    ds_read_b64_tr_b16 a[234:235], v4 offset:576
    ds_read_b64_tr_b16 a[236:237], v4 offset:96
    ds_read_b64_tr_b16 a[238:239], v4 offset:608
    ds_read_b64_tr_b16 a[240:241], v4 offset:128
    ds_read_b64_tr_b16 a[242:243], v4 offset:640
    ds_read_b64_tr_b16 a[244:245], v4 offset:160
    ds_read_b64_tr_b16 a[246:247], v4 offset:672
    ds_read_b64_tr_b16 a[248:249], v4 offset:192
    ds_read_b64_tr_b16 a[250:251], v4 offset:704
    ds_read_b64_tr_b16 a[252:253], v4 offset:224
    ds_read_b64_tr_b16 a[254:255], v4 offset:736
    v_rcp_f32 v10, v20
    s_nop 0
    v_pk_mul_f32 v[116:117], v[116:117], v[10:11] op_sel_hi:[1,0]
    v_pk_mul_f32 v[118:119], v[118:119], v[10:11] op_sel_hi:[1,0]
    v_pk_mul_f32 v[120:121], v[120:121], v[10:11] op_sel_hi:[1,0]
    v_pk_mul_f32 v[122:123], v[122:123], v[10:11] op_sel_hi:[1,0]
    v_cvt_pk_bf16_f32 v16, v116, v117
    v_cvt_pk_bf16_f32 v17, v118, v119
    v_cvt_pk_bf16_f32 v18, v120, v121
    v_cvt_pk_bf16_f32 v19, v122, v123
    s_add_u32 s57, s68, 0
    buffer_store_dwordx4 v[16:19], v5, s[40:43], s57 offen offset:0 sc1
    v_pk_mul_f32 v[124:125], v[124:125], v[10:11] op_sel_hi:[1,0]
    v_pk_mul_f32 v[126:127], v[126:127], v[10:11] op_sel_hi:[1,0]
    v_pk_mul_f32 v[128:129], v[128:129], v[10:11] op_sel_hi:[1,0]
    v_pk_mul_f32 v[130:131], v[130:131], v[10:11] op_sel_hi:[1,0]
    v_cvt_pk_bf16_f32 v212, v124, v125
    v_cvt_pk_bf16_f32 v213, v126, v127
    v_cvt_pk_bf16_f32 v214, v128, v129
    v_cvt_pk_bf16_f32 v215, v130, v131
    buffer_store_dwordx4 v[212:215], v5, s[40:43], s57 offen offset:1024 sc1
    v_pk_mul_f32 v[132:133], v[132:133], v[10:11] op_sel_hi:[1,0]
    v_pk_mul_f32 v[134:135], v[134:135], v[10:11] op_sel_hi:[1,0]
    v_pk_mul_f32 v[136:137], v[136:137], v[10:11] op_sel_hi:[1,0]
    v_pk_mul_f32 v[138:139], v[138:139], v[10:11] op_sel_hi:[1,0]
    v_cvt_pk_bf16_f32 v216, v132, v133
    v_cvt_pk_bf16_f32 v217, v134, v135
    v_cvt_pk_bf16_f32 v218, v136, v137
    v_cvt_pk_bf16_f32 v219, v138, v139
    buffer_store_dwordx4 v[216:219], v5, s[40:43], s57 offen offset:2048 sc1
    v_pk_mul_f32 v[140:141], v[140:141], v[10:11] op_sel_hi:[1,0]
    v_pk_mul_f32 v[142:143], v[142:143], v[10:11] op_sel_hi:[1,0]
    v_pk_mul_f32 v[144:145], v[144:145], v[10:11] op_sel_hi:[1,0]
    v_pk_mul_f32 v[146:147], v[146:147], v[10:11] op_sel_hi:[1,0]
    v_cvt_pk_bf16_f32 v220, v140, v141
    v_cvt_pk_bf16_f32 v221, v142, v143
    v_cvt_pk_bf16_f32 v222, v144, v145
    v_cvt_pk_bf16_f32 v223, v146, v147
    buffer_store_dwordx4 v[220:223], v5, s[40:43], s57 offen offset:3072 sc1
    v_rcp_f32 v10, v24
    s_nop 0
    v_pk_mul_f32 v[148:149], v[148:149], v[10:11] op_sel_hi:[1,0]
    v_pk_mul_f32 v[150:151], v[150:151], v[10:11] op_sel_hi:[1,0]
    v_pk_mul_f32 v[152:153], v[152:153], v[10:11] op_sel_hi:[1,0]
    v_pk_mul_f32 v[154:155], v[154:155], v[10:11] op_sel_hi:[1,0]
    v_cvt_pk_bf16_f32 v224, v148, v149
    v_cvt_pk_bf16_f32 v225, v150, v151
    v_cvt_pk_bf16_f32 v226, v152, v153
    v_cvt_pk_bf16_f32 v227, v154, v155
    s_add_u32 s57, s68, 4096
    buffer_store_dwordx4 v[224:227], v5, s[40:43], s57 offen offset:0 sc1
    v_pk_mul_f32 v[156:157], v[156:157], v[10:11] op_sel_hi:[1,0]
    v_pk_mul_f32 v[158:159], v[158:159], v[10:11] op_sel_hi:[1,0]
    v_pk_mul_f32 v[160:161], v[160:161], v[10:11] op_sel_hi:[1,0]
    v_pk_mul_f32 v[162:163], v[162:163], v[10:11] op_sel_hi:[1,0]
    v_cvt_pk_bf16_f32 v228, v156, v157
    v_cvt_pk_bf16_f32 v229, v158, v159
    v_cvt_pk_bf16_f32 v230, v160, v161
    v_cvt_pk_bf16_f32 v231, v162, v163
    buffer_store_dwordx4 v[228:231], v5, s[40:43], s57 offen offset:1024 sc1
    v_pk_mul_f32 v[164:165], v[164:165], v[10:11] op_sel_hi:[1,0]
    v_pk_mul_f32 v[166:167], v[166:167], v[10:11] op_sel_hi:[1,0]
    v_pk_mul_f32 v[168:169], v[168:169], v[10:11] op_sel_hi:[1,0]
    v_pk_mul_f32 v[170:171], v[170:171], v[10:11] op_sel_hi:[1,0]
    v_cvt_pk_bf16_f32 v232, v164, v165
    v_cvt_pk_bf16_f32 v233, v166, v167
    v_cvt_pk_bf16_f32 v234, v168, v169
    v_cvt_pk_bf16_f32 v235, v170, v171
    buffer_store_dwordx4 v[232:235], v5, s[40:43], s57 offen offset:2048 sc1
    v_pk_mul_f32 v[172:173], v[172:173], v[10:11] op_sel_hi:[1,0]
    v_pk_mul_f32 v[174:175], v[174:175], v[10:11] op_sel_hi:[1,0]
    v_pk_mul_f32 v[176:177], v[176:177], v[10:11] op_sel_hi:[1,0]
    v_pk_mul_f32 v[178:179], v[178:179], v[10:11] op_sel_hi:[1,0]
    v_cvt_pk_bf16_f32 v236, v172, v173
    v_cvt_pk_bf16_f32 v237, v174, v175
    v_cvt_pk_bf16_f32 v238, v176, v177
    v_cvt_pk_bf16_f32 v239, v178, v179
    buffer_store_dwordx4 v[236:239], v5, s[40:43], s57 offen offset:3072 sc1
    v_rcp_f32 v10, v28
    s_nop 0
    v_pk_mul_f32 v[180:181], v[180:181], v[10:11] op_sel_hi:[1,0]
    v_pk_mul_f32 v[182:183], v[182:183], v[10:11] op_sel_hi:[1,0]
    v_pk_mul_f32 v[184:185], v[184:185], v[10:11] op_sel_hi:[1,0]
    v_pk_mul_f32 v[186:187], v[186:187], v[10:11] op_sel_hi:[1,0]
    v_cvt_pk_bf16_f32 v240, v180, v181
    v_cvt_pk_bf16_f32 v241, v182, v183
    v_cvt_pk_bf16_f32 v242, v184, v185
    v_cvt_pk_bf16_f32 v243, v186, v187
    s_add_u32 s57, s68, 8192
    buffer_store_dwordx4 v[240:243], v5, s[40:43], s57 offen offset:0 sc1
    v_pk_mul_f32 v[188:189], v[188:189], v[10:11] op_sel_hi:[1,0]
    v_pk_mul_f32 v[190:191], v[190:191], v[10:11] op_sel_hi:[1,0]
    v_pk_mul_f32 v[192:193], v[192:193], v[10:11] op_sel_hi:[1,0]
    v_pk_mul_f32 v[194:195], v[194:195], v[10:11] op_sel_hi:[1,0]
    v_cvt_pk_bf16_f32 v244, v188, v189
    v_cvt_pk_bf16_f32 v245, v190, v191
    v_cvt_pk_bf16_f32 v246, v192, v193
    v_cvt_pk_bf16_f32 v247, v194, v195
    buffer_store_dwordx4 v[244:247], v5, s[40:43], s57 offen offset:1024 sc1
    v_pk_mul_f32 v[196:197], v[196:197], v[10:11] op_sel_hi:[1,0]
    v_pk_mul_f32 v[198:199], v[198:199], v[10:11] op_sel_hi:[1,0]
    v_pk_mul_f32 v[200:201], v[200:201], v[10:11] op_sel_hi:[1,0]
    v_pk_mul_f32 v[202:203], v[202:203], v[10:11] op_sel_hi:[1,0]
    v_cvt_pk_bf16_f32 v248, v196, v197
    v_cvt_pk_bf16_f32 v249, v198, v199
    v_cvt_pk_bf16_f32 v250, v200, v201
    v_cvt_pk_bf16_f32 v251, v202, v203
    buffer_store_dwordx4 v[248:251], v5, s[40:43], s57 offen offset:2048 sc1
    v_pk_mul_f32 v[204:205], v[204:205], v[10:11] op_sel_hi:[1,0]
    v_pk_mul_f32 v[206:207], v[206:207], v[10:11] op_sel_hi:[1,0]
    v_pk_mul_f32 v[208:209], v[208:209], v[10:11] op_sel_hi:[1,0]
    v_pk_mul_f32 v[210:211], v[210:211], v[10:11] op_sel_hi:[1,0]
    v_cvt_pk_bf16_f32 v252, v204, v205
    v_cvt_pk_bf16_f32 v253, v206, v207
    v_cvt_pk_bf16_f32 v254, v208, v209
    v_cvt_pk_bf16_f32 v255, v210, v211
    buffer_store_dwordx4 v[252:255], v5, s[40:43], s57 offen offset:3072 sc1
    s_waitcnt vmcnt(12)
    v_lshl_or_b32 v6, v7, 1, v6
    v_lshl_or_b32 v8, v9, 1, v8
    v_lshl_or_b32 v6, v8, 2, v6
    s_nop 0
    v_readfirstlane_b32 s81, v6
    buffer_load_dwordx4 v[6:9], off, s[40:43], s69 sc1
    s_waitcnt lgkmcnt(0)
    v_mfma_f32_16x16x32_bf16 v[124:127], a[232:235], v[16:19], 0
    s_and_b32 s56, s80, s81
    ds_read_b64_tr_b16 a[200:201], v4 offset:8512
    ds_read_b64_tr_b16 a[202:203], v4 offset:9024
    v_mfma_f32_16x16x32_bf16 v[156:159], a[232:235], v[224:227], 0
    s_cselect_b32 s22, 37797888, 0
    ds_read_b64_tr_b16 a[204:205], v4 offset:8544
    ds_read_b64_tr_b16 a[206:207], v4 offset:9056
    v_mfma_f32_16x16x32_bf16 v[188:191], a[232:235], v[240:243], 0
    s_cselect_b32 s82, 1, s82
    ds_read_b64_tr_b16 a[208:209], v4 offset:8576
    v_mfma_f32_16x16x32_bf16 v[128:131], a[236:239], v[16:19], 0
    s_ff1_i32_b32 s56, s56
    ds_read_b64_tr_b16 a[210:211], v4 offset:9088
    v_mfma_f32_16x16x32_bf16 v[160:163], a[236:239], v[224:227], 0
    s_bitset0_b32 s80, s56
    ds_read_b64_tr_b16 a[212:213], v4 offset:8608
    v_mfma_f32_16x16x32_bf16 v[192:195], a[236:239], v[240:243], 0
    s_mul_i32 s57, s56, 36864
    ds_read_b64_tr_b16 a[214:215], v4 offset:9120
    v_mfma_f32_16x16x32_bf16 v[132:135], a[240:243], v[16:19], 0
    s_add_u32 s78, s57, s86
    ds_read_b64_tr_b16 a[216:217], v4 offset:8640
    v_mfma_f32_16x16x32_bf16 v[164:167], a[240:243], v[224:227], 0
    s_add_u32 s87, s78, 4096
    ds_read_b64_tr_b16 a[218:219], v4 offset:9152
    v_mfma_f32_16x16x32_bf16 v[196:199], a[240:243], v[240:243], 0
    s_add_u32 s88, s78, 8192
    ds_read_b64_tr_b16 a[220:221], v4 offset:8672
    v_mfma_f32_16x16x32_bf16 v[136:139], a[244:247], v[16:19], 0
    s_sub_u32 s56, s56, s55
    buffer_load_dwordx4 v[68:71], v5, s[20:23], s78 offen offset:0 sc1
    v_mfma_f32_16x16x32_bf16 v[168:171], a[244:247], v[224:227], 0
    s_and_b32 s56, s56, 3
    ds_read_b64_tr_b16 a[222:223], v4 offset:9184
    v_mfma_f32_16x16x32_bf16 v[200:203], a[244:247], v[240:243], 0
    s_mul_i32 s83, s56, 33792
    buffer_load_dwordx4 v[84:87], v5, s[20:23], s87 offen offset:0 sc1
    v_mfma_f32_16x16x32_bf16 v[140:143], a[248:251], v[16:19], 0
    v_mfma_f32_16x16x32_bf16 v[172:175], a[248:251], v[224:227], 0
    buffer_load_dwordx4 v[100:103], v5, s[20:23], s88 offen offset:0 sc1
    v_mfma_f32_16x16x32_bf16 v[204:207], a[248:251], v[240:243], 0
    v_mfma_f32_16x16x32_bf16 v[144:147], a[252:255], v[16:19], 0
    buffer_load_dwordx4 v[72:75], v5, s[20:23], s78 offen offset:1024 sc1
    v_mfma_f32_16x16x32_bf16 v[176:179], a[252:255], v[224:227], 0
    v_mfma_f32_16x16x32_bf16 v[208:211], a[252:255], v[240:243], 0
    buffer_load_dwordx4 v[88:91], v5, s[20:23], s87 offen offset:1024 sc1
    s_waitcnt lgkmcnt(0)
    v_mfma_f32_16x16x32_bf16 v[124:127], a[200:203], v[212:215], v[124:127]
    buffer_load_dwordx4 v[104:107], v5, s[20:23], s88 offen offset:1024 sc1
    v_mfma_f32_16x16x32_bf16 v[156:159], a[200:203], v[228:231], v[156:159]
    ds_read_b64_tr_b16 a[232:233], v1 offset:16960
    ds_read_b64_tr_b16 a[234:235], v1 offset:17472
    v_mfma_f32_16x16x32_bf16 v[188:191], a[200:203], v[244:247], v[188:191]
    buffer_load_dwordx4 v[76:79], v5, s[20:23], s78 offen offset:2048 sc1
    v_mfma_f32_16x16x32_bf16 v[128:131], a[204:207], v[212:215], v[128:131]
    ds_read_b64_tr_b16 a[236:237], v1 offset:16992
    ds_read_b64_tr_b16 a[238:239], v1 offset:17504
    v_mfma_f32_16x16x32_bf16 v[160:163], a[204:207], v[228:231], v[160:163]
    buffer_load_dwordx4 v[92:95], v5, s[20:23], s87 offen offset:2048 sc1
    v_mfma_f32_16x16x32_bf16 v[192:195], a[204:207], v[244:247], v[192:195]
    ds_read_b64_tr_b16 a[240:241], v1 offset:17024
    ds_read_b64_tr_b16 a[242:243], v1 offset:17536
    v_mfma_f32_16x16x32_bf16 v[132:135], a[208:211], v[212:215], v[132:135]
    buffer_load_dwordx4 v[108:111], v5, s[20:23], s88 offen offset:2048 sc1
    v_mfma_f32_16x16x32_bf16 v[164:167], a[208:211], v[228:231], v[164:167]
    ds_read_b64_tr_b16 a[244:245], v1 offset:17056
    ds_read_b64_tr_b16 a[246:247], v1 offset:17568
    v_mfma_f32_16x16x32_bf16 v[196:199], a[208:211], v[244:247], v[196:199]
    buffer_load_dwordx4 v[80:83], v5, s[20:23], s78 offen offset:3072 sc1
    v_mfma_f32_16x16x32_bf16 v[136:139], a[212:215], v[212:215], v[136:139]
    ds_read_b64_tr_b16 a[248:249], v1 offset:17088
    v_mfma_f32_16x16x32_bf16 v[168:171], a[212:215], v[228:231], v[168:171]
    buffer_load_dwordx4 v[96:99], v5, s[20:23], s87 offen offset:3072 sc1
    v_mfma_f32_16x16x32_bf16 v[200:203], a[212:215], v[244:247], v[200:203]
    ds_read_b64_tr_b16 a[250:251], v1 offset:17600
    v_mfma_f32_16x16x32_bf16 v[140:143], a[216:219], v[212:215], v[140:143]
    buffer_load_dwordx4 v[112:115], v5, s[20:23], s88 offen offset:3072 sc1
    v_mfma_f32_16x16x32_bf16 v[172:175], a[216:219], v[228:231], v[172:175]
    ds_read_b64_tr_b16 a[252:253], v1 offset:17120
    v_accvgpr_read_b32 v32, a84
    v_mfma_f32_16x16x32_bf16 v[204:207], a[216:219], v[244:247], v[204:207]
    ds_read_b64_tr_b16 a[254:255], v1 offset:17632
    v_accvgpr_read_b32 v33, a85
    v_mfma_f32_16x16x32_bf16 v[144:147], a[220:223], v[212:215], v[144:147]
    v_accvgpr_read_b32 v34, a86
    v_accvgpr_read_b32 v35, a87
    v_mfma_f32_16x16x32_bf16 v[176:179], a[220:223], v[228:231], v[176:179]
    v_add_f32 v200, v200, v32
    v_add_f32 v201, v201, v33
    v_mfma_f32_16x16x32_bf16 v[208:211], a[220:223], v[244:247], v[208:211]
    v_add_f32 v202, v202, v34
    v_add_f32 v203, v203, v35
    s_waitcnt lgkmcnt(0)
    v_mfma_f32_16x16x32_bf16 v[124:127], a[232:235], v[216:219], v[124:127]
    s_and_b32 s56, s80, s81
    ds_read_b64_tr_b16 a[200:201], v1 offset:25408
    v_accvgpr_read_b32 v36, a60
    v_mfma_f32_16x16x32_bf16 v[156:159], a[232:235], v[232:235], v[156:159]
    s_cselect_b32 s22, 37797888, 0
    ds_read_b64_tr_b16 a[202:203], v1 offset:25920
    v_accvgpr_read_b32 v37, a61
    v_mfma_f32_16x16x32_bf16 v[188:191], a[232:235], v[248:251], v[188:191]
    s_cselect_b32 s82, 2, s82
    ds_read_b64_tr_b16 a[204:205], v1 offset:25440
    v_accvgpr_read_b32 v38, a62
    v_mfma_f32_16x16x32_bf16 v[128:131], a[236:239], v[216:219], v[128:131]
    s_ff1_i32_b32 s56, s56
    ds_read_b64_tr_b16 a[206:207], v1 offset:25952
    v_accvgpr_read_b32 v39, a63
    v_mfma_f32_16x16x32_bf16 v[160:163], a[236:239], v[232:235], v[160:163]
    s_bitset0_b32 s80, s56
    ds_read_b64_tr_b16 a[208:209], v1 offset:25472
    v_add_f32 v176, v176, v36
    v_mfma_f32_16x16x32_bf16 v[192:195], a[236:239], v[248:251], v[192:195]
    s_mul_i32 s57, s56, 36864
    ds_read_b64_tr_b16 a[210:211], v1 offset:25984
    v_add_f32 v177, v177, v37
    v_mfma_f32_16x16x32_bf16 v[132:135], a[240:243], v[216:219], v[132:135]
    s_add_u32 s78, s57, s86
    ds_read_b64_tr_b16 a[212:213], v1 offset:25504
    v_add_f32 v178, v178, v38
    v_mfma_f32_16x16x32_bf16 v[164:167], a[240:243], v[232:235], v[164:167]
    s_add_u32 s87, s78, 4096
    ds_read_b64_tr_b16 a[214:215], v1 offset:26016
    v_add_f32 v179, v179, v39
    v_mfma_f32_16x16x32_bf16 v[196:199], a[240:243], v[248:251], v[196:199]
    s_add_u32 s88, s78, 8192
    ds_read_b64_tr_b16 a[216:217], v1 offset:25536
    v_accvgpr_read_b32 v40, a16
    v_mfma_f32_16x16x32_bf16 v[136:139], a[244:247], v[216:219], v[136:139]
    s_sub_u32 s56, s56, s55
    ds_read_b64_tr_b16 a[218:219], v1 offset:26048
    v_accvgpr_read_b32 v41, a17
    v_mfma_f32_16x16x32_bf16 v[168:171], a[244:247], v[232:235], v[168:171]
    s_and_b32 s56, s56, 3
    ds_read_b64_tr_b16 a[220:221], v1 offset:25568
    v_accvgpr_read_b32 v42, a18
    v_mfma_f32_16x16x32_bf16 v[200:203], a[244:247], v[248:251], v[200:203]
    s_mul_i32 s84, s56, 33792
    ds_read_b64_tr_b16 a[222:223], v1 offset:26080
    v_accvgpr_read_b32 v43, a19
    v_mfma_f32_16x16x32_bf16 v[140:143], a[248:251], v[216:219], v[140:143]
    v_add_f32 v132, v132, v40
    v_add_f32 v133, v133, v41
    v_mfma_f32_16x16x32_bf16 v[172:175], a[248:251], v[232:235], v[172:175]
    v_add_f32 v134, v134, v42
    v_add_f32 v135, v135, v43
    v_mfma_f32_16x16x32_bf16 v[204:207], a[248:251], v[248:251], v[204:207]
    v_accvgpr_read_b32 v44, a24
    v_accvgpr_read_b32 v45, a25
    v_mfma_f32_16x16x32_bf16 v[144:147], a[252:255], v[216:219], v[144:147]
    v_accvgpr_read_b32 v46, a26
    v_accvgpr_read_b32 v47, a27
    v_mfma_f32_16x16x32_bf16 v[176:179], a[252:255], v[232:235], v[176:179]
    v_add_f32 v140, v140, v44
    v_add_f32 v141, v141, v45
    v_mfma_f32_16x16x32_bf16 v[208:211], a[252:255], v[248:251], v[208:211]
    v_add_f32 v142, v142, v46
    v_add_f32 v143, v143, v47
    s_waitcnt lgkmcnt(0)
    s_waitcnt vmcnt(12)
    s_mov_b64 exec, 15
    v_mov_b32 v11, 1
    buffer_store_dword v11, v2, s[40:43], s76 offen sc1
    s_mov_b64 exec, -1
    s_barrier
    s_cmp_ge_u32 s82, 2
    s_cbranch_scc1 L_bd1
    v_lshl_or_b32 v6, v7, 1, v6
    v_lshl_or_b32 v8, v9, 1, v8
    v_lshl_or_b32 v6, v8, 2, v6
    s_nop 0
    v_readfirstlane_b32 s81, v6
    s_nop 1
    s_cmp_ge_u32 s82, 1
    s_cbranch_scc1 L_en1_e
    s_mov_b32 s72, 131072
L_en1:
    s_and_b32 s56, s80, s81
    s_cbranch_scc1 L_en1_g
    s_sub_u32 s72, s72, 1
    s_cmp_eq_u32 s72, 0
    s_cbranch_scc1 L_en1_e
    buffer_load_dwordx4 v[6:9], off, s[40:43], s69 sc1
    s_waitcnt vmcnt(0)
    v_lshl_or_b32 v6, v7, 1, v6
    v_lshl_or_b32 v8, v9, 1, v8
    v_lshl_or_b32 v6, v8, 2, v6
    s_nop 0
    v_readfirstlane_b32 s81, v6
    s_nop 1
    s_branch L_en1
L_en1_g:
    s_ff1_i32_b32 s56, s56
    s_bitset0_b32 s80, s56
    s_mul_i32 s57, s56, 36864
    s_add_u32 s78, s57, s86
    s_add_u32 s87, s78, 4096
    s_add_u32 s88, s78, 8192
    s_sub_u32 s56, s56, s55
    s_and_b32 s56, s56, 3
    s_mul_i32 s83, s56, 33792
    s_mov_b32 s82, 1
    buffer_load_dwordx4 v[68:71], v5, s[40:43], s78 offen offset:0 sc1
    buffer_load_dwordx4 v[84:87], v5, s[40:43], s87 offen offset:0 sc1
    buffer_load_dwordx4 v[100:103], v5, s[40:43], s88 offen offset:0 sc1
    buffer_load_dwordx4 v[72:75], v5, s[40:43], s78 offen offset:1024 sc1
    buffer_load_dwordx4 v[88:91], v5, s[40:43], s87 offen offset:1024 sc1
    buffer_load_dwordx4 v[104:107], v5, s[40:43], s88 offen offset:1024 sc1
    buffer_load_dwordx4 v[76:79], v5, s[40:43], s78 offen offset:2048 sc1
    buffer_load_dwordx4 v[92:95], v5, s[40:43], s87 offen offset:2048 sc1
    buffer_load_dwordx4 v[108:111], v5, s[40:43], s88 offen offset:2048 sc1
    buffer_load_dwordx4 v[80:83], v5, s[40:43], s78 offen offset:3072 sc1
    buffer_load_dwordx4 v[96:99], v5, s[40:43], s87 offen offset:3072 sc1
    buffer_load_dwordx4 v[112:115], v5, s[40:43], s88 offen offset:3072 sc1
    s_mov_b64 exec, 15
    v_mov_b32 v11, 1
    buffer_store_dword v11, v2, s[40:43], s76 offen sc1
    s_mov_b64 exec, -1
L_en1_e:
    s_mov_b32 s22, 0
    s_and_b32 s56, s80, s81
    s_cbranch_scc0 L_arm2
    s_ff1_i32_b32 s56, s56
    s_bitset0_b32 s80, s56
    s_mul_i32 s57, s56, 36864
    s_add_u32 s78, s57, s86
    s_add_u32 s87, s78, 4096
    s_add_u32 s88, s78, 8192
    s_sub_u32 s56, s56, s55
    s_and_b32 s56, s56, 3
    s_mul_i32 s84, s56, 33792
    s_mov_b32 s82, 2
    s_mov_b32 s22, 37797888
L_arm2:
L_bd1:
    v_add_u32 v3, s83, v1
    v_mfma_f32_16x16x32_bf16 v[124:127], a[200:203], v[220:223], v[124:127]
    ds_read_b64_tr_b16 a[232:233], v3 offset:64
    ds_read_b64_tr_b16 a[234:235], v3 offset:576
    v_mfma_f32_16x16x32_bf16 v[156:159], a[200:203], v[236:239], v[156:159]
    buffer_load_dwordx4 a[96:99], v5, s[20:23], s78 offen offset:0 sc1
    v_mfma_f32_16x16x32_bf16 v[188:191], a[200:203], v[252:255], v[188:191]
    ds_read_b64_tr_b16 a[236:237], v3 offset:96
    ds_read_b64_tr_b16 a[238:239], v3 offset:608
    v_mfma_f32_16x16x32_bf16 v[128:131], a[204:207], v[220:223], v[128:131]
    ds_read_b64_tr_b16 a[240:241], v3 offset:128
    v_accvgpr_read_b32 v48, a40
    v_mfma_f32_16x16x32_bf16 v[160:163], a[204:207], v[236:239], v[160:163]
    buffer_load_dwordx4 a[112:115], v5, s[20:23], s87 offen offset:0 sc1
    v_mfma_f32_16x16x32_bf16 v[192:195], a[204:207], v[252:255], v[192:195]
    ds_read_b64_tr_b16 a[242:243], v3 offset:640
    v_accvgpr_read_b32 v49, a41
    v_mfma_f32_16x16x32_bf16 v[132:135], a[208:211], v[220:223], v[132:135]
    ds_read_b64_tr_b16 a[244:245], v3 offset:160
    v_accvgpr_read_b32 v50, a42
    v_mfma_f32_16x16x32_bf16 v[164:167], a[208:211], v[236:239], v[164:167]
    buffer_load_dwordx4 a[128:131], v5, s[20:23], s88 offen offset:0 sc1
    v_mfma_f32_16x16x32_bf16 v[196:199], a[208:211], v[252:255], v[196:199]
    ds_read_b64_tr_b16 a[246:247], v3 offset:672
    v_accvgpr_read_b32 v51, a43
    v_mfma_f32_16x16x32_bf16 v[136:139], a[212:215], v[220:223], v[136:139]
    ds_read_b64_tr_b16 a[248:249], v3 offset:192
    v_add_f32 v156, v156, v48
    v_mfma_f32_16x16x32_bf16 v[168:171], a[212:215], v[236:239], v[168:171]
    buffer_load_dwordx4 a[100:103], v5, s[20:23], s78 offen offset:1024 sc1
    v_mfma_f32_16x16x32_bf16 v[200:203], a[212:215], v[252:255], v[200:203]
    ds_read_b64_tr_b16 a[250:251], v3 offset:704
    v_add_f32 v157, v157, v49
    v_mfma_f32_16x16x32_bf16 v[140:143], a[216:219], v[220:223], v[140:143]
    ds_read_b64_tr_b16 a[252:253], v3 offset:224
    v_add_f32 v158, v158, v50
    v_mfma_f32_16x16x32_bf16 v[172:175], a[216:219], v[236:239], v[172:175]
    buffer_load_dwordx4 a[116:119], v5, s[20:23], s87 offen offset:1024 sc1
    v_mfma_f32_16x16x32_bf16 v[204:207], a[216:219], v[252:255], v[204:207]
    ds_read_b64_tr_b16 a[254:255], v3 offset:736
    v_add_f32 v159, v159, v51
    v_mfma_f32_16x16x32_bf16 v[144:147], a[220:223], v[220:223], v[144:147]
    v_accvgpr_read_b32 v52, a56
    v_accvgpr_read_b32 v53, a57
    v_mfma_f32_16x16x32_bf16 v[176:179], a[220:223], v[236:239], v[176:179]
    buffer_load_dwordx4 a[132:135], v5, s[20:23], s88 offen offset:1024 sc1
    v_mfma_f32_16x16x32_bf16 v[208:211], a[220:223], v[252:255], v[208:211]
    v_accvgpr_read_b32 v54, a58
    v_accvgpr_read_b32 v55, a59
    s_waitcnt lgkmcnt(0)
    s_waitcnt vmcnt(7)
    buffer_load_dwordx4 v[6:9], off, s[40:43], s69 sc1
    v_mfma_f32_16x16x32_bf16 v[124:127], a[232:235], v[68:71], v[124:127]
    ds_read_b64_tr_b16 a[200:201], v3 offset:8512
    ds_read_b64_tr_b16 a[202:203], v3 offset:9024
    v_mfma_f32_16x16x32_bf16 v[156:159], a[232:235], v[84:87], v[156:159]
    buffer_load_dwordx4 a[104:107], v5, s[20:23], s78 offen offset:2048 sc1
    v_mfma_f32_16x16x32_bf16 v[188:191], a[232:235], v[100:103], v[188:191]
    ds_read_b64_tr_b16 a[204:205], v3 offset:8544
    ds_read_b64_tr_b16 a[206:207], v3 offset:9056
    v_mfma_f32_16x16x32_bf16 v[128:131], a[236:239], v[68:71], v[128:131]
    ds_read_b64_tr_b16 a[208:209], v3 offset:8576
    v_add_f32 v172, v172, v52
    v_mfma_f32_16x16x32_bf16 v[160:163], a[236:239], v[84:87], v[160:163]
    buffer_load_dwordx4 a[120:123], v5, s[20:23], s87 offen offset:2048 sc1
    v_mfma_f32_16x16x32_bf16 v[192:195], a[236:239], v[100:103], v[192:195]
    ds_read_b64_tr_b16 a[210:211], v3 offset:9088
    v_add_f32 v173, v173, v53
    v_mfma_f32_16x16x32_bf16 v[132:135], a[240:243], v[68:71], v[132:135]
    ds_read_b64_tr_b16 a[212:213], v3 offset:8608
    v_add_f32 v174, v174, v54
    v_mfma_f32_16x16x32_bf16 v[164:167], a[240:243], v[84:87], v[164:167]
    buffer_load_dwordx4 a[136:139], v5, s[20:23], s88 offen offset:2048 sc1
    v_mfma_f32_16x16x32_bf16 v[196:199], a[240:243], v[100:103], v[196:199]
    ds_read_b64_tr_b16 a[214:215], v3 offset:9120
    v_add_f32 v175, v175, v55
    v_mfma_f32_16x16x32_bf16 v[136:139], a[244:247], v[68:71], v[136:139]
    ds_read_b64_tr_b16 a[216:217], v3 offset:8640
    v_accvgpr_read_b32 v32, a48
    v_mfma_f32_16x16x32_bf16 v[168:171], a[244:247], v[84:87], v[168:171]
    buffer_load_dwordx4 a[108:111], v5, s[20:23], s78 offen offset:3072 sc1
    v_mfma_f32_16x16x32_bf16 v[200:203], a[244:247], v[100:103], v[200:203]
    ds_read_b64_tr_b16 a[218:219], v3 offset:9152
    v_accvgpr_read_b32 v33, a49
    v_mfma_f32_16x16x32_bf16 v[140:143], a[248:251], v[68:71], v[140:143]
    ds_read_b64_tr_b16 a[220:221], v3 offset:8672
    v_accvgpr_read_b32 v34, a50
    v_mfma_f32_16x16x32_bf16 v[172:175], a[248:251], v[84:87], v[172:175]
    buffer_load_dwordx4 a[124:127], v5, s[20:23], s87 offen offset:3072 sc1
    v_mfma_f32_16x16x32_bf16 v[204:207], a[248:251], v[100:103], v[204:207]
    ds_read_b64_tr_b16 a[222:223], v3 offset:9184
    v_accvgpr_read_b32 v35, a51
    v_mfma_f32_16x16x32_bf16 v[144:147], a[252:255], v[68:71], v[144:147]
    v_add_f32 v164, v164, v32
    v_add_f32 v165, v165, v33
    v_mfma_f32_16x16x32_bf16 v[176:179], a[252:255], v[84:87], v[176:179]
    buffer_load_dwordx4 a[140:143], v5, s[20:23], s88 offen offset:3072 sc1
    v_mfma_f32_16x16x32_bf16 v[208:211], a[252:255], v[100:103], v[208:211]
    v_add_f32 v166, v166, v34
    v_add_f32 v167, v167, v35
    s_waitcnt lgkmcnt(0)
    v_mfma_f32_16x16x32_bf16 v[124:127], a[200:203], v[72:75], v[124:127]
    s_mov_b64 s[24:25], s[40:41]
    ds_read_b64_tr_b16 a[232:233], v3 offset:16960
    v_accvgpr_read_b32 v36, a28
    v_mfma_f32_16x16x32_bf16 v[156:159], a[200:203], v[88:91], v[156:159]
    s_mov_b64 s[28:29], s[40:41]
    ds_read_b64_tr_b16 a[234:235], v3 offset:17472
    v_accvgpr_read_b32 v37, a29
    v_mfma_f32_16x16x32_bf16 v[188:191], a[200:203], v[104:107], v[188:191]
    ds_read_b64_tr_b16 a[236:237], v3 offset:16992
    v_accvgpr_read_b32 v38, a30
    v_mfma_f32_16x16x32_bf16 v[128:131], a[204:207], v[72:75], v[128:131]
    ds_read_b64_tr_b16 a[238:239], v3 offset:17504
    v_accvgpr_read_b32 v39, a31
    v_mfma_f32_16x16x32_bf16 v[160:163], a[204:207], v[88:91], v[160:163]
    ds_read_b64_tr_b16 a[240:241], v3 offset:17024
    v_add_f32 v144, v144, v36
    v_mfma_f32_16x16x32_bf16 v[192:195], a[204:207], v[104:107], v[192:195]
    ds_read_b64_tr_b16 a[242:243], v3 offset:17536
    v_add_f32 v145, v145, v37
    v_mfma_f32_16x16x32_bf16 v[132:135], a[208:211], v[72:75], v[132:135]
    ds_read_b64_tr_b16 a[244:245], v3 offset:17056
    v_add_f32 v146, v146, v38
    v_mfma_f32_16x16x32_bf16 v[164:167], a[208:211], v[88:91], v[164:167]
    ds_read_b64_tr_b16 a[246:247], v3 offset:17568
    v_add_f32 v147, v147, v39
    v_mfma_f32_16x16x32_bf16 v[196:199], a[208:211], v[104:107], v[196:199]
    ds_read_b64_tr_b16 a[248:249], v3 offset:17088
    v_accvgpr_read_b32 v40, a76
    v_mfma_f32_16x16x32_bf16 v[136:139], a[212:215], v[72:75], v[136:139]
    ds_read_b64_tr_b16 a[250:251], v3 offset:17600
    v_accvgpr_read_b32 v41, a77
    v_mfma_f32_16x16x32_bf16 v[168:171], a[212:215], v[88:91], v[168:171]
    ds_read_b64_tr_b16 a[252:253], v3 offset:17120
    v_accvgpr_read_b32 v42, a78
    v_mfma_f32_16x16x32_bf16 v[200:203], a[212:215], v[104:107], v[200:203]
    ds_read_b64_tr_b16 a[254:255], v3 offset:17632
    v_accvgpr_read_b32 v43, a79
    v_mfma_f32_16x16x32_bf16 v[140:143], a[216:219], v[72:75], v[140:143]
    v_add_f32 v192, v192, v40
    v_add_f32 v193, v193, v41
    v_mfma_f32_16x16x32_bf16 v[172:175], a[216:219], v[88:91], v[172:175]
    v_add_f32 v194, v194, v42
    v_add_f32 v195, v195, v43
    v_mfma_f32_16x16x32_bf16 v[204:207], a[216:219], v[104:107], v[204:207]
    v_accvgpr_read_b32 v44, a52
    v_accvgpr_read_b32 v45, a53
    v_mfma_f32_16x16x32_bf16 v[144:147], a[220:223], v[72:75], v[144:147]
    v_accvgpr_read_b32 v46, a54
    v_accvgpr_read_b32 v47, a55
    v_mfma_f32_16x16x32_bf16 v[176:179], a[220:223], v[88:91], v[176:179]
    v_add_f32 v168, v168, v44
    v_add_f32 v169, v169, v45
    v_mfma_f32_16x16x32_bf16 v[208:211], a[220:223], v[104:107], v[208:211]
    v_add_f32 v170, v170, v46
    v_add_f32 v171, v171, v47
    s_waitcnt lgkmcnt(0)
    v_mfma_f32_16x16x32_bf16 v[124:127], a[232:235], v[76:79], v[124:127]
    s_and_b32 s56, s80, s81
    ds_read_b64_tr_b16 a[200:201], v3 offset:25408
    v_accvgpr_read_b32 v48, a88
    v_mfma_f32_16x16x32_bf16 v[156:159], a[232:235], v[92:95], v[156:159]
    s_cselect_b32 s22, 37797888, 0
    ds_read_b64_tr_b16 a[202:203], v3 offset:25920
    v_accvgpr_read_b32 v49, a89
    v_mfma_f32_16x16x32_bf16 v[188:191], a[232:235], v[108:111], v[188:191]
    s_cselect_b32 s82, 3, s82
    ds_read_b64_tr_b16 a[204:205], v3 offset:25440
    v_accvgpr_read_b32 v50, a90
    v_mfma_f32_16x16x32_bf16 v[128:131], a[236:239], v[76:79], v[128:131]
    s_ff1_i32_b32 s56, s56
    ds_read_b64_tr_b16 a[206:207], v3 offset:25952
    v_accvgpr_read_b32 v51, a91
    v_mfma_f32_16x16x32_bf16 v[160:163], a[236:239], v[92:95], v[160:163]
    s_bitset0_b32 s80, s56
    ds_read_b64_tr_b16 a[208:209], v3 offset:25472
    v_add_f32 v204, v204, v48
    v_mfma_f32_16x16x32_bf16 v[192:195], a[236:239], v[108:111], v[192:195]
    s_mul_i32 s57, s56, 36864
    ds_read_b64_tr_b16 a[210:211], v3 offset:25984
    v_add_f32 v205, v205, v49
    v_mfma_f32_16x16x32_bf16 v[132:135], a[240:243], v[76:79], v[132:135]
    s_add_u32 s78, s57, s86
    ds_read_b64_tr_b16 a[212:213], v3 offset:25504
    v_add_f32 v206, v206, v50
    v_mfma_f32_16x16x32_bf16 v[164:167], a[240:243], v[92:95], v[164:167]
    s_add_u32 s87, s78, 4096
    ds_read_b64_tr_b16 a[214:215], v3 offset:26016
    v_add_f32 v207, v207, v51
    v_mfma_f32_16x16x32_bf16 v[196:199], a[240:243], v[108:111], v[196:199]
    s_add_u32 s88, s78, 8192
    ds_read_b64_tr_b16 a[216:217], v3 offset:25536
    v_accvgpr_read_b32 v52, a44
    v_mfma_f32_16x16x32_bf16 v[136:139], a[244:247], v[76:79], v[136:139]
    s_sub_u32 s56, s56, s55
    ds_read_b64_tr_b16 a[218:219], v3 offset:26048
    v_accvgpr_read_b32 v53, a45
    v_mfma_f32_16x16x32_bf16 v[168:171], a[244:247], v[92:95], v[168:171]
    s_and_b32 s56, s56, 3
    ds_read_b64_tr_b16 a[220:221], v3 offset:25568
    v_accvgpr_read_b32 v54, a46
    v_mfma_f32_16x16x32_bf16 v[200:203], a[244:247], v[108:111], v[200:203]
    s_mul_i32 s85, s56, 33792
    ds_read_b64_tr_b16 a[222:223], v3 offset:26080
    v_accvgpr_read_b32 v55, a47
    v_mfma_f32_16x16x32_bf16 v[140:143], a[248:251], v[76:79], v[140:143]
    v_add_f32 v160, v160, v52
    v_add_f32 v161, v161, v53
    v_mfma_f32_16x16x32_bf16 v[172:175], a[248:251], v[92:95], v[172:175]
    v_add_f32 v162, v162, v54
    v_add_f32 v163, v163, v55
    v_mfma_f32_16x16x32_bf16 v[204:207], a[248:251], v[108:111], v[204:207]
    v_accvgpr_read_b32 v32, a20
    v_accvgpr_read_b32 v33, a21
    v_mfma_f32_16x16x32_bf16 v[144:147], a[252:255], v[76:79], v[144:147]
    v_accvgpr_read_b32 v34, a22
    v_accvgpr_read_b32 v35, a23
    v_mfma_f32_16x16x32_bf16 v[176:179], a[252:255], v[92:95], v[176:179]
    v_add_f32 v136, v136, v32
    v_add_f32 v137, v137, v33
    v_mfma_f32_16x16x32_bf16 v[208:211], a[252:255], v[108:111], v[208:211]
    v_add_f32 v138, v138, v34
    v_add_f32 v139, v139, v35
    s_waitcnt lgkmcnt(0)
    s_cmp_ge_u32 s82, 3
    s_cbranch_scc1 L_bd2
    s_waitcnt vmcnt(6)
    v_lshl_or_b32 v6, v7, 1, v6
    v_lshl_or_b32 v8, v9, 1, v8
    v_lshl_or_b32 v6, v8, 2, v6
    s_nop 0
    v_readfirstlane_b32 s81, v6
    s_nop 1
    s_cmp_ge_u32 s82, 2
    s_cbranch_scc1 L_en2_e
    s_mov_b32 s72, 131072
L_en2:
    s_and_b32 s56, s80, s81
    s_cbranch_scc1 L_en2_g
    s_sub_u32 s72, s72, 1
    s_cmp_eq_u32 s72, 0
    s_cbranch_scc1 L_en2_e
    buffer_load_dwordx4 v[6:9], off, s[40:43], s69 sc1
    s_waitcnt vmcnt(0)
    v_lshl_or_b32 v6, v7, 1, v6
    v_lshl_or_b32 v8, v9, 1, v8
    v_lshl_or_b32 v6, v8, 2, v6
    s_nop 0
    v_readfirstlane_b32 s81, v6
    s_nop 1
    s_branch L_en2
L_en2_g:
    s_ff1_i32_b32 s56, s56
    s_bitset0_b32 s80, s56
    s_mul_i32 s57, s56, 36864
    s_add_u32 s78, s57, s86
    s_add_u32 s87, s78, 4096
    s_add_u32 s88, s78, 8192
    s_sub_u32 s56, s56, s55
    s_and_b32 s56, s56, 3
    s_mul_i32 s84, s56, 33792
    s_mov_b32 s82, 2
    buffer_load_dwordx4 a[96:99], v5, s[40:43], s78 offen offset:0 sc1
    buffer_load_dwordx4 a[112:115], v5, s[40:43], s87 offen offset:0 sc1
    buffer_load_dwordx4 a[128:131], v5, s[40:43], s88 offen offset:0 sc1
    buffer_load_dwordx4 a[100:103], v5, s[40:43], s78 offen offset:1024 sc1
    buffer_load_dwordx4 a[116:119], v5, s[40:43], s87 offen offset:1024 sc1
    buffer_load_dwordx4 a[132:135], v5, s[40:43], s88 offen offset:1024 sc1
    buffer_load_dwordx4 a[104:107], v5, s[40:43], s78 offen offset:2048 sc1
    buffer_load_dwordx4 a[120:123], v5, s[40:43], s87 offen offset:2048 sc1
    buffer_load_dwordx4 a[136:139], v5, s[40:43], s88 offen offset:2048 sc1
    buffer_load_dwordx4 a[108:111], v5, s[40:43], s78 offen offset:3072 sc1
    buffer_load_dwordx4 a[124:127], v5, s[40:43], s87 offen offset:3072 sc1
    buffer_load_dwordx4 a[140:143], v5, s[40:43], s88 offen offset:3072 sc1
L_en2_e:
    s_mov_b32 s22, 0
    s_and_b32 s56, s80, s81
    s_cbranch_scc0 L_arm3
    s_ff1_i32_b32 s56, s56
    s_bitset0_b32 s80, s56
    s_mul_i32 s57, s56, 36864
    s_add_u32 s78, s57, s86
    s_add_u32 s87, s78, 4096
    s_add_u32 s88, s78, 8192
    s_sub_u32 s56, s56, s55
    s_and_b32 s56, s56, 3
    s_mul_i32 s85, s56, 33792
    s_mov_b32 s82, 3
    s_mov_b32 s22, 37797888
L_arm3:
L_bd2:
    v_add_u32 v3, s84, v1
    v_mfma_f32_16x16x32_bf16 v[124:127], a[200:203], v[80:83], v[124:127]
    ds_read_b64_tr_b16 a[232:233], v3 offset:64
    ds_read_b64_tr_b16 a[234:235], v3 offset:576
    v_mfma_f32_16x16x32_bf16 v[156:159], a[200:203], v[96:99], v[156:159]
    buffer_load_dwordx4 a[144:147], v5, s[20:23], s78 offen offset:0 sc1
    v_mfma_f32_16x16x32_bf16 v[188:191], a[200:203], v[112:115], v[188:191]
    ds_read_b64_tr_b16 a[236:237], v3 offset:96
    ds_read_b64_tr_b16 a[238:239], v3 offset:608
    v_mfma_f32_16x16x32_bf16 v[128:131], a[204:207], v[80:83], v[128:131]
    ds_read_b64_tr_b16 a[240:241], v3 offset:128
    v_accvgpr_read_b32 v36, a8
    v_mfma_f32_16x16x32_bf16 v[160:163], a[204:207], v[96:99], v[160:163]
    buffer_load_dwordx4 a[160:163], v5, s[20:23], s87 offen offset:0 sc1
    v_mfma_f32_16x16x32_bf16 v[192:195], a[204:207], v[112:115], v[192:195]
    ds_read_b64_tr_b16 a[242:243], v3 offset:640
    v_accvgpr_read_b32 v37, a9
    v_mfma_f32_16x16x32_bf16 v[132:135], a[208:211], v[80:83], v[132:135]
    ds_read_b64_tr_b16 a[244:245], v3 offset:160
    v_accvgpr_read_b32 v38, a10
    v_mfma_f32_16x16x32_bf16 v[164:167], a[208:211], v[96:99], v[164:167]
    buffer_load_dwordx4 a[176:179], v5, s[20:23], s88 offen offset:0 sc1
    v_mfma_f32_16x16x32_bf16 v[196:199], a[208:211], v[112:115], v[196:199]
    ds_read_b64_tr_b16 a[246:247], v3 offset:672
    v_accvgpr_read_b32 v39, a11
    v_mfma_f32_16x16x32_bf16 v[136:139], a[212:215], v[80:83], v[136:139]
    ds_read_b64_tr_b16 a[248:249], v3 offset:192
    v_add_f32 v124, v124, v36
    v_mfma_f32_16x16x32_bf16 v[168:171], a[212:215], v[96:99], v[168:171]
    buffer_load_dwordx4 a[148:151], v5, s[20:23], s78 offen offset:1024 sc1
    v_mfma_f32_16x16x32_bf16 v[200:203], a[212:215], v[112:115], v[200:203]
    ds_read_b64_tr_b16 a[250:251], v3 offset:704
    v_add_f32 v125, v125, v37
    v_mfma_f32_16x16x32_bf16 v[140:143], a[216:219], v[80:83], v[140:143]
    ds_read_b64_tr_b16 a[252:253], v3 offset:224
    v_add_f32 v126, v126, v38
    v_mfma_f32_16x16x32_bf16 v[172:175], a[216:219], v[96:99], v[172:175]
    buffer_load_dwordx4 a[164:167], v5, s[20:23], s87 offen offset:1024 sc1
    v_mfma_f32_16x16x32_bf16 v[204:207], a[216:219], v[112:115], v[204:207]
    ds_read_b64_tr_b16 a[254:255], v3 offset:736
    v_add_f32 v127, v127, v39
    v_mfma_f32_16x16x32_bf16 v[144:147], a[220:223], v[80:83], v[144:147]
    v_accvgpr_read_b32 v40, a80
    v_accvgpr_read_b32 v41, a81
    v_mfma_f32_16x16x32_bf16 v[176:179], a[220:223], v[96:99], v[176:179]
    buffer_load_dwordx4 a[180:183], v5, s[20:23], s88 offen offset:1024 sc1
    v_mfma_f32_16x16x32_bf16 v[208:211], a[220:223], v[112:115], v[208:211]
    v_accvgpr_read_b32 v42, a82
    v_accvgpr_read_b32 v43, a83
    s_waitcnt lgkmcnt(0)
    s_waitcnt vmcnt(6)
    buffer_load_dwordx4 v[6:9], off, s[40:43], s69 sc1
    v_mfma_f32_16x16x32_bf16 v[124:127], a[232:235], a[96:99], v[124:127]
    ds_read_b64_tr_b16 a[200:201], v3 offset:8512
    ds_read_b64_tr_b16 a[202:203], v3 offset:9024
    v_mfma_f32_16x16x32_bf16 v[156:159], a[232:235], a[112:115], v[156:159]
    buffer_load_dwordx4 a[152:155], v5, s[20:23], s78 offen offset:2048 sc1
    v_mfma_f32_16x16x32_bf16 v[188:191], a[232:235], a[128:131], v[188:191]
    ds_read_b64_tr_b16 a[204:205], v3 offset:8544
    ds_read_b64_tr_b16 a[206:207], v3 offset:9056
    v_mfma_f32_16x16x32_bf16 v[128:131], a[236:239], a[96:99], v[128:131]
    ds_read_b64_tr_b16 a[208:209], v3 offset:8576
    v_add_f32 v196, v196, v40
    v_mfma_f32_16x16x32_bf16 v[160:163], a[236:239], a[112:115], v[160:163]
    buffer_load_dwordx4 a[168:171], v5, s[20:23], s87 offen offset:2048 sc1
    v_mfma_f32_16x16x32_bf16 v[192:195], a[236:239], a[128:131], v[192:195]
    ds_read_b64_tr_b16 a[210:211], v3 offset:9088
    v_add_f32 v197, v197, v41
    v_mfma_f32_16x16x32_bf16 v[132:135], a[240:243], a[96:99], v[132:135]
    ds_read_b64_tr_b16 a[212:213], v3 offset:8608
    v_accvgpr_read_b32 v44, a12
    v_mfma_f32_16x16x32_bf16 v[164:167], a[240:243], a[112:115], v[164:167]
    buffer_load_dwordx4 a[184:187], v5, s[20:23], s88 offen offset:2048 sc1
    v_mfma_f32_16x16x32_bf16 v[196:199], a[240:243], a[128:131], v[196:199]
    ds_read_b64_tr_b16 a[214:215], v3 offset:9120
    v_accvgpr_read_b32 v45, a13
    v_mfma_f32_16x16x32_bf16 v[136:139], a[244:247], a[96:99], v[136:139]
    ds_read_b64_tr_b16 a[216:217], v3 offset:8640
    v_accvgpr_read_b32 v46, a14
    v_mfma_f32_16x16x32_bf16 v[168:171], a[244:247], a[112:115], v[168:171]
    buffer_load_dwordx4 a[156:159], v5, s[20:23], s78 offen offset:3072 sc1
    v_mfma_f32_16x16x32_bf16 v[200:203], a[244:247], a[128:131], v[200:203]
    ds_read_b64_tr_b16 a[218:219], v3 offset:9152
    v_add_f32 v198, v198, v42
    v_mfma_f32_16x16x32_bf16 v[140:143], a[248:251], a[96:99], v[140:143]
    ds_read_b64_tr_b16 a[220:221], v3 offset:8672
    v_add_f32 v199, v199, v43
    v_mfma_f32_16x16x32_bf16 v[172:175], a[248:251], a[112:115], v[172:175]
    buffer_load_dwordx4 a[172:175], v5, s[20:23], s87 offen offset:3072 sc1
    v_mfma_f32_16x16x32_bf16 v[204:207], a[248:251], a[128:131], v[204:207]
    ds_read_b64_tr_b16 a[222:223], v3 offset:9184
    v_accvgpr_read_b32 v47, a15
    v_mfma_f32_16x16x32_bf16 v[144:147], a[252:255], a[96:99], v[144:147]
    v_add_f32 v128, v128, v44
    v_add_f32 v129, v129, v45
    v_mfma_f32_16x16x32_bf16 v[176:179], a[252:255], a[112:115], v[176:179]
    buffer_load_dwordx4 a[188:191], v5, s[20:23], s88 offen offset:3072 sc1
    v_mfma_f32_16x16x32_bf16 v[208:211], a[252:255], a[128:131], v[208:211]
    v_add_f32 v130, v130, v46
    v_add_f32 v131, v131, v47
    s_waitcnt lgkmcnt(0)
    v_mfma_f32_16x16x32_bf16 v[124:127], a[200:203], a[100:103], v[124:127]
    ds_read_b64_tr_b16 a[232:233], v3 offset:16960
    v_accvgpr_read_b32 v48, a72
    v_mfma_f32_16x16x32_bf16 v[156:159], a[200:203], a[116:119], v[156:159]
    ds_read_b64_tr_b16 a[234:235], v3 offset:17472
    v_accvgpr_read_b32 v49, a73
    v_mfma_f32_16x16x32_bf16 v[188:191], a[200:203], a[132:135], v[188:191]
    ds_read_b64_tr_b16 a[236:237], v3 offset:16992
    v_accvgpr_read_b32 v50, a74
    v_mfma_f32_16x16x32_bf16 v[128:131], a[204:207], a[100:103], v[128:131]
    ds_read_b64_tr_b16 a[238:239], v3 offset:17504
    v_accvgpr_read_b32 v51, a75
    v_mfma_f32_16x16x32_bf16 v[160:163], a[204:207], a[116:119], v[160:163]
    ds_read_b64_tr_b16 a[240:241], v3 offset:17024
    v_accvgpr_read_b32 v52, a92
    v_mfma_f32_16x16x32_bf16 v[192:195], a[204:207], a[132:135], v[192:195]
    ds_read_b64_tr_b16 a[242:243], v3 offset:17536
    v_add_f32 v188, v188, v48
    v_mfma_f32_16x16x32_bf16 v[132:135], a[208:211], a[100:103], v[132:135]
    ds_read_b64_tr_b16 a[244:245], v3 offset:17056
    v_add_f32 v189, v189, v49
    v_mfma_f32_16x16x32_bf16 v[164:167], a[208:211], a[116:119], v[164:167]
    ds_read_b64_tr_b16 a[246:247], v3 offset:17568
    v_add_f32 v190, v190, v50
    v_mfma_f32_16x16x32_bf16 v[196:199], a[208:211], a[132:135], v[196:199]
    ds_read_b64_tr_b16 a[248:249], v3 offset:17088
    v_add_f32 v191, v191, v51
    v_mfma_f32_16x16x32_bf16 v[136:139], a[212:215], a[100:103], v[136:139]
    ds_read_b64_tr_b16 a[250:251], v3 offset:17600
    v_accvgpr_read_b32 v53, a93
    v_mfma_f32_16x16x32_bf16 v[168:171], a[212:215], a[116:119], v[168:171]
    ds_read_b64_tr_b16 a[252:253], v3 offset:17120
    v_accvgpr_read_b32 v54, a94
    v_mfma_f32_16x16x32_bf16 v[200:203], a[212:215], a[132:135], v[200:203]
    ds_read_b64_tr_b16 a[254:255], v3 offset:17632
    v_accvgpr_read_b32 v55, a95
    v_mfma_f32_16x16x32_bf16 v[140:143], a[216:219], a[100:103], v[140:143]
    ds_read_b64_tr_b16 a[84:85], v4 offset:0
    v_add_f32 v208, v208, v52
    v_mfma_f32_16x16x32_bf16 v[172:175], a[216:219], a[116:119], v[172:175]
    ds_read_b64_tr_b16 a[86:87], v4 offset:512
    v_add_f32 v209, v209, v53
    v_mfma_f32_16x16x32_bf16 v[204:207], a[216:219], a[132:135], v[204:207]
    ds_read_b64_tr_b16 a[60:61], v4 offset:32
    v_add_f32 v210, v210, v54
    v_mfma_f32_16x16x32_bf16 v[144:147], a[220:223], a[100:103], v[144:147]
    ds_read_b64_tr_b16 a[62:63], v4 offset:544
    v_lshlrev_b32 v59, 2, v0
    v_mfma_f32_16x16x32_bf16 v[176:179], a[220:223], a[116:119], v[176:179]
    ds_read_b64_tr_b16 a[16:17], v4 offset:8448
    v_add3_u32 v60, v0, s54, 1
    v_mfma_f32_16x16x32_bf16 v[208:211], a[220:223], a[132:135], v[208:211]
    ds_read_b64_tr_b16 a[18:19], v4 offset:8960
    v_and_b32 v60, 3, v60
    s_waitcnt lgkmcnt(6)
    v_mfma_f32_16x16x32_bf16 v[124:127], a[232:235], a[104:107], v[124:127]
    ds_read_b64_tr_b16 a[200:201], v3 offset:25408
    v_mul_u32_u24 v60, 384, v60
    v_mfma_f32_16x16x32_bf16 v[156:159], a[232:235], a[120:123], v[156:159]
    ds_read_b64_tr_b16 a[202:203], v3 offset:25920
    v_add_f32 v211, v211, v55
    v_mfma_f32_16x16x32_bf16 v[188:191], a[232:235], a[136:139], v[188:191]
    ds_read_b64_tr_b16 a[204:205], v3 offset:25440
    v_sub_u32 v60, v60, v59
    v_mfma_f32_16x16x32_bf16 v[128:131], a[236:239], a[104:107], v[128:131]
    ds_read_b64_tr_b16 a[206:207], v3 offset:25952
    v_add_u32 v60, s14, v60
    v_mfma_f32_16x16x32_bf16 v[160:163], a[236:239], a[120:123], v[160:163]
    ds_read_b64_tr_b16 a[208:209], v3 offset:25472
    v_mov_b32 v61, s11
    v_mfma_f32_16x16x32_bf16 v[192:195], a[236:239], a[136:139], v[192:195]
    ds_read_b64_tr_b16 a[210:211], v3 offset:25984
    v_writelane_b32 v61, s12, 1
    v_mfma_f32_16x16x32_bf16 v[132:135], a[240:243], a[104:107], v[132:135]
    ds_read_b64_tr_b16 a[212:213], v3 offset:25504
    v_writelane_b32 v61, s13, 2
    v_mfma_f32_16x16x32_bf16 v[164:167], a[240:243], a[120:123], v[164:167]
    ds_read_b64_tr_b16 a[214:215], v3 offset:26016
    v_accvgpr_read_b32 v116, a0
    v_mfma_f32_16x16x32_bf16 v[196:199], a[240:243], a[136:139], v[196:199]
    ds_read_b64_tr_b16 a[216:217], v3 offset:25536
    v_accvgpr_read_b32 v117, a1
    v_mfma_f32_16x16x32_bf16 v[136:139], a[244:247], a[104:107], v[136:139]
    ds_read_b64_tr_b16 a[218:219], v3 offset:26048
    v_accvgpr_read_b32 v118, a2
    v_mfma_f32_16x16x32_bf16 v[168:171], a[244:247], a[120:123], v[168:171]
    ds_read_b64_tr_b16 a[220:221], v3 offset:25568
    v_accvgpr_read_b32 v119, a3
    v_mfma_f32_16x16x32_bf16 v[200:203], a[244:247], a[136:139], v[200:203]
    ds_read_b64_tr_b16 a[222:223], v3 offset:26080
    v_accvgpr_read_b32 v120, a4
    v_mfma_f32_16x16x32_bf16 v[140:143], a[248:251], a[104:107], v[140:143]
    ds_read_b64_tr_b16 a[24:25], v4 offset:8480
    v_accvgpr_read_b32 v121, a5
    v_mfma_f32_16x16x32_bf16 v[172:175], a[248:251], a[120:123], v[172:175]
    ds_read_b64_tr_b16 a[26:27], v4 offset:8992
    v_accvgpr_read_b32 v122, a6
    v_mfma_f32_16x16x32_bf16 v[204:207], a[248:251], a[136:139], v[204:207]
    ds_read_b64_tr_b16 a[40:41], v1 offset:16896
    v_accvgpr_read_b32 v123, a7
    v_mfma_f32_16x16x32_bf16 v[144:147], a[252:255], a[104:107], v[144:147]
    ds_read_b64_tr_b16 a[42:43], v1 offset:17408
    v_accvgpr_read_b32 v148, a32
    v_mfma_f32_16x16x32_bf16 v[176:179], a[252:255], a[120:123], v[176:179]
    ds_read_b64_tr_b16 a[56:57], v1 offset:16928
    v_accvgpr_read_b32 v149, a33
    v_mfma_f32_16x16x32_bf16 v[208:211], a[252:255], a[136:139], v[208:211]
    ds_read_b64_tr_b16 a[58:59], v1 offset:17440
    v_accvgpr_read_b32 v150, a34
    s_waitcnt lgkmcnt(6)
    s_cmp_ge_u32 s82, 3
    s_cbranch_scc1 L_bd3
    s_waitcnt vmcnt(6)
    v_lshl_or_b32 v6, v7, 1, v6
    v_lshl_or_b32 v8, v9, 1, v8
    v_lshl_or_b32 v6, v8, 2, v6
    s_nop 0
    v_readfirstlane_b32 s81, v6
    s_nop 1
    s_cmp_ge_u32 s82, 3
    s_cbranch_scc1 L_en3_e
    s_mov_b32 s72, 131072
L_en3:
    s_and_b32 s56, s80, s81
    s_cbranch_scc1 L_en3_g
    s_sub_u32 s72, s72, 1
    s_cmp_eq_u32 s72, 0
    s_cbranch_scc1 L_en3_e
    buffer_load_dwordx4 v[6:9], off, s[40:43], s69 sc1
    s_waitcnt vmcnt(0)
    v_lshl_or_b32 v6, v7, 1, v6
    v_lshl_or_b32 v8, v9, 1, v8
    v_lshl_or_b32 v6, v8, 2, v6
    s_nop 0
    v_readfirstlane_b32 s81, v6
    s_nop 1
    s_branch L_en3
L_en3_g:
    s_ff1_i32_b32 s56, s56
    s_bitset0_b32 s80, s56
    s_mul_i32 s57, s56, 36864
    s_add_u32 s78, s57, s86
    s_add_u32 s87, s78, 4096
    s_add_u32 s88, s78, 8192
    s_sub_u32 s56, s56, s55
    s_and_b32 s56, s56, 3
    s_mul_i32 s85, s56, 33792
    s_mov_b32 s82, 3
    buffer_load_dwordx4 a[144:147], v5, s[40:43], s78 offen offset:0 sc1
    buffer_load_dwordx4 a[160:163], v5, s[40:43], s87 offen offset:0 sc1
    buffer_load_dwordx4 a[176:179], v5, s[40:43], s88 offen offset:0 sc1
    buffer_load_dwordx4 a[148:151], v5, s[40:43], s78 offen offset:1024 sc1
    buffer_load_dwordx4 a[164:167], v5, s[40:43], s87 offen offset:1024 sc1
    buffer_load_dwordx4 a[180:183], v5, s[40:43], s88 offen offset:1024 sc1
    buffer_load_dwordx4 a[152:155], v5, s[40:43], s78 offen offset:2048 sc1
    buffer_load_dwordx4 a[168:171], v5, s[40:43], s87 offen offset:2048 sc1
    buffer_load_dwordx4 a[184:187], v5, s[40:43], s88 offen offset:2048 sc1
    buffer_load_dwordx4 a[156:159], v5, s[40:43], s78 offen offset:3072 sc1
    buffer_load_dwordx4 a[172:175], v5, s[40:43], s87 offen offset:3072 sc1
    buffer_load_dwordx4 a[188:191], v5, s[40:43], s88 offen offset:3072 sc1
L_en3_e:
L_bd3:
    v_add_u32 v3, s85, v1
    v_mfma_f32_16x16x32_bf16 v[124:127], a[200:203], a[108:111], v[124:127]
    ds_read_b64_tr_b16 a[232:233], v3 offset:64
    v_accvgpr_read_b32 v151, a35
    v_mfma_f32_16x16x32_bf16 v[156:159], a[200:203], a[124:127], v[156:159]
    ds_read_b64_tr_b16 a[234:235], v3 offset:576
    v_accvgpr_read_b32 v152, a36
    v_mfma_f32_16x16x32_bf16 v[188:191], a[200:203], a[140:143], v[188:191]
    ds_read_b64_tr_b16 a[236:237], v3 offset:96
    v_accvgpr_read_b32 v153, a37
    v_mfma_f32_16x16x32_bf16 v[128:131], a[204:207], a[108:111], v[128:131]
    ds_read_b64_tr_b16 a[238:239], v3 offset:608
    v_accvgpr_read_b32 v154, a38
    v_mfma_f32_16x16x32_bf16 v[160:163], a[204:207], a[124:127], v[160:163]
    ds_read_b64_tr_b16 a[240:241], v3 offset:128
    v_accvgpr_read_b32 v155, a39
    v_mfma_f32_16x16x32_bf16 v[192:195], a[204:207], a[140:143], v[192:195]
    ds_read_b64_tr_b16 a[242:243], v3 offset:640
    v_accvgpr_read_b32 v180, a64
    v_mfma_f32_16x16x32_bf16 v[132:135], a[208:211], a[108:111], v[132:135]
    ds_read_b64_tr_b16 a[244:245], v3 offset:160
    v_accvgpr_read_b32 v181, a65
    v_mfma_f32_16x16x32_bf16 v[164:167], a[208:211], a[124:127], v[164:167]
    ds_read_b64_tr_b16 a[246:247], v3 offset:672
    v_accvgpr_read_b32 v182, a66
    v_mfma_f32_16x16x32_bf16 v[196:199], a[208:211], a[140:143], v[196:199]
    ds_read_b64_tr_b16 a[248:249], v3 offset:192
    v_accvgpr_read_b32 v183, a67
    v_mfma_f32_16x16x32_bf16 v[136:139], a[212:215], a[108:111], v[136:139]
    ds_read_b64_tr_b16 a[250:251], v3 offset:704
    v_accvgpr_read_b32 v184, a68
    v_mfma_f32_16x16x32_bf16 v[168:171], a[212:215], a[124:127], v[168:171]
    ds_read_b64_tr_b16 a[252:253], v3 offset:224
    v_accvgpr_read_b32 v185, a69
    v_mfma_f32_16x16x32_bf16 v[200:203], a[212:215], a[140:143], v[200:203]
    ds_read_b64_tr_b16 a[254:255], v3 offset:736
    v_accvgpr_read_b32 v186, a70
    v_mfma_f32_16x16x32_bf16 v[140:143], a[216:219], a[108:111], v[140:143]
    ds_read_b64_tr_b16 a[48:49], v1 offset:25344
    v_accvgpr_read_b32 v187, a71
    v_mfma_f32_16x16x32_bf16 v[172:175], a[216:219], a[124:127], v[172:175]
    ds_read_b64_tr_b16 a[50:51], v1 offset:25856
    v_accvgpr_write_b32 a224, 0
    v_mfma_f32_16x16x32_bf16 v[204:207], a[216:219], a[140:143], v[204:207]
    ds_read_b64_tr_b16 a[28:29], v1 offset:25376
    v_accvgpr_write_b32 a225, 0
    v_mfma_f32_16x16x32_bf16 v[144:147], a[220:223], a[108:111], v[144:147]
    ds_read_b64_tr_b16 a[30:31], v1 offset:25888
    v_accvgpr_write_b32 a226, v14
    v_mfma_f32_16x16x32_bf16 v[176:179], a[220:223], a[124:127], v[176:179]
    v_accvgpr_write_b32 a227, v15
    v_accvgpr_write_b32 a228, 0
    v_mfma_f32_16x16x32_bf16 v[208:211], a[220:223], a[140:143], v[208:211]
    v_accvgpr_write_b32 a229, 0
    v_and_b32 v11, 15, v0
    s_waitcnt lgkmcnt(4)
    s_waitcnt vmcnt(0)
    v_add_u32 v10, s83, v1
    v_mfma_f32_16x16x32_bf16 v[124:127], a[232:235], a[144:147], v[124:127]
    ds_read_b64_tr_b16 a[200:201], v3 offset:8512
    v_lshlrev_b32 v11, 10, v11
    v_mfma_f32_16x16x32_bf16 v[156:159], a[232:235], a[160:163], v[156:159]
    ds_read_b64_tr_b16 a[202:203], v3 offset:9024
    v_lshrrev_b32 v2, 4, v0
    v_mfma_f32_16x16x32_bf16 v[188:191], a[232:235], a[176:179], v[188:191]
    ds_read_b64_tr_b16 a[204:205], v3 offset:8544
    v_lshl_add_u32 v2, v2, 4, v11
    v_mfma_f32_16x16x32_bf16 v[128:131], a[236:239], a[144:147], v[128:131]
    ds_read_b64_tr_b16 a[206:207], v3 offset:9056
    v_and_b32 v11, 12, v59
    v_mfma_f32_16x16x32_bf16 v[160:163], a[236:239], a[160:163], v[160:163]
    ds_read_b64_tr_b16 a[208:209], v3 offset:8576
    v_mfma_f32_16x16x32_bf16 v[192:195], a[236:239], a[176:179], v[192:195]
    ds_read_b64_tr_b16 a[210:211], v3 offset:9088
    v_mfma_f32_16x16x32_bf16 v[132:135], a[240:243], a[144:147], v[132:135]
    ds_read_b64_tr_b16 a[212:213], v3 offset:8608
    v_mfma_f32_16x16x32_bf16 v[164:167], a[240:243], a[160:163], v[164:167]
    ds_read_b64_tr_b16 a[214:215], v3 offset:9120
    v_mfma_f32_16x16x32_bf16 v[196:199], a[240:243], a[176:179], v[196:199]
    ds_read_b64_tr_b16 a[216:217], v3 offset:8640
    v_mfma_f32_16x16x32_bf16 v[136:139], a[244:247], a[144:147], v[136:139]
    ds_read_b64_tr_b16 a[218:219], v3 offset:9152
    v_mfma_f32_16x16x32_bf16 v[168:171], a[244:247], a[160:163], v[168:171]
    ds_read_b64_tr_b16 a[220:221], v3 offset:8672
    v_mfma_f32_16x16x32_bf16 v[200:203], a[244:247], a[176:179], v[200:203]
    ds_read_b64_tr_b16 a[222:223], v3 offset:9184
    v_mfma_f32_16x16x32_bf16 v[140:143], a[248:251], a[144:147], v[140:143]
    ds_read_b64_tr_b16 a[76:77], v10 offset:0
    v_mfma_f32_16x16x32_bf16 v[172:175], a[248:251], a[160:163], v[172:175]
    ds_read_b64_tr_b16 a[78:79], v10 offset:512
    v_mfma_f32_16x16x32_bf16 v[204:207], a[248:251], a[176:179], v[204:207]
    ds_read_b64_tr_b16 a[52:53], v10 offset:32
    v_mfma_f32_16x16x32_bf16 v[144:147], a[252:255], a[144:147], v[144:147]
    ds_read_b64_tr_b16 a[54:55], v10 offset:544
    v_mfma_f32_16x16x32_bf16 v[176:179], a[252:255], a[160:163], v[176:179]
    ds_read_b64_tr_b16 a[88:89], v10 offset:8448
    v_mfma_f32_16x16x32_bf16 v[208:211], a[252:255], a[176:179], v[208:211]
    ds_read_b64_tr_b16 a[90:91], v10 offset:8960
    s_waitcnt lgkmcnt(6)
    v_mfma_f32_16x16x32_bf16 v[124:127], a[200:203], a[148:151], v[124:127]
    ds_read_b64_tr_b16 a[232:233], v3 offset:16960
    ds_read_b64_tr_b16 a[234:235], v3 offset:17472
    v_mfma_f32_16x16x32_bf16 v[156:159], a[200:203], a[164:167], v[156:159]
    ds_read_b64_tr_b16 a[236:237], v3 offset:16992
    ds_read_b64_tr_b16 a[238:239], v3 offset:17504
    v_mfma_f32_16x16x32_bf16 v[188:191], a[200:203], a[180:183], v[188:191]
    ds_read_b64_tr_b16 a[240:241], v3 offset:17024
    ds_read_b64_tr_b16 a[242:243], v3 offset:17536
    v_mfma_f32_16x16x32_bf16 v[128:131], a[204:207], a[148:151], v[128:131]
    ds_read_b64_tr_b16 a[244:245], v3 offset:17056
    ds_read_b64_tr_b16 a[246:247], v3 offset:17568
    v_mfma_f32_16x16x32_bf16 v[160:163], a[204:207], a[164:167], v[160:163]
    ds_read_b64_tr_b16 a[248:249], v3 offset:17088
    v_mfma_f32_16x16x32_bf16 v[192:195], a[204:207], a[180:183], v[192:195]
    ds_read_b64_tr_b16 a[250:251], v3 offset:17600
    v_mfma_f32_16x16x32_bf16 v[132:135], a[208:211], a[148:151], v[132:135]
    ds_read_b64_tr_b16 a[252:253], v3 offset:17120
    v_mfma_f32_16x16x32_bf16 v[164:167], a[208:211], a[164:167], v[164:167]
    ds_read_b64_tr_b16 a[254:255], v3 offset:17632
    v_mfma_f32_16x16x32_bf16 v[196:199], a[208:211], a[180:183], v[196:199]
    ds_read_b64_tr_b16 a[200:201], v3 offset:25408
    v_mfma_f32_16x16x32_bf16 v[136:139], a[212:215], a[148:151], v[136:139]
    ds_read_b64_tr_b16 a[202:203], v3 offset:25920
    v_mfma_f32_16x16x32_bf16 v[168:171], a[212:215], a[164:167], v[168:171]
    ds_read_b64_tr_b16 a[204:205], v3 offset:25440
    v_mfma_f32_16x16x32_bf16 v[200:203], a[212:215], a[180:183], v[200:203]
    ds_read_b64_tr_b16 a[206:207], v3 offset:25952
    v_mfma_f32_16x16x32_bf16 v[140:143], a[216:219], a[148:151], v[140:143]
    ds_read_b64_tr_b16 a[44:45], v10 offset:8480
    v_mfma_f32_16x16x32_bf16 v[172:175], a[216:219], a[164:167], v[172:175]
    ds_read_b64_tr_b16 a[46:47], v10 offset:8992
    v_mfma_f32_16x16x32_bf16 v[204:207], a[216:219], a[180:183], v[204:207]
    ds_read_b64_tr_b16 a[20:21], v10 offset:16896
    v_mfma_f32_16x16x32_bf16 v[144:147], a[220:223], a[148:151], v[144:147]
    ds_read_b64_tr_b16 a[22:23], v10 offset:17408
    v_mfma_f32_16x16x32_bf16 v[176:179], a[220:223], a[164:167], v[176:179]
    ds_read_b64_tr_b16 a[8:9], v10 offset:16928
    v_mfma_f32_16x16x32_bf16 v[208:211], a[220:223], a[180:183], v[208:211]
    ds_read_b64_tr_b16 a[10:11], v10 offset:17440
    s_waitcnt lgkmcnt(6)
    buffer_load_dword v66, v11, s[40:43], s70 offen sc1
    s_mul_i32 s70, s54, 384
    s_add_u32 s70, s70, s14
    s_sub_u32 s70, s70, 8
    buffer_load_dword v67, v11, s[40:43], s70 offen sc1
    v_mfma_f32_16x16x32_bf16 v[124:127], a[232:235], a[152:155], v[124:127]
    ds_read_b64_tr_b16 a[208:209], v3 offset:25472
    ds_read_b64_tr_b16 a[210:211], v3 offset:25984
    v_mfma_f32_16x16x32_bf16 v[128:131], a[236:239], a[152:155], v[128:131]
    ds_read_b64_tr_b16 a[212:213], v3 offset:25504
    ds_read_b64_tr_b16 a[214:215], v3 offset:26016
    v_mfma_f32_16x16x32_bf16 v[124:127], a[200:203], a[156:159], v[124:127]
    ds_read_b64_tr_b16 a[216:217], v3 offset:25536
    ds_read_b64_tr_b16 a[218:219], v3 offset:26048
    v_mfma_f32_16x16x32_bf16 v[128:131], a[204:207], a[156:159], v[128:131]
    ds_read_b64_tr_b16 a[220:221], v3 offset:25568
    ds_read_b64_tr_b16 a[222:223], v3 offset:26080
    v_mfma_f32_16x16x32_bf16 v[156:159], a[232:235], a[168:171], v[156:159]
    ds_read_b64_tr_b16 a[80:81], v10 offset:25344
    v_mfma_f32_16x16x32_bf16 v[160:163], a[236:239], a[168:171], v[160:163]
    ds_read_b64_tr_b16 a[82:83], v10 offset:25856
    v_cvt_pk_bf16_f32 v20, v124, v125
    v_mfma_f32_16x16x32_bf16 v[156:159], a[200:203], a[172:175], v[156:159]
    ds_read_b64_tr_b16 a[12:13], v10 offset:25376
    v_cvt_pk_bf16_f32 v21, v126, v127
    v_mfma_f32_16x16x32_bf16 v[160:163], a[204:207], a[172:175], v[160:163]
    ds_read_b64_tr_b16 a[14:15], v10 offset:25888
    v_cvt_pk_bf16_f32 v22, v128, v129
    v_mfma_f32_16x16x32_bf16 v[188:191], a[232:235], a[184:187], v[188:191]
    v_cvt_pk_bf16_f32 v23, v130, v131
    v_mfma_f32_16x16x32_bf16 v[192:195], a[236:239], a[184:187], v[192:195]
    buffer_store_dwordx4 v[20:23], v5, s[40:43], s4 offen offset:0 sc1
    v_mfma_f32_16x16x32_bf16 v[188:191], a[200:203], a[188:191], v[188:191]
    v_add3_u32 v56, v20, v21, s11
    v_add3_u32 v56, v22, v23, v56
    v_mfma_f32_16x16x32_bf16 v[192:195], a[204:207], a[188:191], v[192:195]
    v_cvt_pk_bf16_f32 v24, v156, v157
    v_cvt_pk_bf16_f32 v25, v158, v159
    v_mfma_f32_16x16x32_bf16 v[132:135], a[240:243], a[152:155], v[132:135]
    v_cvt_pk_bf16_f32 v26, v160, v161
    v_cvt_pk_bf16_f32 v27, v162, v163
    v_mfma_f32_16x16x32_bf16 v[136:139], a[244:247], a[152:155], v[136:139]
    buffer_store_dwordx4 v[24:27], v5, s[40:43], s4 offen offset:1024 sc1
    s_waitcnt lgkmcnt(0)
    v_mfma_f32_16x16x32_bf16 v[132:135], a[208:211], a[156:159], v[132:135]
    v_add3_u32 v56, v24, v25, v56
    v_add3_u32 v56, v26, v27, v56
    v_mfma_f32_16x16x32_bf16 v[136:139], a[212:215], a[156:159], v[136:139]
    v_cvt_pk_bf16_f32 v28, v188, v189
    v_cvt_pk_bf16_f32 v29, v190, v191
    s_mov_b64 exec, 7
    buffer_store_dword v61, v60, s[40:43], 0 offen sc1
    s_mov_b64 exec, -1
    v_mfma_f32_16x16x32_bf16 v[164:167], a[240:243], a[168:171], v[164:167]
    v_cvt_pk_bf16_f32 v30, v192, v193
    v_cvt_pk_bf16_f32 v31, v194, v195
    v_mfma_f32_16x16x32_bf16 v[168:171], a[244:247], a[168:171], v[168:171]
    buffer_store_dwordx4 v[28:31], v5, s[40:43], s4 offen offset:2048 sc1
    v_mfma_f32_16x16x32_bf16 v[164:167], a[208:211], a[172:175], v[164:167]
    v_add3_u32 v56, v28, v29, v56
    v_add3_u32 v56, v30, v31, v56
    v_mfma_f32_16x16x32_bf16 v[168:171], a[212:215], a[172:175], v[168:171]
    buffer_store_dword v56, v59, s[40:43], s4 offen offset:3072 sc1
    v_mfma_f32_16x16x32_bf16 v[196:199], a[240:243], a[184:187], v[196:199]
    v_cvt_pk_bf16_f32 v32, v132, v133
    v_cvt_pk_bf16_f32 v33, v134, v135
    v_mfma_f32_16x16x32_bf16 v[200:203], a[244:247], a[184:187], v[200:203]
    v_cvt_pk_bf16_f32 v34, v136, v137
    v_cvt_pk_bf16_f32 v35, v138, v139
    v_mfma_f32_16x16x32_bf16 v[196:199], a[208:211], a[188:191], v[196:199]
    buffer_store_dwordx4 v[32:35], v5, s[40:43], s5 offen offset:0 sc1
    v_mfma_f32_16x16x32_bf16 v[200:203], a[212:215], a[188:191], v[200:203]
    v_add3_u32 v57, v32, v33, s12
    v_add3_u32 v57, v34, v35, v57
    v_mfma_f32_16x16x32_bf16 v[140:143], a[248:251], a[152:155], v[140:143]
    v_cvt_pk_bf16_f32 v36, v164, v165
    v_cvt_pk_bf16_f32 v37, v166, v167
    v_mfma_f32_16x16x32_bf16 v[144:147], a[252:255], a[152:155], v[144:147]
    v_cvt_pk_bf16_f32 v38, v168, v169
    v_cvt_pk_bf16_f32 v39, v170, v171
    v_mfma_f32_16x16x32_bf16 v[140:143], a[216:219], a[156:159], v[140:143]
    buffer_store_dwordx4 v[36:39], v5, s[40:43], s5 offen offset:1024 sc1
    v_mfma_f32_16x16x32_bf16 v[144:147], a[220:223], a[156:159], v[144:147]
    v_add3_u32 v57, v36, v37, v57
    v_add3_u32 v57, v38, v39, v57
    v_mfma_f32_16x16x32_bf16 v[172:175], a[248:251], a[168:171], v[172:175]
    v_cvt_pk_bf16_f32 v40, v196, v197
    v_cvt_pk_bf16_f32 v41, v198, v199
    v_mfma_f32_16x16x32_bf16 v[176:179], a[252:255], a[168:171], v[176:179]
    v_cvt_pk_bf16_f32 v42, v200, v201
    v_cvt_pk_bf16_f32 v43, v202, v203
    v_mfma_f32_16x16x32_bf16 v[172:175], a[216:219], a[172:175], v[172:175]
    buffer_store_dwordx4 v[40:43], v5, s[40:43], s5 offen offset:2048 sc1
    v_mfma_f32_16x16x32_bf16 v[176:179], a[220:223], a[172:175], v[176:179]
    v_add3_u32 v57, v40, v41, v57
    v_add3_u32 v57, v42, v43, v57
    v_mfma_f32_16x16x32_bf16 v[204:207], a[248:251], a[184:187], v[204:207]
    buffer_store_dword v57, v59, s[40:43], s5 offen offset:3072 sc1
    v_mfma_f32_16x16x32_bf16 v[208:211], a[252:255], a[184:187], v[208:211]
    v_cvt_pk_bf16_f32 v44, v140, v141
    v_cvt_pk_bf16_f32 v45, v142, v143
    v_mfma_f32_16x16x32_bf16 v[204:207], a[216:219], a[188:191], v[204:207]
    v_cvt_pk_bf16_f32 v46, v144, v145
    v_cvt_pk_bf16_f32 v47, v146, v147
    v_mfma_f32_16x16x32_bf16 v[208:211], a[220:223], a[188:191], v[208:211]
    buffer_store_dwordx4 v[44:47], v5, s[40:43], s6 offen offset:0 sc1
    v_mfma_f32_16x16x32_bf16 v[116:119], a[84:87], v[16:19], v[116:119]
    v_add3_u32 v58, v44, v45, s13
    v_add3_u32 v58, v46, v47, v58
    v_mfma_f32_16x16x32_bf16 v[148:151], a[84:87], v[224:227], v[148:151]
    v_cvt_pk_bf16_f32 v48, v172, v173
    v_cvt_pk_bf16_f32 v49, v174, v175
    v_mfma_f32_16x16x32_bf16 v[180:183], a[84:87], v[240:243], v[180:183]
    v_cvt_pk_bf16_f32 v50, v176, v177
    v_cvt_pk_bf16_f32 v51, v178, v179
    v_mfma_f32_16x16x32_bf16 v[120:123], a[60:63], v[16:19], v[120:123]
    buffer_store_dwordx4 v[48:51], v5, s[40:43], s6 offen offset:1024 sc1
    v_mfma_f32_16x16x32_bf16 v[152:155], a[60:63], v[224:227], v[152:155]
    v_add3_u32 v58, v48, v49, v58
    v_add3_u32 v58, v50, v51, v58
    v_mfma_f32_16x16x32_bf16 v[184:187], a[60:63], v[240:243], v[184:187]
    v_cvt_pk_bf16_f32 v52, v204, v205
    v_cvt_pk_bf16_f32 v53, v206, v207
    v_mfma_f32_16x16x32_bf16 v[116:119], a[16:19], v[212:215], v[116:119]
    v_cvt_pk_bf16_f32 v54, v208, v209
    v_cvt_pk_bf16_f32 v55, v210, v211
    v_mfma_f32_16x16x32_bf16 v[148:151], a[16:19], v[228:231], v[148:151]
    buffer_store_dwordx4 v[52:55], v5, s[40:43], s6 offen offset:2048 sc1
    v_mfma_f32_16x16x32_bf16 v[180:183], a[16:19], v[244:247], v[180:183]
    v_add3_u32 v58, v52, v53, v58
    v_add3_u32 v58, v54, v55, v58
    v_mfma_f32_16x16x32_bf16 v[120:123], a[24:27], v[212:215], v[120:123]
    buffer_store_dword v58, v59, s[40:43], s6 offen offset:3072 sc1
    v_mfma_f32_16x16x32_bf16 v[152:155], a[24:27], v[228:231], v[152:155]
    s_waitcnt vmcnt(13)
    v_cmp_eq_u32 vcc, v67, v66
    v_mfma_f32_16x16x32_bf16 v[184:187], a[24:27], v[244:247], v[184:187]
    s_nop 0
    s_and_b32 s81, vcc_lo, 7
    v_mfma_f32_16x16x32_bf16 v[116:119], a[40:43], v[216:219], v[116:119]
    s_mov_b32 s82, s81
    s_bitcmp1_b32 s81, 0
    v_mfma_f32_16x16x32_bf16 v[148:151], a[40:43], v[232:235], v[148:151]
    s_cselect_b32 s22, 37797888, 0
    s_bitcmp1_b32 s81, 1
    v_mfma_f32_16x16x32_bf16 v[180:183], a[40:43], v[248:251], v[180:183]
    s_cselect_b32 s26, 37797888, 0
    s_bitcmp1_b32 s81, 2
    v_mfma_f32_16x16x32_bf16 v[120:123], a[56:59], v[216:219], v[120:123]
    s_cselect_b32 s30, 37797888, 0
    v_readlane_b32 s78, v66, 0
    v_mfma_f32_16x16x32_bf16 v[152:155], a[56:59], v[232:235], v[152:155]
    v_readlane_b32 s87, v66, 1
    v_readlane_b32 s88, v66, 2
    v_mfma_f32_16x16x32_bf16 v[184:187], a[56:59], v[248:251], v[184:187]
    v_mfma_f32_16x16x32_bf16 v[116:119], a[48:51], v[220:223], v[116:119]
    v_mfma_f32_16x16x32_bf16 v[148:151], a[48:51], v[236:239], v[148:151]
    v_mfma_f32_16x16x32_bf16 v[180:183], a[48:51], v[252:255], v[180:183]
    v_mfma_f32_16x16x32_bf16 v[120:123], a[28:31], v[220:223], v[120:123]
    v_mfma_f32_16x16x32_bf16 v[152:155], a[28:31], v[236:239], v[152:155]
    v_mfma_f32_16x16x32_bf16 v[184:187], a[28:31], v[252:255], v[184:187]
    s_waitcnt lgkmcnt(0)
    v_add_u32 v10, s84, v1
    buffer_load_dword v67, v11, s[40:43], s70 offen sc1
    v_mfma_f32_16x16x32_bf16 v[116:119], a[76:79], v[68:71], v[116:119]
    buffer_load_dwordx4 v[124:127], v5, s[20:23], s7 offen offset:0 sc1
    v_mfma_f32_16x16x32_bf16 v[148:151], a[76:79], v[84:87], v[148:151]
    ds_read_b64_tr_b16 a[84:85], v10 offset:0
    ds_read_b64_tr_b16 a[86:87], v10 offset:512
    v_mfma_f32_16x16x32_bf16 v[180:183], a[76:79], v[100:103], v[180:183]
    buffer_load_dwordx4 v[156:159], v5, s[20:23], s7 offen offset:1024 sc1
    v_mfma_f32_16x16x32_bf16 v[120:123], a[52:55], v[68:71], v[120:123]
    ds_read_b64_tr_b16 a[60:61], v10 offset:32
    ds_read_b64_tr_b16 a[62:63], v10 offset:544
    v_mfma_f32_16x16x32_bf16 v[152:155], a[52:55], v[84:87], v[152:155]
    buffer_load_dwordx4 v[188:191], v5, s[20:23], s7 offen offset:2048 sc1
    v_mfma_f32_16x16x32_bf16 v[184:187], a[52:55], v[100:103], v[184:187]
    ds_read_b64_tr_b16 a[16:17], v10 offset:8448
    ds_read_b64_tr_b16 a[18:19], v10 offset:8960
    v_mfma_f32_16x16x32_bf16 v[116:119], a[88:91], v[72:75], v[116:119]
    buffer_load_dword v60, v59, s[20:23], s7 offen offset:3072 sc1
    v_mfma_f32_16x16x32_bf16 v[148:151], a[88:91], v[88:91], v[148:151]
    ds_read_b64_tr_b16 a[24:25], v10 offset:8480
    ds_read_b64_tr_b16 a[26:27], v10 offset:8992
    v_mfma_f32_16x16x32_bf16 v[180:183], a[88:91], v[104:107], v[180:183]
    buffer_load_dwordx4 v[132:135], v5, s[24:27], s8 offen offset:0 sc1
    v_mfma_f32_16x16x32_bf16 v[120:123], a[44:47], v[72:75], v[120:123]
    ds_read_b64_tr_b16 a[40:41], v10 offset:16896
    v_mfma_f32_16x16x32_bf16 v[152:155], a[44:47], v[88:91], v[152:155]
    buffer_load_dwordx4 v[164:167], v5, s[24:27], s8 offen offset:1024 sc1
    v_mfma_f32_16x16x32_bf16 v[184:187], a[44:47], v[104:107], v[184:187]
    ds_read_b64_tr_b16 a[42:43], v10 offset:17408
    v_mfma_f32_16x16x32_bf16 v[116:119], a[20:23], v[76:79], v[116:119]
    buffer_load_dwordx4 v[196:199], v5, s[24:27], s8 offen offset:2048 sc1
    v_mfma_f32_16x16x32_bf16 v[148:151], a[20:23], v[92:95], v[148:151]
    ds_read_b64_tr_b16 a[56:57], v10 offset:16928
    v_mfma_f32_16x16x32_bf16 v[180:183], a[20:23], v[108:111], v[180:183]
    buffer_load_dword v61, v59, s[24:27], s8 offen offset:3072 sc1
    v_mfma_f32_16x16x32_bf16 v[120:123], a[8:11], v[76:79], v[120:123]
    ds_read_b64_tr_b16 a[58:59], v10 offset:17440
    v_mfma_f32_16x16x32_bf16 v[152:155], a[8:11], v[92:95], v[152:155]
    buffer_load_dwordx4 v[140:143], v5, s[28:31], s9 offen offset:0 sc1
    v_mfma_f32_16x16x32_bf16 v[184:187], a[8:11], v[108:111], v[184:187]
    ds_read_b64_tr_b16 a[48:49], v10 offset:25344
    v_mfma_f32_16x16x32_bf16 v[116:119], a[80:83], v[80:83], v[116:119]
    buffer_load_dwordx4 v[172:175], v5, s[28:31], s9 offen offset:1024 sc1
    v_mfma_f32_16x16x32_bf16 v[148:151], a[80:83], v[96:99], v[148:151]
    ds_read_b64_tr_b16 a[50:51], v10 offset:25856
    v_mfma_f32_16x16x32_bf16 v[180:183], a[80:83], v[112:115], v[180:183]
    buffer_load_dwordx4 v[204:207], v5, s[28:31], s9 offen offset:2048 sc1
    v_mfma_f32_16x16x32_bf16 v[120:123], a[12:15], v[80:83], v[120:123]
    ds_read_b64_tr_b16 a[28:29], v10 offset:25376
    v_mfma_f32_16x16x32_bf16 v[152:155], a[12:15], v[96:99], v[152:155]
    buffer_load_dword v62, v59, s[28:31], s9 offen offset:3072 sc1
    v_mfma_f32_16x16x32_bf16 v[184:187], a[12:15], v[112:115], v[184:187]
    ds_read_b64_tr_b16 a[30:31], v10 offset:25888
    s_waitcnt lgkmcnt(0)
    v_add_u32 v10, s85, v1
    v_mfma_f32_16x16x32_bf16 v[116:119], a[84:87], a[96:99], v[116:119]
    ds_read_b64_tr_b16 a[76:77], v10 offset:0
    v_mfma_f32_16x16x32_bf16 v[148:151], a[84:87], a[112:115], v[148:151]
    ds_read_b64_tr_b16 a[78:79], v10 offset:512
    v_mfma_f32_16x16x32_bf16 v[180:183], a[84:87], a[128:131], v[180:183]
    ds_read_b64_tr_b16 a[52:53], v10 offset:32
    v_mfma_f32_16x16x32_bf16 v[120:123], a[60:63], a[96:99], v[120:123]
    ds_read_b64_tr_b16 a[54:55], v10 offset:544
    v_mfma_f32_16x16x32_bf16 v[152:155], a[60:63], a[112:115], v[152:155]
    ds_read_b64_tr_b16 a[88:89], v10 offset:8448
    v_mfma_f32_16x16x32_bf16 v[184:187], a[60:63], a[128:131], v[184:187]
    ds_read_b64_tr_b16 a[90:91], v10 offset:8960
    v_mfma_f32_16x16x32_bf16 v[116:119], a[16:19], a[100:103], v[116:119]
    ds_read_b64_tr_b16 a[44:45], v10 offset:8480
    v_mfma_f32_16x16x32_bf16 v[148:151], a[16:19], a[116:119], v[148:151]
    ds_read_b64_tr_b16 a[46:47], v10 offset:8992
    v_mfma_f32_16x16x32_bf16 v[180:183], a[16:19], a[132:135], v[180:183]
    ds_read_b64_tr_b16 a[20:21], v10 offset:16896
    v_mfma_f32_16x16x32_bf16 v[120:123], a[24:27], a[100:103], v[120:123]
    ds_read_b64_tr_b16 a[22:23], v10 offset:17408
    v_mfma_f32_16x16x32_bf16 v[152:155], a[24:27], a[116:119], v[152:155]
    ds_read_b64_tr_b16 a[8:9], v10 offset:16928
    v_mfma_f32_16x16x32_bf16 v[184:187], a[24:27], a[132:135], v[184:187]
    ds_read_b64_tr_b16 a[10:11], v10 offset:17440
    v_mfma_f32_16x16x32_bf16 v[116:119], a[40:43], a[104:107], v[116:119]
    ds_read_b64_tr_b16 a[80:81], v10 offset:25344
    v_mfma_f32_16x16x32_bf16 v[148:151], a[40:43], a[120:123], v[148:151]
    ds_read_b64_tr_b16 a[82:83], v10 offset:25856
    v_mfma_f32_16x16x32_bf16 v[180:183], a[40:43], a[136:139], v[180:183]
    ds_read_b64_tr_b16 a[12:13], v10 offset:25376
    v_mfma_f32_16x16x32_bf16 v[120:123], a[56:59], a[104:107], v[120:123]
    ds_read_b64_tr_b16 a[14:15], v10 offset:25888
    v_mfma_f32_16x16x32_bf16 v[152:155], a[56:59], a[120:123], v[152:155]
    v_mfma_f32_16x16x32_bf16 v[184:187], a[56:59], a[136:139], v[184:187]
    v_mfma_f32_16x16x32_bf16 v[116:119], a[48:51], a[108:111], v[116:119]
    v_mfma_f32_16x16x32_bf16 v[148:151], a[48:51], a[124:127], v[148:151]
    v_mfma_f32_16x16x32_bf16 v[180:183], a[48:51], a[140:143], v[180:183]
    v_mfma_f32_16x16x32_bf16 v[120:123], a[28:31], a[108:111], v[120:123]
    v_mfma_f32_16x16x32_bf16 v[152:155], a[28:31], a[124:127], v[152:155]
    v_mfma_f32_16x16x32_bf16 v[184:187], a[28:31], a[140:143], v[184:187]
    s_waitcnt lgkmcnt(0)
    s_cmp_eq_u32 s81, 7
    s_cbranch_scc1 L_fea
    s_waitcnt vmcnt(12)
    v_cmp_eq_u32 vcc, v67, v66
    s_nop 0
    s_and_b32 s81, vcc_lo, 7
    s_andn2_b32 s56, s81, s82
    s_cbranch_scc0 L_fea_p
    s_mov_b32 s82, s81
    s_bitcmp0_b32 s56, 0
    s_cbranch_scc1 L_fea_0
    buffer_load_dwordx4 v[124:127], v5, s[40:43], s7 offen offset:0 sc1
    buffer_load_dwordx4 v[156:159], v5, s[40:43], s7 offen offset:1024 sc1
    buffer_load_dwordx4 v[188:191], v5, s[40:43], s7 offen offset:2048 sc1
    buffer_load_dword v60, v59, s[40:43], s7 offen offset:3072 sc1
L_fea_0:
    s_bitcmp0_b32 s56, 1
    s_cbranch_scc1 L_fea_1
    buffer_load_dwordx4 v[132:135], v5, s[40:43], s8 offen offset:0 sc1
    buffer_load_dwordx4 v[164:167], v5, s[40:43], s8 offen offset:1024 sc1
    buffer_load_dwordx4 v[196:199], v5, s[40:43], s8 offen offset:2048 sc1
    buffer_load_dword v61, v59, s[40:43], s8 offen offset:3072 sc1
L_fea_1:
    s_bitcmp0_b32 s56, 2
    s_cbranch_scc1 L_fea_2
    buffer_load_dwordx4 v[140:143], v5, s[40:43], s9 offen offset:0 sc1
    buffer_load_dwordx4 v[172:175], v5, s[40:43], s9 offen offset:1024 sc1
    buffer_load_dwordx4 v[204:207], v5, s[40:43], s9 offen offset:2048 sc1
    buffer_load_dword v62, v59, s[40:43], s9 offen offset:3072 sc1
L_fea_2:
L_fea_p:
    buffer_load_dword v67, v11, s[40:43], s70 offen sc1
L_fea:
    v_mfma_f32_16x16x32_bf16 v[116:119], a[76:79], a[144:147], v[116:119]
    v_mfma_f32_16x16x32_bf16 v[148:151], a[76:79], a[160:163], v[148:151]
    v_mfma_f32_16x16x32_bf16 v[180:183], a[76:79], a[176:179], v[180:183]
    v_mfma_f32_16x16x32_bf16 v[120:123], a[52:55], a[144:147], v[120:123]
    v_mfma_f32_16x16x32_bf16 v[152:155], a[52:55], a[160:163], v[152:155]
    v_mfma_f32_16x16x32_bf16 v[184:187], a[52:55], a[176:179], v[184:187]
    v_mfma_f32_16x16x32_bf16 v[116:119], a[88:91], a[148:151], v[116:119]
    v_mfma_f32_16x16x32_bf16 v[148:151], a[88:91], a[164:167], v[148:151]
    v_mfma_f32_16x16x32_bf16 v[180:183], a[88:91], a[180:183], v[180:183]
    v_mfma_f32_16x16x32_bf16 v[120:123], a[44:47], a[148:151], v[120:123]
    v_mfma_f32_16x16x32_bf16 v[152:155], a[44:47], a[164:167], v[152:155]
    v_mfma_f32_16x16x32_bf16 v[184:187], a[44:47], a[180:183], v[184:187]
    v_mfma_f32_16x16x32_bf16 v[116:119], a[20:23], a[152:155], v[116:119]
    v_mfma_f32_16x16x32_bf16 v[148:151], a[20:23], a[168:171], v[148:151]
    s_waitcnt vmcnt(0)
    v_mfma_f32_16x16x32_bf16 v[180:183], a[20:23], a[184:187], v[180:183]
    v_add3_u32 v63, v124, v125, s78
    v_add3_u32 v63, v126, v127, v63
    v_mfma_f32_16x16x32_bf16 v[120:123], a[8:11], a[152:155], v[120:123]
    v_add3_u32 v63, v156, v157, v63
    v_add3_u32 v63, v158, v159, v63
    v_mfma_f32_16x16x32_bf16 v[152:155], a[8:11], a[168:171], v[152:155]
    v_add3_u32 v63, v188, v189, v63
    v_add3_u32 v63, v190, v191, v63
    v_mfma_f32_16x16x32_bf16 v[184:187], a[8:11], a[184:187], v[184:187]
    v_add3_u32 v64, v132, v133, s87
    v_add3_u32 v64, v134, v135, v64
    v_mfma_f32_16x16x32_bf16 v[116:119], a[80:83], a[156:159], v[116:119]
    v_add3_u32 v64, v164, v165, v64
    v_add3_u32 v64, v166, v167, v64
    v_mfma_f32_16x16x32_bf16 v[148:151], a[80:83], a[172:175], v[148:151]
    v_add3_u32 v64, v196, v197, v64
    v_add3_u32 v64, v198, v199, v64
    v_mfma_f32_16x16x32_bf16 v[180:183], a[80:83], a[188:191], v[180:183]
    v_add3_u32 v65, v140, v141, s88
    v_add3_u32 v65, v142, v143, v65
    v_mfma_f32_16x16x32_bf16 v[120:123], a[12:15], a[156:159], v[120:123]
    v_add3_u32 v65, v172, v173, v65
    v_add3_u32 v65, v174, v175, v65
    v_mfma_f32_16x16x32_bf16 v[152:155], a[12:15], a[172:175], v[152:155]
    v_add3_u32 v65, v204, v205, v65
    v_add3_u32 v65, v206, v207, v65
    v_mfma_f32_16x16x32_bf16 v[184:187], a[12:15], a[188:191], v[184:187]
    v_xor_b32 v63, v63, v60
    v_xor_b32 v64, v64, v61
    v_xor_b32 v65, v65, v62
    v_or3_b32 v10, v63, v64, v65
    s_xor_b32 s56, s82, 7
    v_or_b32 v10, s56, v10
    v_cmp_ne_u32 vcc, 0, v10
    s_nop 0
    s_cbranch_vccz L_f2_f
    s_mov_b32 s72, 131072
    s_mov_b32 s80, 7
L_f2:
    s_waitcnt vmcnt(0)
    s_and_b32 s86, s82, s80
    s_cmp_eq_u32 s81, 7
    s_cbranch_scc1 L_feb
    v_cmp_eq_u32 vcc, v67, v66
    s_nop 0
    s_and_b32 s81, vcc_lo, 7
    s_andn2_b32 s56, s81, s82
    s_cbranch_scc0 L_feb_p
    s_mov_b32 s82, s81
    s_bitcmp0_b32 s56, 0
    s_cbranch_scc1 L_feb_0
    buffer_load_dwordx4 v[124:127], v5, s[40:43], s7 offen offset:0 sc1
    buffer_load_dwordx4 v[156:159], v5, s[40:43], s7 offen offset:1024 sc1
    buffer_load_dwordx4 v[188:191], v5, s[40:43], s7 offen offset:2048 sc1
    buffer_load_dword v60, v59, s[40:43], s7 offen offset:3072 sc1
L_feb_0:
    s_bitcmp0_b32 s56, 1
    s_cbranch_scc1 L_feb_1
    buffer_load_dwordx4 v[132:135], v5, s[40:43], s8 offen offset:0 sc1
    buffer_load_dwordx4 v[164:167], v5, s[40:43], s8 offen offset:1024 sc1
    buffer_load_dwordx4 v[196:199], v5, s[40:43], s8 offen offset:2048 sc1
    buffer_load_dword v61, v59, s[40:43], s8 offen offset:3072 sc1
L_feb_1:
    s_bitcmp0_b32 s56, 2
    s_cbranch_scc1 L_feb_2
    buffer_load_dwordx4 v[140:143], v5, s[40:43], s9 offen offset:0 sc1
    buffer_load_dwordx4 v[172:175], v5, s[40:43], s9 offen offset:1024 sc1
    buffer_load_dwordx4 v[204:207], v5, s[40:43], s9 offen offset:2048 sc1
    buffer_load_dword v62, v59, s[40:43], s9 offen offset:3072 sc1
L_feb_2:
L_feb_p:
    buffer_load_dword v67, v11, s[40:43], s70 offen sc1
L_feb:
    s_cmp_eq_u32 s86, 0
    s_cbranch_scc1 L_f2_n2
    s_bitcmp0_b32 s86, 0
    s_cbranch_scc1 L_f2_n0
    v_add3_u32 v63, v124, v125, s78
    v_add3_u32 v63, v126, v127, v63
    v_add3_u32 v63, v156, v157, v63
    v_add3_u32 v63, v158, v159, v63
    v_add3_u32 v63, v188, v189, v63
    v_add3_u32 v63, v190, v191, v63
    v_cmp_ne_u32 vcc, v63, v60
    s_nop 0
    s_cbranch_vccz L_f2_a0
    buffer_load_dwordx4 v[124:127], v5, s[40:43], s7 offen offset:0 sc1
    buffer_load_dwordx4 v[156:159], v5, s[40:43], s7 offen offset:1024 sc1
    buffer_load_dwordx4 v[188:191], v5, s[40:43], s7 offen offset:2048 sc1
    buffer_load_dword v60, v59, s[40:43], s7 offen offset:3072 sc1
    s_branch L_f2_n0
L_f2_a0:
    v_mfma_f32_16x16x32_bf16 v[116:119], a[226:229], v[124:127], v[116:119]
    v_mfma_f32_16x16x32_bf16 v[120:123], a[224:227], v[124:127], v[120:123]
    v_mfma_f32_16x16x32_bf16 v[148:151], a[226:229], v[156:159], v[148:151]
    v_mfma_f32_16x16x32_bf16 v[152:155], a[224:227], v[156:159], v[152:155]
    v_mfma_f32_16x16x32_bf16 v[180:183], a[226:229], v[188:191], v[180:183]
    v_mfma_f32_16x16x32_bf16 v[184:187], a[224:227], v[188:191], v[184:187]
    s_bitset0_b32 s80, 0
L_f2_n0:
    s_bitcmp0_b32 s86, 1
    s_cbranch_scc1 L_f2_n1
    v_add3_u32 v64, v132, v133, s87
    v_add3_u32 v64, v134, v135, v64
    v_add3_u32 v64, v164, v165, v64
    v_add3_u32 v64, v166, v167, v64
    v_add3_u32 v64, v196, v197, v64
    v_add3_u32 v64, v198, v199, v64
    v_cmp_ne_u32 vcc, v64, v61
    s_nop 0
    s_cbranch_vccz L_f2_a1
    buffer_load_dwordx4 v[132:135], v5, s[40:43], s8 offen offset:0 sc1
    buffer_load_dwordx4 v[164:167], v5, s[40:43], s8 offen offset:1024 sc1
    buffer_load_dwordx4 v[196:199], v5, s[40:43], s8 offen offset:2048 sc1
    buffer_load_dword v61, v59, s[40:43], s8 offen offset:3072 sc1
    s_branch L_f2_n1
L_f2_a1:
    v_mfma_f32_16x16x32_bf16 v[116:119], a[226:229], v[132:135], v[116:119]
    v_mfma_f32_16x16x32_bf16 v[120:123], a[224:227], v[132:135], v[120:123]
    v_mfma_f32_16x16x32_bf16 v[148:151], a[226:229], v[164:167], v[148:151]
    v_mfma_f32_16x16x32_bf16 v[152:155], a[224:227], v[164:167], v[152:155]
    v_mfma_f32_16x16x32_bf16 v[180:183], a[226:229], v[196:199], v[180:183]
    v_mfma_f32_16x16x32_bf16 v[184:187], a[224:227], v[196:199], v[184:187]
    s_bitset0_b32 s80, 1
L_f2_n1:
    s_bitcmp0_b32 s86, 2
    s_cbranch_scc1 L_f2_n2
    v_add3_u32 v65, v140, v141, s88
    v_add3_u32 v65, v142, v143, v65
    v_add3_u32 v65, v172, v173, v65
    v_add3_u32 v65, v174, v175, v65
    v_add3_u32 v65, v204, v205, v65
    v_add3_u32 v65, v206, v207, v65
    v_cmp_ne_u32 vcc, v65, v62
    s_nop 0
    s_cbranch_vccz L_f2_a2
    buffer_load_dwordx4 v[140:143], v5, s[40:43], s9 offen offset:0 sc1
    buffer_load_dwordx4 v[172:175], v5, s[40:43], s9 offen offset:1024 sc1
    buffer_load_dwordx4 v[204:207], v5, s[40:43], s9 offen offset:2048 sc1
    buffer_load_dword v62, v59, s[40:43], s9 offen offset:3072 sc1
    s_branch L_f2_n2
L_f2_a2:
    v_mfma_f32_16x16x32_bf16 v[116:119], a[226:229], v[140:143], v[116:119]
    v_mfma_f32_16x16x32_bf16 v[120:123], a[224:227], v[140:143], v[120:123]
    v_mfma_f32_16x16x32_bf16 v[148:151], a[226:229], v[172:175], v[148:151]
    v_mfma_f32_16x16x32_bf16 v[152:155], a[224:227], v[172:175], v[152:155]
    v_mfma_f32_16x16x32_bf16 v[180:183], a[226:229], v[204:207], v[180:183]
    v_mfma_f32_16x16x32_bf16 v[184:187], a[224:227], v[204:207], v[184:187]
    s_bitset0_b32 s80, 2
L_f2_n2:
    s_cmp_eq_u32 s80, 0
    s_cbranch_scc1 L_f2_e
    s_sub_u32 s72, s72, 1
    s_cmp_lg_u32 s72, 0
    s_cbranch_scc1 L_f2
    s_branch L_f2_e
L_f2_f:
    v_mfma_f32_16x16x32_bf16 v[116:119], a[226:229], v[124:127], v[116:119]
    v_mfma_f32_16x16x32_bf16 v[120:123], a[224:227], v[124:127], v[120:123]
    v_mfma_f32_16x16x32_bf16 v[148:151], a[226:229], v[156:159], v[148:151]
    v_mfma_f32_16x16x32_bf16 v[152:155], a[224:227], v[156:159], v[152:155]
    v_mfma_f32_16x16x32_bf16 v[180:183], a[226:229], v[188:191], v[180:183]
    v_mfma_f32_16x16x32_bf16 v[184:187], a[224:227], v[188:191], v[184:187]
    v_mfma_f32_16x16x32_bf16 v[116:119], a[226:229], v[132:135], v[116:119]
    v_mfma_f32_16x16x32_bf16 v[120:123], a[224:227], v[132:135], v[120:123]
    v_mfma_f32_16x16x32_bf16 v[148:151], a[226:229], v[164:167], v[148:151]
    v_mfma_f32_16x16x32_bf16 v[152:155], a[224:227], v[164:167], v[152:155]
    v_mfma_f32_16x16x32_bf16 v[180:183], a[226:229], v[196:199], v[180:183]
    v_mfma_f32_16x16x32_bf16 v[184:187], a[224:227], v[196:199], v[184:187]
    v_mfma_f32_16x16x32_bf16 v[116:119], a[226:229], v[140:143], v[116:119]
    v_mfma_f32_16x16x32_bf16 v[120:123], a[224:227], v[140:143], v[120:123]
    v_mfma_f32_16x16x32_bf16 v[148:151], a[226:229], v[172:175], v[148:151]
    v_mfma_f32_16x16x32_bf16 v[152:155], a[224:227], v[172:175], v[152:155]
    v_mfma_f32_16x16x32_bf16 v[180:183], a[226:229], v[204:207], v[180:183]
    v_mfma_f32_16x16x32_bf16 v[184:187], a[224:227], v[204:207], v[184:187]
L_f2_e:
    s_nop 2
    v_cvt_pk_bf16_f32 v56, v116, v117
    v_cvt_pk_bf16_f32 v57, v118, v119
    v_cvt_pk_bf16_f32 v58, v120, v121
    v_cvt_pk_bf16_f32 v59, v122, v123
    v_cvt_pk_bf16_f32 v60, v148, v149
    v_cvt_pk_bf16_f32 v61, v150, v151
    v_cvt_pk_bf16_f32 v62, v152, v153
    v_cvt_pk_bf16_f32 v63, v154, v155
    v_cvt_pk_bf16_f32 v64, v180, v181
    v_cvt_pk_bf16_f32 v65, v182, v183
    v_cvt_pk_bf16_f32 v66, v184, v185
    v_cvt_pk_bf16_f32 v67, v186, v187
    s_nop 1
    v_permlane32_swap_b32 v56, v58
    v_permlane32_swap_b32 v57, v59
    v_permlane32_swap_b32 v60, v62
    v_permlane32_swap_b32 v61, v63
    v_permlane32_swap_b32 v64, v66
    v_permlane32_swap_b32 v65, v67
    v_permlane16_swap_b32 v56, v58
    v_permlane16_swap_b32 v57, v59
    v_permlane16_swap_b32 v60, v62
    v_permlane16_swap_b32 v61, v63
    v_permlane16_swap_b32 v64, v66
    v_permlane16_swap_b32 v65, v67
    s_nop 1
    buffer_store_dwordx4 v[56:59], v2, s[44:47], s10 offen
    s_add_u32 s10, s10, 16384
    buffer_store_dwordx4 v[60:63], v2, s[44:47], s10 offen
    s_add_u32 s10, s10, 16384
    buffer_store_dwordx4 v[64:67], v2, s[44:47], s10 offen
    s_add_u32 s10, s10, 16384
    s_endpgm
L_fb0:
    s_waitcnt vmcnt(0)
    s_lshl_b32 s58, s71, 18
    s_add_u32 s58, s58, 96
    v_and_b32 v10, 15, v0
    v_lshrrev_b32 v11, 4, v0
    v_lshlrev_b32 v9, 8, v10
    v_lshl_add_u32 v9, v11, 4, v9
    v_lshlrev_b32 v11, 10, v11
    v_lshl_add_u32 v10, v10, 1, v11
    v_add_u32 v11, 4096, v10
    v_mov_b32 v6, 0xff800000
    v_mov_b32 v7, 0xff800000
    v_mov_b32 v8, 0xff800000
    s_mov_b32 s56, 32
    s_mov_b32 s57, s58
L_fb0_p1:
    s_add_u32 s59, s57, 0
    buffer_load_dwordx4 a[224:227], v9, s[24:27], s59 offen offset:0
    buffer_load_dwordx4 a[228:231], v9, s[24:27], s59 offen offset:64
    buffer_load_dwordx4 a[232:235], v9, s[24:27], s59 offen offset:128
    buffer_load_dwordx4 a[236:239], v9, s[24:27], s59 offen offset:192
    s_add_u32 s59, s57, 4096
    buffer_load_dwordx4 a[240:243], v9, s[24:27], s59 offen offset:0
    buffer_load_dwordx4 a[244:247], v9, s[24:27], s59 offen offset:64
    buffer_load_dwordx4 a[248:251], v9, s[24:27], s59 offen offset:128
    buffer_load_dwordx4 a[252:255], v9, s[24:27], s59 offen offset:192
    s_waitcnt vmcnt(0)
    v_mfma_f32_16x16x32_bf16 v[32:35], a[224:227], v[68:71], 0
    v_mfma_f32_16x16x32_bf16 v[32:35], a[228:231], v[72:75], v[32:35]
    v_mfma_f32_16x16x32_bf16 v[32:35], a[232:235], v[76:79], v[32:35]
    v_mfma_f32_16x16x32_bf16 v[32:35], a[236:239], v[80:83], v[32:35]
    v_mfma_f32_16x16x32_bf16 v[36:39], a[240:243], v[68:71], 0
    v_mfma_f32_16x16x32_bf16 v[36:39], a[244:247], v[72:75], v[36:39]
    v_mfma_f32_16x16x32_bf16 v[36:39], a[248:251], v[76:79], v[36:39]
    v_mfma_f32_16x16x32_bf16 v[36:39], a[252:255], v[80:83], v[36:39]
    v_mfma_f32_16x16x32_bf16 v[40:43], a[224:227], v[84:87], 0
    v_mfma_f32_16x16x32_bf16 v[40:43], a[228:231], v[88:91], v[40:43]
    v_mfma_f32_16x16x32_bf16 v[40:43], a[232:235], v[92:95], v[40:43]
    v_mfma_f32_16x16x32_bf16 v[40:43], a[236:239], v[96:99], v[40:43]
    v_mfma_f32_16x16x32_bf16 v[44:47], a[240:243], v[84:87], 0
    v_mfma_f32_16x16x32_bf16 v[44:47], a[244:247], v[88:91], v[44:47]
    v_mfma_f32_16x16x32_bf16 v[44:47], a[248:251], v[92:95], v[44:47]
    v_mfma_f32_16x16x32_bf16 v[44:47], a[252:255], v[96:99], v[44:47]
    v_mfma_f32_16x16x32_bf16 v[48:51], a[224:227], v[100:103], 0
    v_mfma_f32_16x16x32_bf16 v[48:51], a[228:231], v[104:107], v[48:51]
    v_mfma_f32_16x16x32_bf16 v[48:51], a[232:235], v[108:111], v[48:51]
    v_mfma_f32_16x16x32_bf16 v[48:51], a[236:239], v[112:115], v[48:51]
    v_mfma_f32_16x16x32_bf16 v[52:55], a[240:243], v[100:103], 0
    v_mfma_f32_16x16x32_bf16 v[52:55], a[244:247], v[104:107], v[52:55]
    v_mfma_f32_16x16x32_bf16 v[52:55], a[248:251], v[108:111], v[52:55]
    v_mfma_f32_16x16x32_bf16 v[52:55], a[252:255], v[112:115], v[52:55]
    s_nop 7
    v_max3_f32 v6, v6, v32, v33
    v_max3_f32 v6, v6, v34, v35
    v_max3_f32 v6, v6, v36, v37
    v_max3_f32 v6, v6, v38, v39
    v_max3_f32 v7, v7, v40, v41
    v_max3_f32 v7, v7, v42, v43
    v_max3_f32 v7, v7, v44, v45
    v_max3_f32 v7, v7, v46, v47
    v_max3_f32 v8, v8, v48, v49
    v_max3_f32 v8, v8, v50, v51
    v_max3_f32 v8, v8, v52, v53
    v_max3_f32 v8, v8, v54, v55
    s_add_u32 s57, s57, 8192
    s_sub_u32 s56, s56, 1
    s_cmp_lg_u32 s56, 0
    s_cbranch_scc1 L_fb0_p1
    v_mov_b32 v32, v6
    s_nop 1
    v_permlane32_swap_b32 v32, v6
    s_nop 0
    v_max_f32 v6, v32, v6
    v_mov_b32 v32, v6
    s_nop 1
    v_permlane16_swap_b32 v32, v6
    s_nop 0
    v_max_f32 v6, v32, v6
    v_mov_b32 v32, v7
    s_nop 1
    v_permlane32_swap_b32 v32, v7
    s_nop 0
    v_max_f32 v7, v32, v7
    v_mov_b32 v32, v7
    s_nop 1
    v_permlane16_swap_b32 v32, v7
    s_nop 0
    v_max_f32 v7, v32, v7
    v_mov_b32 v32, v8
    s_nop 1
    v_permlane32_swap_b32 v32, v8
    s_nop 0
    v_max_f32 v8, v32, v8
    v_mov_b32 v32, v8
    s_nop 1
    v_permlane16_swap_b32 v32, v8
    s_nop 0
    v_max_f32 v8, v32, v8
    v_mov_b32 v20, 0
    v_mov_b32 v21, 0
    v_mov_b32 v22, 0
    v_mov_b32 v23, 0
    v_mov_b32 v24, 0
    v_mov_b32 v25, 0
    v_mov_b32 v26, 0
    v_mov_b32 v27, 0
    v_mov_b32 v28, 0
    v_mov_b32 v29, 0
    v_mov_b32 v30, 0
    v_mov_b32 v31, 0
    v_mov_b32 v116, 0
    v_mov_b32 v117, 0
    v_mov_b32 v118, 0
    v_mov_b32 v119, 0
    v_mov_b32 v120, 0
    v_mov_b32 v121, 0
    v_mov_b32 v122, 0
    v_mov_b32 v123, 0
    v_mov_b32 v124, 0
    v_mov_b32 v125, 0
    v_mov_b32 v126, 0
    v_mov_b32 v127, 0
    v_mov_b32 v128, 0
    v_mov_b32 v129, 0
    v_mov_b32 v130, 0
    v_mov_b32 v131, 0
    v_mov_b32 v132, 0
    v_mov_b32 v133, 0
    v_mov_b32 v134, 0
    v_mov_b32 v135, 0
    v_mov_b32 v136, 0
    v_mov_b32 v137, 0
    v_mov_b32 v138, 0
    v_mov_b32 v139, 0
    v_mov_b32 v140, 0
    v_mov_b32 v141, 0
    v_mov_b32 v142, 0
    v_mov_b32 v143, 0
    v_mov_b32 v144, 0
    v_mov_b32 v145, 0
    v_mov_b32 v146, 0
    v_mov_b32 v147, 0
    v_mov_b32 v148, 0
    v_mov_b32 v149, 0
    v_mov_b32 v150, 0
    v_mov_b32 v151, 0
    v_mov_b32 v152, 0
    v_mov_b32 v153, 0
    v_mov_b32 v154, 0
    v_mov_b32 v155, 0
    v_mov_b32 v156, 0
    v_mov_b32 v157, 0
    v_mov_b32 v158, 0
    v_mov_b32 v159, 0
    v_mov_b32 v160, 0
    v_mov_b32 v161, 0
    v_mov_b32 v162, 0
    v_mov_b32 v163, 0
    v_mov_b32 v164, 0
    v_mov_b32 v165, 0
    v_mov_b32 v166, 0
    v_mov_b32 v167, 0
    v_mov_b32 v168, 0
    v_mov_b32 v169, 0
    v_mov_b32 v170, 0
    v_mov_b32 v171, 0
    v_mov_b32 v172, 0
    v_mov_b32 v173, 0
    v_mov_b32 v174, 0
    v_mov_b32 v175, 0
    v_mov_b32 v176, 0
    v_mov_b32 v177, 0
    v_mov_b32 v178, 0
    v_mov_b32 v179, 0
    v_mov_b32 v180, 0
    v_mov_b32 v181, 0
    v_mov_b32 v182, 0
    v_mov_b32 v183, 0
    v_mov_b32 v184, 0
    v_mov_b32 v185, 0
    v_mov_b32 v186, 0
    v_mov_b32 v187, 0
    v_mov_b32 v188, 0
    v_mov_b32 v189, 0
    v_mov_b32 v190, 0
    v_mov_b32 v191, 0
    v_mov_b32 v192, 0
    v_mov_b32 v193, 0
    v_mov_b32 v194, 0
    v_mov_b32 v195, 0
    v_mov_b32 v196, 0
    v_mov_b32 v197, 0
    v_mov_b32 v198, 0
    v_mov_b32 v199, 0
    v_mov_b32 v200, 0
    v_mov_b32 v201, 0
    v_mov_b32 v202, 0
    v_mov_b32 v203, 0
    v_mov_b32 v204, 0
    v_mov_b32 v205, 0
    v_mov_b32 v206, 0
    v_mov_b32 v207, 0
    v_mov_b32 v208, 0
    v_mov_b32 v209, 0
    v_mov_b32 v210, 0
    v_mov_b32 v211, 0
    s_mov_b32 s56, 32
    s_mov_b32 s57, s58
L_fb0_p2:
    s_add_u32 s59, s57, 0
    buffer_load_dwordx4 a[224:227], v9, s[24:27], s59 offen offset:0
    buffer_load_dwordx4 a[228:231], v9, s[24:27], s59 offen offset:64
    buffer_load_dwordx4 a[232:235], v9, s[24:27], s59 offen offset:128
    buffer_load_dwordx4 a[236:239], v9, s[24:27], s59 offen offset:192
    s_add_u32 s59, s57, 4096
    buffer_load_dwordx4 a[240:243], v9, s[24:27], s59 offen offset:0
    buffer_load_dwordx4 a[244:247], v9, s[24:27], s59 offen offset:64
    buffer_load_dwordx4 a[248:251], v9, s[24:27], s59 offen offset:128
    buffer_load_dwordx4 a[252:255], v9, s[24:27], s59 offen offset:192
    buffer_load_ushort v32, v10, s[28:31], s57 offen offset:0
    buffer_load_ushort v33, v10, s[28:31], s57 offen offset:256
    buffer_load_ushort v34, v10, s[28:31], s57 offen offset:512
    buffer_load_ushort v35, v10, s[28:31], s57 offen offset:768
    buffer_load_ushort v36, v11, s[28:31], s57 offen offset:0
    buffer_load_ushort v37, v11, s[28:31], s57 offen offset:256
    buffer_load_ushort v38, v11, s[28:31], s57 offen offset:512
    buffer_load_ushort v39, v11, s[28:31], s57 offen offset:768
    buffer_load_ushort v40, v10, s[28:31], s57 offen offset:32
    buffer_load_ushort v41, v10, s[28:31], s57 offen offset:288
    buffer_load_ushort v42, v10, s[28:31], s57 offen offset:544
    buffer_load_ushort v43, v10, s[28:31], s57 offen offset:800
    buffer_load_ushort v44, v11, s[28:31], s57 offen offset:32
    buffer_load_ushort v45, v11, s[28:31], s57 offen offset:288
    buffer_load_ushort v46, v11, s[28:31], s57 offen offset:544
    buffer_load_ushort v47, v11, s[28:31], s57 offen offset:800
    buffer_load_ushort v48, v10, s[28:31], s57 offen offset:64
    buffer_load_ushort v49, v10, s[28:31], s57 offen offset:320
    buffer_load_ushort v50, v10, s[28:31], s57 offen offset:576
    buffer_load_ushort v51, v10, s[28:31], s57 offen offset:832
    buffer_load_ushort v52, v11, s[28:31], s57 offen offset:64
    buffer_load_ushort v53, v11, s[28:31], s57 offen offset:320
    buffer_load_ushort v54, v11, s[28:31], s57 offen offset:576
    buffer_load_ushort v55, v11, s[28:31], s57 offen offset:832
    s_waitcnt vmcnt(0)
    v_lshl_or_b32 v212, v33, 16, v32
    v_lshl_or_b32 v213, v35, 16, v34
    v_lshl_or_b32 v214, v37, 16, v36
    v_lshl_or_b32 v215, v39, 16, v38
    v_lshl_or_b32 v216, v41, 16, v40
    v_lshl_or_b32 v217, v43, 16, v42
    v_lshl_or_b32 v218, v45, 16, v44
    v_lshl_or_b32 v219, v47, 16, v46
    v_lshl_or_b32 v220, v49, 16, v48
    v_lshl_or_b32 v221, v51, 16, v50
    v_lshl_or_b32 v222, v53, 16, v52
    v_lshl_or_b32 v223, v55, 16, v54
    buffer_load_ushort v32, v10, s[28:31], s57 offen offset:96
    buffer_load_ushort v33, v10, s[28:31], s57 offen offset:352
    buffer_load_ushort v34, v10, s[28:31], s57 offen offset:608
    buffer_load_ushort v35, v10, s[28:31], s57 offen offset:864
    buffer_load_ushort v36, v11, s[28:31], s57 offen offset:96
    buffer_load_ushort v37, v11, s[28:31], s57 offen offset:352
    buffer_load_ushort v38, v11, s[28:31], s57 offen offset:608
    buffer_load_ushort v39, v11, s[28:31], s57 offen offset:864
    buffer_load_ushort v40, v10, s[28:31], s57 offen offset:128
    buffer_load_ushort v41, v10, s[28:31], s57 offen offset:384
    buffer_load_ushort v42, v10, s[28:31], s57 offen offset:640
    buffer_load_ushort v43, v10, s[28:31], s57 offen offset:896
    buffer_load_ushort v44, v11, s[28:31], s57 offen offset:128
    buffer_load_ushort v45, v11, s[28:31], s57 offen offset:384
    buffer_load_ushort v46, v11, s[28:31], s57 offen offset:640
    buffer_load_ushort v47, v11, s[28:31], s57 offen offset:896
    buffer_load_ushort v48, v10, s[28:31], s57 offen offset:160
    buffer_load_ushort v49, v10, s[28:31], s57 offen offset:416
    buffer_load_ushort v50, v10, s[28:31], s57 offen offset:672
    buffer_load_ushort v51, v10, s[28:31], s57 offen offset:928
    buffer_load_ushort v52, v11, s[28:31], s57 offen offset:160
    buffer_load_ushort v53, v11, s[28:31], s57 offen offset:416
    buffer_load_ushort v54, v11, s[28:31], s57 offen offset:672
    buffer_load_ushort v55, v11, s[28:31], s57 offen offset:928
    s_waitcnt vmcnt(0)
    v_lshl_or_b32 v224, v33, 16, v32
    v_lshl_or_b32 v225, v35, 16, v34
    v_lshl_or_b32 v226, v37, 16, v36
    v_lshl_or_b32 v227, v39, 16, v38
    v_lshl_or_b32 v228, v41, 16, v40
    v_lshl_or_b32 v229, v43, 16, v42
    v_lshl_or_b32 v230, v45, 16, v44
    v_lshl_or_b32 v231, v47, 16, v46
    v_lshl_or_b32 v232, v49, 16, v48
    v_lshl_or_b32 v233, v51, 16, v50
    v_lshl_or_b32 v234, v53, 16, v52
    v_lshl_or_b32 v235, v55, 16, v54
    buffer_load_ushort v32, v10, s[28:31], s57 offen offset:192
    buffer_load_ushort v33, v10, s[28:31], s57 offen offset:448
    buffer_load_ushort v34, v10, s[28:31], s57 offen offset:704
    buffer_load_ushort v35, v10, s[28:31], s57 offen offset:960
    buffer_load_ushort v36, v11, s[28:31], s57 offen offset:192
    buffer_load_ushort v37, v11, s[28:31], s57 offen offset:448
    buffer_load_ushort v38, v11, s[28:31], s57 offen offset:704
    buffer_load_ushort v39, v11, s[28:31], s57 offen offset:960
    buffer_load_ushort v40, v10, s[28:31], s57 offen offset:224
    buffer_load_ushort v41, v10, s[28:31], s57 offen offset:480
    buffer_load_ushort v42, v10, s[28:31], s57 offen offset:736
    buffer_load_ushort v43, v10, s[28:31], s57 offen offset:992
    buffer_load_ushort v44, v11, s[28:31], s57 offen offset:224
    buffer_load_ushort v45, v11, s[28:31], s57 offen offset:480
    buffer_load_ushort v46, v11, s[28:31], s57 offen offset:736
    buffer_load_ushort v47, v11, s[28:31], s57 offen offset:992
    s_waitcnt vmcnt(0)
    v_lshl_or_b32 v236, v33, 16, v32
    v_lshl_or_b32 v237, v35, 16, v34
    v_lshl_or_b32 v238, v37, 16, v36
    v_lshl_or_b32 v239, v39, 16, v38
    v_lshl_or_b32 v240, v41, 16, v40
    v_lshl_or_b32 v241, v43, 16, v42
    v_lshl_or_b32 v242, v45, 16, v44
    v_lshl_or_b32 v243, v47, 16, v46
    s_waitcnt vmcnt(0)
    v_mfma_f32_16x16x32_bf16 v[32:35], a[224:227], v[68:71], 0
    v_mfma_f32_16x16x32_bf16 v[32:35], a[228:231], v[72:75], v[32:35]
    v_mfma_f32_16x16x32_bf16 v[32:35], a[232:235], v[76:79], v[32:35]
    v_mfma_f32_16x16x32_bf16 v[32:35], a[236:239], v[80:83], v[32:35]
    v_mfma_f32_16x16x32_bf16 v[36:39], a[240:243], v[68:71], 0
    v_mfma_f32_16x16x32_bf16 v[36:39], a[244:247], v[72:75], v[36:39]
    v_mfma_f32_16x16x32_bf16 v[36:39], a[248:251], v[76:79], v[36:39]
    v_mfma_f32_16x16x32_bf16 v[36:39], a[252:255], v[80:83], v[36:39]
    v_mfma_f32_16x16x32_bf16 v[40:43], a[224:227], v[84:87], 0
    v_mfma_f32_16x16x32_bf16 v[40:43], a[228:231], v[88:91], v[40:43]
    v_mfma_f32_16x16x32_bf16 v[40:43], a[232:235], v[92:95], v[40:43]
    v_mfma_f32_16x16x32_bf16 v[40:43], a[236:239], v[96:99], v[40:43]
    v_mfma_f32_16x16x32_bf16 v[44:47], a[240:243], v[84:87], 0
    v_mfma_f32_16x16x32_bf16 v[44:47], a[244:247], v[88:91], v[44:47]
    v_mfma_f32_16x16x32_bf16 v[44:47], a[248:251], v[92:95], v[44:47]
    v_mfma_f32_16x16x32_bf16 v[44:47], a[252:255], v[96:99], v[44:47]
    v_mfma_f32_16x16x32_bf16 v[48:51], a[224:227], v[100:103], 0
    v_mfma_f32_16x16x32_bf16 v[48:51], a[228:231], v[104:107], v[48:51]
    v_mfma_f32_16x16x32_bf16 v[48:51], a[232:235], v[108:111], v[48:51]
    v_mfma_f32_16x16x32_bf16 v[48:51], a[236:239], v[112:115], v[48:51]
    v_mfma_f32_16x16x32_bf16 v[52:55], a[240:243], v[100:103], 0
    v_mfma_f32_16x16x32_bf16 v[52:55], a[244:247], v[104:107], v[52:55]
    v_mfma_f32_16x16x32_bf16 v[52:55], a[248:251], v[108:111], v[52:55]
    v_mfma_f32_16x16x32_bf16 v[52:55], a[252:255], v[112:115], v[52:55]
    s_nop 7
    v_sub_f32 v32, v32, v6
    v_sub_f32 v33, v33, v6
    v_sub_f32 v34, v34, v6
    v_sub_f32 v35, v35, v6
    v_sub_f32 v36, v36, v6
    v_sub_f32 v37, v37, v6
    v_sub_f32 v38, v38, v6
    v_sub_f32 v39, v39, v6
    v_exp_f32 v32, v32
    v_exp_f32 v33, v33
    v_exp_f32 v34, v34
    v_exp_f32 v35, v35
    v_exp_f32 v36, v36
    v_exp_f32 v37, v37
    v_exp_f32 v38, v38
    v_exp_f32 v39, v39
    s_nop 0
    v_cvt_pk_bf16_f32 v56, v32, v33
    v_cvt_pk_bf16_f32 v57, v34, v35
    v_cvt_pk_bf16_f32 v58, v36, v37
    v_cvt_pk_bf16_f32 v59, v38, v39
    v_sub_f32 v40, v40, v7
    v_sub_f32 v41, v41, v7
    v_sub_f32 v42, v42, v7
    v_sub_f32 v43, v43, v7
    v_sub_f32 v44, v44, v7
    v_sub_f32 v45, v45, v7
    v_sub_f32 v46, v46, v7
    v_sub_f32 v47, v47, v7
    v_exp_f32 v40, v40
    v_exp_f32 v41, v41
    v_exp_f32 v42, v42
    v_exp_f32 v43, v43
    v_exp_f32 v44, v44
    v_exp_f32 v45, v45
    v_exp_f32 v46, v46
    v_exp_f32 v47, v47
    s_nop 0
    v_cvt_pk_bf16_f32 v60, v40, v41
    v_cvt_pk_bf16_f32 v61, v42, v43
    v_cvt_pk_bf16_f32 v62, v44, v45
    v_cvt_pk_bf16_f32 v63, v46, v47
    v_sub_f32 v48, v48, v8
    v_sub_f32 v49, v49, v8
    v_sub_f32 v50, v50, v8
    v_sub_f32 v51, v51, v8
    v_sub_f32 v52, v52, v8
    v_sub_f32 v53, v53, v8
    v_sub_f32 v54, v54, v8
    v_sub_f32 v55, v55, v8
    v_exp_f32 v48, v48
    v_exp_f32 v49, v49
    v_exp_f32 v50, v50
    v_exp_f32 v51, v51
    v_exp_f32 v52, v52
    v_exp_f32 v53, v53
    v_exp_f32 v54, v54
    v_exp_f32 v55, v55
    s_nop 0
    v_cvt_pk_bf16_f32 v64, v48, v49
    v_cvt_pk_bf16_f32 v65, v50, v51
    v_cvt_pk_bf16_f32 v66, v52, v53
    v_cvt_pk_bf16_f32 v67, v54, v55
    s_nop 1
    v_mfma_f32_16x16x32_bf16 v[116:119], v[212:215], v[56:59], v[116:119]
    v_mfma_f32_16x16x32_bf16 v[120:123], v[216:219], v[56:59], v[120:123]
    v_mfma_f32_16x16x32_bf16 v[124:127], v[220:223], v[56:59], v[124:127]
    v_mfma_f32_16x16x32_bf16 v[128:131], v[224:227], v[56:59], v[128:131]
    v_mfma_f32_16x16x32_bf16 v[132:135], v[228:231], v[56:59], v[132:135]
    v_mfma_f32_16x16x32_bf16 v[136:139], v[232:235], v[56:59], v[136:139]
    v_mfma_f32_16x16x32_bf16 v[140:143], v[236:239], v[56:59], v[140:143]
    v_mfma_f32_16x16x32_bf16 v[144:147], v[240:243], v[56:59], v[144:147]
    v_mfma_f32_16x16x32_bf16 v[20:23], a[168:171], v[56:59], v[20:23]
    v_mfma_f32_16x16x32_bf16 v[148:151], v[212:215], v[60:63], v[148:151]
    v_mfma_f32_16x16x32_bf16 v[152:155], v[216:219], v[60:63], v[152:155]
    v_mfma_f32_16x16x32_bf16 v[156:159], v[220:223], v[60:63], v[156:159]
    v_mfma_f32_16x16x32_bf16 v[160:163], v[224:227], v[60:63], v[160:163]
    v_mfma_f32_16x16x32_bf16 v[164:167], v[228:231], v[60:63], v[164:167]
    v_mfma_f32_16x16x32_bf16 v[168:171], v[232:235], v[60:63], v[168:171]
    v_mfma_f32_16x16x32_bf16 v[172:175], v[236:239], v[60:63], v[172:175]
    v_mfma_f32_16x16x32_bf16 v[176:179], v[240:243], v[60:63], v[176:179]
    v_mfma_f32_16x16x32_bf16 v[24:27], a[168:171], v[60:63], v[24:27]
    v_mfma_f32_16x16x32_bf16 v[180:183], v[212:215], v[64:67], v[180:183]
    v_mfma_f32_16x16x32_bf16 v[184:187], v[216:219], v[64:67], v[184:187]
    v_mfma_f32_16x16x32_bf16 v[188:191], v[220:223], v[64:67], v[188:191]
    v_mfma_f32_16x16x32_bf16 v[192:195], v[224:227], v[64:67], v[192:195]
    v_mfma_f32_16x16x32_bf16 v[196:199], v[228:231], v[64:67], v[196:199]
    v_mfma_f32_16x16x32_bf16 v[200:203], v[232:235], v[64:67], v[200:203]
    v_mfma_f32_16x16x32_bf16 v[204:207], v[236:239], v[64:67], v[204:207]
    v_mfma_f32_16x16x32_bf16 v[208:211], v[240:243], v[64:67], v[208:211]
    v_mfma_f32_16x16x32_bf16 v[28:31], a[168:171], v[64:67], v[28:31]
    s_add_u32 s57, s57, 8192
    s_sub_u32 s56, s56, 1
    s_cmp_lg_u32 s56, 0
    s_cbranch_scc1 L_fb0_p2
    v_mov_b32 v6, 0
    v_mov_b32 v7, 0
    v_mov_b32 v8, 0
    v_mov_b32 v9, 0
    s_nop 7
    s_branch L_fbret0
L_fb1:
    s_waitcnt vmcnt(0)
    s_lshl_b32 s58, s71, 18
    s_add_u32 s58, s58, 1048672
    v_and_b32 v10, 15, v0
    v_lshrrev_b32 v11, 4, v0
    v_lshlrev_b32 v9, 8, v10
    v_lshl_add_u32 v9, v11, 4, v9
    v_lshlrev_b32 v11, 10, v11
    v_lshl_add_u32 v10, v10, 1, v11
    v_add_u32 v11, 4096, v10
    v_mov_b32 v6, 0xff800000
    v_mov_b32 v7, 0xff800000
    v_mov_b32 v8, 0xff800000
    s_mov_b32 s56, 32
    s_mov_b32 s57, s58
L_fb1_p1:
    s_add_u32 s59, s57, 0
    buffer_load_dwordx4 a[224:227], v9, s[24:27], s59 offen offset:0
    buffer_load_dwordx4 a[228:231], v9, s[24:27], s59 offen offset:64
    buffer_load_dwordx4 a[232:235], v9, s[24:27], s59 offen offset:128
    buffer_load_dwordx4 a[236:239], v9, s[24:27], s59 offen offset:192
    s_add_u32 s59, s57, 4096
    buffer_load_dwordx4 a[240:243], v9, s[24:27], s59 offen offset:0
    buffer_load_dwordx4 a[244:247], v9, s[24:27], s59 offen offset:64
    buffer_load_dwordx4 a[248:251], v9, s[24:27], s59 offen offset:128
    buffer_load_dwordx4 a[252:255], v9, s[24:27], s59 offen offset:192
    s_waitcnt vmcnt(0)
    v_mfma_f32_16x16x32_bf16 v[32:35], a[224:227], v[68:71], 0
    v_mfma_f32_16x16x32_bf16 v[32:35], a[228:231], v[72:75], v[32:35]
    v_mfma_f32_16x16x32_bf16 v[32:35], a[232:235], v[76:79], v[32:35]
    v_mfma_f32_16x16x32_bf16 v[32:35], a[236:239], v[80:83], v[32:35]
    v_mfma_f32_16x16x32_bf16 v[36:39], a[240:243], v[68:71], 0
    v_mfma_f32_16x16x32_bf16 v[36:39], a[244:247], v[72:75], v[36:39]
    v_mfma_f32_16x16x32_bf16 v[36:39], a[248:251], v[76:79], v[36:39]
    v_mfma_f32_16x16x32_bf16 v[36:39], a[252:255], v[80:83], v[36:39]
    v_mfma_f32_16x16x32_bf16 v[40:43], a[224:227], v[84:87], 0
    v_mfma_f32_16x16x32_bf16 v[40:43], a[228:231], v[88:91], v[40:43]
    v_mfma_f32_16x16x32_bf16 v[40:43], a[232:235], v[92:95], v[40:43]
    v_mfma_f32_16x16x32_bf16 v[40:43], a[236:239], v[96:99], v[40:43]
    v_mfma_f32_16x16x32_bf16 v[44:47], a[240:243], v[84:87], 0
    v_mfma_f32_16x16x32_bf16 v[44:47], a[244:247], v[88:91], v[44:47]
    v_mfma_f32_16x16x32_bf16 v[44:47], a[248:251], v[92:95], v[44:47]
    v_mfma_f32_16x16x32_bf16 v[44:47], a[252:255], v[96:99], v[44:47]
    v_mfma_f32_16x16x32_bf16 v[48:51], a[224:227], v[100:103], 0
    v_mfma_f32_16x16x32_bf16 v[48:51], a[228:231], v[104:107], v[48:51]
    v_mfma_f32_16x16x32_bf16 v[48:51], a[232:235], v[108:111], v[48:51]
    v_mfma_f32_16x16x32_bf16 v[48:51], a[236:239], v[112:115], v[48:51]
    v_mfma_f32_16x16x32_bf16 v[52:55], a[240:243], v[100:103], 0
    v_mfma_f32_16x16x32_bf16 v[52:55], a[244:247], v[104:107], v[52:55]
    v_mfma_f32_16x16x32_bf16 v[52:55], a[248:251], v[108:111], v[52:55]
    v_mfma_f32_16x16x32_bf16 v[52:55], a[252:255], v[112:115], v[52:55]
    s_nop 7
    v_max3_f32 v6, v6, v32, v33
    v_max3_f32 v6, v6, v34, v35
    v_max3_f32 v6, v6, v36, v37
    v_max3_f32 v6, v6, v38, v39
    v_max3_f32 v7, v7, v40, v41
    v_max3_f32 v7, v7, v42, v43
    v_max3_f32 v7, v7, v44, v45
    v_max3_f32 v7, v7, v46, v47
    v_max3_f32 v8, v8, v48, v49
    v_max3_f32 v8, v8, v50, v51
    v_max3_f32 v8, v8, v52, v53
    v_max3_f32 v8, v8, v54, v55
    s_add_u32 s57, s57, 8192
    s_sub_u32 s56, s56, 1
    s_cmp_lg_u32 s56, 0
    s_cbranch_scc1 L_fb1_p1
    v_mov_b32 v32, v6
    s_nop 1
    v_permlane32_swap_b32 v32, v6
    s_nop 0
    v_max_f32 v6, v32, v6
    v_mov_b32 v32, v6
    s_nop 1
    v_permlane16_swap_b32 v32, v6
    s_nop 0
    v_max_f32 v6, v32, v6
    v_mov_b32 v32, v7
    s_nop 1
    v_permlane32_swap_b32 v32, v7
    s_nop 0
    v_max_f32 v7, v32, v7
    v_mov_b32 v32, v7
    s_nop 1
    v_permlane16_swap_b32 v32, v7
    s_nop 0
    v_max_f32 v7, v32, v7
    v_mov_b32 v32, v8
    s_nop 1
    v_permlane32_swap_b32 v32, v8
    s_nop 0
    v_max_f32 v8, v32, v8
    v_mov_b32 v32, v8
    s_nop 1
    v_permlane16_swap_b32 v32, v8
    s_nop 0
    v_max_f32 v8, v32, v8
    v_mov_b32 v20, 0
    v_mov_b32 v21, 0
    v_mov_b32 v22, 0
    v_mov_b32 v23, 0
    v_mov_b32 v24, 0
    v_mov_b32 v25, 0
    v_mov_b32 v26, 0
    v_mov_b32 v27, 0
    v_mov_b32 v28, 0
    v_mov_b32 v29, 0
    v_mov_b32 v30, 0
    v_mov_b32 v31, 0
    v_mov_b32 v116, 0
    v_mov_b32 v117, 0
    v_mov_b32 v118, 0
    v_mov_b32 v119, 0
    v_mov_b32 v120, 0
    v_mov_b32 v121, 0
    v_mov_b32 v122, 0
    v_mov_b32 v123, 0
    v_mov_b32 v124, 0
    v_mov_b32 v125, 0
    v_mov_b32 v126, 0
    v_mov_b32 v127, 0
    v_mov_b32 v128, 0
    v_mov_b32 v129, 0
    v_mov_b32 v130, 0
    v_mov_b32 v131, 0
    v_mov_b32 v132, 0
    v_mov_b32 v133, 0
    v_mov_b32 v134, 0
    v_mov_b32 v135, 0
    v_mov_b32 v136, 0
    v_mov_b32 v137, 0
    v_mov_b32 v138, 0
    v_mov_b32 v139, 0
    v_mov_b32 v140, 0
    v_mov_b32 v141, 0
    v_mov_b32 v142, 0
    v_mov_b32 v143, 0
    v_mov_b32 v144, 0
    v_mov_b32 v145, 0
    v_mov_b32 v146, 0
    v_mov_b32 v147, 0
    v_mov_b32 v148, 0
    v_mov_b32 v149, 0
    v_mov_b32 v150, 0
    v_mov_b32 v151, 0
    v_mov_b32 v152, 0
    v_mov_b32 v153, 0
    v_mov_b32 v154, 0
    v_mov_b32 v155, 0
    v_mov_b32 v156, 0
    v_mov_b32 v157, 0
    v_mov_b32 v158, 0
    v_mov_b32 v159, 0
    v_mov_b32 v160, 0
    v_mov_b32 v161, 0
    v_mov_b32 v162, 0
    v_mov_b32 v163, 0
    v_mov_b32 v164, 0
    v_mov_b32 v165, 0
    v_mov_b32 v166, 0
    v_mov_b32 v167, 0
    v_mov_b32 v168, 0
    v_mov_b32 v169, 0
    v_mov_b32 v170, 0
    v_mov_b32 v171, 0
    v_mov_b32 v172, 0
    v_mov_b32 v173, 0
    v_mov_b32 v174, 0
    v_mov_b32 v175, 0
    v_mov_b32 v176, 0
    v_mov_b32 v177, 0
    v_mov_b32 v178, 0
    v_mov_b32 v179, 0
    v_mov_b32 v180, 0
    v_mov_b32 v181, 0
    v_mov_b32 v182, 0
    v_mov_b32 v183, 0
    v_mov_b32 v184, 0
    v_mov_b32 v185, 0
    v_mov_b32 v186, 0
    v_mov_b32 v187, 0
    v_mov_b32 v188, 0
    v_mov_b32 v189, 0
    v_mov_b32 v190, 0
    v_mov_b32 v191, 0
    v_mov_b32 v192, 0
    v_mov_b32 v193, 0
    v_mov_b32 v194, 0
    v_mov_b32 v195, 0
    v_mov_b32 v196, 0
    v_mov_b32 v197, 0
    v_mov_b32 v198, 0
    v_mov_b32 v199, 0
    v_mov_b32 v200, 0
    v_mov_b32 v201, 0
    v_mov_b32 v202, 0
    v_mov_b32 v203, 0
    v_mov_b32 v204, 0
    v_mov_b32 v205, 0
    v_mov_b32 v206, 0
    v_mov_b32 v207, 0
    v_mov_b32 v208, 0
    v_mov_b32 v209, 0
    v_mov_b32 v210, 0
    v_mov_b32 v211, 0
    s_mov_b32 s56, 32
    s_mov_b32 s57, s58
L_fb1_p2:
    s_add_u32 s59, s57, 0
    buffer_load_dwordx4 a[224:227], v9, s[24:27], s59 offen offset:0
    buffer_load_dwordx4 a[228:231], v9, s[24:27], s59 offen offset:64
    buffer_load_dwordx4 a[232:235], v9, s[24:27], s59 offen offset:128
    buffer_load_dwordx4 a[236:239], v9, s[24:27], s59 offen offset:192
    s_add_u32 s59, s57, 4096
    buffer_load_dwordx4 a[240:243], v9, s[24:27], s59 offen offset:0
    buffer_load_dwordx4 a[244:247], v9, s[24:27], s59 offen offset:64
    buffer_load_dwordx4 a[248:251], v9, s[24:27], s59 offen offset:128
    buffer_load_dwordx4 a[252:255], v9, s[24:27], s59 offen offset:192
    buffer_load_ushort v32, v10, s[28:31], s57 offen offset:0
    buffer_load_ushort v33, v10, s[28:31], s57 offen offset:256
    buffer_load_ushort v34, v10, s[28:31], s57 offen offset:512
    buffer_load_ushort v35, v10, s[28:31], s57 offen offset:768
    buffer_load_ushort v36, v11, s[28:31], s57 offen offset:0
    buffer_load_ushort v37, v11, s[28:31], s57 offen offset:256
    buffer_load_ushort v38, v11, s[28:31], s57 offen offset:512
    buffer_load_ushort v39, v11, s[28:31], s57 offen offset:768
    buffer_load_ushort v40, v10, s[28:31], s57 offen offset:32
    buffer_load_ushort v41, v10, s[28:31], s57 offen offset:288
    buffer_load_ushort v42, v10, s[28:31], s57 offen offset:544
    buffer_load_ushort v43, v10, s[28:31], s57 offen offset:800
    buffer_load_ushort v44, v11, s[28:31], s57 offen offset:32
    buffer_load_ushort v45, v11, s[28:31], s57 offen offset:288
    buffer_load_ushort v46, v11, s[28:31], s57 offen offset:544
    buffer_load_ushort v47, v11, s[28:31], s57 offen offset:800
    buffer_load_ushort v48, v10, s[28:31], s57 offen offset:64
    buffer_load_ushort v49, v10, s[28:31], s57 offen offset:320
    buffer_load_ushort v50, v10, s[28:31], s57 offen offset:576
    buffer_load_ushort v51, v10, s[28:31], s57 offen offset:832
    buffer_load_ushort v52, v11, s[28:31], s57 offen offset:64
    buffer_load_ushort v53, v11, s[28:31], s57 offen offset:320
    buffer_load_ushort v54, v11, s[28:31], s57 offen offset:576
    buffer_load_ushort v55, v11, s[28:31], s57 offen offset:832
    s_waitcnt vmcnt(0)
    v_lshl_or_b32 v212, v33, 16, v32
    v_lshl_or_b32 v213, v35, 16, v34
    v_lshl_or_b32 v214, v37, 16, v36
    v_lshl_or_b32 v215, v39, 16, v38
    v_lshl_or_b32 v216, v41, 16, v40
    v_lshl_or_b32 v217, v43, 16, v42
    v_lshl_or_b32 v218, v45, 16, v44
    v_lshl_or_b32 v219, v47, 16, v46
    v_lshl_or_b32 v220, v49, 16, v48
    v_lshl_or_b32 v221, v51, 16, v50
    v_lshl_or_b32 v222, v53, 16, v52
    v_lshl_or_b32 v223, v55, 16, v54
    buffer_load_ushort v32, v10, s[28:31], s57 offen offset:96
    buffer_load_ushort v33, v10, s[28:31], s57 offen offset:352
    buffer_load_ushort v34, v10, s[28:31], s57 offen offset:608
    buffer_load_ushort v35, v10, s[28:31], s57 offen offset:864
    buffer_load_ushort v36, v11, s[28:31], s57 offen offset:96
    buffer_load_ushort v37, v11, s[28:31], s57 offen offset:352
    buffer_load_ushort v38, v11, s[28:31], s57 offen offset:608
    buffer_load_ushort v39, v11, s[28:31], s57 offen offset:864
    buffer_load_ushort v40, v10, s[28:31], s57 offen offset:128
    buffer_load_ushort v41, v10, s[28:31], s57 offen offset:384
    buffer_load_ushort v42, v10, s[28:31], s57 offen offset:640
    buffer_load_ushort v43, v10, s[28:31], s57 offen offset:896
    buffer_load_ushort v44, v11, s[28:31], s57 offen offset:128
    buffer_load_ushort v45, v11, s[28:31], s57 offen offset:384
    buffer_load_ushort v46, v11, s[28:31], s57 offen offset:640
    buffer_load_ushort v47, v11, s[28:31], s57 offen offset:896
    buffer_load_ushort v48, v10, s[28:31], s57 offen offset:160
    buffer_load_ushort v49, v10, s[28:31], s57 offen offset:416
    buffer_load_ushort v50, v10, s[28:31], s57 offen offset:672
    buffer_load_ushort v51, v10, s[28:31], s57 offen offset:928
    buffer_load_ushort v52, v11, s[28:31], s57 offen offset:160
    buffer_load_ushort v53, v11, s[28:31], s57 offen offset:416
    buffer_load_ushort v54, v11, s[28:31], s57 offen offset:672
    buffer_load_ushort v55, v11, s[28:31], s57 offen offset:928
    s_waitcnt vmcnt(0)
    v_lshl_or_b32 v224, v33, 16, v32
    v_lshl_or_b32 v225, v35, 16, v34
    v_lshl_or_b32 v226, v37, 16, v36
    v_lshl_or_b32 v227, v39, 16, v38
    v_lshl_or_b32 v228, v41, 16, v40
    v_lshl_or_b32 v229, v43, 16, v42
    v_lshl_or_b32 v230, v45, 16, v44
    v_lshl_or_b32 v231, v47, 16, v46
    v_lshl_or_b32 v232, v49, 16, v48
    v_lshl_or_b32 v233, v51, 16, v50
    v_lshl_or_b32 v234, v53, 16, v52
    v_lshl_or_b32 v235, v55, 16, v54
    buffer_load_ushort v32, v10, s[28:31], s57 offen offset:192
    buffer_load_ushort v33, v10, s[28:31], s57 offen offset:448
    buffer_load_ushort v34, v10, s[28:31], s57 offen offset:704
    buffer_load_ushort v35, v10, s[28:31], s57 offen offset:960
    buffer_load_ushort v36, v11, s[28:31], s57 offen offset:192
    buffer_load_ushort v37, v11, s[28:31], s57 offen offset:448
    buffer_load_ushort v38, v11, s[28:31], s57 offen offset:704
    buffer_load_ushort v39, v11, s[28:31], s57 offen offset:960
    buffer_load_ushort v40, v10, s[28:31], s57 offen offset:224
    buffer_load_ushort v41, v10, s[28:31], s57 offen offset:480
    buffer_load_ushort v42, v10, s[28:31], s57 offen offset:736
    buffer_load_ushort v43, v10, s[28:31], s57 offen offset:992
    buffer_load_ushort v44, v11, s[28:31], s57 offen offset:224
    buffer_load_ushort v45, v11, s[28:31], s57 offen offset:480
    buffer_load_ushort v46, v11, s[28:31], s57 offen offset:736
    buffer_load_ushort v47, v11, s[28:31], s57 offen offset:992
    s_waitcnt vmcnt(0)
    v_lshl_or_b32 v236, v33, 16, v32
    v_lshl_or_b32 v237, v35, 16, v34
    v_lshl_or_b32 v238, v37, 16, v36
    v_lshl_or_b32 v239, v39, 16, v38
    v_lshl_or_b32 v240, v41, 16, v40
    v_lshl_or_b32 v241, v43, 16, v42
    v_lshl_or_b32 v242, v45, 16, v44
    v_lshl_or_b32 v243, v47, 16, v46
    s_waitcnt vmcnt(0)
    v_mfma_f32_16x16x32_bf16 v[32:35], a[224:227], v[68:71], 0
    v_mfma_f32_16x16x32_bf16 v[32:35], a[228:231], v[72:75], v[32:35]
    v_mfma_f32_16x16x32_bf16 v[32:35], a[232:235], v[76:79], v[32:35]
    v_mfma_f32_16x16x32_bf16 v[32:35], a[236:239], v[80:83], v[32:35]
    v_mfma_f32_16x16x32_bf16 v[36:39], a[240:243], v[68:71], 0
    v_mfma_f32_16x16x32_bf16 v[36:39], a[244:247], v[72:75], v[36:39]
    v_mfma_f32_16x16x32_bf16 v[36:39], a[248:251], v[76:79], v[36:39]
    v_mfma_f32_16x16x32_bf16 v[36:39], a[252:255], v[80:83], v[36:39]
    v_mfma_f32_16x16x32_bf16 v[40:43], a[224:227], v[84:87], 0
    v_mfma_f32_16x16x32_bf16 v[40:43], a[228:231], v[88:91], v[40:43]
    v_mfma_f32_16x16x32_bf16 v[40:43], a[232:235], v[92:95], v[40:43]
    v_mfma_f32_16x16x32_bf16 v[40:43], a[236:239], v[96:99], v[40:43]
    v_mfma_f32_16x16x32_bf16 v[44:47], a[240:243], v[84:87], 0
    v_mfma_f32_16x16x32_bf16 v[44:47], a[244:247], v[88:91], v[44:47]
    v_mfma_f32_16x16x32_bf16 v[44:47], a[248:251], v[92:95], v[44:47]
    v_mfma_f32_16x16x32_bf16 v[44:47], a[252:255], v[96:99], v[44:47]
    v_mfma_f32_16x16x32_bf16 v[48:51], a[224:227], v[100:103], 0
    v_mfma_f32_16x16x32_bf16 v[48:51], a[228:231], v[104:107], v[48:51]
    v_mfma_f32_16x16x32_bf16 v[48:51], a[232:235], v[108:111], v[48:51]
    v_mfma_f32_16x16x32_bf16 v[48:51], a[236:239], v[112:115], v[48:51]
    v_mfma_f32_16x16x32_bf16 v[52:55], a[240:243], v[100:103], 0
    v_mfma_f32_16x16x32_bf16 v[52:55], a[244:247], v[104:107], v[52:55]
    v_mfma_f32_16x16x32_bf16 v[52:55], a[248:251], v[108:111], v[52:55]
    v_mfma_f32_16x16x32_bf16 v[52:55], a[252:255], v[112:115], v[52:55]
    s_nop 7
    v_sub_f32 v32, v32, v6
    v_sub_f32 v33, v33, v6
    v_sub_f32 v34, v34, v6
    v_sub_f32 v35, v35, v6
    v_sub_f32 v36, v36, v6
    v_sub_f32 v37, v37, v6
    v_sub_f32 v38, v38, v6
    v_sub_f32 v39, v39, v6
    v_exp_f32 v32, v32
    v_exp_f32 v33, v33
    v_exp_f32 v34, v34
    v_exp_f32 v35, v35
    v_exp_f32 v36, v36
    v_exp_f32 v37, v37
    v_exp_f32 v38, v38
    v_exp_f32 v39, v39
    s_nop 0
    v_cvt_pk_bf16_f32 v56, v32, v33
    v_cvt_pk_bf16_f32 v57, v34, v35
    v_cvt_pk_bf16_f32 v58, v36, v37
    v_cvt_pk_bf16_f32 v59, v38, v39
    v_sub_f32 v40, v40, v7
    v_sub_f32 v41, v41, v7
    v_sub_f32 v42, v42, v7
    v_sub_f32 v43, v43, v7
    v_sub_f32 v44, v44, v7
    v_sub_f32 v45, v45, v7
    v_sub_f32 v46, v46, v7
    v_sub_f32 v47, v47, v7
    v_exp_f32 v40, v40
    v_exp_f32 v41, v41
    v_exp_f32 v42, v42
    v_exp_f32 v43, v43
    v_exp_f32 v44, v44
    v_exp_f32 v45, v45
    v_exp_f32 v46, v46
    v_exp_f32 v47, v47
    s_nop 0
    v_cvt_pk_bf16_f32 v60, v40, v41
    v_cvt_pk_bf16_f32 v61, v42, v43
    v_cvt_pk_bf16_f32 v62, v44, v45
    v_cvt_pk_bf16_f32 v63, v46, v47
    v_sub_f32 v48, v48, v8
    v_sub_f32 v49, v49, v8
    v_sub_f32 v50, v50, v8
    v_sub_f32 v51, v51, v8
    v_sub_f32 v52, v52, v8
    v_sub_f32 v53, v53, v8
    v_sub_f32 v54, v54, v8
    v_sub_f32 v55, v55, v8
    v_exp_f32 v48, v48
    v_exp_f32 v49, v49
    v_exp_f32 v50, v50
    v_exp_f32 v51, v51
    v_exp_f32 v52, v52
    v_exp_f32 v53, v53
    v_exp_f32 v54, v54
    v_exp_f32 v55, v55
    s_nop 0
    v_cvt_pk_bf16_f32 v64, v48, v49
    v_cvt_pk_bf16_f32 v65, v50, v51
    v_cvt_pk_bf16_f32 v66, v52, v53
    v_cvt_pk_bf16_f32 v67, v54, v55
    s_nop 1
    v_mfma_f32_16x16x32_bf16 v[116:119], v[212:215], v[56:59], v[116:119]
    v_mfma_f32_16x16x32_bf16 v[120:123], v[216:219], v[56:59], v[120:123]
    v_mfma_f32_16x16x32_bf16 v[124:127], v[220:223], v[56:59], v[124:127]
    v_mfma_f32_16x16x32_bf16 v[128:131], v[224:227], v[56:59], v[128:131]
    v_mfma_f32_16x16x32_bf16 v[132:135], v[228:231], v[56:59], v[132:135]
    v_mfma_f32_16x16x32_bf16 v[136:139], v[232:235], v[56:59], v[136:139]
    v_mfma_f32_16x16x32_bf16 v[140:143], v[236:239], v[56:59], v[140:143]
    v_mfma_f32_16x16x32_bf16 v[144:147], v[240:243], v[56:59], v[144:147]
    v_mfma_f32_16x16x32_bf16 v[20:23], a[168:171], v[56:59], v[20:23]
    v_mfma_f32_16x16x32_bf16 v[148:151], v[212:215], v[60:63], v[148:151]
    v_mfma_f32_16x16x32_bf16 v[152:155], v[216:219], v[60:63], v[152:155]
    v_mfma_f32_16x16x32_bf16 v[156:159], v[220:223], v[60:63], v[156:159]
    v_mfma_f32_16x16x32_bf16 v[160:163], v[224:227], v[60:63], v[160:163]
    v_mfma_f32_16x16x32_bf16 v[164:167], v[228:231], v[60:63], v[164:167]
    v_mfma_f32_16x16x32_bf16 v[168:171], v[232:235], v[60:63], v[168:171]
    v_mfma_f32_16x16x32_bf16 v[172:175], v[236:239], v[60:63], v[172:175]
    v_mfma_f32_16x16x32_bf16 v[176:179], v[240:243], v[60:63], v[176:179]
    v_mfma_f32_16x16x32_bf16 v[24:27], a[168:171], v[60:63], v[24:27]
    v_mfma_f32_16x16x32_bf16 v[180:183], v[212:215], v[64:67], v[180:183]
    v_mfma_f32_16x16x32_bf16 v[184:187], v[216:219], v[64:67], v[184:187]
    v_mfma_f32_16x16x32_bf16 v[188:191], v[220:223], v[64:67], v[188:191]
    v_mfma_f32_16x16x32_bf16 v[192:195], v[224:227], v[64:67], v[192:195]
    v_mfma_f32_16x16x32_bf16 v[196:199], v[228:231], v[64:67], v[196:199]
    v_mfma_f32_16x16x32_bf16 v[200:203], v[232:235], v[64:67], v[200:203]
    v_mfma_f32_16x16x32_bf16 v[204:207], v[236:239], v[64:67], v[204:207]
    v_mfma_f32_16x16x32_bf16 v[208:211], v[240:243], v[64:67], v[208:211]
    v_mfma_f32_16x16x32_bf16 v[28:31], a[168:171], v[64:67], v[28:31]
    s_add_u32 s57, s57, 8192
    s_sub_u32 s56, s56, 1
    s_cmp_lg_u32 s56, 0
    s_cbranch_scc1 L_fb1_p2
    v_mov_b32 v6, 0
    v_mov_b32 v7, 0
    v_mov_b32 v8, 0
    v_mov_b32 v9, 0
    s_nop 7
    s_branch L_fbret1
L_helper:
    v_add_u32 v2, 96, v5
    v_add_u32 v3, 64, v5
    v_add_u32 v4, 32, v5
    s_add_u32 m0, s79, 33792
    s_mov_b32 s57, s65
    buffer_load_dwordx4 v6, s[32:35], s57 offen offset:0 lds
    buffer_load_dwordx4 v7, s[32:35], s57 offen offset:1056 lds
    buffer_load_dwordx4 v8, s[32:35], s57 offen offset:2112 lds
    buffer_load_dwordx4 v9, s[32:35], s57 offen offset:3168 lds
    s_add_u32 s65, s65, 262144
    s_and_b32 s65, s65, 0x3fffff
    s_lshl_b32 s64, s71, 18
    s_lshr_b32 s66, s2, 3
    s_lshl_b32 s66, s66, 13
    s_mov_b32 s68, s66
    v_lshlrev_b32 v161, 7, v0
    s_add_u32 s63, s64, s66
    s_mov_b32 s60, 0
    s_mov_b32 s61, 118272
    s_mov_b64 exec, 1
    buffer_load_dword v162, off, s[24:27], s63 offset:96 nt
    buffer_load_dword v163, off, s[28:31], s63 offset:96 nt
    s_mov_b64 exec, -1
    v_lshrrev_b32 v11, 4, v0
    v_bfe_u32 v10, v0, 1, 3
    v_xor_b32 v10, v10, v11
    v_lshlrev_b32 v10, 4, v10
    v_and_b32 v11, 15, v0
    v_lshl_add_u32 v10, v11, 7, v10
    v_xor_b32 v11, 64, v10
    v_add_u32 v10, 118272, v10
    v_add_u32 v11, 118272, v11
    v_add_u32 v160, 50688, v1
    s_add_u32 s56, s55, 0
    s_and_b32 s56, s56, 3
    s_lshl_b32 s57, s54, 3
    s_add_u32 s57, s57, s56
    s_lshl_b32 s57, s57, 17
    s_lshl_b32 s58, s53, 1
    s_lshr_b32 s58, 2045222521, s58
    s_add_u32 s58, s58, s55
    s_and_b32 s58, s58, 3
    s_lshl_b32 s58, s58, 8
    s_add_u32 s75, s57, s58
    s_lshl_b32 s57, s53, 2
    s_add_u32 s57, s57, s54
    s_lshl_b32 s57, s57, 2
    s_add_u32 s57, s57, s56
    s_mul_i32 s80, s57, 36864
    s_add_u32 s56, s55, 1
    s_and_b32 s56, s56, 3
    s_lshl_b32 s57, s54, 3
    s_add_u32 s57, s57, s56
    s_lshl_b32 s57, s57, 17
    s_lshl_b32 s58, s53, 1
    s_lshr_b32 s58, 2045222521, s58
    s_add_u32 s58, s58, s55
    s_and_b32 s58, s58, 3
    s_lshl_b32 s58, s58, 8
    s_add_u32 s76, s57, s58
    s_lshl_b32 s57, s53, 2
    s_add_u32 s57, s57, s54
    s_lshl_b32 s57, s57, 2
    s_add_u32 s57, s57, s56
    s_mul_i32 s81, s57, 36864
    s_add_u32 s56, s55, 2
    s_and_b32 s56, s56, 3
    s_lshl_b32 s57, s54, 3
    s_add_u32 s57, s57, s56
    s_lshl_b32 s57, s57, 17
    s_lshl_b32 s58, s53, 1
    s_lshr_b32 s58, 2045222521, s58
    s_add_u32 s58, s58, s55
    s_and_b32 s58, s58, 3
    s_lshl_b32 s58, s58, 8
    s_add_u32 s77, s57, s58
    s_lshl_b32 s57, s53, 2
    s_add_u32 s57, s57, s54
    s_lshl_b32 s57, s57, 2
    s_add_u32 s57, s57, s56
    s_mul_i32 s82, s57, 36864
    s_add_u32 s56, s55, 3
    s_and_b32 s56, s56, 3
    s_lshl_b32 s57, s54, 3
    s_add_u32 s57, s57, s56
    s_lshl_b32 s57, s57, 17
    s_lshl_b32 s58, s53, 1
    s_lshr_b32 s58, 2045222521, s58
    s_add_u32 s58, s58, s55
    s_and_b32 s58, s58, 3
    s_lshl_b32 s58, s58, 8
    s_add_u32 s78, s57, s58
    s_lshl_b32 s57, s53, 2
    s_add_u32 s57, s57, s54
    s_lshl_b32 s57, s57, 2
    s_add_u32 s57, s57, s56
    s_mul_i32 s83, s57, 36864
    s_lshl_b32 s57, s53, 2
    s_add_u32 s57, s57, s54
    s_lshl_b32 s57, s57, 7
    s_add_u32 s57, s57, 37748736
    s_add_u32 s56, s55, 1
    s_and_b32 s56, s56, 3
    s_lshl_b32 s56, s56, 2
    s_add_u32 s87, s57, s56
    s_add_u32 s56, s55, 2
    s_and_b32 s56, s56, 3
    s_lshl_b32 s56, s56, 2
    s_add_u32 s88, s57, s56
    s_add_u32 s56, s55, 3
    s_and_b32 s56, s56, 3
    s_lshl_b32 s56, s56, 2
    s_add_u32 s89, s57, s56
    s_waitcnt vmcnt(6)
    s_barrier
    ds_read_b128 a[32:35], v10 offset:0
    ds_read_b128 a[36:39], v10 offset:2048
    ds_read_b128 a[40:43], v10 offset:4096
    ds_read_b128 a[44:47], v10 offset:6144
    ds_read_b128 a[48:51], v10 offset:8192
    ds_read_b128 a[52:55], v10 offset:10240
    ds_read_b128 a[56:59], v10 offset:12288
    ds_read_b128 a[60:63], v10 offset:14336
    ds_read_b128 a[64:67], v10 offset:16384
    ds_read_b64_tr_b16 a[0:1], v160 offset:8576
    ds_read_b64_tr_b16 a[2:3], v160 offset:9088
    ds_read_b64_tr_b16 a[4:5], v160 offset:8608
    ds_read_b64_tr_b16 a[6:7], v160 offset:9120
    ds_read_b64_tr_b16 a[8:9], v160 offset:8640
    ds_read_b64_tr_b16 a[10:11], v160 offset:9152
    ds_read_b64_tr_b16 a[12:13], v160 offset:8672
    ds_read_b64_tr_b16 a[14:15], v160 offset:9184
    s_waitcnt lgkmcnt(0)
    v_mfma_f32_16x16x32_bf16 v[16:19], a[0:3], a[32:35], 0
    s_add_u32 m0, s79, 50688
    ds_read_b128 a[68:71], v11 offset:0
    v_mfma_f32_16x16x32_bf16 v[32:35], a[0:3], a[36:39], 0
    s_mov_b32 s57, s65
    ds_read_b128 a[72:75], v11 offset:2048
    v_mfma_f32_16x16x32_bf16 v[48:51], a[0:3], a[40:43], 0
    buffer_load_dwordx4 v6, s[32:35], s57 offen offset:0 lds
    v_mfma_f32_16x16x32_bf16 v[64:67], a[0:3], a[44:47], 0
    ds_read_b128 a[76:79], v11 offset:4096
    v_mfma_f32_16x16x32_bf16 v[80:83], a[0:3], a[48:51], 0
    buffer_load_dwordx4 v7, s[32:35], s57 offen offset:1056 lds
    v_mfma_f32_16x16x32_bf16 v[96:99], a[0:3], a[52:55], 0
    ds_read_b128 a[80:83], v11 offset:6144
    v_mfma_f32_16x16x32_bf16 v[112:115], a[0:3], a[56:59], 0
    buffer_load_dwordx4 v8, s[32:35], s57 offen offset:2112 lds
    v_mfma_f32_16x16x32_bf16 v[128:131], a[0:3], a[60:63], 0
    ds_read_b128 a[84:87], v11 offset:8192
    v_mfma_f32_16x16x32_bf16 v[144:147], a[0:3], a[64:67], 0
    buffer_load_dwordx4 v9, s[32:35], s57 offen offset:3168 lds
    v_mfma_f32_16x16x32_bf16 v[20:23], a[4:7], a[32:35], 0
    ds_read_b128 a[88:91], v11 offset:10240
    v_mfma_f32_16x16x32_bf16 v[36:39], a[4:7], a[36:39], 0
    s_add_u32 s65, s65, 262144
    ds_read_b128 a[92:95], v11 offset:12288
    v_mfma_f32_16x16x32_bf16 v[52:55], a[4:7], a[40:43], 0
    s_and_b32 s65, s65, 0x3fffff
    ds_read_b128 a[96:99], v11 offset:14336
    v_mfma_f32_16x16x32_bf16 v[68:71], a[4:7], a[44:47], 0
    ds_read_b128 a[100:103], v11 offset:16384
    v_mfma_f32_16x16x32_bf16 v[84:87], a[4:7], a[48:51], 0
    ds_read_b64_tr_b16 a[16:17], v160 offset:25472
    v_mfma_f32_16x16x32_bf16 v[100:103], a[4:7], a[52:55], 0
    ds_read_b64_tr_b16 a[18:19], v160 offset:25984
    v_mfma_f32_16x16x32_bf16 v[116:119], a[4:7], a[56:59], 0
    ds_read_b64_tr_b16 a[20:21], v160 offset:25504
    v_mfma_f32_16x16x32_bf16 v[132:135], a[4:7], a[60:63], 0
    ds_read_b64_tr_b16 a[22:23], v160 offset:26016
    v_mfma_f32_16x16x32_bf16 v[148:151], a[4:7], a[64:67], 0
    ds_read_b64_tr_b16 a[24:25], v160 offset:25536
    v_mfma_f32_16x16x32_bf16 v[24:27], a[8:11], a[32:35], 0
    ds_read_b64_tr_b16 a[26:27], v160 offset:26048
    v_mfma_f32_16x16x32_bf16 v[40:43], a[8:11], a[36:39], 0
    ds_read_b64_tr_b16 a[28:29], v160 offset:25568
    v_mfma_f32_16x16x32_bf16 v[56:59], a[8:11], a[40:43], 0
    ds_read_b64_tr_b16 a[30:31], v160 offset:26080
    v_mfma_f32_16x16x32_bf16 v[72:75], a[8:11], a[44:47], 0
    v_mfma_f32_16x16x32_bf16 v[88:91], a[8:11], a[48:51], 0
    v_mfma_f32_16x16x32_bf16 v[104:107], a[8:11], a[52:55], 0
    v_mfma_f32_16x16x32_bf16 v[120:123], a[8:11], a[56:59], 0
    v_mfma_f32_16x16x32_bf16 v[136:139], a[8:11], a[60:63], 0
    v_mfma_f32_16x16x32_bf16 v[152:155], a[8:11], a[64:67], 0
    v_mfma_f32_16x16x32_bf16 v[28:31], a[12:15], a[32:35], 0
    v_mfma_f32_16x16x32_bf16 v[44:47], a[12:15], a[36:39], 0
    v_mfma_f32_16x16x32_bf16 v[60:63], a[12:15], a[40:43], 0
    v_mfma_f32_16x16x32_bf16 v[76:79], a[12:15], a[44:47], 0
    v_mfma_f32_16x16x32_bf16 v[92:95], a[12:15], a[48:51], 0
    v_mfma_f32_16x16x32_bf16 v[108:111], a[12:15], a[52:55], 0
    v_mfma_f32_16x16x32_bf16 v[124:127], a[12:15], a[56:59], 0
    v_mfma_f32_16x16x32_bf16 v[140:143], a[12:15], a[60:63], 0
    v_mfma_f32_16x16x32_bf16 v[156:159], a[12:15], a[64:67], 0
    s_waitcnt vmcnt(6) lgkmcnt(0)
    s_barrier
    v_mfma_f32_16x16x32_bf16 v[16:19], a[16:19], a[68:71], v[16:19]
    s_add_u32 m0, s79, 0
    ds_read_b128 a[32:35], v10 offset:18432
    v_mfma_f32_16x16x32_bf16 v[32:35], a[16:19], a[72:75], v[32:35]
    s_mov_b32 s57, s65
    ds_read_b128 a[36:39], v10 offset:20480
    v_mfma_f32_16x16x32_bf16 v[48:51], a[16:19], a[76:79], v[48:51]
    buffer_load_dwordx4 v6, s[32:35], s57 offen offset:0 lds
    v_mfma_f32_16x16x32_bf16 v[64:67], a[16:19], a[80:83], v[64:67]
    ds_read_b128 a[40:43], v10 offset:22528
    v_mfma_f32_16x16x32_bf16 v[80:83], a[16:19], a[84:87], v[80:83]
    buffer_load_dwordx4 v7, s[32:35], s57 offen offset:1056 lds
    v_mfma_f32_16x16x32_bf16 v[96:99], a[16:19], a[88:91], v[96:99]
    ds_read_b128 a[44:47], v10 offset:24576
    v_mfma_f32_16x16x32_bf16 v[112:115], a[16:19], a[92:95], v[112:115]
    buffer_load_dwordx4 v8, s[32:35], s57 offen offset:2112 lds
    v_mfma_f32_16x16x32_bf16 v[128:131], a[16:19], a[96:99], v[128:131]
    ds_read_b128 a[48:51], v10 offset:26624
    v_mfma_f32_16x16x32_bf16 v[144:147], a[16:19], a[100:103], v[144:147]
    buffer_load_dwordx4 v9, s[32:35], s57 offen offset:3168 lds
    v_mfma_f32_16x16x32_bf16 v[20:23], a[20:23], a[68:71], v[20:23]
    ds_read_b128 a[52:55], v10 offset:28672
    v_mfma_f32_16x16x32_bf16 v[36:39], a[20:23], a[72:75], v[36:39]
    s_add_u32 s65, s65, 262144
    ds_read_b128 a[56:59], v10 offset:30720
    v_mfma_f32_16x16x32_bf16 v[52:55], a[20:23], a[76:79], v[52:55]
    s_and_b32 s65, s65, 0x3fffff
    ds_read_b128 a[60:63], v10 offset:32768
    v_mfma_f32_16x16x32_bf16 v[68:71], a[20:23], a[80:83], v[68:71]
    s_add_u32 m0, s79, 16896
    ds_read_b128 a[64:67], v10 offset:34816
    v_mfma_f32_16x16x32_bf16 v[84:87], a[20:23], a[84:87], v[84:87]
    s_mov_b32 s57, s65
    ds_read_b64_tr_b16 a[0:1], v160 offset:42368
    v_mfma_f32_16x16x32_bf16 v[100:103], a[20:23], a[88:91], v[100:103]
    buffer_load_dwordx4 v6, s[32:35], s57 offen offset:0 lds
    v_mfma_f32_16x16x32_bf16 v[116:119], a[20:23], a[92:95], v[116:119]
    ds_read_b64_tr_b16 a[2:3], v160 offset:42880
    v_mfma_f32_16x16x32_bf16 v[132:135], a[20:23], a[96:99], v[132:135]
    buffer_load_dwordx4 v7, s[32:35], s57 offen offset:1056 lds
    v_mfma_f32_16x16x32_bf16 v[148:151], a[20:23], a[100:103], v[148:151]
    ds_read_b64_tr_b16 a[4:5], v160 offset:42400
    v_mfma_f32_16x16x32_bf16 v[24:27], a[24:27], a[68:71], v[24:27]
    buffer_load_dwordx4 v8, s[32:35], s57 offen offset:2112 lds
    v_mfma_f32_16x16x32_bf16 v[40:43], a[24:27], a[72:75], v[40:43]
    ds_read_b64_tr_b16 a[6:7], v160 offset:42912
    v_mfma_f32_16x16x32_bf16 v[56:59], a[24:27], a[76:79], v[56:59]
    buffer_load_dwordx4 v9, s[32:35], s57 offen offset:3168 lds
    v_mfma_f32_16x16x32_bf16 v[72:75], a[24:27], a[80:83], v[72:75]
    ds_read_b64_tr_b16 a[8:9], v160 offset:42432
    v_mfma_f32_16x16x32_bf16 v[88:91], a[24:27], a[84:87], v[88:91]
    s_add_u32 s65, s65, 262144
    ds_read_b64_tr_b16 a[10:11], v160 offset:42944
    v_mfma_f32_16x16x32_bf16 v[104:107], a[24:27], a[88:91], v[104:107]
    s_and_b32 s65, s65, 0x3fffff
    ds_read_b64_tr_b16 a[12:13], v160 offset:42464
    v_mfma_f32_16x16x32_bf16 v[120:123], a[24:27], a[92:95], v[120:123]
    ds_read_b64_tr_b16 a[14:15], v160 offset:42976
    v_mfma_f32_16x16x32_bf16 v[136:139], a[24:27], a[96:99], v[136:139]
    v_mfma_f32_16x16x32_bf16 v[152:155], a[24:27], a[100:103], v[152:155]
    v_mfma_f32_16x16x32_bf16 v[28:31], a[28:31], a[68:71], v[28:31]
    v_mfma_f32_16x16x32_bf16 v[44:47], a[28:31], a[72:75], v[44:47]
    v_mfma_f32_16x16x32_bf16 v[60:63], a[28:31], a[76:79], v[60:63]
    v_mfma_f32_16x16x32_bf16 v[76:79], a[28:31], a[80:83], v[76:79]
    v_mfma_f32_16x16x32_bf16 v[92:95], a[28:31], a[84:87], v[92:95]
    v_mfma_f32_16x16x32_bf16 v[108:111], a[28:31], a[88:91], v[108:111]
    v_mfma_f32_16x16x32_bf16 v[124:127], a[28:31], a[92:95], v[124:127]
    v_mfma_f32_16x16x32_bf16 v[140:143], a[28:31], a[96:99], v[140:143]
    v_mfma_f32_16x16x32_bf16 v[156:159], a[28:31], a[100:103], v[156:159]
    s_waitcnt vmcnt(8) lgkmcnt(0)
    s_barrier
    v_mfma_f32_16x16x32_bf16 v[16:19], a[0:3], a[32:35], v[16:19]
    s_add_u32 m0, s79, 33792
    ds_read_b128 a[68:71], v11 offset:18432
    v_mfma_f32_16x16x32_bf16 v[32:35], a[0:3], a[36:39], v[32:35]
    s_mov_b32 s57, s65
    ds_read_b128 a[72:75], v11 offset:20480
    v_mfma_f32_16x16x32_bf16 v[48:51], a[0:3], a[40:43], v[48:51]
    buffer_load_dwordx4 v6, s[32:35], s57 offen offset:0 lds
    v_mfma_f32_16x16x32_bf16 v[64:67], a[0:3], a[44:47], v[64:67]
    ds_read_b128 a[76:79], v11 offset:22528
    v_mfma_f32_16x16x32_bf16 v[80:83], a[0:3], a[48:51], v[80:83]
    buffer_load_dwordx4 v7, s[32:35], s57 offen offset:1056 lds
    v_mfma_f32_16x16x32_bf16 v[96:99], a[0:3], a[52:55], v[96:99]
    ds_read_b128 a[80:83], v11 offset:24576
    v_mfma_f32_16x16x32_bf16 v[112:115], a[0:3], a[56:59], v[112:115]
    buffer_load_dwordx4 v8, s[32:35], s57 offen offset:2112 lds
    v_mfma_f32_16x16x32_bf16 v[128:131], a[0:3], a[60:63], v[128:131]
    ds_read_b128 a[84:87], v11 offset:26624
    v_mfma_f32_16x16x32_bf16 v[144:147], a[0:3], a[64:67], v[144:147]
    buffer_load_dwordx4 v9, s[32:35], s57 offen offset:3168 lds
    v_mfma_f32_16x16x32_bf16 v[20:23], a[4:7], a[32:35], v[20:23]
    ds_read_b128 a[88:91], v11 offset:28672
    v_mfma_f32_16x16x32_bf16 v[36:39], a[4:7], a[36:39], v[36:39]
    s_add_u32 s65, s65, 262144
    ds_read_b128 a[92:95], v11 offset:30720
    v_mfma_f32_16x16x32_bf16 v[52:55], a[4:7], a[40:43], v[52:55]
    s_and_b32 s65, s65, 0x3fffff
    ds_read_b128 a[96:99], v11 offset:32768
    v_mfma_f32_16x16x32_bf16 v[68:71], a[4:7], a[44:47], v[68:71]
    ds_read_b128 a[100:103], v11 offset:34816
    v_mfma_f32_16x16x32_bf16 v[84:87], a[4:7], a[48:51], v[84:87]
    ds_read_b64_tr_b16 a[16:17], v160 offset:59264
    v_mfma_f32_16x16x32_bf16 v[100:103], a[4:7], a[52:55], v[100:103]
    ds_read_b64_tr_b16 a[18:19], v160 offset:59776
    v_mfma_f32_16x16x32_bf16 v[116:119], a[4:7], a[56:59], v[116:119]
    ds_read_b64_tr_b16 a[20:21], v160 offset:59296
    v_mfma_f32_16x16x32_bf16 v[132:135], a[4:7], a[60:63], v[132:135]
    ds_read_b64_tr_b16 a[22:23], v160 offset:59808
    v_mfma_f32_16x16x32_bf16 v[148:151], a[4:7], a[64:67], v[148:151]
    ds_read_b64_tr_b16 a[24:25], v160 offset:59328
    v_mfma_f32_16x16x32_bf16 v[24:27], a[8:11], a[32:35], v[24:27]
    ds_read_b64_tr_b16 a[26:27], v160 offset:59840
    v_mfma_f32_16x16x32_bf16 v[40:43], a[8:11], a[36:39], v[40:43]
    ds_read_b64_tr_b16 a[28:29], v160 offset:59360
    v_mfma_f32_16x16x32_bf16 v[56:59], a[8:11], a[40:43], v[56:59]
    ds_read_b64_tr_b16 a[30:31], v160 offset:59872
    v_mfma_f32_16x16x32_bf16 v[72:75], a[8:11], a[44:47], v[72:75]
    v_mfma_f32_16x16x32_bf16 v[88:91], a[8:11], a[48:51], v[88:91]
    v_mfma_f32_16x16x32_bf16 v[104:107], a[8:11], a[52:55], v[104:107]
    v_mfma_f32_16x16x32_bf16 v[120:123], a[8:11], a[56:59], v[120:123]
    v_mfma_f32_16x16x32_bf16 v[136:139], a[8:11], a[60:63], v[136:139]
    v_mfma_f32_16x16x32_bf16 v[152:155], a[8:11], a[64:67], v[152:155]
    v_mfma_f32_16x16x32_bf16 v[28:31], a[12:15], a[32:35], v[28:31]
    v_mfma_f32_16x16x32_bf16 v[44:47], a[12:15], a[36:39], v[44:47]
    v_mfma_f32_16x16x32_bf16 v[60:63], a[12:15], a[40:43], v[60:63]
    v_mfma_f32_16x16x32_bf16 v[76:79], a[12:15], a[44:47], v[76:79]
    v_mfma_f32_16x16x32_bf16 v[92:95], a[12:15], a[48:51], v[92:95]
    v_mfma_f32_16x16x32_bf16 v[108:111], a[12:15], a[52:55], v[108:111]
    v_mfma_f32_16x16x32_bf16 v[124:127], a[12:15], a[56:59], v[124:127]
    v_mfma_f32_16x16x32_bf16 v[140:143], a[12:15], a[60:63], v[140:143]
    v_mfma_f32_16x16x32_bf16 v[156:159], a[12:15], a[64:67], v[156:159]
    s_waitcnt vmcnt(8) lgkmcnt(0)
    s_barrier
    v_mfma_f32_16x16x32_bf16 v[16:19], a[16:19], a[68:71], v[16:19]
    s_add_u32 m0, s79, 50688
    ds_read_b128 a[32:35], v10 offset:0
    v_mfma_f32_16x16x32_bf16 v[32:35], a[16:19], a[72:75], v[32:35]
    s_mov_b32 s57, s65
    ds_read_b128 a[36:39], v10 offset:2048
    v_mfma_f32_16x16x32_bf16 v[48:51], a[16:19], a[76:79], v[48:51]
    buffer_load_dwordx4 v6, s[32:35], s57 offen offset:0 lds
    v_mfma_f32_16x16x32_bf16 v[64:67], a[16:19], a[80:83], v[64:67]
    ds_read_b128 a[40:43], v10 offset:4096
    v_mfma_f32_16x16x32_bf16 v[80:83], a[16:19], a[84:87], v[80:83]
    buffer_load_dwordx4 v7, s[32:35], s57 offen offset:1056 lds
    v_mfma_f32_16x16x32_bf16 v[96:99], a[16:19], a[88:91], v[96:99]
    ds_read_b128 a[44:47], v10 offset:6144
    v_mfma_f32_16x16x32_bf16 v[112:115], a[16:19], a[92:95], v[112:115]
    buffer_load_dwordx4 v8, s[32:35], s57 offen offset:2112 lds
    v_mfma_f32_16x16x32_bf16 v[128:131], a[16:19], a[96:99], v[128:131]
    ds_read_b128 a[48:51], v10 offset:8192
    v_mfma_f32_16x16x32_bf16 v[144:147], a[16:19], a[100:103], v[144:147]
    buffer_load_dwordx4 v9, s[32:35], s57 offen offset:3168 lds
    v_mfma_f32_16x16x32_bf16 v[20:23], a[20:23], a[68:71], v[20:23]
    ds_read_b128 a[52:55], v10 offset:10240
    v_mfma_f32_16x16x32_bf16 v[36:39], a[20:23], a[72:75], v[36:39]
    s_add_u32 s65, s65, 262144
    ds_read_b128 a[56:59], v10 offset:12288
    v_mfma_f32_16x16x32_bf16 v[52:55], a[20:23], a[76:79], v[52:55]
    s_and_b32 s65, s65, 0x3fffff
    ds_read_b128 a[60:63], v10 offset:14336
    v_mfma_f32_16x16x32_bf16 v[68:71], a[20:23], a[80:83], v[68:71]
    s_add_u32 m0, s60, 8448
    ds_read_b128 a[64:67], v10 offset:16384
    v_mfma_f32_16x16x32_bf16 v[84:87], a[20:23], a[84:87], v[84:87]
    s_add_u32 s57, s63, 0
    ds_read_b64_tr_b16 a[0:1], v160 offset:8576
    v_mfma_f32_16x16x32_bf16 v[100:103], a[20:23], a[88:91], v[100:103]
    buffer_load_dwordx4 v2, s[24:27], s57 offen offset:0 nt lds
    v_mfma_f32_16x16x32_bf16 v[116:119], a[20:23], a[92:95], v[116:119]
    ds_read_b64_tr_b16 a[2:3], v160 offset:9088
    v_mfma_f32_16x16x32_bf16 v[132:135], a[20:23], a[96:99], v[132:135]
    buffer_load_dwordx4 v3, s[24:27], s57 offen offset:1056 nt lds
    v_mfma_f32_16x16x32_bf16 v[148:151], a[20:23], a[100:103], v[148:151]
    ds_read_b64_tr_b16 a[4:5], v160 offset:8608
    v_mfma_f32_16x16x32_bf16 v[24:27], a[24:27], a[68:71], v[24:27]
    buffer_load_dwordx4 v4, s[24:27], s57 offen offset:2112 nt lds
    v_mfma_f32_16x16x32_bf16 v[40:43], a[24:27], a[72:75], v[40:43]
    ds_read_b64_tr_b16 a[6:7], v160 offset:9120
    v_mfma_f32_16x16x32_bf16 v[56:59], a[24:27], a[76:79], v[56:59]
    buffer_load_dwordx4 v5, s[24:27], s57 offen offset:3168 nt lds
    v_mfma_f32_16x16x32_bf16 v[72:75], a[24:27], a[80:83], v[72:75]
    ds_read_b64_tr_b16 a[8:9], v160 offset:8640
    v_mfma_f32_16x16x32_bf16 v[88:91], a[24:27], a[84:87], v[88:91]
    s_add_u32 m0, s60, 12672
    ds_read_b64_tr_b16 a[10:11], v160 offset:9152
    v_mfma_f32_16x16x32_bf16 v[104:107], a[24:27], a[88:91], v[104:107]
    s_add_u32 s57, s63, 4096
    ds_read_b64_tr_b16 a[12:13], v160 offset:8672
    v_mfma_f32_16x16x32_bf16 v[120:123], a[24:27], a[92:95], v[120:123]
    buffer_load_dwordx4 v2, s[24:27], s57 offen offset:0 nt lds
    v_mfma_f32_16x16x32_bf16 v[136:139], a[24:27], a[96:99], v[136:139]
    ds_read_b64_tr_b16 a[14:15], v160 offset:9184
    v_mfma_f32_16x16x32_bf16 v[152:155], a[24:27], a[100:103], v[152:155]
    buffer_load_dwordx4 v3, s[24:27], s57 offen offset:1056 nt lds
    v_mfma_f32_16x16x32_bf16 v[28:31], a[28:31], a[68:71], v[28:31]
    buffer_load_dwordx4 v4, s[24:27], s57 offen offset:2112 nt lds
    v_mfma_f32_16x16x32_bf16 v[44:47], a[28:31], a[72:75], v[44:47]
    buffer_load_dwordx4 v5, s[24:27], s57 offen offset:3168 nt lds
    v_mfma_f32_16x16x32_bf16 v[60:63], a[28:31], a[76:79], v[60:63]
    s_add_u32 s60, s60, 16896
    v_mfma_f32_16x16x32_bf16 v[76:79], a[28:31], a[80:83], v[76:79]
    s_cmp_ge_u32 s60, s61
    v_mfma_f32_16x16x32_bf16 v[92:95], a[28:31], a[84:87], v[92:95]
    s_cselect_b32 s60, 0, s60
    v_mfma_f32_16x16x32_bf16 v[108:111], a[28:31], a[88:91], v[108:111]
    v_mfma_f32_16x16x32_bf16 v[124:127], a[28:31], a[92:95], v[124:127]
    v_mfma_f32_16x16x32_bf16 v[140:143], a[28:31], a[96:99], v[140:143]
    v_mfma_f32_16x16x32_bf16 v[156:159], a[28:31], a[100:103], v[156:159]
    s_waitcnt vmcnt(16) lgkmcnt(0)
    s_barrier
    v_mfma_f32_16x16x32_bf16 v[16:19], a[0:3], a[32:35], v[16:19]
    s_add_u32 m0, s79, 0
    ds_read_b128 a[68:71], v11 offset:0
    v_mfma_f32_16x16x32_bf16 v[32:35], a[0:3], a[36:39], v[32:35]
    s_mov_b32 s57, s65
    ds_read_b128 a[72:75], v11 offset:2048
    v_mfma_f32_16x16x32_bf16 v[48:51], a[0:3], a[40:43], v[48:51]
    buffer_load_dwordx4 v6, s[32:35], s57 offen offset:0 lds
    v_mfma_f32_16x16x32_bf16 v[64:67], a[0:3], a[44:47], v[64:67]
    ds_read_b128 a[76:79], v11 offset:4096
    v_mfma_f32_16x16x32_bf16 v[80:83], a[0:3], a[48:51], v[80:83]
    buffer_load_dwordx4 v7, s[32:35], s57 offen offset:1056 lds
    v_mfma_f32_16x16x32_bf16 v[96:99], a[0:3], a[52:55], v[96:99]
    ds_read_b128 a[80:83], v11 offset:6144
    v_mfma_f32_16x16x32_bf16 v[112:115], a[0:3], a[56:59], v[112:115]
    buffer_load_dwordx4 v8, s[32:35], s57 offen offset:2112 lds
    v_mfma_f32_16x16x32_bf16 v[128:131], a[0:3], a[60:63], v[128:131]
    ds_read_b128 a[84:87], v11 offset:8192
    v_mfma_f32_16x16x32_bf16 v[144:147], a[0:3], a[64:67], v[144:147]
    buffer_load_dwordx4 v9, s[32:35], s57 offen offset:3168 lds
    v_mfma_f32_16x16x32_bf16 v[20:23], a[4:7], a[32:35], v[20:23]
    ds_read_b128 a[88:91], v11 offset:10240
    v_mfma_f32_16x16x32_bf16 v[36:39], a[4:7], a[36:39], v[36:39]
    s_add_u32 s65, s65, 262144
    ds_read_b128 a[92:95], v11 offset:12288
    v_mfma_f32_16x16x32_bf16 v[52:55], a[4:7], a[40:43], v[52:55]
    s_and_b32 s65, s65, 0x3fffff
    ds_read_b128 a[96:99], v11 offset:14336
    v_mfma_f32_16x16x32_bf16 v[68:71], a[4:7], a[44:47], v[68:71]
    s_add_u32 s58, s68, 49152
    ds_read_b128 a[100:103], v11 offset:16384
    v_mfma_f32_16x16x32_bf16 v[84:87], a[4:7], a[48:51], v[84:87]
    s_and_b32 s58, s58, 0x3ffff
    ds_read_b64_tr_b16 a[16:17], v160 offset:25472
    v_mfma_f32_16x16x32_bf16 v[100:103], a[4:7], a[52:55], v[100:103]
    s_add_u32 s58, s58, s64
    ds_read_b64_tr_b16 a[18:19], v160 offset:25984
    v_mfma_f32_16x16x32_bf16 v[116:119], a[4:7], a[56:59], v[116:119]
    buffer_load_dwordx4 a[104:107], v2, s[28:31], s58 offen offset:0 nt
    v_mfma_f32_16x16x32_bf16 v[132:135], a[4:7], a[60:63], v[132:135]
    ds_read_b64_tr_b16 a[20:21], v160 offset:25504
    v_mfma_f32_16x16x32_bf16 v[148:151], a[4:7], a[64:67], v[148:151]
    buffer_load_dwordx4 a[108:111], v3, s[28:31], s58 offen offset:1056 nt
    v_mfma_f32_16x16x32_bf16 v[24:27], a[8:11], a[32:35], v[24:27]
    ds_read_b64_tr_b16 a[22:23], v160 offset:26016
    v_mfma_f32_16x16x32_bf16 v[40:43], a[8:11], a[36:39], v[40:43]
    buffer_load_dwordx4 a[112:115], v4, s[28:31], s58 offen offset:2112 nt
    v_mfma_f32_16x16x32_bf16 v[56:59], a[8:11], a[40:43], v[56:59]
    ds_read_b64_tr_b16 a[24:25], v160 offset:25536
    v_mfma_f32_16x16x32_bf16 v[72:75], a[8:11], a[44:47], v[72:75]
    buffer_load_dwordx4 a[116:119], v5, s[28:31], s58 offen offset:3168 nt
    v_mfma_f32_16x16x32_bf16 v[88:91], a[8:11], a[48:51], v[88:91]
    ds_read_b64_tr_b16 a[26:27], v160 offset:26048
    v_mfma_f32_16x16x32_bf16 v[104:107], a[8:11], a[52:55], v[104:107]
    s_add_u32 s58, s58, 4096
    ds_read_b64_tr_b16 a[28:29], v160 offset:25568
    v_mfma_f32_16x16x32_bf16 v[120:123], a[8:11], a[56:59], v[120:123]
    buffer_load_dwordx4 a[120:123], v2, s[28:31], s58 offen offset:0 nt
    v_mfma_f32_16x16x32_bf16 v[136:139], a[8:11], a[60:63], v[136:139]
    ds_read_b64_tr_b16 a[30:31], v160 offset:26080
    v_mfma_f32_16x16x32_bf16 v[152:155], a[8:11], a[64:67], v[152:155]
    buffer_load_dwordx4 a[124:127], v3, s[28:31], s58 offen offset:1056 nt
    v_mfma_f32_16x16x32_bf16 v[28:31], a[12:15], a[32:35], v[28:31]
    buffer_load_dwordx4 a[128:131], v4, s[28:31], s58 offen offset:2112 nt
    v_mfma_f32_16x16x32_bf16 v[44:47], a[12:15], a[36:39], v[44:47]
    buffer_load_dwordx4 a[132:135], v5, s[28:31], s58 offen offset:3168 nt
    v_mfma_f32_16x16x32_bf16 v[60:63], a[12:15], a[40:43], v[60:63]
    v_mfma_f32_16x16x32_bf16 v[76:79], a[12:15], a[44:47], v[76:79]
    v_mfma_f32_16x16x32_bf16 v[92:95], a[12:15], a[48:51], v[92:95]
    v_mfma_f32_16x16x32_bf16 v[108:111], a[12:15], a[52:55], v[108:111]
    v_mfma_f32_16x16x32_bf16 v[124:127], a[12:15], a[56:59], v[124:127]
    v_mfma_f32_16x16x32_bf16 v[140:143], a[12:15], a[60:63], v[140:143]
    v_mfma_f32_16x16x32_bf16 v[156:159], a[12:15], a[64:67], v[156:159]
    s_waitcnt vmcnt(24) lgkmcnt(0)
    s_barrier
    v_mfma_f32_16x16x32_bf16 v[16:19], a[16:19], a[68:71], v[16:19]
    s_add_u32 m0, s79, 16896
    ds_read_b128 a[32:35], v10 offset:18432
    v_mfma_f32_16x16x32_bf16 v[32:35], a[16:19], a[72:75], v[32:35]
    s_mov_b32 s57, s65
    ds_read_b128 a[36:39], v10 offset:20480
    v_mfma_f32_16x16x32_bf16 v[48:51], a[16:19], a[76:79], v[48:51]
    buffer_load_dwordx4 v6, s[32:35], s57 offen offset:0 lds
    v_mfma_f32_16x16x32_bf16 v[64:67], a[16:19], a[80:83], v[64:67]
    ds_read_b128 a[40:43], v10 offset:22528
    v_mfma_f32_16x16x32_bf16 v[80:83], a[16:19], a[84:87], v[80:83]
    buffer_load_dwordx4 v7, s[32:35], s57 offen offset:1056 lds
    v_mfma_f32_16x16x32_bf16 v[96:99], a[16:19], a[88:91], v[96:99]
    ds_read_b128 a[44:47], v10 offset:24576
    v_mfma_f32_16x16x32_bf16 v[112:115], a[16:19], a[92:95], v[112:115]
    buffer_load_dwordx4 v8, s[32:35], s57 offen offset:2112 lds
    v_mfma_f32_16x16x32_bf16 v[128:131], a[16:19], a[96:99], v[128:131]
    ds_read_b128 a[48:51], v10 offset:26624
    v_mfma_f32_16x16x32_bf16 v[144:147], a[16:19], a[100:103], v[144:147]
    buffer_load_dwordx4 v9, s[32:35], s57 offen offset:3168 lds
    v_mfma_f32_16x16x32_bf16 v[20:23], a[20:23], a[68:71], v[20:23]
    ds_read_b128 a[52:55], v10 offset:28672
    v_mfma_f32_16x16x32_bf16 v[36:39], a[20:23], a[72:75], v[36:39]
    s_add_u32 s65, s65, 262144
    ds_read_b128 a[56:59], v10 offset:30720
    v_mfma_f32_16x16x32_bf16 v[52:55], a[20:23], a[76:79], v[52:55]
    s_and_b32 s65, s65, 0x3fffff
    ds_read_b128 a[60:63], v10 offset:32768
    v_mfma_f32_16x16x32_bf16 v[68:71], a[20:23], a[80:83], v[68:71]
    s_add_u32 m0, s60, 0
    ds_read_b128 a[64:67], v10 offset:34816
    v_mfma_f32_16x16x32_bf16 v[84:87], a[20:23], a[84:87], v[84:87]
    s_add_u32 s57, s63, 0
    ds_read_b64_tr_b16 a[0:1], v160 offset:42368
    v_mfma_f32_16x16x32_bf16 v[100:103], a[20:23], a[88:91], v[100:103]
    buffer_load_dwordx4 v2, s[28:31], s57 offen offset:0 nt lds
    v_mfma_f32_16x16x32_bf16 v[116:119], a[20:23], a[92:95], v[116:119]
    ds_read_b64_tr_b16 a[2:3], v160 offset:42880
    v_mfma_f32_16x16x32_bf16 v[132:135], a[20:23], a[96:99], v[132:135]
    buffer_load_dwordx4 v3, s[28:31], s57 offen offset:1056 nt lds
    v_mfma_f32_16x16x32_bf16 v[148:151], a[20:23], a[100:103], v[148:151]
    ds_read_b64_tr_b16 a[4:5], v160 offset:42400
    v_mfma_f32_16x16x32_bf16 v[24:27], a[24:27], a[68:71], v[24:27]
    buffer_load_dwordx4 v4, s[28:31], s57 offen offset:2112 nt lds
    v_mfma_f32_16x16x32_bf16 v[40:43], a[24:27], a[72:75], v[40:43]
    ds_read_b64_tr_b16 a[6:7], v160 offset:42912
    v_mfma_f32_16x16x32_bf16 v[56:59], a[24:27], a[76:79], v[56:59]
    buffer_load_dwordx4 v5, s[28:31], s57 offen offset:3168 nt lds
    v_mfma_f32_16x16x32_bf16 v[72:75], a[24:27], a[80:83], v[72:75]
    ds_read_b64_tr_b16 a[8:9], v160 offset:42432
    v_mfma_f32_16x16x32_bf16 v[88:91], a[24:27], a[84:87], v[88:91]
    s_add_u32 m0, s60, 4224
    ds_read_b64_tr_b16 a[10:11], v160 offset:42944
    v_mfma_f32_16x16x32_bf16 v[104:107], a[24:27], a[88:91], v[104:107]
    s_add_u32 s57, s63, 4096
    ds_read_b64_tr_b16 a[12:13], v160 offset:42464
    v_mfma_f32_16x16x32_bf16 v[120:123], a[24:27], a[92:95], v[120:123]
    buffer_load_dwordx4 v2, s[28:31], s57 offen offset:0 nt lds
    v_mfma_f32_16x16x32_bf16 v[136:139], a[24:27], a[96:99], v[136:139]
    ds_read_b64_tr_b16 a[14:15], v160 offset:42976
    v_mfma_f32_16x16x32_bf16 v[152:155], a[24:27], a[100:103], v[152:155]
    buffer_load_dwordx4 v3, s[28:31], s57 offen offset:1056 nt lds
    v_mfma_f32_16x16x32_bf16 v[28:31], a[28:31], a[68:71], v[28:31]
    buffer_load_dwordx4 v4, s[28:31], s57 offen offset:2112 nt lds
    v_mfma_f32_16x16x32_bf16 v[44:47], a[28:31], a[72:75], v[44:47]
    buffer_load_dwordx4 v5, s[28:31], s57 offen offset:3168 nt lds
    v_mfma_f32_16x16x32_bf16 v[60:63], a[28:31], a[76:79], v[60:63]
    v_mfma_f32_16x16x32_bf16 v[76:79], a[28:31], a[80:83], v[76:79]
    v_mfma_f32_16x16x32_bf16 v[92:95], a[28:31], a[84:87], v[92:95]
    v_mfma_f32_16x16x32_bf16 v[108:111], a[28:31], a[88:91], v[108:111]
    v_mfma_f32_16x16x32_bf16 v[124:127], a[28:31], a[92:95], v[124:127]
    v_mfma_f32_16x16x32_bf16 v[140:143], a[28:31], a[96:99], v[140:143]
    v_mfma_f32_16x16x32_bf16 v[156:159], a[28:31], a[100:103], v[156:159]
    s_waitcnt vmcnt(32) lgkmcnt(0)
    s_barrier
    v_mfma_f32_16x16x32_bf16 v[16:19], a[0:3], a[32:35], v[16:19]
    s_add_u32 m0, s79, 33792
    ds_read_b128 a[68:71], v11 offset:18432
    v_mfma_f32_16x16x32_bf16 v[32:35], a[0:3], a[36:39], v[32:35]
    s_mov_b32 s57, s65
    ds_read_b128 a[72:75], v11 offset:20480
    v_mfma_f32_16x16x32_bf16 v[48:51], a[0:3], a[40:43], v[48:51]
    buffer_load_dwordx4 v6, s[32:35], s57 offen offset:0 lds
    v_mfma_f32_16x16x32_bf16 v[64:67], a[0:3], a[44:47], v[64:67]
    ds_read_b128 a[76:79], v11 offset:22528
    v_mfma_f32_16x16x32_bf16 v[80:83], a[0:3], a[48:51], v[80:83]
    buffer_load_dwordx4 v7, s[32:35], s57 offen offset:1056 lds
    v_mfma_f32_16x16x32_bf16 v[96:99], a[0:3], a[52:55], v[96:99]
    ds_read_b128 a[80:83], v11 offset:24576
    v_mfma_f32_16x16x32_bf16 v[112:115], a[0:3], a[56:59], v[112:115]
    buffer_load_dwordx4 v8, s[32:35], s57 offen offset:2112 lds
    v_mfma_f32_16x16x32_bf16 v[128:131], a[0:3], a[60:63], v[128:131]
    ds_read_b128 a[84:87], v11 offset:26624
    v_mfma_f32_16x16x32_bf16 v[144:147], a[0:3], a[64:67], v[144:147]
    buffer_load_dwordx4 v9, s[32:35], s57 offen offset:3168 lds
    v_mfma_f32_16x16x32_bf16 v[20:23], a[4:7], a[32:35], v[20:23]
    ds_read_b128 a[88:91], v11 offset:28672
    v_mfma_f32_16x16x32_bf16 v[36:39], a[4:7], a[36:39], v[36:39]
    s_add_u32 s65, s65, 262144
    ds_read_b128 a[92:95], v11 offset:30720
    v_mfma_f32_16x16x32_bf16 v[52:55], a[4:7], a[40:43], v[52:55]
    s_and_b32 s65, s65, 0x3fffff
    ds_read_b128 a[96:99], v11 offset:32768
    v_mfma_f32_16x16x32_bf16 v[68:71], a[4:7], a[44:47], v[68:71]
    s_add_u32 s58, s68, 57344
    ds_read_b128 a[100:103], v11 offset:34816
    v_mfma_f32_16x16x32_bf16 v[84:87], a[4:7], a[48:51], v[84:87]
    s_and_b32 s58, s58, 0x3ffff
    ds_read_b64_tr_b16 a[16:17], v160 offset:59264
    v_mfma_f32_16x16x32_bf16 v[100:103], a[4:7], a[52:55], v[100:103]
    s_add_u32 s58, s58, s64
    ds_read_b64_tr_b16 a[18:19], v160 offset:59776
    v_mfma_f32_16x16x32_bf16 v[116:119], a[4:7], a[56:59], v[116:119]
    buffer_load_dwordx4 a[136:139], v2, s[24:27], s58 offen offset:0 nt
    v_mfma_f32_16x16x32_bf16 v[132:135], a[4:7], a[60:63], v[132:135]
    ds_read_b64_tr_b16 a[20:21], v160 offset:59296
    v_mfma_f32_16x16x32_bf16 v[148:151], a[4:7], a[64:67], v[148:151]
    buffer_load_dwordx4 a[140:143], v3, s[24:27], s58 offen offset:1056 nt
    v_mfma_f32_16x16x32_bf16 v[24:27], a[8:11], a[32:35], v[24:27]
    ds_read_b64_tr_b16 a[22:23], v160 offset:59808
    v_mfma_f32_16x16x32_bf16 v[40:43], a[8:11], a[36:39], v[40:43]
    buffer_load_dwordx4 a[144:147], v4, s[24:27], s58 offen offset:2112 nt
    v_mfma_f32_16x16x32_bf16 v[56:59], a[8:11], a[40:43], v[56:59]
    ds_read_b64_tr_b16 a[24:25], v160 offset:59328
    v_mfma_f32_16x16x32_bf16 v[72:75], a[8:11], a[44:47], v[72:75]
    buffer_load_dwordx4 a[148:151], v5, s[24:27], s58 offen offset:3168 nt
    v_mfma_f32_16x16x32_bf16 v[88:91], a[8:11], a[48:51], v[88:91]
    ds_read_b64_tr_b16 a[26:27], v160 offset:59840
    v_mfma_f32_16x16x32_bf16 v[104:107], a[8:11], a[52:55], v[104:107]
    s_add_u32 s58, s58, 4096
    ds_read_b64_tr_b16 a[28:29], v160 offset:59360
    v_mfma_f32_16x16x32_bf16 v[120:123], a[8:11], a[56:59], v[120:123]
    buffer_load_dwordx4 a[152:155], v2, s[24:27], s58 offen offset:0 nt
    v_mfma_f32_16x16x32_bf16 v[136:139], a[8:11], a[60:63], v[136:139]
    ds_read_b64_tr_b16 a[30:31], v160 offset:59872
    v_mfma_f32_16x16x32_bf16 v[152:155], a[8:11], a[64:67], v[152:155]
    buffer_load_dwordx4 a[156:159], v3, s[24:27], s58 offen offset:1056 nt
    v_mfma_f32_16x16x32_bf16 v[28:31], a[12:15], a[32:35], v[28:31]
    buffer_load_dwordx4 a[160:163], v4, s[24:27], s58 offen offset:2112 nt
    v_mfma_f32_16x16x32_bf16 v[44:47], a[12:15], a[36:39], v[44:47]
    buffer_load_dwordx4 a[164:167], v5, s[24:27], s58 offen offset:3168 nt
    v_mfma_f32_16x16x32_bf16 v[60:63], a[12:15], a[40:43], v[60:63]
    v_mfma_f32_16x16x32_bf16 v[76:79], a[12:15], a[44:47], v[76:79]
    v_mfma_f32_16x16x32_bf16 v[92:95], a[12:15], a[48:51], v[92:95]
    v_mfma_f32_16x16x32_bf16 v[108:111], a[12:15], a[52:55], v[108:111]
    v_mfma_f32_16x16x32_bf16 v[124:127], a[12:15], a[56:59], v[124:127]
    v_mfma_f32_16x16x32_bf16 v[140:143], a[12:15], a[60:63], v[140:143]
    v_mfma_f32_16x16x32_bf16 v[156:159], a[12:15], a[64:67], v[156:159]
    s_waitcnt vmcnt(32) lgkmcnt(0)
    s_barrier
    v_mfma_f32_16x16x32_bf16 v[16:19], a[16:19], a[68:71], v[16:19]
    s_add_u32 m0, s79, 50688
    ds_read_b128 a[32:35], v10 offset:0
    v_mfma_f32_16x16x32_bf16 v[32:35], a[16:19], a[72:75], v[32:35]
    s_mov_b32 s57, s65
    ds_read_b128 a[36:39], v10 offset:2048
    v_mfma_f32_16x16x32_bf16 v[48:51], a[16:19], a[76:79], v[48:51]
    buffer_load_dwordx4 v6, s[32:35], s57 offen offset:0 lds
    v_mfma_f32_16x16x32_bf16 v[64:67], a[16:19], a[80:83], v[64:67]
    ds_read_b128 a[40:43], v10 offset:4096
    v_mfma_f32_16x16x32_bf16 v[80:83], a[16:19], a[84:87], v[80:83]
    buffer_load_dwordx4 v7, s[32:35], s57 offen offset:1056 lds
    v_mfma_f32_16x16x32_bf16 v[96:99], a[16:19], a[88:91], v[96:99]
    ds_read_b128 a[44:47], v10 offset:6144
    v_mfma_f32_16x16x32_bf16 v[112:115], a[16:19], a[92:95], v[112:115]
    buffer_load_dwordx4 v8, s[32:35], s57 offen offset:2112 lds
    v_mfma_f32_16x16x32_bf16 v[128:131], a[16:19], a[96:99], v[128:131]
    ds_read_b128 a[48:51], v10 offset:8192
    v_mfma_f32_16x16x32_bf16 v[144:147], a[16:19], a[100:103], v[144:147]
    buffer_load_dwordx4 v9, s[32:35], s57 offen offset:3168 lds
    v_mfma_f32_16x16x32_bf16 v[20:23], a[20:23], a[68:71], v[20:23]
    ds_read_b128 a[52:55], v10 offset:10240
    v_mfma_f32_16x16x32_bf16 v[36:39], a[20:23], a[72:75], v[36:39]
    s_add_u32 s65, s65, 262144
    ds_read_b128 a[56:59], v10 offset:12288
    v_mfma_f32_16x16x32_bf16 v[52:55], a[20:23], a[76:79], v[52:55]
    s_and_b32 s65, s65, 0x3fffff
    ds_read_b128 a[60:63], v10 offset:14336
    v_mfma_f32_16x16x32_bf16 v[68:71], a[20:23], a[80:83], v[68:71]
    s_add_u32 s66, s66, 8192
    ds_read_b128 a[64:67], v10 offset:16384
    v_mfma_f32_16x16x32_bf16 v[84:87], a[20:23], a[84:87], v[84:87]
    s_and_b32 s66, s66, 0x3ffff
    ds_read_b64_tr_b16 a[0:1], v160 offset:8576
    v_mfma_f32_16x16x32_bf16 v[100:103], a[20:23], a[88:91], v[100:103]
    s_add_u32 s63, s64, s66
    ds_read_b64_tr_b16 a[2:3], v160 offset:9088
    v_mfma_f32_16x16x32_bf16 v[116:119], a[20:23], a[92:95], v[116:119]
    s_add_u32 m0, s60, 8448
    ds_read_b64_tr_b16 a[4:5], v160 offset:8608
    v_mfma_f32_16x16x32_bf16 v[132:135], a[20:23], a[96:99], v[132:135]
    s_add_u32 s57, s63, 0
    ds_read_b64_tr_b16 a[6:7], v160 offset:9120
    v_mfma_f32_16x16x32_bf16 v[148:151], a[20:23], a[100:103], v[148:151]
    buffer_load_dwordx4 v2, s[24:27], s57 offen offset:0 nt lds
    v_mfma_f32_16x16x32_bf16 v[24:27], a[24:27], a[68:71], v[24:27]
    ds_read_b64_tr_b16 a[8:9], v160 offset:8640
    v_mfma_f32_16x16x32_bf16 v[40:43], a[24:27], a[72:75], v[40:43]
    buffer_load_dwordx4 v3, s[24:27], s57 offen offset:1056 nt lds
    v_mfma_f32_16x16x32_bf16 v[56:59], a[24:27], a[76:79], v[56:59]
    ds_read_b64_tr_b16 a[10:11], v160 offset:9152
    v_mfma_f32_16x16x32_bf16 v[72:75], a[24:27], a[80:83], v[72:75]
    buffer_load_dwordx4 v4, s[24:27], s57 offen offset:2112 nt lds
    v_mfma_f32_16x16x32_bf16 v[88:91], a[24:27], a[84:87], v[88:91]
    ds_read_b64_tr_b16 a[12:13], v160 offset:8672
    v_mfma_f32_16x16x32_bf16 v[104:107], a[24:27], a[88:91], v[104:107]
    buffer_load_dwordx4 v5, s[24:27], s57 offen offset:3168 nt lds
    v_mfma_f32_16x16x32_bf16 v[120:123], a[24:27], a[92:95], v[120:123]
    ds_read_b64_tr_b16 a[14:15], v160 offset:9184
    v_mfma_f32_16x16x32_bf16 v[136:139], a[24:27], a[96:99], v[136:139]
    s_add_u32 m0, s60, 12672
    v_mfma_f32_16x16x32_bf16 v[152:155], a[24:27], a[100:103], v[152:155]
    s_add_u32 s57, s63, 4096
    buffer_load_dwordx4 v2, s[24:27], s57 offen offset:0 nt lds
    v_mfma_f32_16x16x32_bf16 v[28:31], a[28:31], a[68:71], v[28:31]
    buffer_load_dwordx4 v3, s[24:27], s57 offen offset:1056 nt lds
    v_mfma_f32_16x16x32_bf16 v[44:47], a[28:31], a[72:75], v[44:47]
    buffer_load_dwordx4 v4, s[24:27], s57 offen offset:2112 nt lds
    v_mfma_f32_16x16x32_bf16 v[60:63], a[28:31], a[76:79], v[60:63]
    buffer_load_dwordx4 v5, s[24:27], s57 offen offset:3168 nt lds
    v_mfma_f32_16x16x32_bf16 v[76:79], a[28:31], a[80:83], v[76:79]
    s_add_u32 s60, s60, 16896
    v_mfma_f32_16x16x32_bf16 v[92:95], a[28:31], a[84:87], v[92:95]
    s_cmp_ge_u32 s60, s61
    v_mfma_f32_16x16x32_bf16 v[108:111], a[28:31], a[88:91], v[108:111]
    s_cselect_b32 s60, 0, s60
    v_mfma_f32_16x16x32_bf16 v[124:127], a[28:31], a[92:95], v[124:127]
    v_mfma_f32_16x16x32_bf16 v[140:143], a[28:31], a[96:99], v[140:143]
    v_mfma_f32_16x16x32_bf16 v[156:159], a[28:31], a[100:103], v[156:159]
    s_waitcnt vmcnt(32) lgkmcnt(0)
    s_barrier
    v_mfma_f32_16x16x32_bf16 v[16:19], a[0:3], a[32:35], v[16:19]
    s_add_u32 m0, s79, 0
    ds_read_b128 a[68:71], v11 offset:0
    v_mfma_f32_16x16x32_bf16 v[32:35], a[0:3], a[36:39], v[32:35]
    s_mov_b32 s57, s65
    ds_read_b128 a[72:75], v11 offset:2048
    v_mfma_f32_16x16x32_bf16 v[48:51], a[0:3], a[40:43], v[48:51]
    buffer_load_dwordx4 v6, s[32:35], s57 offen offset:0 lds
    v_mfma_f32_16x16x32_bf16 v[64:67], a[0:3], a[44:47], v[64:67]
    ds_read_b128 a[76:79], v11 offset:4096
    v_mfma_f32_16x16x32_bf16 v[80:83], a[0:3], a[48:51], v[80:83]
    buffer_load_dwordx4 v7, s[32:35], s57 offen offset:1056 lds
    v_mfma_f32_16x16x32_bf16 v[96:99], a[0:3], a[52:55], v[96:99]
    ds_read_b128 a[80:83], v11 offset:6144
    v_mfma_f32_16x16x32_bf16 v[112:115], a[0:3], a[56:59], v[112:115]
    buffer_load_dwordx4 v8, s[32:35], s57 offen offset:2112 lds
    v_mfma_f32_16x16x32_bf16 v[128:131], a[0:3], a[60:63], v[128:131]
    ds_read_b128 a[84:87], v11 offset:8192
    v_mfma_f32_16x16x32_bf16 v[144:147], a[0:3], a[64:67], v[144:147]
    buffer_load_dwordx4 v9, s[32:35], s57 offen offset:3168 lds
    v_mfma_f32_16x16x32_bf16 v[20:23], a[4:7], a[32:35], v[20:23]
    ds_read_b128 a[88:91], v11 offset:10240
    v_mfma_f32_16x16x32_bf16 v[36:39], a[4:7], a[36:39], v[36:39]
    s_add_u32 s65, s65, 262144
    ds_read_b128 a[92:95], v11 offset:12288
    v_mfma_f32_16x16x32_bf16 v[52:55], a[4:7], a[40:43], v[52:55]
    s_and_b32 s65, s65, 0x3fffff
    ds_read_b128 a[96:99], v11 offset:14336
    v_mfma_f32_16x16x32_bf16 v[68:71], a[4:7], a[44:47], v[68:71]
    s_add_u32 s58, s68, 57344
    ds_read_b128 a[100:103], v11 offset:16384
    v_mfma_f32_16x16x32_bf16 v[84:87], a[4:7], a[48:51], v[84:87]
    s_and_b32 s58, s58, 0x3ffff
    ds_read_b64_tr_b16 a[16:17], v160 offset:25472
    v_mfma_f32_16x16x32_bf16 v[100:103], a[4:7], a[52:55], v[100:103]
    s_add_u32 s58, s58, s64
    ds_read_b64_tr_b16 a[18:19], v160 offset:25984
    v_mfma_f32_16x16x32_bf16 v[116:119], a[4:7], a[56:59], v[116:119]
    buffer_load_dwordx4 a[168:171], v2, s[28:31], s58 offen offset:0 nt
    v_mfma_f32_16x16x32_bf16 v[132:135], a[4:7], a[60:63], v[132:135]
    ds_read_b64_tr_b16 a[20:21], v160 offset:25504
    v_mfma_f32_16x16x32_bf16 v[148:151], a[4:7], a[64:67], v[148:151]
    buffer_load_dwordx4 a[172:175], v3, s[28:31], s58 offen offset:1056 nt
    v_mfma_f32_16x16x32_bf16 v[24:27], a[8:11], a[32:35], v[24:27]
    ds_read_b64_tr_b16 a[22:23], v160 offset:26016
    v_mfma_f32_16x16x32_bf16 v[40:43], a[8:11], a[36:39], v[40:43]
    buffer_load_dwordx4 a[176:179], v4, s[28:31], s58 offen offset:2112 nt
    v_mfma_f32_16x16x32_bf16 v[56:59], a[8:11], a[40:43], v[56:59]
    ds_read_b64_tr_b16 a[24:25], v160 offset:25536
    v_mfma_f32_16x16x32_bf16 v[72:75], a[8:11], a[44:47], v[72:75]
    buffer_load_dwordx4 a[180:183], v5, s[28:31], s58 offen offset:3168 nt
    v_mfma_f32_16x16x32_bf16 v[88:91], a[8:11], a[48:51], v[88:91]
    ds_read_b64_tr_b16 a[26:27], v160 offset:26048
    v_mfma_f32_16x16x32_bf16 v[104:107], a[8:11], a[52:55], v[104:107]
    s_add_u32 s58, s58, 4096
    ds_read_b64_tr_b16 a[28:29], v160 offset:25568
    v_mfma_f32_16x16x32_bf16 v[120:123], a[8:11], a[56:59], v[120:123]
    buffer_load_dwordx4 a[184:187], v2, s[28:31], s58 offen offset:0 nt
    v_mfma_f32_16x16x32_bf16 v[136:139], a[8:11], a[60:63], v[136:139]
    ds_read_b64_tr_b16 a[30:31], v160 offset:26080
    v_mfma_f32_16x16x32_bf16 v[152:155], a[8:11], a[64:67], v[152:155]
    buffer_load_dwordx4 a[188:191], v3, s[28:31], s58 offen offset:1056 nt
    v_mfma_f32_16x16x32_bf16 v[28:31], a[12:15], a[32:35], v[28:31]
    buffer_load_dwordx4 a[192:195], v4, s[28:31], s58 offen offset:2112 nt
    v_mfma_f32_16x16x32_bf16 v[44:47], a[12:15], a[36:39], v[44:47]
    buffer_load_dwordx4 a[196:199], v5, s[28:31], s58 offen offset:3168 nt
    v_mfma_f32_16x16x32_bf16 v[60:63], a[12:15], a[40:43], v[60:63]
    v_mfma_f32_16x16x32_bf16 v[76:79], a[12:15], a[44:47], v[76:79]
    v_mfma_f32_16x16x32_bf16 v[92:95], a[12:15], a[48:51], v[92:95]
    v_mfma_f32_16x16x32_bf16 v[108:111], a[12:15], a[52:55], v[108:111]
    v_mfma_f32_16x16x32_bf16 v[124:127], a[12:15], a[56:59], v[124:127]
    v_mfma_f32_16x16x32_bf16 v[140:143], a[12:15], a[60:63], v[140:143]
    v_mfma_f32_16x16x32_bf16 v[156:159], a[12:15], a[64:67], v[156:159]
    s_waitcnt vmcnt(32) lgkmcnt(0)
    s_barrier
    v_mfma_f32_16x16x32_bf16 v[16:19], a[16:19], a[68:71], v[16:19]
    s_add_u32 m0, s79, 16896
    ds_read_b128 a[32:35], v10 offset:18432
    v_mfma_f32_16x16x32_bf16 v[32:35], a[16:19], a[72:75], v[32:35]
    s_mov_b32 s57, s65
    ds_read_b128 a[36:39], v10 offset:20480
    v_mfma_f32_16x16x32_bf16 v[48:51], a[16:19], a[76:79], v[48:51]
    buffer_load_dwordx4 v6, s[32:35], s57 offen offset:0 lds
    v_mfma_f32_16x16x32_bf16 v[64:67], a[16:19], a[80:83], v[64:67]
    ds_read_b128 a[40:43], v10 offset:22528
    v_mfma_f32_16x16x32_bf16 v[80:83], a[16:19], a[84:87], v[80:83]
    buffer_load_dwordx4 v7, s[32:35], s57 offen offset:1056 lds
    v_mfma_f32_16x16x32_bf16 v[96:99], a[16:19], a[88:91], v[96:99]
    ds_read_b128 a[44:47], v10 offset:24576
    v_mfma_f32_16x16x32_bf16 v[112:115], a[16:19], a[92:95], v[112:115]
    buffer_load_dwordx4 v8, s[32:35], s57 offen offset:2112 lds
    v_mfma_f32_16x16x32_bf16 v[128:131], a[16:19], a[96:99], v[128:131]
    ds_read_b128 a[48:51], v10 offset:26624
    v_mfma_f32_16x16x32_bf16 v[144:147], a[16:19], a[100:103], v[144:147]
    buffer_load_dwordx4 v9, s[32:35], s57 offen offset:3168 lds
    v_mfma_f32_16x16x32_bf16 v[20:23], a[20:23], a[68:71], v[20:23]
    ds_read_b128 a[52:55], v10 offset:28672
    v_mfma_f32_16x16x32_bf16 v[36:39], a[20:23], a[72:75], v[36:39]
    s_add_u32 s65, s65, 262144
    ds_read_b128 a[56:59], v10 offset:30720
    v_mfma_f32_16x16x32_bf16 v[52:55], a[20:23], a[76:79], v[52:55]
    s_and_b32 s65, s65, 0x3fffff
    ds_read_b128 a[60:63], v10 offset:32768
    v_mfma_f32_16x16x32_bf16 v[68:71], a[20:23], a[80:83], v[68:71]
    s_add_u32 m0, s60, 0
    ds_read_b128 a[64:67], v10 offset:34816
    v_mfma_f32_16x16x32_bf16 v[84:87], a[20:23], a[84:87], v[84:87]
    s_add_u32 s57, s63, 0
    ds_read_b64_tr_b16 a[0:1], v160 offset:42368
    v_mfma_f32_16x16x32_bf16 v[100:103], a[20:23], a[88:91], v[100:103]
    buffer_load_dwordx4 v2, s[28:31], s57 offen offset:0 nt lds
    v_mfma_f32_16x16x32_bf16 v[116:119], a[20:23], a[92:95], v[116:119]
    ds_read_b64_tr_b16 a[2:3], v160 offset:42880
    v_mfma_f32_16x16x32_bf16 v[132:135], a[20:23], a[96:99], v[132:135]
    buffer_load_dwordx4 v3, s[28:31], s57 offen offset:1056 nt lds
    v_mfma_f32_16x16x32_bf16 v[148:151], a[20:23], a[100:103], v[148:151]
    ds_read_b64_tr_b16 a[4:5], v160 offset:42400
    v_mfma_f32_16x16x32_bf16 v[24:27], a[24:27], a[68:71], v[24:27]
    buffer_load_dwordx4 v4, s[28:31], s57 offen offset:2112 nt lds
    v_mfma_f32_16x16x32_bf16 v[40:43], a[24:27], a[72:75], v[40:43]
    ds_read_b64_tr_b16 a[6:7], v160 offset:42912
    v_mfma_f32_16x16x32_bf16 v[56:59], a[24:27], a[76:79], v[56:59]
    buffer_load_dwordx4 v5, s[28:31], s57 offen offset:3168 nt lds
    v_mfma_f32_16x16x32_bf16 v[72:75], a[24:27], a[80:83], v[72:75]
    ds_read_b64_tr_b16 a[8:9], v160 offset:42432
    v_mfma_f32_16x16x32_bf16 v[88:91], a[24:27], a[84:87], v[88:91]
    s_add_u32 m0, s60, 4224
    ds_read_b64_tr_b16 a[10:11], v160 offset:42944
    v_mfma_f32_16x16x32_bf16 v[104:107], a[24:27], a[88:91], v[104:107]
    s_add_u32 s57, s63, 4096
    ds_read_b64_tr_b16 a[12:13], v160 offset:42464
    v_mfma_f32_16x16x32_bf16 v[120:123], a[24:27], a[92:95], v[120:123]
    buffer_load_dwordx4 v2, s[28:31], s57 offen offset:0 nt lds
    v_mfma_f32_16x16x32_bf16 v[136:139], a[24:27], a[96:99], v[136:139]
    ds_read_b64_tr_b16 a[14:15], v160 offset:42976
    v_mfma_f32_16x16x32_bf16 v[152:155], a[24:27], a[100:103], v[152:155]
    buffer_load_dwordx4 v3, s[28:31], s57 offen offset:1056 nt lds
    v_mfma_f32_16x16x32_bf16 v[28:31], a[28:31], a[68:71], v[28:31]
    buffer_load_dwordx4 v4, s[28:31], s57 offen offset:2112 nt lds
    v_mfma_f32_16x16x32_bf16 v[44:47], a[28:31], a[72:75], v[44:47]
    buffer_load_dwordx4 v5, s[28:31], s57 offen offset:3168 nt lds
    v_mfma_f32_16x16x32_bf16 v[60:63], a[28:31], a[76:79], v[60:63]
    v_mfma_f32_16x16x32_bf16 v[76:79], a[28:31], a[80:83], v[76:79]
    v_mfma_f32_16x16x32_bf16 v[92:95], a[28:31], a[84:87], v[92:95]
    v_mfma_f32_16x16x32_bf16 v[108:111], a[28:31], a[88:91], v[108:111]
    v_mfma_f32_16x16x32_bf16 v[124:127], a[28:31], a[92:95], v[124:127]
    v_mfma_f32_16x16x32_bf16 v[140:143], a[28:31], a[96:99], v[140:143]
    v_mfma_f32_16x16x32_bf16 v[156:159], a[28:31], a[100:103], v[156:159]
    s_waitcnt vmcnt(32) lgkmcnt(0)
    s_barrier
    v_mfma_f32_16x16x32_bf16 v[16:19], a[0:3], a[32:35], v[16:19]
    s_add_u32 m0, s79, 33792
    ds_read_b128 a[68:71], v11 offset:18432
    v_mfma_f32_16x16x32_bf16 v[32:35], a[0:3], a[36:39], v[32:35]
    s_mov_b32 s57, s65
    ds_read_b128 a[72:75], v11 offset:20480
    v_mfma_f32_16x16x32_bf16 v[48:51], a[0:3], a[40:43], v[48:51]
    buffer_load_dwordx4 v6, s[32:35], s57 offen offset:0 lds
    v_mfma_f32_16x16x32_bf16 v[64:67], a[0:3], a[44:47], v[64:67]
    ds_read_b128 a[76:79], v11 offset:22528
    v_mfma_f32_16x16x32_bf16 v[80:83], a[0:3], a[48:51], v[80:83]
    buffer_load_dwordx4 v7, s[32:35], s57 offen offset:1056 lds
    v_mfma_f32_16x16x32_bf16 v[96:99], a[0:3], a[52:55], v[96:99]
    ds_read_b128 a[80:83], v11 offset:24576
    v_mfma_f32_16x16x32_bf16 v[112:115], a[0:3], a[56:59], v[112:115]
    buffer_load_dwordx4 v8, s[32:35], s57 offen offset:2112 lds
    v_mfma_f32_16x16x32_bf16 v[128:131], a[0:3], a[60:63], v[128:131]
    ds_read_b128 a[84:87], v11 offset:26624
    v_mfma_f32_16x16x32_bf16 v[144:147], a[0:3], a[64:67], v[144:147]
    buffer_load_dwordx4 v9, s[32:35], s57 offen offset:3168 lds
    v_mfma_f32_16x16x32_bf16 v[20:23], a[4:7], a[32:35], v[20:23]
    ds_read_b128 a[88:91], v11 offset:28672
    v_mfma_f32_16x16x32_bf16 v[36:39], a[4:7], a[36:39], v[36:39]
    s_add_u32 s65, s65, 262144
    ds_read_b128 a[92:95], v11 offset:30720
    v_mfma_f32_16x16x32_bf16 v[52:55], a[4:7], a[40:43], v[52:55]
    s_and_b32 s65, s65, 0x3fffff
    ds_read_b128 a[96:99], v11 offset:32768
    v_mfma_f32_16x16x32_bf16 v[68:71], a[4:7], a[44:47], v[68:71]
    s_add_u32 s58, s68, 65536
    ds_read_b128 a[100:103], v11 offset:34816
    v_mfma_f32_16x16x32_bf16 v[84:87], a[4:7], a[48:51], v[84:87]
    s_and_b32 s58, s58, 0x3ffff
    ds_read_b64_tr_b16 a[16:17], v160 offset:59264
    v_mfma_f32_16x16x32_bf16 v[100:103], a[4:7], a[52:55], v[100:103]
    s_add_u32 s58, s58, s64
    ds_read_b64_tr_b16 a[18:19], v160 offset:59776
    v_mfma_f32_16x16x32_bf16 v[116:119], a[4:7], a[56:59], v[116:119]
    buffer_load_dwordx4 a[200:203], v2, s[24:27], s58 offen offset:0 nt
    v_mfma_f32_16x16x32_bf16 v[132:135], a[4:7], a[60:63], v[132:135]
    ds_read_b64_tr_b16 a[20:21], v160 offset:59296
    v_mfma_f32_16x16x32_bf16 v[148:151], a[4:7], a[64:67], v[148:151]
    buffer_load_dwordx4 a[204:207], v3, s[24:27], s58 offen offset:1056 nt
    v_mfma_f32_16x16x32_bf16 v[24:27], a[8:11], a[32:35], v[24:27]
    ds_read_b64_tr_b16 a[22:23], v160 offset:59808
    v_mfma_f32_16x16x32_bf16 v[40:43], a[8:11], a[36:39], v[40:43]
    buffer_load_dwordx4 a[208:211], v4, s[24:27], s58 offen offset:2112 nt
    v_mfma_f32_16x16x32_bf16 v[56:59], a[8:11], a[40:43], v[56:59]
    ds_read_b64_tr_b16 a[24:25], v160 offset:59328
    v_mfma_f32_16x16x32_bf16 v[72:75], a[8:11], a[44:47], v[72:75]
    buffer_load_dwordx4 a[212:215], v5, s[24:27], s58 offen offset:3168 nt
    v_mfma_f32_16x16x32_bf16 v[88:91], a[8:11], a[48:51], v[88:91]
    ds_read_b64_tr_b16 a[26:27], v160 offset:59840
    v_mfma_f32_16x16x32_bf16 v[104:107], a[8:11], a[52:55], v[104:107]
    s_add_u32 s58, s58, 4096
    ds_read_b64_tr_b16 a[28:29], v160 offset:59360
    v_mfma_f32_16x16x32_bf16 v[120:123], a[8:11], a[56:59], v[120:123]
    buffer_load_dwordx4 a[216:219], v2, s[24:27], s58 offen offset:0 nt
    v_mfma_f32_16x16x32_bf16 v[136:139], a[8:11], a[60:63], v[136:139]
    ds_read_b64_tr_b16 a[30:31], v160 offset:59872
    v_mfma_f32_16x16x32_bf16 v[152:155], a[8:11], a[64:67], v[152:155]
    buffer_load_dwordx4 a[220:223], v3, s[24:27], s58 offen offset:1056 nt
    v_mfma_f32_16x16x32_bf16 v[28:31], a[12:15], a[32:35], v[28:31]
    buffer_load_dwordx4 a[224:227], v4, s[24:27], s58 offen offset:2112 nt
    v_mfma_f32_16x16x32_bf16 v[44:47], a[12:15], a[36:39], v[44:47]
    buffer_load_dwordx4 a[228:231], v5, s[24:27], s58 offen offset:3168 nt
    v_mfma_f32_16x16x32_bf16 v[60:63], a[12:15], a[40:43], v[60:63]
    v_mfma_f32_16x16x32_bf16 v[76:79], a[12:15], a[44:47], v[76:79]
    v_mfma_f32_16x16x32_bf16 v[92:95], a[12:15], a[48:51], v[92:95]
    v_mfma_f32_16x16x32_bf16 v[108:111], a[12:15], a[52:55], v[108:111]
    v_mfma_f32_16x16x32_bf16 v[124:127], a[12:15], a[56:59], v[124:127]
    v_mfma_f32_16x16x32_bf16 v[140:143], a[12:15], a[60:63], v[140:143]
    v_mfma_f32_16x16x32_bf16 v[156:159], a[12:15], a[64:67], v[156:159]
    s_waitcnt vmcnt(32) lgkmcnt(0)
    s_barrier
    v_mfma_f32_16x16x32_bf16 v[16:19], a[16:19], a[68:71], v[16:19]
    s_add_u32 m0, s79, 50688
    ds_read_b128 a[32:35], v10 offset:0
    v_mfma_f32_16x16x32_bf16 v[32:35], a[16:19], a[72:75], v[32:35]
    s_mov_b32 s57, s65
    ds_read_b128 a[36:39], v10 offset:2048
    v_mfma_f32_16x16x32_bf16 v[48:51], a[16:19], a[76:79], v[48:51]
    buffer_load_dwordx4 v6, s[32:35], s57 offen offset:0 lds
    v_mfma_f32_16x16x32_bf16 v[64:67], a[16:19], a[80:83], v[64:67]
    ds_read_b128 a[40:43], v10 offset:4096
    v_mfma_f32_16x16x32_bf16 v[80:83], a[16:19], a[84:87], v[80:83]
    buffer_load_dwordx4 v7, s[32:35], s57 offen offset:1056 lds
    v_mfma_f32_16x16x32_bf16 v[96:99], a[16:19], a[88:91], v[96:99]
    ds_read_b128 a[44:47], v10 offset:6144
    v_mfma_f32_16x16x32_bf16 v[112:115], a[16:19], a[92:95], v[112:115]
    buffer_load_dwordx4 v8, s[32:35], s57 offen offset:2112 lds
    v_mfma_f32_16x16x32_bf16 v[128:131], a[16:19], a[96:99], v[128:131]
    ds_read_b128 a[48:51], v10 offset:8192
    v_mfma_f32_16x16x32_bf16 v[144:147], a[16:19], a[100:103], v[144:147]
    buffer_load_dwordx4 v9, s[32:35], s57 offen offset:3168 lds
    v_mfma_f32_16x16x32_bf16 v[20:23], a[20:23], a[68:71], v[20:23]
    ds_read_b128 a[52:55], v10 offset:10240
    v_mfma_f32_16x16x32_bf16 v[36:39], a[20:23], a[72:75], v[36:39]
    s_add_u32 s65, s65, 262144
    ds_read_b128 a[56:59], v10 offset:12288
    v_mfma_f32_16x16x32_bf16 v[52:55], a[20:23], a[76:79], v[52:55]
    s_and_b32 s65, s65, 0x3fffff
    ds_read_b128 a[60:63], v10 offset:14336
    v_mfma_f32_16x16x32_bf16 v[68:71], a[20:23], a[80:83], v[68:71]
    s_add_u32 s66, s66, 8192
    ds_read_b128 a[64:67], v10 offset:16384
    v_mfma_f32_16x16x32_bf16 v[84:87], a[20:23], a[84:87], v[84:87]
    s_and_b32 s66, s66, 0x3ffff
    ds_read_b64_tr_b16 a[0:1], v160 offset:8576
    v_mfma_f32_16x16x32_bf16 v[100:103], a[20:23], a[88:91], v[100:103]
    s_add_u32 s63, s64, s66
    ds_read_b64_tr_b16 a[2:3], v160 offset:9088
    v_mfma_f32_16x16x32_bf16 v[116:119], a[20:23], a[92:95], v[116:119]
    s_add_u32 m0, s60, 8448
    ds_read_b64_tr_b16 a[4:5], v160 offset:8608
    v_mfma_f32_16x16x32_bf16 v[132:135], a[20:23], a[96:99], v[132:135]
    s_add_u32 s57, s63, 0
    ds_read_b64_tr_b16 a[6:7], v160 offset:9120
    v_mfma_f32_16x16x32_bf16 v[148:151], a[20:23], a[100:103], v[148:151]
    buffer_load_dwordx4 v2, s[24:27], s57 offen offset:0 nt lds
    v_mfma_f32_16x16x32_bf16 v[24:27], a[24:27], a[68:71], v[24:27]
    ds_read_b64_tr_b16 a[8:9], v160 offset:8640
    v_mfma_f32_16x16x32_bf16 v[40:43], a[24:27], a[72:75], v[40:43]
    buffer_load_dwordx4 v3, s[24:27], s57 offen offset:1056 nt lds
    v_mfma_f32_16x16x32_bf16 v[56:59], a[24:27], a[76:79], v[56:59]
    ds_read_b64_tr_b16 a[10:11], v160 offset:9152
    v_mfma_f32_16x16x32_bf16 v[72:75], a[24:27], a[80:83], v[72:75]
    buffer_load_dwordx4 v4, s[24:27], s57 offen offset:2112 nt lds
    v_mfma_f32_16x16x32_bf16 v[88:91], a[24:27], a[84:87], v[88:91]
    ds_read_b64_tr_b16 a[12:13], v160 offset:8672
    v_mfma_f32_16x16x32_bf16 v[104:107], a[24:27], a[88:91], v[104:107]
    buffer_load_dwordx4 v5, s[24:27], s57 offen offset:3168 nt lds
    v_mfma_f32_16x16x32_bf16 v[120:123], a[24:27], a[92:95], v[120:123]
    ds_read_b64_tr_b16 a[14:15], v160 offset:9184
    v_mfma_f32_16x16x32_bf16 v[136:139], a[24:27], a[96:99], v[136:139]
    s_add_u32 m0, s60, 12672
    v_mfma_f32_16x16x32_bf16 v[152:155], a[24:27], a[100:103], v[152:155]
    s_add_u32 s57, s63, 4096
    buffer_load_dwordx4 v2, s[24:27], s57 offen offset:0 nt lds
    v_mfma_f32_16x16x32_bf16 v[28:31], a[28:31], a[68:71], v[28:31]
    buffer_load_dwordx4 v3, s[24:27], s57 offen offset:1056 nt lds
    v_mfma_f32_16x16x32_bf16 v[44:47], a[28:31], a[72:75], v[44:47]
    buffer_load_dwordx4 v4, s[24:27], s57 offen offset:2112 nt lds
    v_mfma_f32_16x16x32_bf16 v[60:63], a[28:31], a[76:79], v[60:63]
    buffer_load_dwordx4 v5, s[24:27], s57 offen offset:3168 nt lds
    v_mfma_f32_16x16x32_bf16 v[76:79], a[28:31], a[80:83], v[76:79]
    s_add_u32 s60, s60, 16896
    v_mfma_f32_16x16x32_bf16 v[92:95], a[28:31], a[84:87], v[92:95]
    s_cmp_ge_u32 s60, s61
    v_mfma_f32_16x16x32_bf16 v[108:111], a[28:31], a[88:91], v[108:111]
    s_cselect_b32 s60, 0, s60
    v_mfma_f32_16x16x32_bf16 v[124:127], a[28:31], a[92:95], v[124:127]
    v_mfma_f32_16x16x32_bf16 v[140:143], a[28:31], a[96:99], v[140:143]
    v_mfma_f32_16x16x32_bf16 v[156:159], a[28:31], a[100:103], v[156:159]
    s_waitcnt vmcnt(32) lgkmcnt(0)
    s_barrier
    v_mfma_f32_16x16x32_bf16 v[16:19], a[0:3], a[32:35], v[16:19]
    s_add_u32 m0, s60, 0
    ds_read_b128 a[68:71], v11 offset:0
    v_mfma_f32_16x16x32_bf16 v[32:35], a[0:3], a[36:39], v[32:35]
    s_add_u32 s57, s63, 0
    ds_read_b128 a[72:75], v11 offset:2048
    v_mfma_f32_16x16x32_bf16 v[48:51], a[0:3], a[40:43], v[48:51]
    buffer_load_dwordx4 v2, s[28:31], s57 offen offset:0 nt lds
    v_mfma_f32_16x16x32_bf16 v[64:67], a[0:3], a[44:47], v[64:67]
    ds_read_b128 a[76:79], v11 offset:4096
    v_mfma_f32_16x16x32_bf16 v[80:83], a[0:3], a[48:51], v[80:83]
    buffer_load_dwordx4 v3, s[28:31], s57 offen offset:1056 nt lds
    v_mfma_f32_16x16x32_bf16 v[96:99], a[0:3], a[52:55], v[96:99]
    ds_read_b128 a[80:83], v11 offset:6144
    v_mfma_f32_16x16x32_bf16 v[112:115], a[0:3], a[56:59], v[112:115]
    buffer_load_dwordx4 v4, s[28:31], s57 offen offset:2112 nt lds
    v_mfma_f32_16x16x32_bf16 v[128:131], a[0:3], a[60:63], v[128:131]
    ds_read_b128 a[84:87], v11 offset:8192
    v_mfma_f32_16x16x32_bf16 v[144:147], a[0:3], a[64:67], v[144:147]
    buffer_load_dwordx4 v5, s[28:31], s57 offen offset:3168 nt lds
    v_mfma_f32_16x16x32_bf16 v[20:23], a[4:7], a[32:35], v[20:23]
    ds_read_b128 a[88:91], v11 offset:10240
    v_mfma_f32_16x16x32_bf16 v[36:39], a[4:7], a[36:39], v[36:39]
    s_add_u32 m0, s60, 4224
    ds_read_b128 a[92:95], v11 offset:12288
    v_mfma_f32_16x16x32_bf16 v[52:55], a[4:7], a[40:43], v[52:55]
    s_add_u32 s57, s63, 4096
    ds_read_b128 a[96:99], v11 offset:14336
    v_mfma_f32_16x16x32_bf16 v[68:71], a[4:7], a[44:47], v[68:71]
    buffer_load_dwordx4 v2, s[28:31], s57 offen offset:0 nt lds
    v_mfma_f32_16x16x32_bf16 v[84:87], a[4:7], a[48:51], v[84:87]
    ds_read_b128 a[100:103], v11 offset:16384
    v_mfma_f32_16x16x32_bf16 v[100:103], a[4:7], a[52:55], v[100:103]
    buffer_load_dwordx4 v3, s[28:31], s57 offen offset:1056 nt lds
    v_mfma_f32_16x16x32_bf16 v[116:119], a[4:7], a[56:59], v[116:119]
    ds_read_b64_tr_b16 a[16:17], v160 offset:25472
    v_mfma_f32_16x16x32_bf16 v[132:135], a[4:7], a[60:63], v[132:135]
    buffer_load_dwordx4 v4, s[28:31], s57 offen offset:2112 nt lds
    v_mfma_f32_16x16x32_bf16 v[148:151], a[4:7], a[64:67], v[148:151]
    ds_read_b64_tr_b16 a[18:19], v160 offset:25984
    v_mfma_f32_16x16x32_bf16 v[24:27], a[8:11], a[32:35], v[24:27]
    buffer_load_dwordx4 v5, s[28:31], s57 offen offset:3168 nt lds
    v_mfma_f32_16x16x32_bf16 v[40:43], a[8:11], a[36:39], v[40:43]
    ds_read_b64_tr_b16 a[20:21], v160 offset:25504
    v_mfma_f32_16x16x32_bf16 v[56:59], a[8:11], a[40:43], v[56:59]
    s_add_u32 s66, s66, 8192
    ds_read_b64_tr_b16 a[22:23], v160 offset:26016
    v_mfma_f32_16x16x32_bf16 v[72:75], a[8:11], a[44:47], v[72:75]
    s_and_b32 s66, s66, 0x3ffff
    ds_read_b64_tr_b16 a[24:25], v160 offset:25536
    v_mfma_f32_16x16x32_bf16 v[88:91], a[8:11], a[48:51], v[88:91]
    s_add_u32 s63, s64, s66
    ds_read_b64_tr_b16 a[26:27], v160 offset:26048
    v_mfma_f32_16x16x32_bf16 v[104:107], a[8:11], a[52:55], v[104:107]
    s_add_u32 m0, s60, 8448
    ds_read_b64_tr_b16 a[28:29], v160 offset:25568
    v_mfma_f32_16x16x32_bf16 v[120:123], a[8:11], a[56:59], v[120:123]
    s_add_u32 s57, s63, 0
    ds_read_b64_tr_b16 a[30:31], v160 offset:26080
    v_mfma_f32_16x16x32_bf16 v[136:139], a[8:11], a[60:63], v[136:139]
    buffer_load_dwordx4 v2, s[24:27], s57 offen offset:0 nt lds
    v_mfma_f32_16x16x32_bf16 v[152:155], a[8:11], a[64:67], v[152:155]
    buffer_load_dwordx4 v3, s[24:27], s57 offen offset:1056 nt lds
    v_mfma_f32_16x16x32_bf16 v[28:31], a[12:15], a[32:35], v[28:31]
    buffer_load_dwordx4 v4, s[24:27], s57 offen offset:2112 nt lds
    v_mfma_f32_16x16x32_bf16 v[44:47], a[12:15], a[36:39], v[44:47]
    buffer_load_dwordx4 v5, s[24:27], s57 offen offset:3168 nt lds
    v_mfma_f32_16x16x32_bf16 v[60:63], a[12:15], a[40:43], v[60:63]
    s_add_u32 m0, s60, 12672
    v_mfma_f32_16x16x32_bf16 v[76:79], a[12:15], a[44:47], v[76:79]
    s_add_u32 s57, s63, 4096
    buffer_load_dwordx4 v2, s[24:27], s57 offen offset:0 nt lds
    v_mfma_f32_16x16x32_bf16 v[92:95], a[12:15], a[48:51], v[92:95]
    buffer_load_dwordx4 v3, s[24:27], s57 offen offset:1056 nt lds
    v_mfma_f32_16x16x32_bf16 v[108:111], a[12:15], a[52:55], v[108:111]
    buffer_load_dwordx4 v4, s[24:27], s57 offen offset:2112 nt lds
    v_mfma_f32_16x16x32_bf16 v[124:127], a[12:15], a[56:59], v[124:127]
    buffer_load_dwordx4 v5, s[24:27], s57 offen offset:3168 nt lds
    v_mfma_f32_16x16x32_bf16 v[140:143], a[12:15], a[60:63], v[140:143]
    s_add_u32 s60, s60, 16896
    v_mfma_f32_16x16x32_bf16 v[156:159], a[12:15], a[64:67], v[156:159]
    s_cmp_ge_u32 s60, s61
    s_cselect_b32 s60, 0, s60
    s_waitcnt vmcnt(36) lgkmcnt(0)
    s_barrier
    v_mfma_f32_16x16x32_bf16 v[16:19], a[16:19], a[68:71], v[16:19]
    s_add_u32 m0, s60, 0
    ds_read_b128 a[32:35], v10 offset:18432
    v_mfma_f32_16x16x32_bf16 v[32:35], a[16:19], a[72:75], v[32:35]
    s_add_u32 s57, s63, 0
    ds_read_b128 a[36:39], v10 offset:20480
    v_mfma_f32_16x16x32_bf16 v[48:51], a[16:19], a[76:79], v[48:51]
    buffer_load_dwordx4 v2, s[28:31], s57 offen offset:0 nt lds
    v_mfma_f32_16x16x32_bf16 v[64:67], a[16:19], a[80:83], v[64:67]
    ds_read_b128 a[40:43], v10 offset:22528
    v_mfma_f32_16x16x32_bf16 v[80:83], a[16:19], a[84:87], v[80:83]
    buffer_load_dwordx4 v3, s[28:31], s57 offen offset:1056 nt lds
    v_mfma_f32_16x16x32_bf16 v[96:99], a[16:19], a[88:91], v[96:99]
    ds_read_b128 a[44:47], v10 offset:24576
    v_mfma_f32_16x16x32_bf16 v[112:115], a[16:19], a[92:95], v[112:115]
    buffer_load_dwordx4 v4, s[28:31], s57 offen offset:2112 nt lds
    v_mfma_f32_16x16x32_bf16 v[128:131], a[16:19], a[96:99], v[128:131]
    ds_read_b128 a[48:51], v10 offset:26624
    v_mfma_f32_16x16x32_bf16 v[144:147], a[16:19], a[100:103], v[144:147]
    buffer_load_dwordx4 v5, s[28:31], s57 offen offset:3168 nt lds
    v_mfma_f32_16x16x32_bf16 v[20:23], a[20:23], a[68:71], v[20:23]
    ds_read_b128 a[52:55], v10 offset:28672
    v_mfma_f32_16x16x32_bf16 v[36:39], a[20:23], a[72:75], v[36:39]
    s_add_u32 m0, s60, 4224
    ds_read_b128 a[56:59], v10 offset:30720
    v_mfma_f32_16x16x32_bf16 v[52:55], a[20:23], a[76:79], v[52:55]
    s_add_u32 s57, s63, 4096
    ds_read_b128 a[60:63], v10 offset:32768
    v_mfma_f32_16x16x32_bf16 v[68:71], a[20:23], a[80:83], v[68:71]
    buffer_load_dwordx4 v2, s[28:31], s57 offen offset:0 nt lds
    v_mfma_f32_16x16x32_bf16 v[84:87], a[20:23], a[84:87], v[84:87]
    ds_read_b128 a[64:67], v10 offset:34816
    v_mfma_f32_16x16x32_bf16 v[100:103], a[20:23], a[88:91], v[100:103]
    buffer_load_dwordx4 v3, s[28:31], s57 offen offset:1056 nt lds
    v_mfma_f32_16x16x32_bf16 v[116:119], a[20:23], a[92:95], v[116:119]
    ds_read_b64_tr_b16 a[0:1], v160 offset:42368
    v_mfma_f32_16x16x32_bf16 v[132:135], a[20:23], a[96:99], v[132:135]
    buffer_load_dwordx4 v4, s[28:31], s57 offen offset:2112 nt lds
    v_mfma_f32_16x16x32_bf16 v[148:151], a[20:23], a[100:103], v[148:151]
    ds_read_b64_tr_b16 a[2:3], v160 offset:42880
    v_mfma_f32_16x16x32_bf16 v[24:27], a[24:27], a[68:71], v[24:27]
    buffer_load_dwordx4 v5, s[28:31], s57 offen offset:3168 nt lds
    v_mfma_f32_16x16x32_bf16 v[40:43], a[24:27], a[72:75], v[40:43]
    ds_read_b64_tr_b16 a[4:5], v160 offset:42400
    v_mfma_f32_16x16x32_bf16 v[56:59], a[24:27], a[76:79], v[56:59]
    s_add_u32 s66, s66, 8192
    ds_read_b64_tr_b16 a[6:7], v160 offset:42912
    v_mfma_f32_16x16x32_bf16 v[72:75], a[24:27], a[80:83], v[72:75]
    s_and_b32 s66, s66, 0x3ffff
    ds_read_b64_tr_b16 a[8:9], v160 offset:42432
    v_mfma_f32_16x16x32_bf16 v[88:91], a[24:27], a[84:87], v[88:91]
    s_add_u32 s63, s64, s66
    ds_read_b64_tr_b16 a[10:11], v160 offset:42944
    v_mfma_f32_16x16x32_bf16 v[104:107], a[24:27], a[88:91], v[104:107]
    s_add_u32 m0, s60, 8448
    ds_read_b64_tr_b16 a[12:13], v160 offset:42464
    v_mfma_f32_16x16x32_bf16 v[120:123], a[24:27], a[92:95], v[120:123]
    s_add_u32 s57, s63, 0
    ds_read_b64_tr_b16 a[14:15], v160 offset:42976
    v_mfma_f32_16x16x32_bf16 v[136:139], a[24:27], a[96:99], v[136:139]
    buffer_load_dwordx4 v2, s[24:27], s57 offen offset:0 nt lds
    v_mfma_f32_16x16x32_bf16 v[152:155], a[24:27], a[100:103], v[152:155]
    buffer_load_dwordx4 v3, s[24:27], s57 offen offset:1056 nt lds
    v_mfma_f32_16x16x32_bf16 v[28:31], a[28:31], a[68:71], v[28:31]
    buffer_load_dwordx4 v4, s[24:27], s57 offen offset:2112 nt lds
    v_mfma_f32_16x16x32_bf16 v[44:47], a[28:31], a[72:75], v[44:47]
    buffer_load_dwordx4 v5, s[24:27], s57 offen offset:3168 nt lds
    v_mfma_f32_16x16x32_bf16 v[60:63], a[28:31], a[76:79], v[60:63]
    s_add_u32 m0, s60, 12672
    v_mfma_f32_16x16x32_bf16 v[76:79], a[28:31], a[80:83], v[76:79]
    s_add_u32 s57, s63, 4096
    buffer_load_dwordx4 v2, s[24:27], s57 offen offset:0 nt lds
    v_mfma_f32_16x16x32_bf16 v[92:95], a[28:31], a[84:87], v[92:95]
    buffer_load_dwordx4 v3, s[24:27], s57 offen offset:1056 nt lds
    v_mfma_f32_16x16x32_bf16 v[108:111], a[28:31], a[88:91], v[108:111]
    buffer_load_dwordx4 v4, s[24:27], s57 offen offset:2112 nt lds
    v_mfma_f32_16x16x32_bf16 v[124:127], a[28:31], a[92:95], v[124:127]
    buffer_load_dwordx4 v5, s[24:27], s57 offen offset:3168 nt lds
    v_mfma_f32_16x16x32_bf16 v[140:143], a[28:31], a[96:99], v[140:143]
    s_add_u32 s60, s60, 16896
    v_mfma_f32_16x16x32_bf16 v[156:159], a[28:31], a[100:103], v[156:159]
    s_cmp_ge_u32 s60, s61
    s_cselect_b32 s60, 0, s60
    s_waitcnt vmcnt(40) lgkmcnt(0)
    s_barrier
    v_mfma_f32_16x16x32_bf16 v[16:19], a[0:3], a[32:35], v[16:19]
    s_add_u32 m0, s60, 0
    ds_read_b128 a[68:71], v11 offset:18432
    v_mfma_f32_16x16x32_bf16 v[32:35], a[0:3], a[36:39], v[32:35]
    s_add_u32 s57, s63, 0
    ds_read_b128 a[72:75], v11 offset:20480
    v_mfma_f32_16x16x32_bf16 v[48:51], a[0:3], a[40:43], v[48:51]
    buffer_load_dwordx4 v2, s[28:31], s57 offen offset:0 nt lds
    v_mfma_f32_16x16x32_bf16 v[64:67], a[0:3], a[44:47], v[64:67]
    ds_read_b128 a[76:79], v11 offset:22528
    v_mfma_f32_16x16x32_bf16 v[80:83], a[0:3], a[48:51], v[80:83]
    buffer_load_dwordx4 v3, s[28:31], s57 offen offset:1056 nt lds
    v_mfma_f32_16x16x32_bf16 v[96:99], a[0:3], a[52:55], v[96:99]
    ds_read_b128 a[80:83], v11 offset:24576
    v_mfma_f32_16x16x32_bf16 v[112:115], a[0:3], a[56:59], v[112:115]
    buffer_load_dwordx4 v4, s[28:31], s57 offen offset:2112 nt lds
    v_mfma_f32_16x16x32_bf16 v[128:131], a[0:3], a[60:63], v[128:131]
    ds_read_b128 a[84:87], v11 offset:26624
    v_mfma_f32_16x16x32_bf16 v[144:147], a[0:3], a[64:67], v[144:147]
    buffer_load_dwordx4 v5, s[28:31], s57 offen offset:3168 nt lds
    v_mfma_f32_16x16x32_bf16 v[20:23], a[4:7], a[32:35], v[20:23]
    ds_read_b128 a[88:91], v11 offset:28672
    v_mfma_f32_16x16x32_bf16 v[36:39], a[4:7], a[36:39], v[36:39]
    s_add_u32 m0, s60, 4224
    ds_read_b128 a[92:95], v11 offset:30720
    v_mfma_f32_16x16x32_bf16 v[52:55], a[4:7], a[40:43], v[52:55]
    s_add_u32 s57, s63, 4096
    ds_read_b128 a[96:99], v11 offset:32768
    v_mfma_f32_16x16x32_bf16 v[68:71], a[4:7], a[44:47], v[68:71]
    buffer_load_dwordx4 v2, s[28:31], s57 offen offset:0 nt lds
    v_mfma_f32_16x16x32_bf16 v[84:87], a[4:7], a[48:51], v[84:87]
    ds_read_b128 a[100:103], v11 offset:34816
    v_mfma_f32_16x16x32_bf16 v[100:103], a[4:7], a[52:55], v[100:103]
    buffer_load_dwordx4 v3, s[28:31], s57 offen offset:1056 nt lds
    v_mfma_f32_16x16x32_bf16 v[116:119], a[4:7], a[56:59], v[116:119]
    ds_read_b64_tr_b16 a[16:17], v160 offset:59264
    v_mfma_f32_16x16x32_bf16 v[132:135], a[4:7], a[60:63], v[132:135]
    buffer_load_dwordx4 v4, s[28:31], s57 offen offset:2112 nt lds
    v_mfma_f32_16x16x32_bf16 v[148:151], a[4:7], a[64:67], v[148:151]
    ds_read_b64_tr_b16 a[18:19], v160 offset:59776
    v_mfma_f32_16x16x32_bf16 v[24:27], a[8:11], a[32:35], v[24:27]
    buffer_load_dwordx4 v5, s[28:31], s57 offen offset:3168 nt lds
    v_mfma_f32_16x16x32_bf16 v[40:43], a[8:11], a[36:39], v[40:43]
    ds_read_b64_tr_b16 a[20:21], v160 offset:59296
    v_mfma_f32_16x16x32_bf16 v[56:59], a[8:11], a[40:43], v[56:59]
    s_add_u32 s66, s66, 8192
    ds_read_b64_tr_b16 a[22:23], v160 offset:59808
    v_mfma_f32_16x16x32_bf16 v[72:75], a[8:11], a[44:47], v[72:75]
    s_and_b32 s66, s66, 0x3ffff
    ds_read_b64_tr_b16 a[24:25], v160 offset:59328
    v_mfma_f32_16x16x32_bf16 v[88:91], a[8:11], a[48:51], v[88:91]
    s_add_u32 s63, s64, s66
    ds_read_b64_tr_b16 a[26:27], v160 offset:59840
    v_mfma_f32_16x16x32_bf16 v[104:107], a[8:11], a[52:55], v[104:107]
    s_add_u32 m0, s60, 8448
    ds_read_b64_tr_b16 a[28:29], v160 offset:59360
    v_mfma_f32_16x16x32_bf16 v[120:123], a[8:11], a[56:59], v[120:123]
    s_add_u32 s57, s63, 0
    ds_read_b64_tr_b16 a[30:31], v160 offset:59872
    v_mfma_f32_16x16x32_bf16 v[136:139], a[8:11], a[60:63], v[136:139]
    buffer_load_dwordx4 v2, s[24:27], s57 offen offset:0 nt lds
    v_mfma_f32_16x16x32_bf16 v[152:155], a[8:11], a[64:67], v[152:155]
    buffer_load_dwordx4 v3, s[24:27], s57 offen offset:1056 nt lds
    v_mfma_f32_16x16x32_bf16 v[28:31], a[12:15], a[32:35], v[28:31]
    buffer_load_dwordx4 v4, s[24:27], s57 offen offset:2112 nt lds
    v_mfma_f32_16x16x32_bf16 v[44:47], a[12:15], a[36:39], v[44:47]
    buffer_load_dwordx4 v5, s[24:27], s57 offen offset:3168 nt lds
    v_mfma_f32_16x16x32_bf16 v[60:63], a[12:15], a[40:43], v[60:63]
    s_add_u32 m0, s60, 12672
    v_mfma_f32_16x16x32_bf16 v[76:79], a[12:15], a[44:47], v[76:79]
    s_add_u32 s57, s63, 4096
    buffer_load_dwordx4 v2, s[24:27], s57 offen offset:0 nt lds
    v_mfma_f32_16x16x32_bf16 v[92:95], a[12:15], a[48:51], v[92:95]
    buffer_load_dwordx4 v3, s[24:27], s57 offen offset:1056 nt lds
    v_mfma_f32_16x16x32_bf16 v[108:111], a[12:15], a[52:55], v[108:111]
    buffer_load_dwordx4 v4, s[24:27], s57 offen offset:2112 nt lds
    v_mfma_f32_16x16x32_bf16 v[124:127], a[12:15], a[56:59], v[124:127]
    buffer_load_dwordx4 v5, s[24:27], s57 offen offset:3168 nt lds
    v_mfma_f32_16x16x32_bf16 v[140:143], a[12:15], a[60:63], v[140:143]
    s_add_u32 s60, s60, 16896
    v_mfma_f32_16x16x32_bf16 v[156:159], a[12:15], a[64:67], v[156:159]
    s_cmp_ge_u32 s60, s61
    s_cselect_b32 s60, 0, s60
    s_waitcnt lgkmcnt(0)
    s_barrier
    v_mfma_f32_16x16x32_bf16 v[16:19], a[16:19], a[68:71], v[16:19]
    s_add_u32 m0, s60, 0
    v_mfma_f32_16x16x32_bf16 v[32:35], a[16:19], a[72:75], v[32:35]
    s_add_u32 s57, s63, 0
    buffer_load_dwordx4 v2, s[28:31], s57 offen offset:0 nt lds
    v_mfma_f32_16x16x32_bf16 v[48:51], a[16:19], a[76:79], v[48:51]
    buffer_load_dwordx4 v3, s[28:31], s57 offen offset:1056 nt lds
    v_mfma_f32_16x16x32_bf16 v[64:67], a[16:19], a[80:83], v[64:67]
    buffer_load_dwordx4 v4, s[28:31], s57 offen offset:2112 nt lds
    v_mfma_f32_16x16x32_bf16 v[80:83], a[16:19], a[84:87], v[80:83]
    buffer_load_dwordx4 v5, s[28:31], s57 offen offset:3168 nt lds
    v_mfma_f32_16x16x32_bf16 v[96:99], a[16:19], a[88:91], v[96:99]
    s_add_u32 m0, s60, 4224
    v_mfma_f32_16x16x32_bf16 v[112:115], a[16:19], a[92:95], v[112:115]
    s_add_u32 s57, s63, 4096
    buffer_load_dwordx4 v2, s[28:31], s57 offen offset:0 nt lds
    v_mfma_f32_16x16x32_bf16 v[128:131], a[16:19], a[96:99], v[128:131]
    buffer_load_dwordx4 v3, s[28:31], s57 offen offset:1056 nt lds
    v_mfma_f32_16x16x32_bf16 v[144:147], a[16:19], a[100:103], v[144:147]
    buffer_load_dwordx4 v4, s[28:31], s57 offen offset:2112 nt lds
    v_mfma_f32_16x16x32_bf16 v[20:23], a[20:23], a[68:71], v[20:23]
    buffer_load_dwordx4 v5, s[28:31], s57 offen offset:3168 nt lds
    v_mfma_f32_16x16x32_bf16 v[36:39], a[20:23], a[72:75], v[36:39]
    s_add_u32 s66, s66, 8192
    v_mfma_f32_16x16x32_bf16 v[52:55], a[20:23], a[76:79], v[52:55]
    s_and_b32 s66, s66, 0x3ffff
    v_mfma_f32_16x16x32_bf16 v[68:71], a[20:23], a[80:83], v[68:71]
    s_add_u32 s63, s64, s66
    v_mfma_f32_16x16x32_bf16 v[84:87], a[20:23], a[84:87], v[84:87]
    s_add_u32 m0, s60, 8448
    v_mfma_f32_16x16x32_bf16 v[100:103], a[20:23], a[88:91], v[100:103]
    s_add_u32 s57, s63, 0
    buffer_load_dwordx4 v2, s[24:27], s57 offen offset:0 nt lds
    v_mfma_f32_16x16x32_bf16 v[116:119], a[20:23], a[92:95], v[116:119]
    buffer_load_dwordx4 v3, s[24:27], s57 offen offset:1056 nt lds
    v_mfma_f32_16x16x32_bf16 v[132:135], a[20:23], a[96:99], v[132:135]
    buffer_load_dwordx4 v4, s[24:27], s57 offen offset:2112 nt lds
    v_mfma_f32_16x16x32_bf16 v[148:151], a[20:23], a[100:103], v[148:151]
    buffer_load_dwordx4 v5, s[24:27], s57 offen offset:3168 nt lds
    v_mfma_f32_16x16x32_bf16 v[24:27], a[24:27], a[68:71], v[24:27]
    s_add_u32 m0, s60, 12672
    v_mfma_f32_16x16x32_bf16 v[40:43], a[24:27], a[72:75], v[40:43]
    s_add_u32 s57, s63, 4096
    buffer_load_dwordx4 v2, s[24:27], s57 offen offset:0 nt lds
    v_mfma_f32_16x16x32_bf16 v[56:59], a[24:27], a[76:79], v[56:59]
    buffer_load_dwordx4 v3, s[24:27], s57 offen offset:1056 nt lds
    v_mfma_f32_16x16x32_bf16 v[72:75], a[24:27], a[80:83], v[72:75]
    buffer_load_dwordx4 v4, s[24:27], s57 offen offset:2112 nt lds
    v_mfma_f32_16x16x32_bf16 v[88:91], a[24:27], a[84:87], v[88:91]
    buffer_load_dwordx4 v5, s[24:27], s57 offen offset:3168 nt lds
    v_mfma_f32_16x16x32_bf16 v[104:107], a[24:27], a[88:91], v[104:107]
    s_add_u32 s60, s60, 16896
    v_mfma_f32_16x16x32_bf16 v[120:123], a[24:27], a[92:95], v[120:123]
    s_cmp_ge_u32 s60, s61
    v_mfma_f32_16x16x32_bf16 v[136:139], a[24:27], a[96:99], v[136:139]
    s_cselect_b32 s60, 0, s60
    v_mfma_f32_16x16x32_bf16 v[152:155], a[24:27], a[100:103], v[152:155]
    v_mfma_f32_16x16x32_bf16 v[28:31], a[28:31], a[68:71], v[28:31]
    v_mfma_f32_16x16x32_bf16 v[44:47], a[28:31], a[72:75], v[44:47]
    v_mfma_f32_16x16x32_bf16 v[60:63], a[28:31], a[76:79], v[60:63]
    v_mfma_f32_16x16x32_bf16 v[76:79], a[28:31], a[80:83], v[76:79]
    v_mfma_f32_16x16x32_bf16 v[92:95], a[28:31], a[84:87], v[92:95]
    v_mfma_f32_16x16x32_bf16 v[108:111], a[28:31], a[88:91], v[108:111]
    v_mfma_f32_16x16x32_bf16 v[124:127], a[28:31], a[92:95], v[124:127]
    v_mfma_f32_16x16x32_bf16 v[140:143], a[28:31], a[96:99], v[140:143]
    v_mfma_f32_16x16x32_bf16 v[156:159], a[28:31], a[100:103], v[156:159]
    s_barrier
    s_add_u32 s66, s66, 8192
    s_and_b32 s66, s66, 0x3ffff
    s_add_u32 s63, s64, s66
    s_add_u32 s60, s60, 16896
    s_cmp_ge_u32 s60, s61
    s_cselect_b32 s60, 0, s60
    ds_write_b128 v5, a[104:107] offset:0
    ds_write_b128 v5, a[108:111] offset:1056
    ds_write_b128 v5, a[112:115] offset:2112
    ds_write_b128 v5, a[116:119] offset:3168
    ds_write_b128 v5, a[120:123] offset:4224
    ds_write_b128 v5, a[124:127] offset:5280
    ds_write_b128 v5, a[128:131] offset:6336
    ds_write_b128 v5, a[132:135] offset:7392
    ds_write_b128 v5, a[136:139] offset:8448
    ds_write_b128 v5, a[140:143] offset:9504
    ds_write_b128 v5, a[144:147] offset:10560
    ds_write_b128 v5, a[148:151] offset:11616
    ds_write_b128 v5, a[152:155] offset:12672
    ds_write_b128 v5, a[156:159] offset:13728
    ds_write_b128 v5, a[160:163] offset:14784
    ds_write_b128 v5, a[164:167] offset:15840
    s_waitcnt lgkmcnt(0)
    v_and_b32 v10, 15, v0
    v_lshlrev_b32 v10, 4, v10
    v_lshrrev_b32 v11, 5, v0
    v_lshl_add_u32 v10, v11, 8, v10
    v_bfe_u32 v11, v0, 4, 1
    v_lshl_add_u32 v10, v11, 3, v10
    v_add_u32 v10, 136704, v10
    v_pk_mul_f32 v[16:17], v[16:17], v[14:15]
    v_pk_mul_f32 v[18:19], v[18:19], v[14:15]
    v_pk_mul_f32 v[20:21], v[20:21], v[14:15]
    v_pk_mul_f32 v[22:23], v[22:23], v[14:15]
    v_pk_mul_f32 v[24:25], v[24:25], v[14:15]
    v_pk_mul_f32 v[26:27], v[26:27], v[14:15]
    v_pk_mul_f32 v[28:29], v[28:29], v[14:15]
    v_pk_mul_f32 v[30:31], v[30:31], v[14:15]
    v_cvt_pk_bf16_f32 v16, v16, v17
    v_cvt_pk_bf16_f32 v17, v18, v19
    v_cvt_pk_bf16_f32 v18, v20, v21
    v_cvt_pk_bf16_f32 v19, v22, v23
    v_cvt_pk_bf16_f32 v20, v24, v25
    v_cvt_pk_bf16_f32 v21, v26, v27
    v_cvt_pk_bf16_f32 v22, v28, v29
    v_cvt_pk_bf16_f32 v23, v30, v31
    ds_write_b64 v10, v[16:17] offset:0
    ds_write_b64 v10, v[18:19] offset:512
    ds_write_b64 v10, v[20:21] offset:1024
    ds_write_b64 v10, v[22:23] offset:1536
    s_waitcnt vmcnt(63)
    s_barrier
    s_add_u32 s66, s66, 8192
    s_and_b32 s66, s66, 0x3ffff
    s_add_u32 s63, s64, s66
    s_add_u32 s60, s60, 16896
    s_cmp_ge_u32 s60, s61
    s_cselect_b32 s60, 0, s60
    ds_write_b128 v5, a[168:171] offset:16896
    ds_write_b128 v5, a[172:175] offset:17952
    ds_write_b128 v5, a[176:179] offset:19008
    ds_write_b128 v5, a[180:183] offset:20064
    ds_write_b128 v5, a[184:187] offset:21120
    ds_write_b128 v5, a[188:191] offset:22176
    ds_write_b128 v5, a[192:195] offset:23232
    ds_write_b128 v5, a[196:199] offset:24288
    ds_write_b128 v5, a[200:203] offset:25344
    ds_write_b128 v5, a[204:207] offset:26400
    ds_write_b128 v5, a[208:211] offset:27456
    ds_write_b128 v5, a[212:215] offset:28512
    ds_write_b128 v5, a[216:219] offset:29568
    ds_write_b128 v5, a[220:223] offset:30624
    ds_write_b128 v5, a[224:227] offset:31680
    ds_write_b128 v5, a[228:231] offset:32736
    s_waitcnt lgkmcnt(0)
    v_pk_mul_f32 v[32:33], v[32:33], v[14:15]
    v_pk_mul_f32 v[34:35], v[34:35], v[14:15]
    v_pk_mul_f32 v[36:37], v[36:37], v[14:15]
    v_pk_mul_f32 v[38:39], v[38:39], v[14:15]
    v_pk_mul_f32 v[40:41], v[40:41], v[14:15]
    v_pk_mul_f32 v[42:43], v[42:43], v[14:15]
    v_pk_mul_f32 v[44:45], v[44:45], v[14:15]
    v_pk_mul_f32 v[46:47], v[46:47], v[14:15]
    v_cvt_pk_bf16_f32 v32, v32, v33
    v_cvt_pk_bf16_f32 v33, v34, v35
    v_cvt_pk_bf16_f32 v34, v36, v37
    v_cvt_pk_bf16_f32 v35, v38, v39
    v_cvt_pk_bf16_f32 v36, v40, v41
    v_cvt_pk_bf16_f32 v37, v42, v43
    v_cvt_pk_bf16_f32 v38, v44, v45
    v_cvt_pk_bf16_f32 v39, v46, v47
    ds_write_b64 v10, v[32:33] offset:2048
    ds_write_b64 v10, v[34:35] offset:2560
    ds_write_b64 v10, v[36:37] offset:3072
    ds_write_b64 v10, v[38:39] offset:3584
    s_waitcnt vmcnt(48)
    s_barrier
    s_add_u32 m0, s60, 0
    s_add_u32 s57, s63, 0
    buffer_load_dwordx4 v2, s[28:31], s57 offen offset:0 nt lds
    buffer_load_dwordx4 v3, s[28:31], s57 offen offset:1056 nt lds
    buffer_load_dwordx4 v4, s[28:31], s57 offen offset:2112 nt lds
    buffer_load_dwordx4 v5, s[28:31], s57 offen offset:3168 nt lds
    s_add_u32 m0, s60, 4224
    s_add_u32 s57, s63, 4096
    buffer_load_dwordx4 v2, s[28:31], s57 offen offset:0 nt lds
    buffer_load_dwordx4 v3, s[28:31], s57 offen offset:1056 nt lds
    buffer_load_dwordx4 v4, s[28:31], s57 offen offset:2112 nt lds
    buffer_load_dwordx4 v5, s[28:31], s57 offen offset:3168 nt lds
    s_add_u32 s66, s66, 8192
    s_and_b32 s66, s66, 0x3ffff
    s_add_u32 s63, s64, s66
    s_add_u32 m0, s60, 8448
    s_add_u32 s57, s63, 0
    buffer_load_dwordx4 v2, s[24:27], s57 offen offset:0 nt lds
    buffer_load_dwordx4 v3, s[24:27], s57 offen offset:1056 nt lds
    buffer_load_dwordx4 v4, s[24:27], s57 offen offset:2112 nt lds
    buffer_load_dwordx4 v5, s[24:27], s57 offen offset:3168 nt lds
    s_add_u32 m0, s60, 12672
    s_add_u32 s57, s63, 4096
    buffer_load_dwordx4 v2, s[24:27], s57 offen offset:0 nt lds
    buffer_load_dwordx4 v3, s[24:27], s57 offen offset:1056 nt lds
    buffer_load_dwordx4 v4, s[24:27], s57 offen offset:2112 nt lds
    buffer_load_dwordx4 v5, s[24:27], s57 offen offset:3168 nt lds
    s_add_u32 s60, s60, 16896
    s_cmp_ge_u32 s60, s61
    s_cselect_b32 s60, 0, s60
    v_pk_mul_f32 v[48:49], v[48:49], v[14:15]
    v_pk_mul_f32 v[50:51], v[50:51], v[14:15]
    v_pk_mul_f32 v[52:53], v[52:53], v[14:15]
    v_pk_mul_f32 v[54:55], v[54:55], v[14:15]
    v_pk_mul_f32 v[56:57], v[56:57], v[14:15]
    v_pk_mul_f32 v[58:59], v[58:59], v[14:15]
    v_pk_mul_f32 v[60:61], v[60:61], v[14:15]
    v_pk_mul_f32 v[62:63], v[62:63], v[14:15]
    v_cvt_pk_bf16_f32 v48, v48, v49
    v_cvt_pk_bf16_f32 v49, v50, v51
    v_cvt_pk_bf16_f32 v50, v52, v53
    v_cvt_pk_bf16_f32 v51, v54, v55
    v_cvt_pk_bf16_f32 v52, v56, v57
    v_cvt_pk_bf16_f32 v53, v58, v59
    v_cvt_pk_bf16_f32 v54, v60, v61
    v_cvt_pk_bf16_f32 v55, v62, v63
    ds_write_b64 v10, v[48:49] offset:4096
    ds_write_b64 v10, v[50:51] offset:4608
    ds_write_b64 v10, v[52:53] offset:5120
    ds_write_b64 v10, v[54:55] offset:5632
    s_waitcnt vmcnt(48)
    s_barrier
    s_add_u32 m0, s60, 0
    s_add_u32 s57, s63, 0
    buffer_load_dwordx4 v2, s[28:31], s57 offen offset:0 nt lds
    buffer_load_dwordx4 v3, s[28:31], s57 offen offset:1056 nt lds
    buffer_load_dwordx4 v4, s[28:31], s57 offen offset:2112 nt lds
    buffer_load_dwordx4 v5, s[28:31], s57 offen offset:3168 nt lds
    s_add_u32 m0, s60, 4224
    s_add_u32 s57, s63, 4096
    buffer_load_dwordx4 v2, s[28:31], s57 offen offset:0 nt lds
    buffer_load_dwordx4 v3, s[28:31], s57 offen offset:1056 nt lds
    buffer_load_dwordx4 v4, s[28:31], s57 offen offset:2112 nt lds
    buffer_load_dwordx4 v5, s[28:31], s57 offen offset:3168 nt lds
    s_add_u32 s66, s66, 8192
    s_and_b32 s66, s66, 0x3ffff
    s_add_u32 s63, s64, s66
    s_add_u32 m0, s60, 8448
    s_add_u32 s57, s63, 0
    buffer_load_dwordx4 v2, s[24:27], s57 offen offset:0 nt lds
    buffer_load_dwordx4 v3, s[24:27], s57 offen offset:1056 nt lds
    buffer_load_dwordx4 v4, s[24:27], s57 offen offset:2112 nt lds
    buffer_load_dwordx4 v5, s[24:27], s57 offen offset:3168 nt lds
    s_add_u32 m0, s60, 12672
    s_add_u32 s57, s63, 4096
    buffer_load_dwordx4 v2, s[24:27], s57 offen offset:0 nt lds
    buffer_load_dwordx4 v3, s[24:27], s57 offen offset:1056 nt lds
    buffer_load_dwordx4 v4, s[24:27], s57 offen offset:2112 nt lds
    buffer_load_dwordx4 v5, s[24:27], s57 offen offset:3168 nt lds
    s_add_u32 s60, s60, 16896
    s_cmp_ge_u32 s60, s61
    s_cselect_b32 s60, 0, s60
    v_pk_mul_f32 v[64:65], v[64:65], v[14:15]
    v_pk_mul_f32 v[66:67], v[66:67], v[14:15]
    v_pk_mul_f32 v[68:69], v[68:69], v[14:15]
    v_pk_mul_f32 v[70:71], v[70:71], v[14:15]
    v_pk_mul_f32 v[72:73], v[72:73], v[14:15]
    v_pk_mul_f32 v[74:75], v[74:75], v[14:15]
    v_pk_mul_f32 v[76:77], v[76:77], v[14:15]
    v_pk_mul_f32 v[78:79], v[78:79], v[14:15]
    v_cvt_pk_bf16_f32 v64, v64, v65
    v_cvt_pk_bf16_f32 v65, v66, v67
    v_cvt_pk_bf16_f32 v66, v68, v69
    v_cvt_pk_bf16_f32 v67, v70, v71
    v_cvt_pk_bf16_f32 v68, v72, v73
    v_cvt_pk_bf16_f32 v69, v74, v75
    v_cvt_pk_bf16_f32 v70, v76, v77
    v_cvt_pk_bf16_f32 v71, v78, v79
    ds_write_b64 v10, v[64:65] offset:6144
    ds_write_b64 v10, v[66:67] offset:6656
    ds_write_b64 v10, v[68:69] offset:7168
    ds_write_b64 v10, v[70:71] offset:7680
    s_waitcnt vmcnt(48)
    s_barrier
    s_add_u32 m0, s60, 0
    s_add_u32 s57, s63, 0
    buffer_load_dwordx4 v2, s[28:31], s57 offen offset:0 nt lds
    buffer_load_dwordx4 v3, s[28:31], s57 offen offset:1056 nt lds
    buffer_load_dwordx4 v4, s[28:31], s57 offen offset:2112 nt lds
    buffer_load_dwordx4 v5, s[28:31], s57 offen offset:3168 nt lds
    s_add_u32 m0, s60, 4224
    s_add_u32 s57, s63, 4096
    buffer_load_dwordx4 v2, s[28:31], s57 offen offset:0 nt lds
    buffer_load_dwordx4 v3, s[28:31], s57 offen offset:1056 nt lds
    buffer_load_dwordx4 v4, s[28:31], s57 offen offset:2112 nt lds
    buffer_load_dwordx4 v5, s[28:31], s57 offen offset:3168 nt lds
    s_add_u32 s66, s66, 8192
    s_and_b32 s66, s66, 0x3ffff
    s_add_u32 s63, s64, s66
    s_add_u32 m0, s60, 8448
    s_add_u32 s57, s63, 0
    buffer_load_dwordx4 v2, s[24:27], s57 offen offset:0 nt lds
    buffer_load_dwordx4 v3, s[24:27], s57 offen offset:1056 nt lds
    buffer_load_dwordx4 v4, s[24:27], s57 offen offset:2112 nt lds
    buffer_load_dwordx4 v5, s[24:27], s57 offen offset:3168 nt lds
    s_add_u32 m0, s60, 12672
    s_add_u32 s57, s63, 4096
    buffer_load_dwordx4 v2, s[24:27], s57 offen offset:0 nt lds
    buffer_load_dwordx4 v3, s[24:27], s57 offen offset:1056 nt lds
    buffer_load_dwordx4 v4, s[24:27], s57 offen offset:2112 nt lds
    buffer_load_dwordx4 v5, s[24:27], s57 offen offset:3168 nt lds
    s_add_u32 s60, s60, 16896
    s_cmp_ge_u32 s60, s61
    s_cselect_b32 s60, 0, s60
    v_pk_mul_f32 v[80:81], v[80:81], v[14:15]
    v_pk_mul_f32 v[82:83], v[82:83], v[14:15]
    v_pk_mul_f32 v[84:85], v[84:85], v[14:15]
    v_pk_mul_f32 v[86:87], v[86:87], v[14:15]
    v_pk_mul_f32 v[88:89], v[88:89], v[14:15]
    v_pk_mul_f32 v[90:91], v[90:91], v[14:15]
    v_pk_mul_f32 v[92:93], v[92:93], v[14:15]
    v_pk_mul_f32 v[94:95], v[94:95], v[14:15]
    v_cvt_pk_bf16_f32 v80, v80, v81
    v_cvt_pk_bf16_f32 v81, v82, v83
    v_cvt_pk_bf16_f32 v82, v84, v85
    v_cvt_pk_bf16_f32 v83, v86, v87
    v_cvt_pk_bf16_f32 v84, v88, v89
    v_cvt_pk_bf16_f32 v85, v90, v91
    v_cvt_pk_bf16_f32 v86, v92, v93
    v_cvt_pk_bf16_f32 v87, v94, v95
    ds_write_b64 v10, v[80:81] offset:8192
    ds_write_b64 v10, v[82:83] offset:8704
    ds_write_b64 v10, v[84:85] offset:9216
    ds_write_b64 v10, v[86:87] offset:9728
    s_waitcnt vmcnt(48)
    s_barrier
    s_add_u32 m0, s60, 0
    s_add_u32 s57, s63, 0
    buffer_load_dwordx4 v2, s[28:31], s57 offen offset:0 nt lds
    buffer_load_dwordx4 v3, s[28:31], s57 offen offset:1056 nt lds
    buffer_load_dwordx4 v4, s[28:31], s57 offen offset:2112 nt lds
    buffer_load_dwordx4 v5, s[28:31], s57 offen offset:3168 nt lds
    s_add_u32 m0, s60, 4224
    s_add_u32 s57, s63, 4096
    buffer_load_dwordx4 v2, s[28:31], s57 offen offset:0 nt lds
    buffer_load_dwordx4 v3, s[28:31], s57 offen offset:1056 nt lds
    buffer_load_dwordx4 v4, s[28:31], s57 offen offset:2112 nt lds
    buffer_load_dwordx4 v5, s[28:31], s57 offen offset:3168 nt lds
    s_add_u32 s66, s66, 8192
    s_and_b32 s66, s66, 0x3ffff
    s_add_u32 s63, s64, s66
    s_add_u32 m0, s60, 8448
    s_add_u32 s57, s63, 0
    buffer_load_dwordx4 v2, s[24:27], s57 offen offset:0 nt lds
    buffer_load_dwordx4 v3, s[24:27], s57 offen offset:1056 nt lds
    buffer_load_dwordx4 v4, s[24:27], s57 offen offset:2112 nt lds
    buffer_load_dwordx4 v5, s[24:27], s57 offen offset:3168 nt lds
    s_add_u32 m0, s60, 12672
    s_add_u32 s57, s63, 4096
    buffer_load_dwordx4 v2, s[24:27], s57 offen offset:0 nt lds
    buffer_load_dwordx4 v3, s[24:27], s57 offen offset:1056 nt lds
    buffer_load_dwordx4 v4, s[24:27], s57 offen offset:2112 nt lds
    buffer_load_dwordx4 v5, s[24:27], s57 offen offset:3168 nt lds
    s_add_u32 s60, s60, 16896
    s_cmp_ge_u32 s60, s61
    s_cselect_b32 s60, 0, s60
    v_pk_mul_f32 v[96:97], v[96:97], v[14:15]
    v_pk_mul_f32 v[98:99], v[98:99], v[14:15]
    v_pk_mul_f32 v[100:101], v[100:101], v[14:15]
    v_pk_mul_f32 v[102:103], v[102:103], v[14:15]
    v_pk_mul_f32 v[104:105], v[104:105], v[14:15]
    v_pk_mul_f32 v[106:107], v[106:107], v[14:15]
    v_pk_mul_f32 v[108:109], v[108:109], v[14:15]
    v_pk_mul_f32 v[110:111], v[110:111], v[14:15]
    v_cvt_pk_bf16_f32 v96, v96, v97
    v_cvt_pk_bf16_f32 v97, v98, v99
    v_cvt_pk_bf16_f32 v98, v100, v101
    v_cvt_pk_bf16_f32 v99, v102, v103
    v_cvt_pk_bf16_f32 v100, v104, v105
    v_cvt_pk_bf16_f32 v101, v106, v107
    v_cvt_pk_bf16_f32 v102, v108, v109
    v_cvt_pk_bf16_f32 v103, v110, v111
    ds_write_b64 v10, v[96:97] offset:10240
    ds_write_b64 v10, v[98:99] offset:10752
    ds_write_b64 v10, v[100:101] offset:11264
    ds_write_b64 v10, v[102:103] offset:11776
    s_barrier
    v_pk_mul_f32 v[112:113], v[112:113], v[14:15]
    v_pk_mul_f32 v[114:115], v[114:115], v[14:15]
    v_pk_mul_f32 v[116:117], v[116:117], v[14:15]
    v_pk_mul_f32 v[118:119], v[118:119], v[14:15]
    v_pk_mul_f32 v[120:121], v[120:121], v[14:15]
    v_pk_mul_f32 v[122:123], v[122:123], v[14:15]
    v_pk_mul_f32 v[124:125], v[124:125], v[14:15]
    v_pk_mul_f32 v[126:127], v[126:127], v[14:15]
    v_cvt_pk_bf16_f32 v112, v112, v113
    v_cvt_pk_bf16_f32 v113, v114, v115
    v_cvt_pk_bf16_f32 v114, v116, v117
    v_cvt_pk_bf16_f32 v115, v118, v119
    v_cvt_pk_bf16_f32 v116, v120, v121
    v_cvt_pk_bf16_f32 v117, v122, v123
    v_cvt_pk_bf16_f32 v118, v124, v125
    v_cvt_pk_bf16_f32 v119, v126, v127
    ds_write_b64 v10, v[112:113] offset:12288
    ds_write_b64 v10, v[114:115] offset:12800
    ds_write_b64 v10, v[116:117] offset:13312
    ds_write_b64 v10, v[118:119] offset:13824
    s_barrier
    s_add_u32 m0, s60, 0
    s_add_u32 s57, s63, 0
    buffer_load_dwordx4 v2, s[28:31], s57 offen offset:0 nt lds
    buffer_load_dwordx4 v3, s[28:31], s57 offen offset:1056 nt lds
    buffer_load_dwordx4 v4, s[28:31], s57 offen offset:2112 nt lds
    buffer_load_dwordx4 v5, s[28:31], s57 offen offset:3168 nt lds
    s_add_u32 m0, s60, 4224
    s_add_u32 s57, s63, 4096
    buffer_load_dwordx4 v2, s[28:31], s57 offen offset:0 nt lds
    buffer_load_dwordx4 v3, s[28:31], s57 offen offset:1056 nt lds
    buffer_load_dwordx4 v4, s[28:31], s57 offen offset:2112 nt lds
    buffer_load_dwordx4 v5, s[28:31], s57 offen offset:3168 nt lds
    s_add_u32 s66, s66, 8192
    s_and_b32 s66, s66, 0x3ffff
    s_add_u32 s63, s64, s66
    s_add_u32 m0, s60, 8448
    s_add_u32 s57, s63, 0
    buffer_load_dwordx4 v2, s[24:27], s57 offen offset:0 nt lds
    buffer_load_dwordx4 v3, s[24:27], s57 offen offset:1056 nt lds
    buffer_load_dwordx4 v4, s[24:27], s57 offen offset:2112 nt lds
    buffer_load_dwordx4 v5, s[24:27], s57 offen offset:3168 nt lds
    s_add_u32 m0, s60, 12672
    s_add_u32 s57, s63, 4096
    buffer_load_dwordx4 v2, s[24:27], s57 offen offset:0 nt lds
    buffer_load_dwordx4 v3, s[24:27], s57 offen offset:1056 nt lds
    buffer_load_dwordx4 v4, s[24:27], s57 offen offset:2112 nt lds
    buffer_load_dwordx4 v5, s[24:27], s57 offen offset:3168 nt lds
    s_add_u32 s60, s60, 16896
    s_cmp_ge_u32 s60, s61
    s_cselect_b32 s60, 0, s60
    v_pk_mul_f32 v[128:129], v[128:129], v[14:15]
    v_pk_mul_f32 v[130:131], v[130:131], v[14:15]
    v_pk_mul_f32 v[132:133], v[132:133], v[14:15]
    v_pk_mul_f32 v[134:135], v[134:135], v[14:15]
    v_pk_mul_f32 v[136:137], v[136:137], v[14:15]
    v_pk_mul_f32 v[138:139], v[138:139], v[14:15]
    v_pk_mul_f32 v[140:141], v[140:141], v[14:15]
    v_pk_mul_f32 v[142:143], v[142:143], v[14:15]
    v_cvt_pk_bf16_f32 v128, v128, v129
    v_cvt_pk_bf16_f32 v129, v130, v131
    v_cvt_pk_bf16_f32 v130, v132, v133
    v_cvt_pk_bf16_f32 v131, v134, v135
    v_cvt_pk_bf16_f32 v132, v136, v137
    v_cvt_pk_bf16_f32 v133, v138, v139
    v_cvt_pk_bf16_f32 v134, v140, v141
    v_cvt_pk_bf16_f32 v135, v142, v143
    ds_write_b64 v10, v[128:129] offset:14336
    ds_write_b64 v10, v[130:131] offset:14848
    ds_write_b64 v10, v[132:133] offset:15360
    ds_write_b64 v10, v[134:135] offset:15872
    s_waitcnt vmcnt(63)
    s_barrier
    s_add_u32 m0, s60, 0
    s_add_u32 s57, s63, 0
    buffer_load_dwordx4 v2, s[28:31], s57 offen offset:0 nt lds
    buffer_load_dwordx4 v3, s[28:31], s57 offen offset:1056 nt lds
    buffer_load_dwordx4 v4, s[28:31], s57 offen offset:2112 nt lds
    buffer_load_dwordx4 v5, s[28:31], s57 offen offset:3168 nt lds
    s_add_u32 m0, s60, 4224
    s_add_u32 s57, s63, 4096
    buffer_load_dwordx4 v2, s[28:31], s57 offen offset:0 nt lds
    buffer_load_dwordx4 v3, s[28:31], s57 offen offset:1056 nt lds
    buffer_load_dwordx4 v4, s[28:31], s57 offen offset:2112 nt lds
    buffer_load_dwordx4 v5, s[28:31], s57 offen offset:3168 nt lds
    s_add_u32 s66, s66, 8192
    s_and_b32 s66, s66, 0x3ffff
    s_add_u32 s63, s64, s66
    s_add_u32 m0, s60, 8448
    s_add_u32 s57, s63, 0
    buffer_load_dwordx4 v2, s[24:27], s57 offen offset:0 nt lds
    buffer_load_dwordx4 v3, s[24:27], s57 offen offset:1056 nt lds
    buffer_load_dwordx4 v4, s[24:27], s57 offen offset:2112 nt lds
    buffer_load_dwordx4 v5, s[24:27], s57 offen offset:3168 nt lds
    s_add_u32 m0, s60, 12672
    s_add_u32 s57, s63, 4096
    buffer_load_dwordx4 v2, s[24:27], s57 offen offset:0 nt lds
    buffer_load_dwordx4 v3, s[24:27], s57 offen offset:1056 nt lds
    buffer_load_dwordx4 v4, s[24:27], s57 offen offset:2112 nt lds
    buffer_load_dwordx4 v5, s[24:27], s57 offen offset:3168 nt lds
    s_add_u32 s60, s60, 16896
    s_cmp_ge_u32 s60, s61
    s_cselect_b32 s60, 0, s60
    v_pk_mul_f32 v[144:145], v[144:145], v[14:15]
    v_pk_mul_f32 v[146:147], v[146:147], v[14:15]
    v_pk_mul_f32 v[148:149], v[148:149], v[14:15]
    v_pk_mul_f32 v[150:151], v[150:151], v[14:15]
    v_pk_mul_f32 v[152:153], v[152:153], v[14:15]
    v_pk_mul_f32 v[154:155], v[154:155], v[14:15]
    v_pk_mul_f32 v[156:157], v[156:157], v[14:15]
    v_pk_mul_f32 v[158:159], v[158:159], v[14:15]
    v_cvt_pk_bf16_f32 v144, v144, v145
    v_cvt_pk_bf16_f32 v145, v146, v147
    v_cvt_pk_bf16_f32 v146, v148, v149
    v_cvt_pk_bf16_f32 v147, v150, v151
    v_cvt_pk_bf16_f32 v148, v152, v153
    v_cvt_pk_bf16_f32 v149, v154, v155
    v_cvt_pk_bf16_f32 v150, v156, v157
    v_cvt_pk_bf16_f32 v151, v158, v159
    ds_write_b64 v10, v[144:145] offset:16384
    ds_write_b64 v10, v[146:147] offset:16896
    ds_write_b64 v10, v[148:149] offset:17408
    ds_write_b64 v10, v[150:151] offset:17920
    s_waitcnt lgkmcnt(0)
    s_waitcnt vmcnt(63)
    s_barrier
    s_add_u32 m0, s60, 0
    s_add_u32 s57, s63, 0
    buffer_load_dwordx4 v2, s[28:31], s57 offen offset:0 nt lds
    buffer_load_dwordx4 v3, s[28:31], s57 offen offset:1056 nt lds
    buffer_load_dwordx4 v4, s[28:31], s57 offen offset:2112 nt lds
    buffer_load_dwordx4 v5, s[28:31], s57 offen offset:3168 nt lds
    s_add_u32 m0, s60, 4224
    s_add_u32 s57, s63, 4096
    buffer_load_dwordx4 v2, s[28:31], s57 offen offset:0 nt lds
    buffer_load_dwordx4 v3, s[28:31], s57 offen offset:1056 nt lds
    buffer_load_dwordx4 v4, s[28:31], s57 offen offset:2112 nt lds
    buffer_load_dwordx4 v5, s[28:31], s57 offen offset:3168 nt lds
    s_add_u32 s66, s66, 8192
    s_and_b32 s66, s66, 0x3ffff
    s_add_u32 s63, s64, s66
    s_add_u32 m0, s60, 8448
    s_add_u32 s57, s63, 0
    buffer_load_dwordx4 v2, s[24:27], s57 offen offset:0 nt lds
    buffer_load_dwordx4 v3, s[24:27], s57 offen offset:1056 nt lds
    buffer_load_dwordx4 v4, s[24:27], s57 offen offset:2112 nt lds
    buffer_load_dwordx4 v5, s[24:27], s57 offen offset:3168 nt lds
    s_add_u32 m0, s60, 12672
    s_add_u32 s57, s63, 4096
    buffer_load_dwordx4 v2, s[24:27], s57 offen offset:0 nt lds
    buffer_load_dwordx4 v3, s[24:27], s57 offen offset:1056 nt lds
    buffer_load_dwordx4 v4, s[24:27], s57 offen offset:2112 nt lds
    buffer_load_dwordx4 v5, s[24:27], s57 offen offset:3168 nt lds
    s_add_u32 s60, s60, 16896
    s_cmp_ge_u32 s60, s61
    s_cselect_b32 s60, 0, s60
    v_lshrrev_b32 v10, 4, v0
    v_and_b32 v11, 1, v10
    v_lshlrev_b32 v11, 13, v11
    v_lshrrev_b32 v10, 1, v10
    v_lshl_add_u32 v11, v10, 14, v11
    s_lshl_b32 s56, s54, 2
    v_add_u32 v10, s56, v0
    v_and_b32 v10, 15, v10
    v_lshl_add_u32 v9, v10, 4, v11
    v_add_u32 v6, 96, v9
    v_add_u32 v7, 64, v9
    v_add_u32 v8, 32, v9
    v_add_u32 v10, 67584, v1
    v_add_u32 v11, 118272, v1
    s_mov_b32 s62, 2
    .p2align 3
L_h_loop0:
    s_waitcnt vmcnt(63)
    s_barrier
    s_add_u32 m0, s60, 0
    s_add_u32 s57, s63, 0
    buffer_load_dwordx4 v2, s[28:31], s57 offen offset:0 nt lds
    buffer_load_dwordx4 v3, s[28:31], s57 offen offset:1056 nt lds
    buffer_load_dwordx4 v4, s[28:31], s57 offen offset:2112 nt lds
    buffer_load_dwordx4 v5, s[28:31], s57 offen offset:3168 nt lds
    s_add_u32 m0, s60, 4224
    s_add_u32 s57, s63, 4096
    buffer_load_dwordx4 v2, s[28:31], s57 offen offset:0 nt lds
    buffer_load_dwordx4 v3, s[28:31], s57 offen offset:1056 nt lds
    buffer_load_dwordx4 v4, s[28:31], s57 offen offset:2112 nt lds
    buffer_load_dwordx4 v5, s[28:31], s57 offen offset:3168 nt lds
    s_add_u32 s66, s66, 8192
    s_and_b32 s66, s66, 0x3ffff
    s_add_u32 s63, s64, s66
    s_add_u32 m0, s60, 8448
    s_add_u32 s57, s63, 0
    buffer_load_dwordx4 v2, s[24:27], s57 offen offset:0 nt lds
    buffer_load_dwordx4 v3, s[24:27], s57 offen offset:1056 nt lds
    buffer_load_dwordx4 v4, s[24:27], s57 offen offset:2112 nt lds
    buffer_load_dwordx4 v5, s[24:27], s57 offen offset:3168 nt lds
    s_add_u32 m0, s60, 12672
    s_add_u32 s57, s63, 4096
    buffer_load_dwordx4 v2, s[24:27], s57 offen offset:0 nt lds
    buffer_load_dwordx4 v3, s[24:27], s57 offen offset:1056 nt lds
    buffer_load_dwordx4 v4, s[24:27], s57 offen offset:2112 nt lds
    buffer_load_dwordx4 v5, s[24:27], s57 offen offset:3168 nt lds
    s_add_u32 s60, s60, 16896
    s_cmp_ge_u32 s60, s61
    s_cselect_b32 s60, 0, s60
    s_sub_u32 s62, s62, 1
    s_cmp_lg_u32 s62, 0
    s_cbranch_scc1 L_h_loop0
    s_waitcnt vmcnt(63)
    s_barrier
    s_add_u32 m0, s60, 0
    s_add_u32 s57, s63, 0
    buffer_load_dwordx4 v2, s[28:31], s57 offen offset:0 nt lds
    buffer_load_dwordx4 v3, s[28:31], s57 offen offset:1056 nt lds
    buffer_load_dwordx4 v4, s[28:31], s57 offen offset:2112 nt lds
    buffer_load_dwordx4 v5, s[28:31], s57 offen offset:3168 nt lds
    s_add_u32 m0, s60, 4224
    s_add_u32 s57, s63, 4096
    buffer_load_dwordx4 v2, s[28:31], s57 offen offset:0 nt lds
    buffer_load_dwordx4 v3, s[28:31], s57 offen offset:1056 nt lds
    buffer_load_dwordx4 v4, s[28:31], s57 offen offset:2112 nt lds
    buffer_load_dwordx4 v5, s[28:31], s57 offen offset:3168 nt lds
    s_add_u32 s66, s66, 8192
    s_and_b32 s66, s66, 0x3ffff
    s_add_u32 s63, s64, s66
    s_add_u32 m0, s60, 8448
    s_add_u32 s57, s63, 0
    buffer_load_dwordx4 v2, s[24:27], s57 offen offset:0 nt lds
    buffer_load_dwordx4 v3, s[24:27], s57 offen offset:1056 nt lds
    buffer_load_dwordx4 v4, s[24:27], s57 offen offset:2112 nt lds
    buffer_load_dwordx4 v5, s[24:27], s57 offen offset:3168 nt lds
    s_add_u32 m0, s60, 12672
    s_add_u32 s57, s63, 4096
    buffer_load_dwordx4 v2, s[24:27], s57 offen offset:0 nt lds
    buffer_load_dwordx4 v3, s[24:27], s57 offen offset:1056 nt lds
    buffer_load_dwordx4 v4, s[24:27], s57 offen offset:2112 nt lds
    buffer_load_dwordx4 v5, s[24:27], s57 offen offset:3168 nt lds
    s_add_u32 s60, s60, 16896
    s_cmp_ge_u32 s60, s61
    s_cselect_b32 s60, 0, s60
    buffer_load_dword v19, off, s[48:51], 0 sc1
    s_waitcnt vmcnt(63)
    s_barrier
    s_mov_b32 s62, 2
    .p2align 3
L_h_loop1:
    s_waitcnt vmcnt(49)
    s_barrier
    s_add_u32 m0, s60, 0
    s_add_u32 s57, s63, 0
    buffer_load_dwordx4 v2, s[28:31], s57 offen offset:0 nt lds
    buffer_load_dwordx4 v3, s[28:31], s57 offen offset:1056 nt lds
    buffer_load_dwordx4 v4, s[28:31], s57 offen offset:2112 nt lds
    buffer_load_dwordx4 v5, s[28:31], s57 offen offset:3168 nt lds
    s_add_u32 m0, s60, 4224
    s_add_u32 s57, s63, 4096
    buffer_load_dwordx4 v2, s[28:31], s57 offen offset:0 nt lds
    buffer_load_dwordx4 v3, s[28:31], s57 offen offset:1056 nt lds
    buffer_load_dwordx4 v4, s[28:31], s57 offen offset:2112 nt lds
    buffer_load_dwordx4 v5, s[28:31], s57 offen offset:3168 nt lds
    s_add_u32 s66, s66, 8192
    s_and_b32 s66, s66, 0x3ffff
    s_add_u32 s63, s64, s66
    s_add_u32 m0, s60, 8448
    s_add_u32 s57, s63, 0
    buffer_load_dwordx4 v2, s[24:27], s57 offen offset:0 nt lds
    buffer_load_dwordx4 v3, s[24:27], s57 offen offset:1056 nt lds
    buffer_load_dwordx4 v4, s[24:27], s57 offen offset:2112 nt lds
    buffer_load_dwordx4 v5, s[24:27], s57 offen offset:3168 nt lds
    s_add_u32 m0, s60, 12672
    s_add_u32 s57, s63, 4096
    buffer_load_dwordx4 v2, s[24:27], s57 offen offset:0 nt lds
    buffer_load_dwordx4 v3, s[24:27], s57 offen offset:1056 nt lds
    buffer_load_dwordx4 v4, s[24:27], s57 offen offset:2112 nt lds
    buffer_load_dwordx4 v5, s[24:27], s57 offen offset:3168 nt lds
    s_add_u32 s60, s60, 16896
    s_cmp_ge_u32 s60, s61
    s_cselect_b32 s60, 0, s60
    s_sub_u32 s62, s62, 1
    s_cmp_lg_u32 s62, 0
    s_cbranch_scc1 L_h_loop1
    s_waitcnt vmcnt(49)
    s_barrier
    s_add_u32 m0, s60, 0
    s_add_u32 s57, s63, 0
    buffer_load_dwordx4 v2, s[28:31], s57 offen offset:0 nt lds
    buffer_load_dwordx4 v3, s[28:31], s57 offen offset:1056 nt lds
    buffer_load_dwordx4 v4, s[28:31], s57 offen offset:2112 nt lds
    buffer_load_dwordx4 v5, s[28:31], s57 offen offset:3168 nt lds
    s_add_u32 m0, s60, 4224
    s_add_u32 s57, s63, 4096
    buffer_load_dwordx4 v2, s[28:31], s57 offen offset:0 nt lds
    buffer_load_dwordx4 v3, s[28:31], s57 offen offset:1056 nt lds
    buffer_load_dwordx4 v4, s[28:31], s57 offen offset:2112 nt lds
    buffer_load_dwordx4 v5, s[28:31], s57 offen offset:3168 nt lds
    s_add_u32 s66, s66, 8192
    s_and_b32 s66, s66, 0x3ffff
    s_add_u32 s63, s64, s66
    s_add_u32 m0, s60, 8448
    s_add_u32 s57, s63, 0
    buffer_load_dwordx4 v2, s[24:27], s57 offen offset:0 nt lds
    buffer_load_dwordx4 v3, s[24:27], s57 offen offset:1056 nt lds
    buffer_load_dwordx4 v4, s[24:27], s57 offen offset:2112 nt lds
    buffer_load_dwordx4 v5, s[24:27], s57 offen offset:3168 nt lds
    s_add_u32 m0, s60, 12672
    s_add_u32 s57, s63, 4096
    buffer_load_dwordx4 v2, s[24:27], s57 offen offset:0 nt lds
    buffer_load_dwordx4 v3, s[24:27], s57 offen offset:1056 nt lds
    buffer_load_dwordx4 v4, s[24:27], s57 offen offset:2112 nt lds
    buffer_load_dwordx4 v5, s[24:27], s57 offen offset:3168 nt lds
    s_add_u32 s60, s60, 16896
    s_cmp_ge_u32 s60, s61
    s_cselect_b32 s60, 0, s60
    s_waitcnt vmcnt(48)
    v_readfirstlane_b32 s56, v19
    s_nop 1
    s_cmp_ge_u32 s56, 256
    s_cbranch_scc1 L_cnt_ok
    s_mov_b32 s72, 131072
L_cnt_lp:
    buffer_load_dword v19, off, s[48:51], 0 sc1
    s_waitcnt vmcnt(0)
    v_readfirstlane_b32 s56, v19
    s_nop 1
    s_cmp_ge_u32 s56, 256
    s_cbranch_scc1 L_cnt_ok
    s_sub_u32 s72, s72, 1
    s_cmp_lg_u32 s72, 0
    s_cbranch_scc1 L_cnt_lp
L_cnt_ok:
    s_lshr_b32 s56, s2, 3
    v_mul_u32_u24 v16, 4096, v0
    s_lshl_b32 s56, s56, 7
    s_add_u32 s56, s56, L_trans-standalone__gqa_block_cached__near_ridge_kernel
    v_add_u32 v16, s56, v16
    v_min_u32 v16, L_done-standalone__gqa_block_cached__near_ridge_kernel, v16
    v_mov_b32 v17, s97
    v_add_co_u32 v16, vcc, s96, v16
    s_nop 1
    v_addc_co_u32 v17, vcc, 0, v17, vcc
    global_load_dword v18, v[16:17], off
    s_barrier
    s_add_u32 m0, s60, 0
    s_add_u32 s57, s63, 0
    buffer_load_dwordx4 v2, s[28:31], s57 offen offset:0 nt lds
    buffer_load_dwordx4 v3, s[28:31], s57 offen offset:1056 nt lds
    buffer_load_dwordx4 v4, s[28:31], s57 offen offset:2112 nt lds
    buffer_load_dwordx4 v5, s[28:31], s57 offen offset:3168 nt lds
    s_add_u32 m0, s60, 4224
    s_add_u32 s57, s63, 4096
    buffer_load_dwordx4 v2, s[28:31], s57 offen offset:0 nt lds
    buffer_load_dwordx4 v3, s[28:31], s57 offen offset:1056 nt lds
    buffer_load_dwordx4 v4, s[28:31], s57 offen offset:2112 nt lds
    buffer_load_dwordx4 v5, s[28:31], s57 offen offset:3168 nt lds
    s_add_u32 s66, s66, 8192
    s_and_b32 s66, s66, 0x3ffff
    s_add_u32 s63, s64, s66
    s_add_u32 m0, s60, 8448
    s_add_u32 s57, s63, 0
    buffer_load_dwordx4 v2, s[24:27], s57 offen offset:0 nt lds
    buffer_load_dwordx4 v3, s[24:27], s57 offen offset:1056 nt lds
    buffer_load_dwordx4 v4, s[24:27], s57 offen offset:2112 nt lds
    buffer_load_dwordx4 v5, s[24:27], s57 offen offset:3168 nt lds
    s_add_u32 m0, s60, 12672
    s_add_u32 s57, s63, 4096
    buffer_load_dwordx4 v2, s[24:27], s57 offen offset:0 nt lds
    buffer_load_dwordx4 v3, s[24:27], s57 offen offset:1056 nt lds
    buffer_load_dwordx4 v4, s[24:27], s57 offen offset:2112 nt lds
    buffer_load_dwordx4 v5, s[24:27], s57 offen offset:3168 nt lds
    s_add_u32 s60, s60, 16896
    s_cmp_ge_u32 s60, s61
    s_cselect_b32 s60, 0, s60
    s_mov_b32 s62, 2
    .p2align 3
L_h_loop2:
    s_waitcnt vmcnt(49)
    s_barrier
    s_add_u32 m0, s60, 0
    s_add_u32 s57, s63, 0
    buffer_load_dwordx4 v2, s[28:31], s57 offen offset:0 nt lds
    buffer_load_dwordx4 v3, s[28:31], s57 offen offset:1056 nt lds
    buffer_load_dwordx4 v4, s[28:31], s57 offen offset:2112 nt lds
    buffer_load_dwordx4 v5, s[28:31], s57 offen offset:3168 nt lds
    s_add_u32 m0, s60, 4224
    s_add_u32 s57, s63, 4096
    buffer_load_dwordx4 v2, s[28:31], s57 offen offset:0 nt lds
    buffer_load_dwordx4 v3, s[28:31], s57 offen offset:1056 nt lds
    buffer_load_dwordx4 v4, s[28:31], s57 offen offset:2112 nt lds
    buffer_load_dwordx4 v5, s[28:31], s57 offen offset:3168 nt lds
    s_add_u32 s66, s66, 8192
    s_and_b32 s66, s66, 0x3ffff
    s_add_u32 s63, s64, s66
    s_add_u32 m0, s60, 8448
    s_add_u32 s57, s63, 0
    buffer_load_dwordx4 v2, s[24:27], s57 offen offset:0 nt lds
    buffer_load_dwordx4 v3, s[24:27], s57 offen offset:1056 nt lds
    buffer_load_dwordx4 v4, s[24:27], s57 offen offset:2112 nt lds
    buffer_load_dwordx4 v5, s[24:27], s57 offen offset:3168 nt lds
    s_add_u32 m0, s60, 12672
    s_add_u32 s57, s63, 4096
    buffer_load_dwordx4 v2, s[24:27], s57 offen offset:0 nt lds
    buffer_load_dwordx4 v3, s[24:27], s57 offen offset:1056 nt lds
    buffer_load_dwordx4 v4, s[24:27], s57 offen offset:2112 nt lds
    buffer_load_dwordx4 v5, s[24:27], s57 offen offset:3168 nt lds
    s_add_u32 s60, s60, 16896
    s_cmp_ge_u32 s60, s61
    s_cselect_b32 s60, 0, s60
    s_sub_u32 s62, s62, 1
    s_cmp_lg_u32 s62, 0
    s_cbranch_scc1 L_h_loop2
    s_waitcnt vmcnt(49)
    s_barrier
    s_mov_b32 s62, 2
    .p2align 3
L_h_loop3:
    s_waitcnt vmcnt(32)
    s_barrier
    s_add_u32 m0, s60, 0
    s_add_u32 s57, s63, 0
    buffer_load_dwordx4 v2, s[28:31], s57 offen offset:0 nt lds
    buffer_load_dwordx4 v3, s[28:31], s57 offen offset:1056 nt lds
    buffer_load_dwordx4 v4, s[28:31], s57 offen offset:2112 nt lds
    buffer_load_dwordx4 v5, s[28:31], s57 offen offset:3168 nt lds
    s_add_u32 m0, s60, 4224
    s_add_u32 s57, s63, 4096
    buffer_load_dwordx4 v2, s[28:31], s57 offen offset:0 nt lds
    buffer_load_dwordx4 v3, s[28:31], s57 offen offset:1056 nt lds
    buffer_load_dwordx4 v4, s[28:31], s57 offen offset:2112 nt lds
    buffer_load_dwordx4 v5, s[28:31], s57 offen offset:3168 nt lds
    s_add_u32 s66, s66, 8192
    s_and_b32 s66, s66, 0x3ffff
    s_add_u32 s63, s64, s66
    s_add_u32 m0, s60, 8448
    s_add_u32 s57, s63, 0
    buffer_load_dwordx4 v2, s[24:27], s57 offen offset:0 nt lds
    buffer_load_dwordx4 v3, s[24:27], s57 offen offset:1056 nt lds
    buffer_load_dwordx4 v4, s[24:27], s57 offen offset:2112 nt lds
    buffer_load_dwordx4 v5, s[24:27], s57 offen offset:3168 nt lds
    s_add_u32 m0, s60, 12672
    s_add_u32 s57, s63, 4096
    buffer_load_dwordx4 v2, s[24:27], s57 offen offset:0 nt lds
    buffer_load_dwordx4 v3, s[24:27], s57 offen offset:1056 nt lds
    buffer_load_dwordx4 v4, s[24:27], s57 offen offset:2112 nt lds
    buffer_load_dwordx4 v5, s[24:27], s57 offen offset:3168 nt lds
    s_add_u32 s60, s60, 16896
    s_cmp_ge_u32 s60, s61
    s_cselect_b32 s60, 0, s60
    s_sub_u32 s62, s62, 1
    s_cmp_lg_u32 s62, 0
    s_cbranch_scc1 L_h_loop3
    s_waitcnt vmcnt(32)
    s_barrier
    s_mov_b32 s61, 67584
    s_add_u32 m0, s60, 0
    s_add_u32 s57, s63, 0
    buffer_load_dwordx4 v2, s[28:31], s57 offen offset:0 nt lds
    buffer_load_dwordx4 v3, s[28:31], s57 offen offset:1056 nt lds
    buffer_load_dwordx4 v4, s[28:31], s57 offen offset:2112 nt lds
    buffer_load_dwordx4 v5, s[28:31], s57 offen offset:3168 nt lds
    s_add_u32 m0, s60, 4224
    s_add_u32 s57, s63, 4096
    buffer_load_dwordx4 v2, s[28:31], s57 offen offset:0 nt lds
    buffer_load_dwordx4 v3, s[28:31], s57 offen offset:1056 nt lds
    buffer_load_dwordx4 v4, s[28:31], s57 offen offset:2112 nt lds
    buffer_load_dwordx4 v5, s[28:31], s57 offen offset:3168 nt lds
    s_add_u32 s66, s66, 8192
    s_and_b32 s66, s66, 0x3ffff
    s_add_u32 s63, s64, s66
    s_add_u32 m0, s60, 8448
    s_add_u32 s57, s63, 0
    buffer_load_dwordx4 v2, s[24:27], s57 offen offset:0 nt lds
    buffer_load_dwordx4 v3, s[24:27], s57 offen offset:1056 nt lds
    buffer_load_dwordx4 v4, s[24:27], s57 offen offset:2112 nt lds
    buffer_load_dwordx4 v5, s[24:27], s57 offen offset:3168 nt lds
    s_add_u32 m0, s60, 12672
    s_add_u32 s57, s63, 4096
    buffer_load_dwordx4 v2, s[24:27], s57 offen offset:0 nt lds
    buffer_load_dwordx4 v3, s[24:27], s57 offen offset:1056 nt lds
    buffer_load_dwordx4 v4, s[24:27], s57 offen offset:2112 nt lds
    buffer_load_dwordx4 v5, s[24:27], s57 offen offset:3168 nt lds
    s_add_u32 s60, s60, 16896
    s_cmp_ge_u32 s60, s61
    s_cselect_b32 s60, 0, s60
    s_mov_b32 s62, 4
    .p2align 3
L_h_loop4:
    s_waitcnt vmcnt(32)
    s_barrier
    s_add_u32 m0, s60, 0
    s_add_u32 s57, s63, 0
    buffer_load_dwordx4 v2, s[28:31], s57 offen offset:0 nt lds
    buffer_load_dwordx4 v3, s[28:31], s57 offen offset:1056 nt lds
    buffer_load_dwordx4 v4, s[28:31], s57 offen offset:2112 nt lds
    buffer_load_dwordx4 v5, s[28:31], s57 offen offset:3168 nt lds
    s_add_u32 m0, s60, 4224
    s_add_u32 s57, s63, 4096
    buffer_load_dwordx4 v2, s[28:31], s57 offen offset:0 nt lds
    buffer_load_dwordx4 v3, s[28:31], s57 offen offset:1056 nt lds
    buffer_load_dwordx4 v4, s[28:31], s57 offen offset:2112 nt lds
    buffer_load_dwordx4 v5, s[28:31], s57 offen offset:3168 nt lds
    s_add_u32 s66, s66, 8192
    s_and_b32 s66, s66, 0x3ffff
    s_add_u32 s63, s64, s66
    s_add_u32 m0, s60, 8448
    s_add_u32 s57, s63, 0
    buffer_load_dwordx4 v2, s[24:27], s57 offen offset:0 nt lds
    buffer_load_dwordx4 v3, s[24:27], s57 offen offset:1056 nt lds
    buffer_load_dwordx4 v4, s[24:27], s57 offen offset:2112 nt lds
    buffer_load_dwordx4 v5, s[24:27], s57 offen offset:3168 nt lds
    s_add_u32 m0, s60, 12672
    s_add_u32 s57, s63, 4096
    buffer_load_dwordx4 v2, s[24:27], s57 offen offset:0 nt lds
    buffer_load_dwordx4 v3, s[24:27], s57 offen offset:1056 nt lds
    buffer_load_dwordx4 v4, s[24:27], s57 offen offset:2112 nt lds
    buffer_load_dwordx4 v5, s[24:27], s57 offen offset:3168 nt lds
    s_add_u32 s60, s60, 16896
    s_cmp_ge_u32 s60, s61
    s_cselect_b32 s60, 0, s60
    s_sub_u32 s62, s62, 1
    s_cmp_lg_u32 s62, 0
    s_cbranch_scc1 L_h_loop4
    s_waitcnt vmcnt(32)
    s_barrier
    s_add_u32 m0, s60, 0
    s_add_u32 s57, s63, 0
    buffer_load_dwordx4 v2, s[28:31], s57 offen offset:0 nt lds
    buffer_load_dwordx4 v3, s[28:31], s57 offen offset:1056 nt lds
    buffer_load_dwordx4 v4, s[28:31], s57 offen offset:2112 nt lds
    buffer_load_dwordx4 v5, s[28:31], s57 offen offset:3168 nt lds
    s_add_u32 m0, s60, 4224
    s_add_u32 s57, s63, 4096
    buffer_load_dwordx4 v2, s[28:31], s57 offen offset:0 nt lds
    buffer_load_dwordx4 v3, s[28:31], s57 offen offset:1056 nt lds
    buffer_load_dwordx4 v4, s[28:31], s57 offen offset:2112 nt lds
    buffer_load_dwordx4 v5, s[28:31], s57 offen offset:3168 nt lds
    s_add_u32 s64, s64, 1048576
    s_add_u32 s66, s66, 8192
    s_and_b32 s66, s66, 0x3ffff
    s_add_u32 s63, s64, s66
    s_add_u32 m0, s60, 8448
    s_add_u32 s57, s63, 0
    buffer_load_dwordx4 v2, s[24:27], s57 offen offset:0 nt lds
    buffer_load_dwordx4 v3, s[24:27], s57 offen offset:1056 nt lds
    buffer_load_dwordx4 v4, s[24:27], s57 offen offset:2112 nt lds
    buffer_load_dwordx4 v5, s[24:27], s57 offen offset:3168 nt lds
    s_add_u32 m0, s60, 12672
    s_add_u32 s57, s63, 4096
    buffer_load_dwordx4 v2, s[24:27], s57 offen offset:0 nt lds
    buffer_load_dwordx4 v3, s[24:27], s57 offen offset:1056 nt lds
    buffer_load_dwordx4 v4, s[24:27], s57 offen offset:2112 nt lds
    buffer_load_dwordx4 v5, s[24:27], s57 offen offset:3168 nt lds
    s_add_u32 s60, s60, 16896
    s_cmp_ge_u32 s60, s61
    s_cselect_b32 s60, 0, s60
    s_mov_b32 s62, 4
    .p2align 3
L_h_loop5:
    s_waitcnt vmcnt(32)
    s_barrier
    s_add_u32 m0, s60, 0
    s_add_u32 s57, s63, 0
    buffer_load_dwordx4 v2, s[28:31], s57 offen offset:0 nt lds
    buffer_load_dwordx4 v3, s[28:31], s57 offen offset:1056 nt lds
    buffer_load_dwordx4 v4, s[28:31], s57 offen offset:2112 nt lds
    buffer_load_dwordx4 v5, s[28:31], s57 offen offset:3168 nt lds
    s_add_u32 m0, s60, 4224
    s_add_u32 s57, s63, 4096
    buffer_load_dwordx4 v2, s[28:31], s57 offen offset:0 nt lds
    buffer_load_dwordx4 v3, s[28:31], s57 offen offset:1056 nt lds
    buffer_load_dwordx4 v4, s[28:31], s57 offen offset:2112 nt lds
    buffer_load_dwordx4 v5, s[28:31], s57 offen offset:3168 nt lds
    s_add_u32 s66, s66, 8192
    s_and_b32 s66, s66, 0x3ffff
    s_add_u32 s63, s64, s66
    s_add_u32 m0, s60, 8448
    s_add_u32 s57, s63, 0
    buffer_load_dwordx4 v2, s[24:27], s57 offen offset:0 nt lds
    buffer_load_dwordx4 v3, s[24:27], s57 offen offset:1056 nt lds
    buffer_load_dwordx4 v4, s[24:27], s57 offen offset:2112 nt lds
    buffer_load_dwordx4 v5, s[24:27], s57 offen offset:3168 nt lds
    s_add_u32 m0, s60, 12672
    s_add_u32 s57, s63, 4096
    buffer_load_dwordx4 v2, s[24:27], s57 offen offset:0 nt lds
    buffer_load_dwordx4 v3, s[24:27], s57 offen offset:1056 nt lds
    buffer_load_dwordx4 v4, s[24:27], s57 offen offset:2112 nt lds
    buffer_load_dwordx4 v5, s[24:27], s57 offen offset:3168 nt lds
    s_add_u32 s60, s60, 16896
    s_cmp_ge_u32 s60, s61
    s_cselect_b32 s60, 0, s60
    s_sub_u32 s62, s62, 1
    s_cmp_lg_u32 s62, 0
    s_cbranch_scc1 L_h_loop5
    s_waitcnt vmcnt(32)
    s_barrier
    s_add_u32 m0, s60, 0
    s_add_u32 s57, s63, 0
    buffer_load_dwordx4 v2, s[28:31], s57 offen offset:0 nt lds
    buffer_load_dwordx4 v3, s[28:31], s57 offen offset:1056 nt lds
    buffer_load_dwordx4 v4, s[28:31], s57 offen offset:2112 nt lds
    buffer_load_dwordx4 v5, s[28:31], s57 offen offset:3168 nt lds
    s_add_u32 m0, s60, 4224
    s_add_u32 s57, s63, 4096
    buffer_load_dwordx4 v2, s[28:31], s57 offen offset:0 nt lds
    buffer_load_dwordx4 v3, s[28:31], s57 offen offset:1056 nt lds
    buffer_load_dwordx4 v4, s[28:31], s57 offen offset:2112 nt lds
    buffer_load_dwordx4 v5, s[28:31], s57 offen offset:3168 nt lds
    s_add_u32 s66, s66, 8192
    s_and_b32 s66, s66, 0x3ffff
    s_add_u32 s63, s64, s66
    s_add_u32 m0, s60, 8448
    s_add_u32 s57, s63, 0
    buffer_load_dwordx4 v2, s[24:27], s57 offen offset:0 nt lds
    buffer_load_dwordx4 v3, s[24:27], s57 offen offset:1056 nt lds
    buffer_load_dwordx4 v4, s[24:27], s57 offen offset:2112 nt lds
    buffer_load_dwordx4 v5, s[24:27], s57 offen offset:3168 nt lds
    s_add_u32 m0, s60, 12672
    s_add_u32 s57, s63, 4096
    buffer_load_dwordx4 v2, s[24:27], s57 offen offset:0 nt lds
    buffer_load_dwordx4 v3, s[24:27], s57 offen offset:1056 nt lds
    buffer_load_dwordx4 v4, s[24:27], s57 offen offset:2112 nt lds
    buffer_load_dwordx4 v5, s[24:27], s57 offen offset:3168 nt lds
    s_add_u32 s60, s60, 16896
    s_cmp_ge_u32 s60, s61
    s_cselect_b32 s60, 0, s60
    s_mov_b32 m0, 67584
    s_add_u32 s57, s75, 0
    buffer_load_dwordx4 v6, s[36:39], s57 offen offset:0 lds
    buffer_load_dwordx4 v7, s[36:39], s57 offen offset:1056 lds
    buffer_load_dwordx4 v8, s[36:39], s57 offen offset:2112 lds
    buffer_load_dwordx4 v9, s[36:39], s57 offen offset:3168 lds
    s_mov_b32 m0, 71808
    s_add_u32 s57, s75, 4096
    buffer_load_dwordx4 v6, s[36:39], s57 offen offset:0 lds
    buffer_load_dwordx4 v7, s[36:39], s57 offen offset:1056 lds
    buffer_load_dwordx4 v8, s[36:39], s57 offen offset:2112 lds
    buffer_load_dwordx4 v9, s[36:39], s57 offen offset:3168 lds
    s_mov_b32 m0, 76032
    s_add_u32 s57, s75, 32768
    buffer_load_dwordx4 v6, s[36:39], s57 offen offset:0 lds
    buffer_load_dwordx4 v7, s[36:39], s57 offen offset:1056 lds
    buffer_load_dwordx4 v8, s[36:39], s57 offen offset:2112 lds
    buffer_load_dwordx4 v9, s[36:39], s57 offen offset:3168 lds
    s_mov_b32 m0, 80256
    s_add_u32 s57, s75, 36864
    buffer_load_dwordx4 v6, s[36:39], s57 offen offset:0 lds
    buffer_load_dwordx4 v7, s[36:39], s57 offen offset:1056 lds
    buffer_load_dwordx4 v8, s[36:39], s57 offen offset:2112 lds
    buffer_load_dwordx4 v9, s[36:39], s57 offen offset:3168 lds
    s_waitcnt vmcnt(48)
    s_barrier
    s_add_u32 m0, s60, 0
    s_add_u32 s57, s63, 0
    buffer_load_dwordx4 v2, s[28:31], s57 offen offset:0 nt lds
    buffer_load_dwordx4 v3, s[28:31], s57 offen offset:1056 nt lds
    buffer_load_dwordx4 v4, s[28:31], s57 offen offset:2112 nt lds
    buffer_load_dwordx4 v5, s[28:31], s57 offen offset:3168 nt lds
    s_add_u32 m0, s60, 4224
    s_add_u32 s57, s63, 4096
    buffer_load_dwordx4 v2, s[28:31], s57 offen offset:0 nt lds
    buffer_load_dwordx4 v3, s[28:31], s57 offen offset:1056 nt lds
    buffer_load_dwordx4 v4, s[28:31], s57 offen offset:2112 nt lds
    buffer_load_dwordx4 v5, s[28:31], s57 offen offset:3168 nt lds
    s_add_u32 s66, s66, 8192
    s_and_b32 s66, s66, 0x3ffff
    s_add_u32 s63, s64, s66
    s_add_u32 m0, s60, 8448
    s_add_u32 s57, s63, 0
    buffer_load_dwordx4 v2, s[24:27], s57 offen offset:0 nt lds
    buffer_load_dwordx4 v3, s[24:27], s57 offen offset:1056 nt lds
    buffer_load_dwordx4 v4, s[24:27], s57 offen offset:2112 nt lds
    buffer_load_dwordx4 v5, s[24:27], s57 offen offset:3168 nt lds
    s_add_u32 m0, s60, 12672
    s_add_u32 s57, s63, 4096
    buffer_load_dwordx4 v2, s[24:27], s57 offen offset:0 nt lds
    buffer_load_dwordx4 v3, s[24:27], s57 offen offset:1056 nt lds
    buffer_load_dwordx4 v4, s[24:27], s57 offen offset:2112 nt lds
    buffer_load_dwordx4 v5, s[24:27], s57 offen offset:3168 nt lds
    s_add_u32 s60, s60, 16896
    s_cmp_ge_u32 s60, s61
    s_cselect_b32 s60, 0, s60
    s_mov_b32 m0, 84480
    s_add_u32 s57, s75, 65536
    buffer_load_dwordx4 v6, s[36:39], s57 offen offset:0 lds
    buffer_load_dwordx4 v7, s[36:39], s57 offen offset:1056 lds
    buffer_load_dwordx4 v8, s[36:39], s57 offen offset:2112 lds
    buffer_load_dwordx4 v9, s[36:39], s57 offen offset:3168 lds
    s_mov_b32 m0, 88704
    s_add_u32 s57, s75, 69632
    buffer_load_dwordx4 v6, s[36:39], s57 offen offset:0 lds
    buffer_load_dwordx4 v7, s[36:39], s57 offen offset:1056 lds
    buffer_load_dwordx4 v8, s[36:39], s57 offen offset:2112 lds
    buffer_load_dwordx4 v9, s[36:39], s57 offen offset:3168 lds
    s_mov_b32 m0, 92928
    s_add_u32 s57, s75, 98304
    buffer_load_dwordx4 v6, s[36:39], s57 offen offset:0 lds
    buffer_load_dwordx4 v7, s[36:39], s57 offen offset:1056 lds
    buffer_load_dwordx4 v8, s[36:39], s57 offen offset:2112 lds
    buffer_load_dwordx4 v9, s[36:39], s57 offen offset:3168 lds
    s_mov_b32 m0, 97152
    s_add_u32 s57, s75, 102400
    buffer_load_dwordx4 v6, s[36:39], s57 offen offset:0 lds
    buffer_load_dwordx4 v7, s[36:39], s57 offen offset:1056 lds
    buffer_load_dwordx4 v8, s[36:39], s57 offen offset:2112 lds
    buffer_load_dwordx4 v9, s[36:39], s57 offen offset:3168 lds
    s_waitcnt vmcnt(63)
    s_barrier
    s_add_u32 m0, s60, 0
    s_add_u32 s57, s63, 0
    buffer_load_dwordx4 v2, s[28:31], s57 offen offset:0 nt lds
    buffer_load_dwordx4 v3, s[28:31], s57 offen offset:1056 nt lds
    buffer_load_dwordx4 v4, s[28:31], s57 offen offset:2112 nt lds
    buffer_load_dwordx4 v5, s[28:31], s57 offen offset:3168 nt lds
    s_add_u32 m0, s60, 4224
    s_add_u32 s57, s63, 4096
    buffer_load_dwordx4 v2, s[28:31], s57 offen offset:0 nt lds
    buffer_load_dwordx4 v3, s[28:31], s57 offen offset:1056 nt lds
    buffer_load_dwordx4 v4, s[28:31], s57 offen offset:2112 nt lds
    buffer_load_dwordx4 v5, s[28:31], s57 offen offset:3168 nt lds
    s_add_u32 s66, s66, 8192
    s_and_b32 s66, s66, 0x3ffff
    s_add_u32 s63, s64, s66
    s_add_u32 m0, s60, 8448
    s_add_u32 s57, s63, 0
    buffer_load_dwordx4 v2, s[24:27], s57 offen offset:0 nt lds
    buffer_load_dwordx4 v3, s[24:27], s57 offen offset:1056 nt lds
    buffer_load_dwordx4 v4, s[24:27], s57 offen offset:2112 nt lds
    buffer_load_dwordx4 v5, s[24:27], s57 offen offset:3168 nt lds
    s_add_u32 m0, s60, 12672
    s_add_u32 s57, s63, 4096
    buffer_load_dwordx4 v2, s[24:27], s57 offen offset:0 nt lds
    buffer_load_dwordx4 v3, s[24:27], s57 offen offset:1056 nt lds
    buffer_load_dwordx4 v4, s[24:27], s57 offen offset:2112 nt lds
    buffer_load_dwordx4 v5, s[24:27], s57 offen offset:3168 nt lds
    s_add_u32 s60, s60, 16896
    s_cmp_ge_u32 s60, s61
    s_cselect_b32 s60, 0, s60
    s_mov_b32 m0, 101376
    s_add_u32 s57, s76, 0
    buffer_load_dwordx4 v6, s[36:39], s57 offen offset:0 lds
    buffer_load_dwordx4 v7, s[36:39], s57 offen offset:1056 lds
    buffer_load_dwordx4 v8, s[36:39], s57 offen offset:2112 lds
    buffer_load_dwordx4 v9, s[36:39], s57 offen offset:3168 lds
    s_mov_b32 m0, 105600
    s_add_u32 s57, s76, 4096
    buffer_load_dwordx4 v6, s[36:39], s57 offen offset:0 lds
    buffer_load_dwordx4 v7, s[36:39], s57 offen offset:1056 lds
    buffer_load_dwordx4 v8, s[36:39], s57 offen offset:2112 lds
    buffer_load_dwordx4 v9, s[36:39], s57 offen offset:3168 lds
    s_mov_b32 m0, 109824
    s_add_u32 s57, s76, 32768
    buffer_load_dwordx4 v6, s[36:39], s57 offen offset:0 lds
    buffer_load_dwordx4 v7, s[36:39], s57 offen offset:1056 lds
    buffer_load_dwordx4 v8, s[36:39], s57 offen offset:2112 lds
    buffer_load_dwordx4 v9, s[36:39], s57 offen offset:3168 lds
    s_mov_b32 m0, 114048
    s_add_u32 s57, s76, 36864
    buffer_load_dwordx4 v6, s[36:39], s57 offen offset:0 lds
    buffer_load_dwordx4 v7, s[36:39], s57 offen offset:1056 lds
    buffer_load_dwordx4 v8, s[36:39], s57 offen offset:2112 lds
    buffer_load_dwordx4 v9, s[36:39], s57 offen offset:3168 lds
    s_add_u32 s58, s80, 0
    buffer_load_dwordx4 a[112:115], v5, s[40:43], s58 offen offset:0 sc1
    s_add_u32 s58, s80, 4096
    buffer_load_dwordx4 a[116:119], v5, s[40:43], s58 offen offset:0 sc1
    s_add_u32 s58, s80, 8192
    buffer_load_dwordx4 a[120:123], v5, s[40:43], s58 offen offset:0 sc1
    s_add_u32 s58, s80, 12288
    buffer_load_dwordx4 a[124:127], v5, s[40:43], s58 offen offset:0 sc1
    s_add_u32 s58, s80, 16384
    buffer_load_dwordx4 a[128:131], v5, s[40:43], s58 offen offset:0 sc1
    s_add_u32 s58, s80, 20480
    buffer_load_dwordx4 a[132:135], v5, s[40:43], s58 offen offset:0 sc1
    s_add_u32 s58, s80, 24576
    buffer_load_dwordx4 a[136:139], v5, s[40:43], s58 offen offset:0 sc1
    s_add_u32 s58, s80, 28672
    buffer_load_dwordx4 a[140:143], v5, s[40:43], s58 offen offset:0 sc1
    s_add_u32 s58, s80, 32768
    buffer_load_dwordx4 a[144:147], v5, s[40:43], s58 offen offset:0 sc1
    s_add_u32 s58, s80, 0
    buffer_load_dwordx4 a[148:151], v5, s[40:43], s58 offen offset:1024 sc1
    s_add_u32 s58, s80, 4096
    buffer_load_dwordx4 a[152:155], v5, s[40:43], s58 offen offset:1024 sc1
    s_add_u32 s58, s80, 8192
    buffer_load_dwordx4 a[156:159], v5, s[40:43], s58 offen offset:1024 sc1
    s_add_u32 s58, s80, 12288
    buffer_load_dwordx4 a[160:163], v5, s[40:43], s58 offen offset:1024 sc1
    s_add_u32 s58, s80, 16384
    buffer_load_dwordx4 a[164:167], v5, s[40:43], s58 offen offset:1024 sc1
    s_add_u32 s58, s80, 20480
    buffer_load_dwordx4 a[168:171], v5, s[40:43], s58 offen offset:1024 sc1
    s_add_u32 s58, s80, 24576
    buffer_load_dwordx4 a[172:175], v5, s[40:43], s58 offen offset:1024 sc1
    s_add_u32 s58, s80, 28672
    buffer_load_dwordx4 a[176:179], v5, s[40:43], s58 offen offset:1024 sc1
    s_add_u32 s58, s80, 32768
    buffer_load_dwordx4 a[180:183], v5, s[40:43], s58 offen offset:1024 sc1
    s_waitcnt vmcnt(63)
    s_barrier
    s_add_u32 m0, s60, 0
    s_add_u32 s57, s63, 0
    buffer_load_dwordx4 v2, s[28:31], s57 offen offset:0 nt lds
    buffer_load_dwordx4 v3, s[28:31], s57 offen offset:1056 nt lds
    buffer_load_dwordx4 v4, s[28:31], s57 offen offset:2112 nt lds
    buffer_load_dwordx4 v5, s[28:31], s57 offen offset:3168 nt lds
    s_add_u32 m0, s60, 4224
    s_add_u32 s57, s63, 4096
    buffer_load_dwordx4 v2, s[28:31], s57 offen offset:0 nt lds
    buffer_load_dwordx4 v3, s[28:31], s57 offen offset:1056 nt lds
    buffer_load_dwordx4 v4, s[28:31], s57 offen offset:2112 nt lds
    buffer_load_dwordx4 v5, s[28:31], s57 offen offset:3168 nt lds
    s_add_u32 s66, s66, 8192
    s_and_b32 s66, s66, 0x3ffff
    s_add_u32 s63, s64, s66
    s_add_u32 m0, s60, 8448
    s_add_u32 s57, s63, 0
    buffer_load_dwordx4 v2, s[24:27], s57 offen offset:0 nt lds
    buffer_load_dwordx4 v3, s[24:27], s57 offen offset:1056 nt lds
    buffer_load_dwordx4 v4, s[24:27], s57 offen offset:2112 nt lds
    buffer_load_dwordx4 v5, s[24:27], s57 offen offset:3168 nt lds
    s_add_u32 m0, s60, 12672
    s_add_u32 s57, s63, 4096
    buffer_load_dwordx4 v2, s[24:27], s57 offen offset:0 nt lds
    buffer_load_dwordx4 v3, s[24:27], s57 offen offset:1056 nt lds
    buffer_load_dwordx4 v4, s[24:27], s57 offen offset:2112 nt lds
    buffer_load_dwordx4 v5, s[24:27], s57 offen offset:3168 nt lds
    s_add_u32 s60, s60, 16896
    s_cmp_ge_u32 s60, s61
    s_cselect_b32 s60, 0, s60
    s_add_u32 s58, s80, 0
    buffer_load_dwordx4 a[184:187], v5, s[40:43], s58 offen offset:2048 sc1
    s_add_u32 s58, s80, 4096
    buffer_load_dwordx4 a[188:191], v5, s[40:43], s58 offen offset:2048 sc1
    s_add_u32 s58, s80, 8192
    buffer_load_dwordx4 a[192:195], v5, s[40:43], s58 offen offset:2048 sc1
    s_add_u32 s58, s80, 12288
    buffer_load_dwordx4 a[196:199], v5, s[40:43], s58 offen offset:2048 sc1
    s_add_u32 s58, s80, 16384
    buffer_load_dwordx4 a[200:203], v5, s[40:43], s58 offen offset:2048 sc1
    s_add_u32 s58, s80, 20480
    buffer_load_dwordx4 a[204:207], v5, s[40:43], s58 offen offset:2048 sc1
    s_add_u32 s58, s80, 24576
    buffer_load_dwordx4 a[208:211], v5, s[40:43], s58 offen offset:2048 sc1
    s_add_u32 s58, s80, 28672
    buffer_load_dwordx4 a[212:215], v5, s[40:43], s58 offen offset:2048 sc1
    s_add_u32 s58, s80, 32768
    buffer_load_dwordx4 a[216:219], v5, s[40:43], s58 offen offset:2048 sc1
    s_mov_b64 exec, 7
    buffer_load_dword v14, v5, s[40:43], s87 offen sc1
    s_mov_b64 exec, -1
    ds_read_b64_tr_b16 a[48:49], v10 offset:0
    ds_read_b64_tr_b16 a[50:51], v10 offset:512
    ds_read_b64_tr_b16 a[52:53], v10 offset:32
    ds_read_b64_tr_b16 a[54:55], v10 offset:544
    ds_read_b64_tr_b16 a[56:57], v10 offset:64
    ds_read_b64_tr_b16 a[58:59], v10 offset:576
    ds_read_b64_tr_b16 a[60:61], v10 offset:96
    ds_read_b64_tr_b16 a[62:63], v10 offset:608
    ds_read_b64_tr_b16 a[64:65], v10 offset:128
    ds_read_b64_tr_b16 a[66:67], v10 offset:640
    ds_read_b64_tr_b16 a[68:69], v10 offset:160
    ds_read_b64_tr_b16 a[70:71], v10 offset:672
    ds_read_b64_tr_b16 a[72:73], v10 offset:192
    ds_read_b64_tr_b16 a[74:75], v10 offset:704
    ds_read_b64_tr_b16 a[76:77], v10 offset:224
    ds_read_b64_tr_b16 a[78:79], v10 offset:736
    s_barrier
    s_waitcnt vmcnt(35) lgkmcnt(0)
    v_mfma_f32_16x16x32_bf16 v[16:19], a[48:51], a[112:115], 0
    ds_read_b64_tr_b16 a[80:81], v10 offset:8448
    v_mfma_f32_16x16x32_bf16 v[48:51], a[48:51], a[116:119], 0
    s_add_u32 m0, s60, 0
    ds_read_b64_tr_b16 a[82:83], v10 offset:8960
    v_mfma_f32_16x16x32_bf16 v[80:83], a[48:51], a[120:123], 0
    s_add_u32 s57, s63, 0
    buffer_load_dwordx4 v2, s[28:31], s57 offen offset:0 nt lds
    v_mfma_f32_16x16x32_bf16 v[112:115], a[48:51], a[124:127], 0
    s_add_u32 s58, s80, 0
    ds_read_b64_tr_b16 a[84:85], v10 offset:8480
    v_mfma_f32_16x16x32_bf16 v[144:147], a[48:51], a[128:131], 0
    buffer_load_dwordx4 a[220:223], v5, s[40:43], s58 offen offset:3072 sc1
    v_mfma_f32_16x16x32_bf16 v[176:179], a[48:51], a[132:135], 0
    s_add_u32 s58, s80, 4096
    ds_read_b64_tr_b16 a[86:87], v10 offset:8992
    v_mfma_f32_16x16x32_bf16 v[208:211], a[48:51], a[136:139], 0
    buffer_load_dwordx4 v3, s[28:31], s57 offen offset:1056 nt lds
    v_mfma_f32_16x16x32_bf16 v[240:243], a[48:51], a[140:143], 0
    ds_read_b64_tr_b16 a[88:89], v10 offset:8512
    v_mfma_f32_16x16x32_bf16 a[16:19], a[48:51], a[144:147], 0
    buffer_load_dwordx4 a[224:227], v5, s[40:43], s58 offen offset:3072 sc1
    v_mfma_f32_16x16x32_bf16 v[20:23], a[52:55], a[112:115], 0
    s_add_u32 s58, s80, 8192
    ds_read_b64_tr_b16 a[90:91], v10 offset:9024
    v_mfma_f32_16x16x32_bf16 v[52:55], a[52:55], a[116:119], 0
    buffer_load_dwordx4 v4, s[28:31], s57 offen offset:2112 nt lds
    v_mfma_f32_16x16x32_bf16 v[84:87], a[52:55], a[120:123], 0
    ds_read_b64_tr_b16 a[92:93], v10 offset:8544
    v_mfma_f32_16x16x32_bf16 v[116:119], a[52:55], a[124:127], 0
    ds_read_b64_tr_b16 a[94:95], v10 offset:9056
    v_mfma_f32_16x16x32_bf16 v[148:151], a[52:55], a[128:131], 0
    buffer_load_dwordx4 v5, s[28:31], s57 offen offset:3168 nt lds
    v_mfma_f32_16x16x32_bf16 v[180:183], a[52:55], a[132:135], 0
    s_add_u32 m0, s60, 4224
    ds_read_b64_tr_b16 a[96:97], v10 offset:8576
    v_mfma_f32_16x16x32_bf16 v[212:215], a[52:55], a[136:139], 0
    s_add_u32 s57, s63, 4096
    buffer_load_dwordx4 a[228:231], v5, s[40:43], s58 offen offset:3072 sc1
    v_mfma_f32_16x16x32_bf16 v[244:247], a[52:55], a[140:143], 0
    s_add_u32 s58, s80, 12288
    ds_read_b64_tr_b16 a[98:99], v10 offset:9088
    v_mfma_f32_16x16x32_bf16 a[20:23], a[52:55], a[144:147], 0
    buffer_load_dwordx4 v2, s[28:31], s57 offen offset:0 nt lds
    v_mfma_f32_16x16x32_bf16 v[24:27], a[56:59], a[112:115], 0
    ds_read_b64_tr_b16 a[100:101], v10 offset:8608
    v_mfma_f32_16x16x32_bf16 v[56:59], a[56:59], a[116:119], 0
    ds_read_b64_tr_b16 a[102:103], v10 offset:9120
    v_mfma_f32_16x16x32_bf16 v[88:91], a[56:59], a[120:123], 0
    ds_read_b64_tr_b16 a[104:105], v10 offset:8640
    v_mfma_f32_16x16x32_bf16 v[120:123], a[56:59], a[124:127], 0
    buffer_load_dwordx4 a[232:235], v5, s[40:43], s58 offen offset:3072 sc1
    v_mfma_f32_16x16x32_bf16 v[152:155], a[56:59], a[128:131], 0
    s_add_u32 s58, s80, 16384
    ds_read_b64_tr_b16 a[106:107], v10 offset:9152
    v_mfma_f32_16x16x32_bf16 v[184:187], a[56:59], a[132:135], 0
    buffer_load_dwordx4 v3, s[28:31], s57 offen offset:1056 nt lds
    v_mfma_f32_16x16x32_bf16 v[216:219], a[56:59], a[136:139], 0
    ds_read_b64_tr_b16 a[108:109], v10 offset:8672
    v_mfma_f32_16x16x32_bf16 v[248:251], a[56:59], a[140:143], 0
    ds_read_b64_tr_b16 a[110:111], v10 offset:9184
    v_mfma_f32_16x16x32_bf16 a[24:27], a[56:59], a[144:147], 0
    buffer_load_dwordx4 v4, s[28:31], s57 offen offset:2112 nt lds
    v_mfma_f32_16x16x32_bf16 v[28:31], a[60:63], a[112:115], 0
    v_mfma_f32_16x16x32_bf16 v[60:63], a[60:63], a[116:119], 0
    buffer_load_dwordx4 a[236:239], v5, s[40:43], s58 offen offset:3072 sc1
    v_mfma_f32_16x16x32_bf16 v[92:95], a[60:63], a[120:123], 0
    s_add_u32 s58, s80, 20480
    v_mfma_f32_16x16x32_bf16 v[124:127], a[60:63], a[124:127], 0
    buffer_load_dwordx4 v5, s[28:31], s57 offen offset:3168 nt lds
    v_mfma_f32_16x16x32_bf16 v[156:159], a[60:63], a[128:131], 0
    s_add_u32 s66, s66, 8192
    v_mfma_f32_16x16x32_bf16 v[188:191], a[60:63], a[132:135], 0
    s_and_b32 s66, s66, 0x3ffff
    v_mfma_f32_16x16x32_bf16 v[220:223], a[60:63], a[136:139], 0
    s_add_u32 s63, s64, s66
    v_mfma_f32_16x16x32_bf16 v[252:255], a[60:63], a[140:143], 0
    s_add_u32 m0, s60, 8448
    v_mfma_f32_16x16x32_bf16 a[28:31], a[60:63], a[144:147], 0
    s_add_u32 s57, s63, 0
    buffer_load_dwordx4 v2, s[24:27], s57 offen offset:0 nt lds
    v_mfma_f32_16x16x32_bf16 v[32:35], a[64:67], a[112:115], 0
    v_mfma_f32_16x16x32_bf16 v[64:67], a[64:67], a[116:119], 0
    buffer_load_dwordx4 a[240:243], v5, s[40:43], s58 offen offset:3072 sc1
    v_mfma_f32_16x16x32_bf16 v[96:99], a[64:67], a[120:123], 0
    s_add_u32 s58, s80, 24576
    v_mfma_f32_16x16x32_bf16 v[128:131], a[64:67], a[124:127], 0
    buffer_load_dwordx4 v3, s[24:27], s57 offen offset:1056 nt lds
    v_mfma_f32_16x16x32_bf16 v[160:163], a[64:67], a[128:131], 0
    v_mfma_f32_16x16x32_bf16 v[192:195], a[64:67], a[132:135], 0
    v_mfma_f32_16x16x32_bf16 v[224:227], a[64:67], a[136:139], 0
    buffer_load_dwordx4 a[244:247], v5, s[40:43], s58 offen offset:3072 sc1
    v_mfma_f32_16x16x32_bf16 a[0:3], a[64:67], a[140:143], 0
    s_add_u32 s58, s80, 28672
    v_mfma_f32_16x16x32_bf16 a[32:35], a[64:67], a[144:147], 0
    buffer_load_dwordx4 v4, s[24:27], s57 offen offset:2112 nt lds
    v_mfma_f32_16x16x32_bf16 v[36:39], a[68:71], a[112:115], 0
    v_mfma_f32_16x16x32_bf16 v[68:71], a[68:71], a[116:119], 0
    v_mfma_f32_16x16x32_bf16 v[100:103], a[68:71], a[120:123], 0
    v_mfma_f32_16x16x32_bf16 v[132:135], a[68:71], a[124:127], 0
    buffer_load_dwordx4 v5, s[24:27], s57 offen offset:3168 nt lds
    v_mfma_f32_16x16x32_bf16 v[164:167], a[68:71], a[128:131], 0
    s_add_u32 m0, s60, 12672
    v_mfma_f32_16x16x32_bf16 v[196:199], a[68:71], a[132:135], 0
    s_add_u32 s57, s63, 4096
    buffer_load_dwordx4 a[248:251], v5, s[40:43], s58 offen offset:3072 sc1
    v_mfma_f32_16x16x32_bf16 v[228:231], a[68:71], a[136:139], 0
    s_add_u32 s58, s80, 32768
    v_mfma_f32_16x16x32_bf16 a[4:7], a[68:71], a[140:143], 0
    buffer_load_dwordx4 v2, s[24:27], s57 offen offset:0 nt lds
    v_mfma_f32_16x16x32_bf16 a[36:39], a[68:71], a[144:147], 0
    v_mfma_f32_16x16x32_bf16 v[40:43], a[72:75], a[112:115], 0
    v_mfma_f32_16x16x32_bf16 v[72:75], a[72:75], a[116:119], 0
    v_mfma_f32_16x16x32_bf16 v[104:107], a[72:75], a[120:123], 0
    buffer_load_dwordx4 v3, s[24:27], s57 offen offset:1056 nt lds
    v_mfma_f32_16x16x32_bf16 v[136:139], a[72:75], a[124:127], 0
    v_mfma_f32_16x16x32_bf16 v[168:171], a[72:75], a[128:131], 0
    buffer_load_dwordx4 a[252:255], v5, s[40:43], s58 offen offset:3072 sc1
    v_mfma_f32_16x16x32_bf16 v[200:203], a[72:75], a[132:135], 0
    v_mfma_f32_16x16x32_bf16 v[232:235], a[72:75], a[136:139], 0
    v_mfma_f32_16x16x32_bf16 a[8:11], a[72:75], a[140:143], 0
    buffer_load_dwordx4 v4, s[24:27], s57 offen offset:2112 nt lds
    v_mfma_f32_16x16x32_bf16 a[40:43], a[72:75], a[144:147], 0
    v_mfma_f32_16x16x32_bf16 v[44:47], a[76:79], a[112:115], 0
    v_mfma_f32_16x16x32_bf16 v[76:79], a[76:79], a[116:119], 0
    v_mfma_f32_16x16x32_bf16 v[108:111], a[76:79], a[120:123], 0
    buffer_load_dwordx4 v5, s[24:27], s57 offen offset:3168 nt lds
    v_mfma_f32_16x16x32_bf16 v[140:143], a[76:79], a[124:127], 0
    s_add_u32 s60, s60, 16896
    v_mfma_f32_16x16x32_bf16 v[172:175], a[76:79], a[128:131], 0
    s_cmp_ge_u32 s60, s61
    v_mfma_f32_16x16x32_bf16 v[204:207], a[76:79], a[132:135], 0
    s_cselect_b32 s60, 0, s60
    v_mfma_f32_16x16x32_bf16 v[236:239], a[76:79], a[136:139], 0
    v_mfma_f32_16x16x32_bf16 a[12:15], a[76:79], a[140:143], 0
    v_mfma_f32_16x16x32_bf16 a[44:47], a[76:79], a[144:147], 0
    s_barrier
    s_waitcnt vmcnt(51) lgkmcnt(0)
    s_waitcnt vmcnt(25)
    v_cmp_eq_u32 vcc, 1, v14
    s_nop 1
    s_and_b32 s56, vcc_lo, 7
    s_cmp_eq_u32 s56, 7
    s_cbranch_scc1 L_hf1_ok
    s_mov_b32 s72, 131072
L_hf1_lp:
    s_mov_b64 exec, 7
    buffer_load_dword v14, v5, s[40:43], s87 offen sc1
    s_mov_b64 exec, -1
    s_waitcnt vmcnt(0)
    v_cmp_eq_u32 vcc, 1, v14
    s_nop 1
    s_and_b32 s56, vcc_lo, 7
    s_cmp_eq_u32 s56, 7
    s_cbranch_scc1 L_hf1_ok
    s_sub_u32 s72, s72, 1
    s_cmp_lg_u32 s72, 0
    s_cbranch_scc1 L_hf1_lp
L_hf1_ok:
    v_mfma_f32_16x16x32_bf16 v[16:19], a[80:83], a[148:151], v[16:19]
    ds_read_b64_tr_b16 a[48:49], v10 offset:16896
    v_mfma_f32_16x16x32_bf16 v[48:51], a[80:83], a[152:155], v[48:51]
    s_add_u32 m0, s60, 0
    ds_read_b64_tr_b16 a[50:51], v10 offset:17408
    v_mfma_f32_16x16x32_bf16 v[80:83], a[80:83], a[156:159], v[80:83]
    s_add_u32 s57, s63, 0
    buffer_load_dwordx4 v2, s[28:31], s57 offen offset:0 nt lds
    v_mfma_f32_16x16x32_bf16 v[112:115], a[80:83], a[160:163], v[112:115]
    s_add_u32 s58, s81, 0
    ds_read_b64_tr_b16 a[52:53], v10 offset:16928
    v_mfma_f32_16x16x32_bf16 v[144:147], a[80:83], a[164:167], v[144:147]
    buffer_load_dwordx4 a[112:115], v5, s[40:43], s58 offen offset:0 sc1
    v_mfma_f32_16x16x32_bf16 v[176:179], a[80:83], a[168:171], v[176:179]
    s_add_u32 s58, s81, 4096
    ds_read_b64_tr_b16 a[54:55], v10 offset:17440
    v_mfma_f32_16x16x32_bf16 v[208:211], a[80:83], a[172:175], v[208:211]
    buffer_load_dwordx4 v3, s[28:31], s57 offen offset:1056 nt lds
    v_mfma_f32_16x16x32_bf16 v[240:243], a[80:83], a[176:179], v[240:243]
    ds_read_b64_tr_b16 a[56:57], v10 offset:16960
    v_mfma_f32_16x16x32_bf16 a[16:19], a[80:83], a[180:183], a[16:19]
    buffer_load_dwordx4 v4, s[28:31], s57 offen offset:2112 nt lds
    v_mfma_f32_16x16x32_bf16 v[20:23], a[84:87], a[148:151], v[20:23]
    ds_read_b64_tr_b16 a[58:59], v10 offset:17472
    v_mfma_f32_16x16x32_bf16 v[52:55], a[84:87], a[152:155], v[52:55]
    buffer_load_dwordx4 v5, s[28:31], s57 offen offset:3168 nt lds
    v_mfma_f32_16x16x32_bf16 v[84:87], a[84:87], a[156:159], v[84:87]
    s_mov_b32 m0, 67584
    ds_read_b64_tr_b16 a[60:61], v10 offset:16992
    v_mfma_f32_16x16x32_bf16 v[116:119], a[84:87], a[160:163], v[116:119]
    s_add_u32 s57, s76, 65536
    buffer_load_dwordx4 v6, s[36:39], s57 offen offset:0 lds
    v_mfma_f32_16x16x32_bf16 v[148:151], a[84:87], a[164:167], v[148:151]
    ds_read_b64_tr_b16 a[62:63], v10 offset:17504
    v_mfma_f32_16x16x32_bf16 v[180:183], a[84:87], a[168:171], v[180:183]
    buffer_load_dwordx4 a[116:119], v5, s[40:43], s58 offen offset:0 sc1
    v_mfma_f32_16x16x32_bf16 v[212:215], a[84:87], a[172:175], v[212:215]
    s_add_u32 s58, s81, 8192
    ds_read_b64_tr_b16 a[64:65], v10 offset:17024
    v_mfma_f32_16x16x32_bf16 v[244:247], a[84:87], a[176:179], v[244:247]
    buffer_load_dwordx4 v7, s[36:39], s57 offen offset:1056 lds
    v_mfma_f32_16x16x32_bf16 a[20:23], a[84:87], a[180:183], a[20:23]
    ds_read_b64_tr_b16 a[66:67], v10 offset:17536
    v_mfma_f32_16x16x32_bf16 v[24:27], a[88:91], a[148:151], v[24:27]
    buffer_load_dwordx4 a[120:123], v5, s[40:43], s58 offen offset:0 sc1
    v_mfma_f32_16x16x32_bf16 v[56:59], a[88:91], a[152:155], v[56:59]
    s_add_u32 s58, s81, 12288
    ds_read_b64_tr_b16 a[68:69], v10 offset:17056
    v_mfma_f32_16x16x32_bf16 v[88:91], a[88:91], a[156:159], v[88:91]
    buffer_load_dwordx4 v8, s[36:39], s57 offen offset:2112 lds
    v_mfma_f32_16x16x32_bf16 v[120:123], a[88:91], a[160:163], v[120:123]
    ds_read_b64_tr_b16 a[70:71], v10 offset:17568
    v_mfma_f32_16x16x32_bf16 v[152:155], a[88:91], a[164:167], v[152:155]
    buffer_load_dwordx4 v9, s[36:39], s57 offen offset:3168 lds
    v_mfma_f32_16x16x32_bf16 v[184:187], a[88:91], a[168:171], v[184:187]
    s_add_u32 m0, s60, 4224
    ds_read_b64_tr_b16 a[72:73], v10 offset:17088
    v_mfma_f32_16x16x32_bf16 v[216:219], a[88:91], a[172:175], v[216:219]
    s_add_u32 s57, s63, 4096
    buffer_load_dwordx4 v2, s[28:31], s57 offen offset:0 nt lds
    v_mfma_f32_16x16x32_bf16 v[248:251], a[88:91], a[176:179], v[248:251]
    ds_read_b64_tr_b16 a[74:75], v10 offset:17600
    v_mfma_f32_16x16x32_bf16 a[24:27], a[88:91], a[180:183], a[24:27]
    buffer_load_dwordx4 v3, s[28:31], s57 offen offset:1056 nt lds
    v_mfma_f32_16x16x32_bf16 v[28:31], a[92:95], a[148:151], v[28:31]
    ds_read_b64_tr_b16 a[76:77], v10 offset:17120
    v_mfma_f32_16x16x32_bf16 v[60:63], a[92:95], a[152:155], v[60:63]
    buffer_load_dwordx4 a[124:127], v5, s[40:43], s58 offen offset:0 sc1
    v_mfma_f32_16x16x32_bf16 v[92:95], a[92:95], a[156:159], v[92:95]
    s_add_u32 s58, s81, 16384
    ds_read_b64_tr_b16 a[78:79], v10 offset:17632
    v_mfma_f32_16x16x32_bf16 v[124:127], a[92:95], a[160:163], v[124:127]
    buffer_load_dwordx4 v4, s[28:31], s57 offen offset:2112 nt lds
    v_mfma_f32_16x16x32_bf16 v[156:159], a[92:95], a[164:167], v[156:159]
    v_mfma_f32_16x16x32_bf16 v[188:191], a[92:95], a[168:171], v[188:191]
    buffer_load_dwordx4 a[128:131], v5, s[40:43], s58 offen offset:0 sc1
    v_mfma_f32_16x16x32_bf16 v[220:223], a[92:95], a[172:175], v[220:223]
    s_add_u32 s58, s81, 20480
    v_mfma_f32_16x16x32_bf16 v[252:255], a[92:95], a[176:179], v[252:255]
    buffer_load_dwordx4 v5, s[28:31], s57 offen offset:3168 nt lds
    v_mfma_f32_16x16x32_bf16 a[28:31], a[92:95], a[180:183], a[28:31]
    s_add_u32 s66, s66, 8192
    v_mfma_f32_16x16x32_bf16 v[32:35], a[96:99], a[148:151], v[32:35]
    s_and_b32 s66, s66, 0x3ffff
    buffer_load_dwordx4 a[132:135], v5, s[40:43], s58 offen offset:0 sc1
    v_mfma_f32_16x16x32_bf16 v[64:67], a[96:99], a[152:155], v[64:67]
    s_add_u32 s63, s64, s66
    v_mfma_f32_16x16x32_bf16 v[96:99], a[96:99], a[156:159], v[96:99]
    s_add_u32 m0, s60, 8448
    v_mfma_f32_16x16x32_bf16 v[128:131], a[96:99], a[160:163], v[128:131]
    s_add_u32 s57, s63, 0
    buffer_load_dwordx4 v2, s[24:27], s57 offen offset:0 nt lds
    v_mfma_f32_16x16x32_bf16 v[160:163], a[96:99], a[164:167], v[160:163]
    s_add_u32 s58, s81, 24576
    v_mfma_f32_16x16x32_bf16 v[192:195], a[96:99], a[168:171], v[192:195]
    buffer_load_dwordx4 v3, s[24:27], s57 offen offset:1056 nt lds
    v_mfma_f32_16x16x32_bf16 v[224:227], a[96:99], a[172:175], v[224:227]
    v_mfma_f32_16x16x32_bf16 a[0:3], a[96:99], a[176:179], a[0:3]
    buffer_load_dwordx4 v4, s[24:27], s57 offen offset:2112 nt lds
    v_mfma_f32_16x16x32_bf16 a[32:35], a[96:99], a[180:183], a[32:35]
    v_mfma_f32_16x16x32_bf16 v[36:39], a[100:103], a[148:151], v[36:39]
    buffer_load_dwordx4 v5, s[24:27], s57 offen offset:3168 nt lds
    v_mfma_f32_16x16x32_bf16 v[68:71], a[100:103], a[152:155], v[68:71]
    s_mov_b32 m0, 71808
    v_mfma_f32_16x16x32_bf16 v[100:103], a[100:103], a[156:159], v[100:103]
    s_add_u32 s57, s76, 69632
    buffer_load_dwordx4 v6, s[36:39], s57 offen offset:0 lds
    v_mfma_f32_16x16x32_bf16 v[132:135], a[100:103], a[160:163], v[132:135]
    v_mfma_f32_16x16x32_bf16 v[164:167], a[100:103], a[164:167], v[164:167]
    buffer_load_dwordx4 v7, s[36:39], s57 offen offset:1056 lds
    v_mfma_f32_16x16x32_bf16 v[196:199], a[100:103], a[168:171], v[196:199]
    v_mfma_f32_16x16x32_bf16 v[228:231], a[100:103], a[172:175], v[228:231]
    buffer_load_dwordx4 a[136:139], v5, s[40:43], s58 offen offset:0 sc1
    v_mfma_f32_16x16x32_bf16 a[4:7], a[100:103], a[176:179], a[4:7]
    s_add_u32 s58, s81, 28672
    v_mfma_f32_16x16x32_bf16 a[36:39], a[100:103], a[180:183], a[36:39]
    buffer_load_dwordx4 v8, s[36:39], s57 offen offset:2112 lds
    v_mfma_f32_16x16x32_bf16 v[40:43], a[104:107], a[148:151], v[40:43]
    v_mfma_f32_16x16x32_bf16 v[72:75], a[104:107], a[152:155], v[72:75]
    buffer_load_dwordx4 a[140:143], v5, s[40:43], s58 offen offset:0 sc1
    v_mfma_f32_16x16x32_bf16 v[104:107], a[104:107], a[156:159], v[104:107]
    s_add_u32 s58, s81, 32768
    v_mfma_f32_16x16x32_bf16 v[136:139], a[104:107], a[160:163], v[136:139]
    buffer_load_dwordx4 v9, s[36:39], s57 offen offset:3168 lds
    v_mfma_f32_16x16x32_bf16 v[168:171], a[104:107], a[164:167], v[168:171]
    s_add_u32 m0, s60, 12672
    v_mfma_f32_16x16x32_bf16 v[200:203], a[104:107], a[168:171], v[200:203]
    s_add_u32 s57, s63, 4096
    buffer_load_dwordx4 v2, s[24:27], s57 offen offset:0 nt lds
    v_mfma_f32_16x16x32_bf16 v[232:235], a[104:107], a[172:175], v[232:235]
    v_mfma_f32_16x16x32_bf16 a[8:11], a[104:107], a[176:179], a[8:11]
    buffer_load_dwordx4 v3, s[24:27], s57 offen offset:1056 nt lds
    v_mfma_f32_16x16x32_bf16 a[40:43], a[104:107], a[180:183], a[40:43]
    v_mfma_f32_16x16x32_bf16 v[44:47], a[108:111], a[148:151], v[44:47]
    buffer_load_dwordx4 a[144:147], v5, s[40:43], s58 offen offset:0 sc1
    v_mfma_f32_16x16x32_bf16 v[76:79], a[108:111], a[152:155], v[76:79]
    v_mfma_f32_16x16x32_bf16 v[108:111], a[108:111], a[156:159], v[108:111]
    buffer_load_dwordx4 v4, s[24:27], s57 offen offset:2112 nt lds
    v_mfma_f32_16x16x32_bf16 v[140:143], a[108:111], a[160:163], v[140:143]
    v_mfma_f32_16x16x32_bf16 v[172:175], a[108:111], a[164:167], v[172:175]
    buffer_load_dwordx4 v5, s[24:27], s57 offen offset:3168 nt lds
    v_mfma_f32_16x16x32_bf16 v[204:207], a[108:111], a[168:171], v[204:207]
    s_add_u32 s60, s60, 16896
    v_mfma_f32_16x16x32_bf16 v[236:239], a[108:111], a[172:175], v[236:239]
    s_cmp_ge_u32 s60, s61
    v_mfma_f32_16x16x32_bf16 a[12:15], a[108:111], a[176:179], a[12:15]
    s_cselect_b32 s60, 0, s60
    v_mfma_f32_16x16x32_bf16 a[44:47], a[108:111], a[180:183], a[44:47]
    s_barrier
    s_waitcnt lgkmcnt(0)
    v_mfma_f32_16x16x32_bf16 v[16:19], a[48:51], a[184:187], v[16:19]
    ds_read_b64_tr_b16 a[80:81], v10 offset:25344
    v_mfma_f32_16x16x32_bf16 v[48:51], a[48:51], a[188:191], v[48:51]
    s_add_u32 m0, s60, 0
    ds_read_b64_tr_b16 a[82:83], v10 offset:25856
    v_mfma_f32_16x16x32_bf16 v[80:83], a[48:51], a[192:195], v[80:83]
    s_add_u32 s57, s63, 0
    buffer_load_dwordx4 v2, s[28:31], s57 offen offset:0 nt lds
    v_mfma_f32_16x16x32_bf16 v[112:115], a[48:51], a[196:199], v[112:115]
    s_add_u32 s58, s81, 0
    ds_read_b64_tr_b16 a[84:85], v10 offset:25376
    v_mfma_f32_16x16x32_bf16 v[144:147], a[48:51], a[200:203], v[144:147]
    buffer_load_dwordx4 a[148:151], v5, s[40:43], s58 offen offset:1024 sc1
    v_mfma_f32_16x16x32_bf16 v[176:179], a[48:51], a[204:207], v[176:179]
    s_add_u32 s58, s81, 4096
    ds_read_b64_tr_b16 a[86:87], v10 offset:25888
    v_mfma_f32_16x16x32_bf16 v[208:211], a[48:51], a[208:211], v[208:211]
    buffer_load_dwordx4 v3, s[28:31], s57 offen offset:1056 nt lds
    v_mfma_f32_16x16x32_bf16 v[240:243], a[48:51], a[212:215], v[240:243]
    ds_read_b64_tr_b16 a[88:89], v10 offset:25408
    v_mfma_f32_16x16x32_bf16 a[16:19], a[48:51], a[216:219], a[16:19]
    buffer_load_dwordx4 v4, s[28:31], s57 offen offset:2112 nt lds
    v_mfma_f32_16x16x32_bf16 v[20:23], a[52:55], a[184:187], v[20:23]
    ds_read_b64_tr_b16 a[90:91], v10 offset:25920
    v_mfma_f32_16x16x32_bf16 v[52:55], a[52:55], a[188:191], v[52:55]
    buffer_load_dwordx4 v5, s[28:31], s57 offen offset:3168 nt lds
    v_mfma_f32_16x16x32_bf16 v[84:87], a[52:55], a[192:195], v[84:87]
    s_mov_b32 m0, 76032
    ds_read_b64_tr_b16 a[92:93], v10 offset:25440
    v_mfma_f32_16x16x32_bf16 v[116:119], a[52:55], a[196:199], v[116:119]
    s_add_u32 s57, s76, 98304
    buffer_load_dwordx4 v6, s[36:39], s57 offen offset:0 lds
    v_mfma_f32_16x16x32_bf16 v[148:151], a[52:55], a[200:203], v[148:151]
    ds_read_b64_tr_b16 a[94:95], v10 offset:25952
    v_mfma_f32_16x16x32_bf16 v[180:183], a[52:55], a[204:207], v[180:183]
    buffer_load_dwordx4 v7, s[36:39], s57 offen offset:1056 lds
    v_mfma_f32_16x16x32_bf16 v[212:215], a[52:55], a[208:211], v[212:215]
    ds_read_b64_tr_b16 a[96:97], v10 offset:25472
    v_mfma_f32_16x16x32_bf16 v[244:247], a[52:55], a[212:215], v[244:247]
    buffer_load_dwordx4 a[152:155], v5, s[40:43], s58 offen offset:1024 sc1
    v_mfma_f32_16x16x32_bf16 a[20:23], a[52:55], a[216:219], a[20:23]
    s_add_u32 s58, s81, 8192
    ds_read_b64_tr_b16 a[98:99], v10 offset:25984
    v_mfma_f32_16x16x32_bf16 v[24:27], a[56:59], a[184:187], v[24:27]
    buffer_load_dwordx4 v8, s[36:39], s57 offen offset:2112 lds
    v_mfma_f32_16x16x32_bf16 v[56:59], a[56:59], a[188:191], v[56:59]
    ds_read_b64_tr_b16 a[100:101], v10 offset:25504
    v_mfma_f32_16x16x32_bf16 v[88:91], a[56:59], a[192:195], v[88:91]
    buffer_load_dwordx4 a[156:159], v5, s[40:43], s58 offen offset:1024 sc1
    v_mfma_f32_16x16x32_bf16 v[120:123], a[56:59], a[196:199], v[120:123]
    s_add_u32 s58, s81, 12288
    ds_read_b64_tr_b16 a[102:103], v10 offset:26016
    v_mfma_f32_16x16x32_bf16 v[152:155], a[56:59], a[200:203], v[152:155]
    buffer_load_dwordx4 v9, s[36:39], s57 offen offset:3168 lds
    v_mfma_f32_16x16x32_bf16 v[184:187], a[56:59], a[204:207], v[184:187]
    s_add_u32 m0, s60, 4224
    ds_read_b64_tr_b16 a[104:105], v10 offset:25536
    v_mfma_f32_16x16x32_bf16 v[216:219], a[56:59], a[208:211], v[216:219]
    s_add_u32 s57, s63, 4096
    buffer_load_dwordx4 v2, s[28:31], s57 offen offset:0 nt lds
    v_mfma_f32_16x16x32_bf16 v[248:251], a[56:59], a[212:215], v[248:251]
    ds_read_b64_tr_b16 a[106:107], v10 offset:26048
    v_mfma_f32_16x16x32_bf16 a[24:27], a[56:59], a[216:219], a[24:27]
    buffer_load_dwordx4 v3, s[28:31], s57 offen offset:1056 nt lds
    v_mfma_f32_16x16x32_bf16 v[28:31], a[60:63], a[184:187], v[28:31]
    ds_read_b64_tr_b16 a[108:109], v10 offset:25568
    v_mfma_f32_16x16x32_bf16 v[60:63], a[60:63], a[188:191], v[60:63]
    buffer_load_dwordx4 a[160:163], v5, s[40:43], s58 offen offset:1024 sc1
    v_mfma_f32_16x16x32_bf16 v[92:95], a[60:63], a[192:195], v[92:95]
    s_add_u32 s58, s81, 16384
    ds_read_b64_tr_b16 a[110:111], v10 offset:26080
    v_mfma_f32_16x16x32_bf16 v[124:127], a[60:63], a[196:199], v[124:127]
    buffer_load_dwordx4 v4, s[28:31], s57 offen offset:2112 nt lds
    v_mfma_f32_16x16x32_bf16 v[156:159], a[60:63], a[200:203], v[156:159]
    v_mfma_f32_16x16x32_bf16 v[188:191], a[60:63], a[204:207], v[188:191]
    buffer_load_dwordx4 a[164:167], v5, s[40:43], s58 offen offset:1024 sc1
    v_mfma_f32_16x16x32_bf16 v[220:223], a[60:63], a[208:211], v[220:223]
    s_add_u32 s58, s81, 20480
    v_mfma_f32_16x16x32_bf16 v[252:255], a[60:63], a[212:215], v[252:255]
    buffer_load_dwordx4 v5, s[28:31], s57 offen offset:3168 nt lds
    v_mfma_f32_16x16x32_bf16 a[28:31], a[60:63], a[216:219], a[28:31]
    s_mov_b32 m0, 80256
    v_mfma_f32_16x16x32_bf16 v[32:35], a[64:67], a[184:187], v[32:35]
    s_add_u32 s57, s76, 102400
    buffer_load_dwordx4 v6, s[36:39], s57 offen offset:0 lds
    v_mfma_f32_16x16x32_bf16 v[64:67], a[64:67], a[188:191], v[64:67]
    v_mfma_f32_16x16x32_bf16 v[96:99], a[64:67], a[192:195], v[96:99]
    buffer_load_dwordx4 v7, s[36:39], s57 offen offset:1056 lds
    v_mfma_f32_16x16x32_bf16 v[128:131], a[64:67], a[196:199], v[128:131]
    v_mfma_f32_16x16x32_bf16 v[160:163], a[64:67], a[200:203], v[160:163]
    buffer_load_dwordx4 a[168:171], v5, s[40:43], s58 offen offset:1024 sc1
    v_mfma_f32_16x16x32_bf16 v[192:195], a[64:67], a[204:207], v[192:195]
    s_add_u32 s58, s81, 24576
    v_mfma_f32_16x16x32_bf16 v[224:227], a[64:67], a[208:211], v[224:227]
    buffer_load_dwordx4 v8, s[36:39], s57 offen offset:2112 lds
    v_mfma_f32_16x16x32_bf16 a[0:3], a[64:67], a[212:215], a[0:3]
    v_mfma_f32_16x16x32_bf16 a[32:35], a[64:67], a[216:219], a[32:35]
    buffer_load_dwordx4 v9, s[36:39], s57 offen offset:3168 lds
    v_mfma_f32_16x16x32_bf16 v[36:39], a[68:71], a[184:187], v[36:39]
    s_add_u32 s66, s66, 8192
    v_mfma_f32_16x16x32_bf16 v[68:71], a[68:71], a[188:191], v[68:71]
    s_and_b32 s66, s66, 0x3ffff
    buffer_load_dwordx4 a[172:175], v5, s[40:43], s58 offen offset:1024 sc1
    v_mfma_f32_16x16x32_bf16 v[100:103], a[68:71], a[192:195], v[100:103]
    s_add_u32 s63, s64, s66
    v_mfma_f32_16x16x32_bf16 v[132:135], a[68:71], a[196:199], v[132:135]
    s_add_u32 m0, s60, 8448
    v_mfma_f32_16x16x32_bf16 v[164:167], a[68:71], a[200:203], v[164:167]
    s_add_u32 s57, s63, 0
    buffer_load_dwordx4 v2, s[24:27], s57 offen offset:0 nt lds
    v_mfma_f32_16x16x32_bf16 v[196:199], a[68:71], a[204:207], v[196:199]
    s_add_u32 s58, s81, 28672
    buffer_load_dwordx4 v3, s[24:27], s57 offen offset:1056 nt lds
    v_mfma_f32_16x16x32_bf16 v[228:231], a[68:71], a[208:211], v[228:231]
    v_mfma_f32_16x16x32_bf16 a[4:7], a[68:71], a[212:215], a[4:7]
    buffer_load_dwordx4 v4, s[24:27], s57 offen offset:2112 nt lds
    v_mfma_f32_16x16x32_bf16 a[36:39], a[68:71], a[216:219], a[36:39]
    v_mfma_f32_16x16x32_bf16 v[40:43], a[72:75], a[184:187], v[40:43]
    buffer_load_dwordx4 v5, s[24:27], s57 offen offset:3168 nt lds
    v_mfma_f32_16x16x32_bf16 v[72:75], a[72:75], a[188:191], v[72:75]
    s_add_u32 m0, s60, 12672
    v_mfma_f32_16x16x32_bf16 v[104:107], a[72:75], a[192:195], v[104:107]
    s_add_u32 s57, s63, 4096
    buffer_load_dwordx4 v2, s[24:27], s57 offen offset:0 nt lds
    v_mfma_f32_16x16x32_bf16 v[136:139], a[72:75], a[196:199], v[136:139]
    v_mfma_f32_16x16x32_bf16 v[168:171], a[72:75], a[200:203], v[168:171]
    buffer_load_dwordx4 a[176:179], v5, s[40:43], s58 offen offset:1024 sc1
    v_mfma_f32_16x16x32_bf16 v[200:203], a[72:75], a[204:207], v[200:203]
    s_add_u32 s58, s81, 32768
    v_mfma_f32_16x16x32_bf16 v[232:235], a[72:75], a[208:211], v[232:235]
    buffer_load_dwordx4 v3, s[24:27], s57 offen offset:1056 nt lds
    v_mfma_f32_16x16x32_bf16 a[8:11], a[72:75], a[212:215], a[8:11]
    v_mfma_f32_16x16x32_bf16 a[40:43], a[72:75], a[216:219], a[40:43]
    buffer_load_dwordx4 a[180:183], v5, s[40:43], s58 offen offset:1024 sc1
    v_mfma_f32_16x16x32_bf16 v[44:47], a[76:79], a[184:187], v[44:47]
    v_mfma_f32_16x16x32_bf16 v[76:79], a[76:79], a[188:191], v[76:79]
    buffer_load_dwordx4 v4, s[24:27], s57 offen offset:2112 nt lds
    v_mfma_f32_16x16x32_bf16 v[108:111], a[76:79], a[192:195], v[108:111]
    v_mfma_f32_16x16x32_bf16 v[140:143], a[76:79], a[196:199], v[140:143]
    buffer_load_dwordx4 v5, s[24:27], s57 offen offset:3168 nt lds
    v_mfma_f32_16x16x32_bf16 v[172:175], a[76:79], a[200:203], v[172:175]
    s_add_u32 s60, s60, 16896
    v_mfma_f32_16x16x32_bf16 v[204:207], a[76:79], a[204:207], v[204:207]
    s_cmp_ge_u32 s60, s61
    v_mfma_f32_16x16x32_bf16 v[236:239], a[76:79], a[208:211], v[236:239]
    s_cselect_b32 s60, 0, s60
    v_mfma_f32_16x16x32_bf16 a[12:15], a[76:79], a[212:215], a[12:15]
    v_mfma_f32_16x16x32_bf16 a[44:47], a[76:79], a[216:219], a[44:47]
    s_waitcnt vmcnt(63)
    s_barrier
    s_waitcnt lgkmcnt(0)
    s_mov_b64 exec, 7
    buffer_load_dword v14, v5, s[40:43], s88 offen sc1
    s_mov_b64 exec, -1
    v_mfma_f32_16x16x32_bf16 v[16:19], a[80:83], a[220:223], v[16:19]
    ds_read_b64_tr_b16 a[48:49], v10 offset:33792
    v_mfma_f32_16x16x32_bf16 v[48:51], a[80:83], a[224:227], v[48:51]
    s_add_u32 m0, s60, 0
    ds_read_b64_tr_b16 a[50:51], v10 offset:34304
    v_mfma_f32_16x16x32_bf16 v[80:83], a[80:83], a[228:231], v[80:83]
    s_add_u32 s57, s63, 0
    buffer_load_dwordx4 v2, s[28:31], s57 offen offset:0 nt lds
    v_mfma_f32_16x16x32_bf16 v[112:115], a[80:83], a[232:235], v[112:115]
    s_add_u32 s58, s81, 0
    ds_read_b64_tr_b16 a[52:53], v10 offset:33824
    v_mfma_f32_16x16x32_bf16 v[144:147], a[80:83], a[236:239], v[144:147]
    buffer_load_dwordx4 a[184:187], v5, s[40:43], s58 offen offset:2048 sc1
    v_mfma_f32_16x16x32_bf16 v[176:179], a[80:83], a[240:243], v[176:179]
    s_add_u32 s58, s81, 4096
    ds_read_b64_tr_b16 a[54:55], v10 offset:34336
    v_mfma_f32_16x16x32_bf16 v[208:211], a[80:83], a[244:247], v[208:211]
    buffer_load_dwordx4 v3, s[28:31], s57 offen offset:1056 nt lds
    v_mfma_f32_16x16x32_bf16 v[240:243], a[80:83], a[248:251], v[240:243]
    ds_read_b64_tr_b16 a[56:57], v10 offset:33856
    v_mfma_f32_16x16x32_bf16 a[16:19], a[80:83], a[252:255], a[16:19]
    buffer_load_dwordx4 v4, s[28:31], s57 offen offset:2112 nt lds
    v_mfma_f32_16x16x32_bf16 v[20:23], a[84:87], a[220:223], v[20:23]
    ds_read_b64_tr_b16 a[58:59], v10 offset:34368
    v_mfma_f32_16x16x32_bf16 v[52:55], a[84:87], a[224:227], v[52:55]
    buffer_load_dwordx4 v5, s[28:31], s57 offen offset:3168 nt lds
    v_mfma_f32_16x16x32_bf16 v[84:87], a[84:87], a[228:231], v[84:87]
    s_mov_b32 m0, 84480
    ds_read_b64_tr_b16 a[60:61], v10 offset:33888
    v_mfma_f32_16x16x32_bf16 v[116:119], a[84:87], a[232:235], v[116:119]
    s_add_u32 s57, s77, 0
    buffer_load_dwordx4 v6, s[36:39], s57 offen offset:0 lds
    v_mfma_f32_16x16x32_bf16 v[148:151], a[84:87], a[236:239], v[148:151]
    ds_read_b64_tr_b16 a[62:63], v10 offset:34400
    v_mfma_f32_16x16x32_bf16 v[180:183], a[84:87], a[240:243], v[180:183]
    buffer_load_dwordx4 a[188:191], v5, s[40:43], s58 offen offset:2048 sc1
    v_mfma_f32_16x16x32_bf16 v[212:215], a[84:87], a[244:247], v[212:215]
    s_add_u32 s58, s81, 8192
    ds_read_b64_tr_b16 a[64:65], v10 offset:33920
    v_mfma_f32_16x16x32_bf16 v[244:247], a[84:87], a[248:251], v[244:247]
    buffer_load_dwordx4 v7, s[36:39], s57 offen offset:1056 lds
    v_mfma_f32_16x16x32_bf16 a[20:23], a[84:87], a[252:255], a[20:23]
    ds_read_b64_tr_b16 a[66:67], v10 offset:34432
    v_mfma_f32_16x16x32_bf16 v[24:27], a[88:91], a[220:223], v[24:27]
    buffer_load_dwordx4 a[192:195], v5, s[40:43], s58 offen offset:2048 sc1
    v_mfma_f32_16x16x32_bf16 v[56:59], a[88:91], a[224:227], v[56:59]
    s_add_u32 s58, s81, 12288
    ds_read_b64_tr_b16 a[68:69], v10 offset:33952
    v_mfma_f32_16x16x32_bf16 v[88:91], a[88:91], a[228:231], v[88:91]
    buffer_load_dwordx4 v8, s[36:39], s57 offen offset:2112 lds
    v_mfma_f32_16x16x32_bf16 v[120:123], a[88:91], a[232:235], v[120:123]
    ds_read_b64_tr_b16 a[70:71], v10 offset:34464
    v_mfma_f32_16x16x32_bf16 v[152:155], a[88:91], a[236:239], v[152:155]
    buffer_load_dwordx4 v9, s[36:39], s57 offen offset:3168 lds
    v_mfma_f32_16x16x32_bf16 v[184:187], a[88:91], a[240:243], v[184:187]
    s_add_u32 m0, s60, 4224
    ds_read_b64_tr_b16 a[72:73], v10 offset:33984
    v_mfma_f32_16x16x32_bf16 v[216:219], a[88:91], a[244:247], v[216:219]
    s_add_u32 s57, s63, 4096
    buffer_load_dwordx4 v2, s[28:31], s57 offen offset:0 nt lds
    v_mfma_f32_16x16x32_bf16 v[248:251], a[88:91], a[248:251], v[248:251]
    ds_read_b64_tr_b16 a[74:75], v10 offset:34496
    v_mfma_f32_16x16x32_bf16 a[24:27], a[88:91], a[252:255], a[24:27]
    buffer_load_dwordx4 v3, s[28:31], s57 offen offset:1056 nt lds
    v_mfma_f32_16x16x32_bf16 v[28:31], a[92:95], a[220:223], v[28:31]
    ds_read_b64_tr_b16 a[76:77], v10 offset:34016
    v_mfma_f32_16x16x32_bf16 v[60:63], a[92:95], a[224:227], v[60:63]
    buffer_load_dwordx4 a[196:199], v5, s[40:43], s58 offen offset:2048 sc1
    v_mfma_f32_16x16x32_bf16 v[92:95], a[92:95], a[228:231], v[92:95]
    s_add_u32 s58, s81, 16384
    ds_read_b64_tr_b16 a[78:79], v10 offset:34528
    v_mfma_f32_16x16x32_bf16 v[124:127], a[92:95], a[232:235], v[124:127]
    buffer_load_dwordx4 v4, s[28:31], s57 offen offset:2112 nt lds
    v_mfma_f32_16x16x32_bf16 v[156:159], a[92:95], a[236:239], v[156:159]
    v_mfma_f32_16x16x32_bf16 v[188:191], a[92:95], a[240:243], v[188:191]
    buffer_load_dwordx4 a[200:203], v5, s[40:43], s58 offen offset:2048 sc1
    v_mfma_f32_16x16x32_bf16 v[220:223], a[92:95], a[244:247], v[220:223]
    s_add_u32 s58, s81, 20480
    v_mfma_f32_16x16x32_bf16 v[252:255], a[92:95], a[248:251], v[252:255]
    buffer_load_dwordx4 v5, s[28:31], s57 offen offset:3168 nt lds
    v_mfma_f32_16x16x32_bf16 a[28:31], a[92:95], a[252:255], a[28:31]
    s_add_u32 s66, s66, 8192
    v_mfma_f32_16x16x32_bf16 v[32:35], a[96:99], a[220:223], v[32:35]
    s_and_b32 s66, s66, 0x3ffff
    buffer_load_dwordx4 a[204:207], v5, s[40:43], s58 offen offset:2048 sc1
    v_mfma_f32_16x16x32_bf16 v[64:67], a[96:99], a[224:227], v[64:67]
    s_add_u32 s63, s64, s66
    v_mfma_f32_16x16x32_bf16 v[96:99], a[96:99], a[228:231], v[96:99]
    s_add_u32 m0, s60, 8448
    v_mfma_f32_16x16x32_bf16 v[128:131], a[96:99], a[232:235], v[128:131]
    s_add_u32 s57, s63, 0
    buffer_load_dwordx4 v2, s[24:27], s57 offen offset:0 nt lds
    v_mfma_f32_16x16x32_bf16 v[160:163], a[96:99], a[236:239], v[160:163]
    s_add_u32 s58, s81, 24576
    v_mfma_f32_16x16x32_bf16 v[192:195], a[96:99], a[240:243], v[192:195]
    buffer_load_dwordx4 v3, s[24:27], s57 offen offset:1056 nt lds
    v_mfma_f32_16x16x32_bf16 v[224:227], a[96:99], a[244:247], v[224:227]
    v_mfma_f32_16x16x32_bf16 a[0:3], a[96:99], a[248:251], a[0:3]
    buffer_load_dwordx4 v4, s[24:27], s57 offen offset:2112 nt lds
    v_mfma_f32_16x16x32_bf16 a[32:35], a[96:99], a[252:255], a[32:35]
    v_mfma_f32_16x16x32_bf16 v[36:39], a[100:103], a[220:223], v[36:39]
    buffer_load_dwordx4 v5, s[24:27], s57 offen offset:3168 nt lds
    v_mfma_f32_16x16x32_bf16 v[68:71], a[100:103], a[224:227], v[68:71]
    s_mov_b32 m0, 88704
    v_mfma_f32_16x16x32_bf16 v[100:103], a[100:103], a[228:231], v[100:103]
    s_add_u32 s57, s77, 4096
    buffer_load_dwordx4 v6, s[36:39], s57 offen offset:0 lds
    v_mfma_f32_16x16x32_bf16 v[132:135], a[100:103], a[232:235], v[132:135]
    v_mfma_f32_16x16x32_bf16 v[164:167], a[100:103], a[236:239], v[164:167]
    buffer_load_dwordx4 v7, s[36:39], s57 offen offset:1056 lds
    v_mfma_f32_16x16x32_bf16 v[196:199], a[100:103], a[240:243], v[196:199]
    v_mfma_f32_16x16x32_bf16 v[228:231], a[100:103], a[244:247], v[228:231]
    buffer_load_dwordx4 a[208:211], v5, s[40:43], s58 offen offset:2048 sc1
    v_mfma_f32_16x16x32_bf16 a[4:7], a[100:103], a[248:251], a[4:7]
    s_add_u32 s58, s81, 28672
    v_mfma_f32_16x16x32_bf16 a[36:39], a[100:103], a[252:255], a[36:39]
    buffer_load_dwordx4 v8, s[36:39], s57 offen offset:2112 lds
    v_mfma_f32_16x16x32_bf16 v[40:43], a[104:107], a[220:223], v[40:43]
    v_mfma_f32_16x16x32_bf16 v[72:75], a[104:107], a[224:227], v[72:75]
    buffer_load_dwordx4 a[212:215], v5, s[40:43], s58 offen offset:2048 sc1
    v_mfma_f32_16x16x32_bf16 v[104:107], a[104:107], a[228:231], v[104:107]
    s_add_u32 s58, s81, 32768
    v_mfma_f32_16x16x32_bf16 v[136:139], a[104:107], a[232:235], v[136:139]
    buffer_load_dwordx4 v9, s[36:39], s57 offen offset:3168 lds
    v_mfma_f32_16x16x32_bf16 v[168:171], a[104:107], a[236:239], v[168:171]
    s_add_u32 m0, s60, 12672
    v_mfma_f32_16x16x32_bf16 v[200:203], a[104:107], a[240:243], v[200:203]
    s_add_u32 s57, s63, 4096
    buffer_load_dwordx4 v2, s[24:27], s57 offen offset:0 nt lds
    v_mfma_f32_16x16x32_bf16 v[232:235], a[104:107], a[244:247], v[232:235]
    v_mfma_f32_16x16x32_bf16 a[8:11], a[104:107], a[248:251], a[8:11]
    buffer_load_dwordx4 v3, s[24:27], s57 offen offset:1056 nt lds
    v_mfma_f32_16x16x32_bf16 a[40:43], a[104:107], a[252:255], a[40:43]
    v_mfma_f32_16x16x32_bf16 v[44:47], a[108:111], a[220:223], v[44:47]
    buffer_load_dwordx4 a[216:219], v5, s[40:43], s58 offen offset:2048 sc1
    v_mfma_f32_16x16x32_bf16 v[76:79], a[108:111], a[224:227], v[76:79]
    v_mfma_f32_16x16x32_bf16 v[108:111], a[108:111], a[228:231], v[108:111]
    buffer_load_dwordx4 v4, s[24:27], s57 offen offset:2112 nt lds
    v_mfma_f32_16x16x32_bf16 v[140:143], a[108:111], a[232:235], v[140:143]
    v_mfma_f32_16x16x32_bf16 v[172:175], a[108:111], a[236:239], v[172:175]
    buffer_load_dwordx4 v5, s[24:27], s57 offen offset:3168 nt lds
    v_mfma_f32_16x16x32_bf16 v[204:207], a[108:111], a[240:243], v[204:207]
    s_add_u32 s60, s60, 16896
    v_mfma_f32_16x16x32_bf16 v[236:239], a[108:111], a[244:247], v[236:239]
    s_cmp_ge_u32 s60, s61
    v_mfma_f32_16x16x32_bf16 a[12:15], a[108:111], a[248:251], a[12:15]
    s_cselect_b32 s60, 0, s60
    v_mfma_f32_16x16x32_bf16 a[44:47], a[108:111], a[252:255], a[44:47]
    s_waitcnt vmcnt(63)
    s_barrier
    s_waitcnt lgkmcnt(0)
    v_mfma_f32_16x16x32_bf16 v[16:19], a[48:51], a[112:115], v[16:19]
    ds_read_b64_tr_b16 a[80:81], v10 offset:42240
    v_mfma_f32_16x16x32_bf16 v[48:51], a[48:51], a[116:119], v[48:51]
    s_add_u32 m0, s60, 0
    ds_read_b64_tr_b16 a[82:83], v10 offset:42752
    v_mfma_f32_16x16x32_bf16 v[80:83], a[48:51], a[120:123], v[80:83]
    s_add_u32 s57, s63, 0
    buffer_load_dwordx4 v2, s[28:31], s57 offen offset:0 nt lds
    v_mfma_f32_16x16x32_bf16 v[112:115], a[48:51], a[124:127], v[112:115]
    s_add_u32 s58, s81, 0
    ds_read_b64_tr_b16 a[84:85], v10 offset:42272
    v_mfma_f32_16x16x32_bf16 v[144:147], a[48:51], a[128:131], v[144:147]
    buffer_load_dwordx4 a[220:223], v5, s[40:43], s58 offen offset:3072 sc1
    v_mfma_f32_16x16x32_bf16 v[176:179], a[48:51], a[132:135], v[176:179]
    s_add_u32 s58, s81, 4096
    ds_read_b64_tr_b16 a[86:87], v10 offset:42784
    v_mfma_f32_16x16x32_bf16 v[208:211], a[48:51], a[136:139], v[208:211]
    buffer_load_dwordx4 v3, s[28:31], s57 offen offset:1056 nt lds
    v_mfma_f32_16x16x32_bf16 v[240:243], a[48:51], a[140:143], v[240:243]
    ds_read_b64_tr_b16 a[88:89], v10 offset:42304
    v_mfma_f32_16x16x32_bf16 a[16:19], a[48:51], a[144:147], a[16:19]
    buffer_load_dwordx4 v4, s[28:31], s57 offen offset:2112 nt lds
    v_mfma_f32_16x16x32_bf16 v[20:23], a[52:55], a[112:115], v[20:23]
    ds_read_b64_tr_b16 a[90:91], v10 offset:42816
    v_mfma_f32_16x16x32_bf16 v[52:55], a[52:55], a[116:119], v[52:55]
    buffer_load_dwordx4 v5, s[28:31], s57 offen offset:3168 nt lds
    v_mfma_f32_16x16x32_bf16 v[84:87], a[52:55], a[120:123], v[84:87]
    s_mov_b32 m0, 92928
    ds_read_b64_tr_b16 a[92:93], v10 offset:42336
    v_mfma_f32_16x16x32_bf16 v[116:119], a[52:55], a[124:127], v[116:119]
    s_add_u32 s57, s77, 32768
    buffer_load_dwordx4 v6, s[36:39], s57 offen offset:0 lds
    v_mfma_f32_16x16x32_bf16 v[148:151], a[52:55], a[128:131], v[148:151]
    ds_read_b64_tr_b16 a[94:95], v10 offset:42848
    v_mfma_f32_16x16x32_bf16 v[180:183], a[52:55], a[132:135], v[180:183]
    buffer_load_dwordx4 v7, s[36:39], s57 offen offset:1056 lds
    v_mfma_f32_16x16x32_bf16 v[212:215], a[52:55], a[136:139], v[212:215]
    ds_read_b64_tr_b16 a[96:97], v10 offset:42368
    v_mfma_f32_16x16x32_bf16 v[244:247], a[52:55], a[140:143], v[244:247]
    buffer_load_dwordx4 a[224:227], v5, s[40:43], s58 offen offset:3072 sc1
    v_mfma_f32_16x16x32_bf16 a[20:23], a[52:55], a[144:147], a[20:23]
    s_add_u32 s58, s81, 8192
    ds_read_b64_tr_b16 a[98:99], v10 offset:42880
    v_mfma_f32_16x16x32_bf16 v[24:27], a[56:59], a[112:115], v[24:27]
    buffer_load_dwordx4 v8, s[36:39], s57 offen offset:2112 lds
    v_mfma_f32_16x16x32_bf16 v[56:59], a[56:59], a[116:119], v[56:59]
    ds_read_b64_tr_b16 a[100:101], v10 offset:42400
    v_mfma_f32_16x16x32_bf16 v[88:91], a[56:59], a[120:123], v[88:91]
    buffer_load_dwordx4 a[228:231], v5, s[40:43], s58 offen offset:3072 sc1
    v_mfma_f32_16x16x32_bf16 v[120:123], a[56:59], a[124:127], v[120:123]
    s_add_u32 s58, s81, 12288
    ds_read_b64_tr_b16 a[102:103], v10 offset:42912
    v_mfma_f32_16x16x32_bf16 v[152:155], a[56:59], a[128:131], v[152:155]
    buffer_load_dwordx4 v9, s[36:39], s57 offen offset:3168 lds
    v_mfma_f32_16x16x32_bf16 v[184:187], a[56:59], a[132:135], v[184:187]
    s_add_u32 m0, s60, 4224
    ds_read_b64_tr_b16 a[104:105], v10 offset:42432
    v_mfma_f32_16x16x32_bf16 v[216:219], a[56:59], a[136:139], v[216:219]
    s_add_u32 s57, s63, 4096
    buffer_load_dwordx4 v2, s[28:31], s57 offen offset:0 nt lds
    v_mfma_f32_16x16x32_bf16 v[248:251], a[56:59], a[140:143], v[248:251]
    ds_read_b64_tr_b16 a[106:107], v10 offset:42944
    v_mfma_f32_16x16x32_bf16 a[24:27], a[56:59], a[144:147], a[24:27]
    buffer_load_dwordx4 v3, s[28:31], s57 offen offset:1056 nt lds
    v_mfma_f32_16x16x32_bf16 v[28:31], a[60:63], a[112:115], v[28:31]
    ds_read_b64_tr_b16 a[108:109], v10 offset:42464
    v_mfma_f32_16x16x32_bf16 v[60:63], a[60:63], a[116:119], v[60:63]
    buffer_load_dwordx4 a[232:235], v5, s[40:43], s58 offen offset:3072 sc1
    v_mfma_f32_16x16x32_bf16 v[92:95], a[60:63], a[120:123], v[92:95]
    s_add_u32 s58, s81, 16384
    ds_read_b64_tr_b16 a[110:111], v10 offset:42976
    v_mfma_f32_16x16x32_bf16 v[124:127], a[60:63], a[124:127], v[124:127]
    buffer_load_dwordx4 v4, s[28:31], s57 offen offset:2112 nt lds
    v_mfma_f32_16x16x32_bf16 v[156:159], a[60:63], a[128:131], v[156:159]
    v_mfma_f32_16x16x32_bf16 v[188:191], a[60:63], a[132:135], v[188:191]
    buffer_load_dwordx4 a[236:239], v5, s[40:43], s58 offen offset:3072 sc1
    v_mfma_f32_16x16x32_bf16 v[220:223], a[60:63], a[136:139], v[220:223]
    s_add_u32 s58, s81, 20480
    v_mfma_f32_16x16x32_bf16 v[252:255], a[60:63], a[140:143], v[252:255]
    buffer_load_dwordx4 v5, s[28:31], s57 offen offset:3168 nt lds
    v_mfma_f32_16x16x32_bf16 a[28:31], a[60:63], a[144:147], a[28:31]
    s_mov_b32 m0, 97152
    v_mfma_f32_16x16x32_bf16 v[32:35], a[64:67], a[112:115], v[32:35]
    s_add_u32 s57, s77, 36864
    buffer_load_dwordx4 v6, s[36:39], s57 offen offset:0 lds
    v_mfma_f32_16x16x32_bf16 v[64:67], a[64:67], a[116:119], v[64:67]
    v_mfma_f32_16x16x32_bf16 v[96:99], a[64:67], a[120:123], v[96:99]
    buffer_load_dwordx4 v7, s[36:39], s57 offen offset:1056 lds
    v_mfma_f32_16x16x32_bf16 v[128:131], a[64:67], a[124:127], v[128:131]
    v_mfma_f32_16x16x32_bf16 v[160:163], a[64:67], a[128:131], v[160:163]
    buffer_load_dwordx4 a[240:243], v5, s[40:43], s58 offen offset:3072 sc1
    v_mfma_f32_16x16x32_bf16 v[192:195], a[64:67], a[132:135], v[192:195]
    s_add_u32 s58, s81, 24576
    v_mfma_f32_16x16x32_bf16 v[224:227], a[64:67], a[136:139], v[224:227]
    buffer_load_dwordx4 v8, s[36:39], s57 offen offset:2112 lds
    v_mfma_f32_16x16x32_bf16 a[0:3], a[64:67], a[140:143], a[0:3]
    v_mfma_f32_16x16x32_bf16 a[32:35], a[64:67], a[144:147], a[32:35]
    buffer_load_dwordx4 v9, s[36:39], s57 offen offset:3168 lds
    v_mfma_f32_16x16x32_bf16 v[36:39], a[68:71], a[112:115], v[36:39]
    s_add_u32 s66, s66, 8192
    v_mfma_f32_16x16x32_bf16 v[68:71], a[68:71], a[116:119], v[68:71]
    s_and_b32 s66, s66, 0x3ffff
    buffer_load_dwordx4 a[244:247], v5, s[40:43], s58 offen offset:3072 sc1
    v_mfma_f32_16x16x32_bf16 v[100:103], a[68:71], a[120:123], v[100:103]
    s_add_u32 s63, s64, s66
    v_mfma_f32_16x16x32_bf16 v[132:135], a[68:71], a[124:127], v[132:135]
    s_add_u32 m0, s60, 8448
    v_mfma_f32_16x16x32_bf16 v[164:167], a[68:71], a[128:131], v[164:167]
    s_add_u32 s57, s63, 0
    buffer_load_dwordx4 v2, s[24:27], s57 offen offset:0 nt lds
    v_mfma_f32_16x16x32_bf16 v[196:199], a[68:71], a[132:135], v[196:199]
    s_add_u32 s58, s81, 28672
    buffer_load_dwordx4 v3, s[24:27], s57 offen offset:1056 nt lds
    v_mfma_f32_16x16x32_bf16 v[228:231], a[68:71], a[136:139], v[228:231]
    v_mfma_f32_16x16x32_bf16 a[4:7], a[68:71], a[140:143], a[4:7]
    buffer_load_dwordx4 v4, s[24:27], s57 offen offset:2112 nt lds
    v_mfma_f32_16x16x32_bf16 a[36:39], a[68:71], a[144:147], a[36:39]
    v_mfma_f32_16x16x32_bf16 v[40:43], a[72:75], a[112:115], v[40:43]
    buffer_load_dwordx4 v5, s[24:27], s57 offen offset:3168 nt lds
    v_mfma_f32_16x16x32_bf16 v[72:75], a[72:75], a[116:119], v[72:75]
    s_add_u32 m0, s60, 12672
    v_mfma_f32_16x16x32_bf16 v[104:107], a[72:75], a[120:123], v[104:107]
    s_add_u32 s57, s63, 4096
    buffer_load_dwordx4 v2, s[24:27], s57 offen offset:0 nt lds
    v_mfma_f32_16x16x32_bf16 v[136:139], a[72:75], a[124:127], v[136:139]
    v_mfma_f32_16x16x32_bf16 v[168:171], a[72:75], a[128:131], v[168:171]
    buffer_load_dwordx4 a[248:251], v5, s[40:43], s58 offen offset:3072 sc1
    v_mfma_f32_16x16x32_bf16 v[200:203], a[72:75], a[132:135], v[200:203]
    s_add_u32 s58, s81, 32768
    v_mfma_f32_16x16x32_bf16 v[232:235], a[72:75], a[136:139], v[232:235]
    buffer_load_dwordx4 v3, s[24:27], s57 offen offset:1056 nt lds
    v_mfma_f32_16x16x32_bf16 a[8:11], a[72:75], a[140:143], a[8:11]
    v_mfma_f32_16x16x32_bf16 a[40:43], a[72:75], a[144:147], a[40:43]
    buffer_load_dwordx4 a[252:255], v5, s[40:43], s58 offen offset:3072 sc1
    v_mfma_f32_16x16x32_bf16 v[44:47], a[76:79], a[112:115], v[44:47]
    v_mfma_f32_16x16x32_bf16 v[76:79], a[76:79], a[116:119], v[76:79]
    buffer_load_dwordx4 v4, s[24:27], s57 offen offset:2112 nt lds
    v_mfma_f32_16x16x32_bf16 v[108:111], a[76:79], a[120:123], v[108:111]
    v_mfma_f32_16x16x32_bf16 v[140:143], a[76:79], a[124:127], v[140:143]
    buffer_load_dwordx4 v5, s[24:27], s57 offen offset:3168 nt lds
    v_mfma_f32_16x16x32_bf16 v[172:175], a[76:79], a[128:131], v[172:175]
    s_add_u32 s60, s60, 16896
    v_mfma_f32_16x16x32_bf16 v[204:207], a[76:79], a[132:135], v[204:207]
    s_cmp_ge_u32 s60, s61
    v_mfma_f32_16x16x32_bf16 v[236:239], a[76:79], a[136:139], v[236:239]
    s_cselect_b32 s60, 0, s60
    v_mfma_f32_16x16x32_bf16 a[12:15], a[76:79], a[140:143], a[12:15]
    v_mfma_f32_16x16x32_bf16 a[44:47], a[76:79], a[144:147], a[44:47]
    s_waitcnt vmcnt(63)
    s_barrier
    s_waitcnt lgkmcnt(0)
    v_cmp_eq_u32 vcc, 1, v14
    s_nop 1
    s_and_b32 s56, vcc_lo, 7
    s_cmp_eq_u32 s56, 7
    s_cbranch_scc1 L_hf2_ok
    s_mov_b32 s72, 131072
L_hf2_lp:
    s_mov_b64 exec, 7
    buffer_load_dword v14, v5, s[40:43], s88 offen sc1
    s_mov_b64 exec, -1
    s_waitcnt vmcnt(0)
    v_cmp_eq_u32 vcc, 1, v14
    s_nop 1
    s_and_b32 s56, vcc_lo, 7
    s_cmp_eq_u32 s56, 7
    s_cbranch_scc1 L_hf2_ok
    s_sub_u32 s72, s72, 1
    s_cmp_lg_u32 s72, 0
    s_cbranch_scc1 L_hf2_lp
L_hf2_ok:
    v_mfma_f32_16x16x32_bf16 v[16:19], a[80:83], a[148:151], v[16:19]
    ds_read_b64_tr_b16 a[48:49], v10 offset:0
    v_mfma_f32_16x16x32_bf16 v[48:51], a[80:83], a[152:155], v[48:51]
    s_add_u32 m0, s60, 0
    ds_read_b64_tr_b16 a[50:51], v10 offset:512
    v_mfma_f32_16x16x32_bf16 v[80:83], a[80:83], a[156:159], v[80:83]
    s_add_u32 s57, s63, 0
    buffer_load_dwordx4 v2, s[28:31], s57 offen offset:0 nt lds
    v_mfma_f32_16x16x32_bf16 v[112:115], a[80:83], a[160:163], v[112:115]
    s_add_u32 s58, s82, 0
    ds_read_b64_tr_b16 a[52:53], v10 offset:32
    v_mfma_f32_16x16x32_bf16 v[144:147], a[80:83], a[164:167], v[144:147]
    buffer_load_dwordx4 a[112:115], v5, s[40:43], s58 offen offset:0 sc1
    v_mfma_f32_16x16x32_bf16 v[176:179], a[80:83], a[168:171], v[176:179]
    s_add_u32 s58, s82, 4096
    ds_read_b64_tr_b16 a[54:55], v10 offset:544
    v_mfma_f32_16x16x32_bf16 v[208:211], a[80:83], a[172:175], v[208:211]
    buffer_load_dwordx4 v3, s[28:31], s57 offen offset:1056 nt lds
    v_mfma_f32_16x16x32_bf16 v[240:243], a[80:83], a[176:179], v[240:243]
    ds_read_b64_tr_b16 a[56:57], v10 offset:64
    v_mfma_f32_16x16x32_bf16 a[16:19], a[80:83], a[180:183], a[16:19]
    buffer_load_dwordx4 v4, s[28:31], s57 offen offset:2112 nt lds
    v_mfma_f32_16x16x32_bf16 v[20:23], a[84:87], a[148:151], v[20:23]
    ds_read_b64_tr_b16 a[58:59], v10 offset:576
    v_mfma_f32_16x16x32_bf16 v[52:55], a[84:87], a[152:155], v[52:55]
    buffer_load_dwordx4 v5, s[28:31], s57 offen offset:3168 nt lds
    v_mfma_f32_16x16x32_bf16 v[84:87], a[84:87], a[156:159], v[84:87]
    s_mov_b32 m0, 101376
    ds_read_b64_tr_b16 a[60:61], v10 offset:96
    v_mfma_f32_16x16x32_bf16 v[116:119], a[84:87], a[160:163], v[116:119]
    s_add_u32 s57, s77, 65536
    buffer_load_dwordx4 v6, s[36:39], s57 offen offset:0 lds
    v_mfma_f32_16x16x32_bf16 v[148:151], a[84:87], a[164:167], v[148:151]
    ds_read_b64_tr_b16 a[62:63], v10 offset:608
    v_mfma_f32_16x16x32_bf16 v[180:183], a[84:87], a[168:171], v[180:183]
    buffer_load_dwordx4 a[116:119], v5, s[40:43], s58 offen offset:0 sc1
    v_mfma_f32_16x16x32_bf16 v[212:215], a[84:87], a[172:175], v[212:215]
    s_add_u32 s58, s82, 8192
    ds_read_b64_tr_b16 a[64:65], v10 offset:128
    v_mfma_f32_16x16x32_bf16 v[244:247], a[84:87], a[176:179], v[244:247]
    buffer_load_dwordx4 v7, s[36:39], s57 offen offset:1056 lds
    v_mfma_f32_16x16x32_bf16 a[20:23], a[84:87], a[180:183], a[20:23]
    ds_read_b64_tr_b16 a[66:67], v10 offset:640
    v_mfma_f32_16x16x32_bf16 v[24:27], a[88:91], a[148:151], v[24:27]
    buffer_load_dwordx4 a[120:123], v5, s[40:43], s58 offen offset:0 sc1
    v_mfma_f32_16x16x32_bf16 v[56:59], a[88:91], a[152:155], v[56:59]
    s_add_u32 s58, s82, 12288
    ds_read_b64_tr_b16 a[68:69], v10 offset:160
    v_mfma_f32_16x16x32_bf16 v[88:91], a[88:91], a[156:159], v[88:91]
    buffer_load_dwordx4 v8, s[36:39], s57 offen offset:2112 lds
    v_mfma_f32_16x16x32_bf16 v[120:123], a[88:91], a[160:163], v[120:123]
    ds_read_b64_tr_b16 a[70:71], v10 offset:672
    v_mfma_f32_16x16x32_bf16 v[152:155], a[88:91], a[164:167], v[152:155]
    buffer_load_dwordx4 v9, s[36:39], s57 offen offset:3168 lds
    v_mfma_f32_16x16x32_bf16 v[184:187], a[88:91], a[168:171], v[184:187]
    s_add_u32 m0, s60, 4224
    ds_read_b64_tr_b16 a[72:73], v10 offset:192
    v_mfma_f32_16x16x32_bf16 v[216:219], a[88:91], a[172:175], v[216:219]
    s_add_u32 s57, s63, 4096
    buffer_load_dwordx4 v2, s[28:31], s57 offen offset:0 nt lds
    v_mfma_f32_16x16x32_bf16 v[248:251], a[88:91], a[176:179], v[248:251]
    ds_read_b64_tr_b16 a[74:75], v10 offset:704
    v_mfma_f32_16x16x32_bf16 a[24:27], a[88:91], a[180:183], a[24:27]
    buffer_load_dwordx4 v3, s[28:31], s57 offen offset:1056 nt lds
    v_mfma_f32_16x16x32_bf16 v[28:31], a[92:95], a[148:151], v[28:31]
    ds_read_b64_tr_b16 a[76:77], v10 offset:224
    v_mfma_f32_16x16x32_bf16 v[60:63], a[92:95], a[152:155], v[60:63]
    buffer_load_dwordx4 a[124:127], v5, s[40:43], s58 offen offset:0 sc1
    v_mfma_f32_16x16x32_bf16 v[92:95], a[92:95], a[156:159], v[92:95]
    s_add_u32 s58, s82, 16384
    ds_read_b64_tr_b16 a[78:79], v10 offset:736
    v_mfma_f32_16x16x32_bf16 v[124:127], a[92:95], a[160:163], v[124:127]
    buffer_load_dwordx4 v4, s[28:31], s57 offen offset:2112 nt lds
    v_mfma_f32_16x16x32_bf16 v[156:159], a[92:95], a[164:167], v[156:159]
    v_mfma_f32_16x16x32_bf16 v[188:191], a[92:95], a[168:171], v[188:191]
    buffer_load_dwordx4 a[128:131], v5, s[40:43], s58 offen offset:0 sc1
    v_mfma_f32_16x16x32_bf16 v[220:223], a[92:95], a[172:175], v[220:223]
    s_add_u32 s58, s82, 20480
    v_mfma_f32_16x16x32_bf16 v[252:255], a[92:95], a[176:179], v[252:255]
    buffer_load_dwordx4 v5, s[28:31], s57 offen offset:3168 nt lds
    v_mfma_f32_16x16x32_bf16 a[28:31], a[92:95], a[180:183], a[28:31]
    s_add_u32 s66, s66, 8192
    v_mfma_f32_16x16x32_bf16 v[32:35], a[96:99], a[148:151], v[32:35]
    s_and_b32 s66, s66, 0x3ffff
    buffer_load_dwordx4 a[132:135], v5, s[40:43], s58 offen offset:0 sc1
    v_mfma_f32_16x16x32_bf16 v[64:67], a[96:99], a[152:155], v[64:67]
    s_add_u32 s63, s64, s66
    v_mfma_f32_16x16x32_bf16 v[96:99], a[96:99], a[156:159], v[96:99]
    s_add_u32 m0, s60, 8448
    v_mfma_f32_16x16x32_bf16 v[128:131], a[96:99], a[160:163], v[128:131]
    s_add_u32 s57, s63, 0
    buffer_load_dwordx4 v2, s[24:27], s57 offen offset:0 nt lds
    v_mfma_f32_16x16x32_bf16 v[160:163], a[96:99], a[164:167], v[160:163]
    s_add_u32 s58, s82, 24576
    v_mfma_f32_16x16x32_bf16 v[192:195], a[96:99], a[168:171], v[192:195]
    buffer_load_dwordx4 v3, s[24:27], s57 offen offset:1056 nt lds
    v_mfma_f32_16x16x32_bf16 v[224:227], a[96:99], a[172:175], v[224:227]
    v_mfma_f32_16x16x32_bf16 a[0:3], a[96:99], a[176:179], a[0:3]
    buffer_load_dwordx4 v4, s[24:27], s57 offen offset:2112 nt lds
    v_mfma_f32_16x16x32_bf16 a[32:35], a[96:99], a[180:183], a[32:35]
    v_mfma_f32_16x16x32_bf16 v[36:39], a[100:103], a[148:151], v[36:39]
    buffer_load_dwordx4 v5, s[24:27], s57 offen offset:3168 nt lds
    v_mfma_f32_16x16x32_bf16 v[68:71], a[100:103], a[152:155], v[68:71]
    s_mov_b32 m0, 105600
    v_mfma_f32_16x16x32_bf16 v[100:103], a[100:103], a[156:159], v[100:103]
    s_add_u32 s57, s77, 69632
    buffer_load_dwordx4 v6, s[36:39], s57 offen offset:0 lds
    v_mfma_f32_16x16x32_bf16 v[132:135], a[100:103], a[160:163], v[132:135]
    v_mfma_f32_16x16x32_bf16 v[164:167], a[100:103], a[164:167], v[164:167]
    buffer_load_dwordx4 v7, s[36:39], s57 offen offset:1056 lds
    v_mfma_f32_16x16x32_bf16 v[196:199], a[100:103], a[168:171], v[196:199]
    v_mfma_f32_16x16x32_bf16 v[228:231], a[100:103], a[172:175], v[228:231]
    buffer_load_dwordx4 a[136:139], v5, s[40:43], s58 offen offset:0 sc1
    v_mfma_f32_16x16x32_bf16 a[4:7], a[100:103], a[176:179], a[4:7]
    s_add_u32 s58, s82, 28672
    v_mfma_f32_16x16x32_bf16 a[36:39], a[100:103], a[180:183], a[36:39]
    buffer_load_dwordx4 v8, s[36:39], s57 offen offset:2112 lds
    v_mfma_f32_16x16x32_bf16 v[40:43], a[104:107], a[148:151], v[40:43]
    v_mfma_f32_16x16x32_bf16 v[72:75], a[104:107], a[152:155], v[72:75]
    buffer_load_dwordx4 a[140:143], v5, s[40:43], s58 offen offset:0 sc1
    v_mfma_f32_16x16x32_bf16 v[104:107], a[104:107], a[156:159], v[104:107]
    s_add_u32 s58, s82, 32768
    v_mfma_f32_16x16x32_bf16 v[136:139], a[104:107], a[160:163], v[136:139]
    buffer_load_dwordx4 v9, s[36:39], s57 offen offset:3168 lds
    v_mfma_f32_16x16x32_bf16 v[168:171], a[104:107], a[164:167], v[168:171]
    s_add_u32 m0, s60, 12672
    v_mfma_f32_16x16x32_bf16 v[200:203], a[104:107], a[168:171], v[200:203]
    s_add_u32 s57, s63, 4096
    buffer_load_dwordx4 v2, s[24:27], s57 offen offset:0 nt lds
    v_mfma_f32_16x16x32_bf16 v[232:235], a[104:107], a[172:175], v[232:235]
    v_mfma_f32_16x16x32_bf16 a[8:11], a[104:107], a[176:179], a[8:11]
    buffer_load_dwordx4 v3, s[24:27], s57 offen offset:1056 nt lds
    v_mfma_f32_16x16x32_bf16 a[40:43], a[104:107], a[180:183], a[40:43]
    v_mfma_f32_16x16x32_bf16 v[44:47], a[108:111], a[148:151], v[44:47]
    buffer_load_dwordx4 a[144:147], v5, s[40:43], s58 offen offset:0 sc1
    v_mfma_f32_16x16x32_bf16 v[76:79], a[108:111], a[152:155], v[76:79]
    v_mfma_f32_16x16x32_bf16 v[108:111], a[108:111], a[156:159], v[108:111]
    buffer_load_dwordx4 v4, s[24:27], s57 offen offset:2112 nt lds
    v_mfma_f32_16x16x32_bf16 v[140:143], a[108:111], a[160:163], v[140:143]
    v_mfma_f32_16x16x32_bf16 v[172:175], a[108:111], a[164:167], v[172:175]
    buffer_load_dwordx4 v5, s[24:27], s57 offen offset:3168 nt lds
    v_mfma_f32_16x16x32_bf16 v[204:207], a[108:111], a[168:171], v[204:207]
    s_add_u32 s60, s60, 16896
    v_mfma_f32_16x16x32_bf16 v[236:239], a[108:111], a[172:175], v[236:239]
    s_cmp_ge_u32 s60, s61
    v_mfma_f32_16x16x32_bf16 a[12:15], a[108:111], a[176:179], a[12:15]
    s_cselect_b32 s60, 0, s60
    v_mfma_f32_16x16x32_bf16 a[44:47], a[108:111], a[180:183], a[44:47]
    s_waitcnt vmcnt(63)
    s_barrier
    s_waitcnt lgkmcnt(0)
    v_mfma_f32_16x16x32_bf16 v[16:19], a[48:51], a[184:187], v[16:19]
    ds_read_b64_tr_b16 a[80:81], v10 offset:8448
    v_mfma_f32_16x16x32_bf16 v[48:51], a[48:51], a[188:191], v[48:51]
    s_add_u32 m0, s60, 0
    ds_read_b64_tr_b16 a[82:83], v10 offset:8960
    v_mfma_f32_16x16x32_bf16 v[80:83], a[48:51], a[192:195], v[80:83]
    s_add_u32 s57, s63, 0
    buffer_load_dwordx4 v2, s[28:31], s57 offen offset:0 nt lds
    v_mfma_f32_16x16x32_bf16 v[112:115], a[48:51], a[196:199], v[112:115]
    s_add_u32 s58, s82, 0
    ds_read_b64_tr_b16 a[84:85], v10 offset:8480
    v_mfma_f32_16x16x32_bf16 v[144:147], a[48:51], a[200:203], v[144:147]
    buffer_load_dwordx4 a[148:151], v5, s[40:43], s58 offen offset:1024 sc1
    v_mfma_f32_16x16x32_bf16 v[176:179], a[48:51], a[204:207], v[176:179]
    s_add_u32 s58, s82, 4096
    ds_read_b64_tr_b16 a[86:87], v10 offset:8992
    v_mfma_f32_16x16x32_bf16 v[208:211], a[48:51], a[208:211], v[208:211]
    buffer_load_dwordx4 v3, s[28:31], s57 offen offset:1056 nt lds
    v_mfma_f32_16x16x32_bf16 v[240:243], a[48:51], a[212:215], v[240:243]
    ds_read_b64_tr_b16 a[88:89], v10 offset:8512
    v_mfma_f32_16x16x32_bf16 a[16:19], a[48:51], a[216:219], a[16:19]
    buffer_load_dwordx4 v4, s[28:31], s57 offen offset:2112 nt lds
    v_mfma_f32_16x16x32_bf16 v[20:23], a[52:55], a[184:187], v[20:23]
    ds_read_b64_tr_b16 a[90:91], v10 offset:9024
    v_mfma_f32_16x16x32_bf16 v[52:55], a[52:55], a[188:191], v[52:55]
    buffer_load_dwordx4 v5, s[28:31], s57 offen offset:3168 nt lds
    v_mfma_f32_16x16x32_bf16 v[84:87], a[52:55], a[192:195], v[84:87]
    s_mov_b32 m0, 109824
    ds_read_b64_tr_b16 a[92:93], v10 offset:8544
    v_mfma_f32_16x16x32_bf16 v[116:119], a[52:55], a[196:199], v[116:119]
    s_add_u32 s57, s77, 98304
    buffer_load_dwordx4 v6, s[36:39], s57 offen offset:0 lds
    v_mfma_f32_16x16x32_bf16 v[148:151], a[52:55], a[200:203], v[148:151]
    ds_read_b64_tr_b16 a[94:95], v10 offset:9056
    v_mfma_f32_16x16x32_bf16 v[180:183], a[52:55], a[204:207], v[180:183]
    buffer_load_dwordx4 v7, s[36:39], s57 offen offset:1056 lds
    v_mfma_f32_16x16x32_bf16 v[212:215], a[52:55], a[208:211], v[212:215]
    ds_read_b64_tr_b16 a[96:97], v10 offset:8576
    v_mfma_f32_16x16x32_bf16 v[244:247], a[52:55], a[212:215], v[244:247]
    buffer_load_dwordx4 a[152:155], v5, s[40:43], s58 offen offset:1024 sc1
    v_mfma_f32_16x16x32_bf16 a[20:23], a[52:55], a[216:219], a[20:23]
    s_add_u32 s58, s82, 8192
    ds_read_b64_tr_b16 a[98:99], v10 offset:9088
    v_mfma_f32_16x16x32_bf16 v[24:27], a[56:59], a[184:187], v[24:27]
    buffer_load_dwordx4 v8, s[36:39], s57 offen offset:2112 lds
    v_mfma_f32_16x16x32_bf16 v[56:59], a[56:59], a[188:191], v[56:59]
    ds_read_b64_tr_b16 a[100:101], v10 offset:8608
    v_mfma_f32_16x16x32_bf16 v[88:91], a[56:59], a[192:195], v[88:91]
    buffer_load_dwordx4 a[156:159], v5, s[40:43], s58 offen offset:1024 sc1
    v_mfma_f32_16x16x32_bf16 v[120:123], a[56:59], a[196:199], v[120:123]
    s_add_u32 s58, s82, 12288
    ds_read_b64_tr_b16 a[102:103], v10 offset:9120
    v_mfma_f32_16x16x32_bf16 v[152:155], a[56:59], a[200:203], v[152:155]
    buffer_load_dwordx4 v9, s[36:39], s57 offen offset:3168 lds
    v_mfma_f32_16x16x32_bf16 v[184:187], a[56:59], a[204:207], v[184:187]
    s_add_u32 m0, s60, 4224
    ds_read_b64_tr_b16 a[104:105], v10 offset:8640
    v_mfma_f32_16x16x32_bf16 v[216:219], a[56:59], a[208:211], v[216:219]
    s_add_u32 s57, s63, 4096
    buffer_load_dwordx4 v2, s[28:31], s57 offen offset:0 nt lds
    v_mfma_f32_16x16x32_bf16 v[248:251], a[56:59], a[212:215], v[248:251]
    ds_read_b64_tr_b16 a[106:107], v10 offset:9152
    v_mfma_f32_16x16x32_bf16 a[24:27], a[56:59], a[216:219], a[24:27]
    buffer_load_dwordx4 v3, s[28:31], s57 offen offset:1056 nt lds
    v_mfma_f32_16x16x32_bf16 v[28:31], a[60:63], a[184:187], v[28:31]
    ds_read_b64_tr_b16 a[108:109], v10 offset:8672
    v_mfma_f32_16x16x32_bf16 v[60:63], a[60:63], a[188:191], v[60:63]
    buffer_load_dwordx4 a[160:163], v5, s[40:43], s58 offen offset:1024 sc1
    v_mfma_f32_16x16x32_bf16 v[92:95], a[60:63], a[192:195], v[92:95]
    s_add_u32 s58, s82, 16384
    ds_read_b64_tr_b16 a[110:111], v10 offset:9184
    v_mfma_f32_16x16x32_bf16 v[124:127], a[60:63], a[196:199], v[124:127]
    buffer_load_dwordx4 v4, s[28:31], s57 offen offset:2112 nt lds
    v_mfma_f32_16x16x32_bf16 v[156:159], a[60:63], a[200:203], v[156:159]
    v_mfma_f32_16x16x32_bf16 v[188:191], a[60:63], a[204:207], v[188:191]
    buffer_load_dwordx4 a[164:167], v5, s[40:43], s58 offen offset:1024 sc1
    v_mfma_f32_16x16x32_bf16 v[220:223], a[60:63], a[208:211], v[220:223]
    s_add_u32 s58, s82, 20480
    v_mfma_f32_16x16x32_bf16 v[252:255], a[60:63], a[212:215], v[252:255]
    buffer_load_dwordx4 v5, s[28:31], s57 offen offset:3168 nt lds
    v_mfma_f32_16x16x32_bf16 a[28:31], a[60:63], a[216:219], a[28:31]
    s_mov_b32 m0, 114048
    v_mfma_f32_16x16x32_bf16 v[32:35], a[64:67], a[184:187], v[32:35]
    s_add_u32 s57, s77, 102400
    buffer_load_dwordx4 v6, s[36:39], s57 offen offset:0 lds
    v_mfma_f32_16x16x32_bf16 v[64:67], a[64:67], a[188:191], v[64:67]
    v_mfma_f32_16x16x32_bf16 v[96:99], a[64:67], a[192:195], v[96:99]
    buffer_load_dwordx4 v7, s[36:39], s57 offen offset:1056 lds
    v_mfma_f32_16x16x32_bf16 v[128:131], a[64:67], a[196:199], v[128:131]
    v_mfma_f32_16x16x32_bf16 v[160:163], a[64:67], a[200:203], v[160:163]
    buffer_load_dwordx4 a[168:171], v5, s[40:43], s58 offen offset:1024 sc1
    v_mfma_f32_16x16x32_bf16 v[192:195], a[64:67], a[204:207], v[192:195]
    s_add_u32 s58, s82, 24576
    v_mfma_f32_16x16x32_bf16 v[224:227], a[64:67], a[208:211], v[224:227]
    buffer_load_dwordx4 v8, s[36:39], s57 offen offset:2112 lds
    v_mfma_f32_16x16x32_bf16 a[0:3], a[64:67], a[212:215], a[0:3]
    v_mfma_f32_16x16x32_bf16 a[32:35], a[64:67], a[216:219], a[32:35]
    buffer_load_dwordx4 v9, s[36:39], s57 offen offset:3168 lds
    v_mfma_f32_16x16x32_bf16 v[36:39], a[68:71], a[184:187], v[36:39]
    s_add_u32 s66, s66, 8192
    v_mfma_f32_16x16x32_bf16 v[68:71], a[68:71], a[188:191], v[68:71]
    s_and_b32 s66, s66, 0x3ffff
    buffer_load_dwordx4 a[172:175], v5, s[40:43], s58 offen offset:1024 sc1
    v_mfma_f32_16x16x32_bf16 v[100:103], a[68:71], a[192:195], v[100:103]
    s_add_u32 s63, s64, s66
    v_mfma_f32_16x16x32_bf16 v[132:135], a[68:71], a[196:199], v[132:135]
    s_add_u32 m0, s60, 8448
    v_mfma_f32_16x16x32_bf16 v[164:167], a[68:71], a[200:203], v[164:167]
    s_add_u32 s57, s63, 0
    buffer_load_dwordx4 v2, s[24:27], s57 offen offset:0 nt lds
    v_mfma_f32_16x16x32_bf16 v[196:199], a[68:71], a[204:207], v[196:199]
    s_add_u32 s58, s82, 28672
    buffer_load_dwordx4 v3, s[24:27], s57 offen offset:1056 nt lds
    v_mfma_f32_16x16x32_bf16 v[228:231], a[68:71], a[208:211], v[228:231]
    v_mfma_f32_16x16x32_bf16 a[4:7], a[68:71], a[212:215], a[4:7]
    buffer_load_dwordx4 v4, s[24:27], s57 offen offset:2112 nt lds
    v_mfma_f32_16x16x32_bf16 a[36:39], a[68:71], a[216:219], a[36:39]
    v_mfma_f32_16x16x32_bf16 v[40:43], a[72:75], a[184:187], v[40:43]
    buffer_load_dwordx4 v5, s[24:27], s57 offen offset:3168 nt lds
    v_mfma_f32_16x16x32_bf16 v[72:75], a[72:75], a[188:191], v[72:75]
    s_add_u32 m0, s60, 12672
    v_mfma_f32_16x16x32_bf16 v[104:107], a[72:75], a[192:195], v[104:107]
    s_add_u32 s57, s63, 4096
    buffer_load_dwordx4 v2, s[24:27], s57 offen offset:0 nt lds
    v_mfma_f32_16x16x32_bf16 v[136:139], a[72:75], a[196:199], v[136:139]
    v_mfma_f32_16x16x32_bf16 v[168:171], a[72:75], a[200:203], v[168:171]
    buffer_load_dwordx4 a[176:179], v5, s[40:43], s58 offen offset:1024 sc1
    v_mfma_f32_16x16x32_bf16 v[200:203], a[72:75], a[204:207], v[200:203]
    s_add_u32 s58, s82, 32768
    v_mfma_f32_16x16x32_bf16 v[232:235], a[72:75], a[208:211], v[232:235]
    buffer_load_dwordx4 v3, s[24:27], s57 offen offset:1056 nt lds
    v_mfma_f32_16x16x32_bf16 a[8:11], a[72:75], a[212:215], a[8:11]
    v_mfma_f32_16x16x32_bf16 a[40:43], a[72:75], a[216:219], a[40:43]
    buffer_load_dwordx4 a[180:183], v5, s[40:43], s58 offen offset:1024 sc1
    v_mfma_f32_16x16x32_bf16 v[44:47], a[76:79], a[184:187], v[44:47]
    v_mfma_f32_16x16x32_bf16 v[76:79], a[76:79], a[188:191], v[76:79]
    buffer_load_dwordx4 v4, s[24:27], s57 offen offset:2112 nt lds
    v_mfma_f32_16x16x32_bf16 v[108:111], a[76:79], a[192:195], v[108:111]
    v_mfma_f32_16x16x32_bf16 v[140:143], a[76:79], a[196:199], v[140:143]
    buffer_load_dwordx4 v5, s[24:27], s57 offen offset:3168 nt lds
    v_mfma_f32_16x16x32_bf16 v[172:175], a[76:79], a[200:203], v[172:175]
    s_add_u32 s60, s60, 16896
    v_mfma_f32_16x16x32_bf16 v[204:207], a[76:79], a[204:207], v[204:207]
    s_cmp_ge_u32 s60, s61
    v_mfma_f32_16x16x32_bf16 v[236:239], a[76:79], a[208:211], v[236:239]
    s_cselect_b32 s60, 0, s60
    v_mfma_f32_16x16x32_bf16 a[12:15], a[76:79], a[212:215], a[12:15]
    v_mfma_f32_16x16x32_bf16 a[44:47], a[76:79], a[216:219], a[44:47]
    s_waitcnt vmcnt(63)
    s_barrier
    s_waitcnt lgkmcnt(0)
    s_mov_b64 exec, 7
    buffer_load_dword v14, v5, s[40:43], s89 offen sc1
    s_mov_b64 exec, -1
    v_mfma_f32_16x16x32_bf16 v[16:19], a[80:83], a[220:223], v[16:19]
    ds_read_b64_tr_b16 a[48:49], v10 offset:16896
    v_mfma_f32_16x16x32_bf16 v[48:51], a[80:83], a[224:227], v[48:51]
    s_add_u32 m0, s60, 0
    ds_read_b64_tr_b16 a[50:51], v10 offset:17408
    v_mfma_f32_16x16x32_bf16 v[80:83], a[80:83], a[228:231], v[80:83]
    s_add_u32 s57, s63, 0
    buffer_load_dwordx4 v2, s[28:31], s57 offen offset:0 nt lds
    v_mfma_f32_16x16x32_bf16 v[112:115], a[80:83], a[232:235], v[112:115]
    s_add_u32 s58, s82, 0
    ds_read_b64_tr_b16 a[52:53], v10 offset:16928
    v_mfma_f32_16x16x32_bf16 v[144:147], a[80:83], a[236:239], v[144:147]
    buffer_load_dwordx4 a[184:187], v5, s[40:43], s58 offen offset:2048 sc1
    v_mfma_f32_16x16x32_bf16 v[176:179], a[80:83], a[240:243], v[176:179]
    s_add_u32 s58, s82, 4096
    ds_read_b64_tr_b16 a[54:55], v10 offset:17440
    v_mfma_f32_16x16x32_bf16 v[208:211], a[80:83], a[244:247], v[208:211]
    buffer_load_dwordx4 v3, s[28:31], s57 offen offset:1056 nt lds
    v_mfma_f32_16x16x32_bf16 v[240:243], a[80:83], a[248:251], v[240:243]
    ds_read_b64_tr_b16 a[56:57], v10 offset:16960
    v_mfma_f32_16x16x32_bf16 a[16:19], a[80:83], a[252:255], a[16:19]
    buffer_load_dwordx4 v4, s[28:31], s57 offen offset:2112 nt lds
    v_mfma_f32_16x16x32_bf16 v[20:23], a[84:87], a[220:223], v[20:23]
    ds_read_b64_tr_b16 a[58:59], v10 offset:17472
    v_mfma_f32_16x16x32_bf16 v[52:55], a[84:87], a[224:227], v[52:55]
    buffer_load_dwordx4 v5, s[28:31], s57 offen offset:3168 nt lds
    v_mfma_f32_16x16x32_bf16 v[84:87], a[84:87], a[228:231], v[84:87]
    s_mov_b32 m0, 67584
    ds_read_b64_tr_b16 a[60:61], v10 offset:16992
    v_mfma_f32_16x16x32_bf16 v[116:119], a[84:87], a[232:235], v[116:119]
    s_add_u32 s57, s78, 0
    buffer_load_dwordx4 v6, s[36:39], s57 offen offset:0 lds
    v_mfma_f32_16x16x32_bf16 v[148:151], a[84:87], a[236:239], v[148:151]
    ds_read_b64_tr_b16 a[62:63], v10 offset:17504
    v_mfma_f32_16x16x32_bf16 v[180:183], a[84:87], a[240:243], v[180:183]
    buffer_load_dwordx4 a[188:191], v5, s[40:43], s58 offen offset:2048 sc1
    v_mfma_f32_16x16x32_bf16 v[212:215], a[84:87], a[244:247], v[212:215]
    s_add_u32 s58, s82, 8192
    ds_read_b64_tr_b16 a[64:65], v10 offset:17024
    v_mfma_f32_16x16x32_bf16 v[244:247], a[84:87], a[248:251], v[244:247]
    buffer_load_dwordx4 v7, s[36:39], s57 offen offset:1056 lds
    v_mfma_f32_16x16x32_bf16 a[20:23], a[84:87], a[252:255], a[20:23]
    ds_read_b64_tr_b16 a[66:67], v10 offset:17536
    v_mfma_f32_16x16x32_bf16 v[24:27], a[88:91], a[220:223], v[24:27]
    buffer_load_dwordx4 a[192:195], v5, s[40:43], s58 offen offset:2048 sc1
    v_mfma_f32_16x16x32_bf16 v[56:59], a[88:91], a[224:227], v[56:59]
    s_add_u32 s58, s82, 12288
    ds_read_b64_tr_b16 a[68:69], v10 offset:17056
    v_mfma_f32_16x16x32_bf16 v[88:91], a[88:91], a[228:231], v[88:91]
    buffer_load_dwordx4 v8, s[36:39], s57 offen offset:2112 lds
    v_mfma_f32_16x16x32_bf16 v[120:123], a[88:91], a[232:235], v[120:123]
    ds_read_b64_tr_b16 a[70:71], v10 offset:17568
    v_mfma_f32_16x16x32_bf16 v[152:155], a[88:91], a[236:239], v[152:155]
    buffer_load_dwordx4 v9, s[36:39], s57 offen offset:3168 lds
    v_mfma_f32_16x16x32_bf16 v[184:187], a[88:91], a[240:243], v[184:187]
    s_add_u32 m0, s60, 4224
    ds_read_b64_tr_b16 a[72:73], v10 offset:17088
    v_mfma_f32_16x16x32_bf16 v[216:219], a[88:91], a[244:247], v[216:219]
    s_add_u32 s57, s63, 4096
    buffer_load_dwordx4 v2, s[28:31], s57 offen offset:0 nt lds
    v_mfma_f32_16x16x32_bf16 v[248:251], a[88:91], a[248:251], v[248:251]
    ds_read_b64_tr_b16 a[74:75], v10 offset:17600
    v_mfma_f32_16x16x32_bf16 a[24:27], a[88:91], a[252:255], a[24:27]
    buffer_load_dwordx4 v3, s[28:31], s57 offen offset:1056 nt lds
    v_mfma_f32_16x16x32_bf16 v[28:31], a[92:95], a[220:223], v[28:31]
    ds_read_b64_tr_b16 a[76:77], v10 offset:17120
    v_mfma_f32_16x16x32_bf16 v[60:63], a[92:95], a[224:227], v[60:63]
    buffer_load_dwordx4 a[196:199], v5, s[40:43], s58 offen offset:2048 sc1
    v_mfma_f32_16x16x32_bf16 v[92:95], a[92:95], a[228:231], v[92:95]
    s_add_u32 s58, s82, 16384
    ds_read_b64_tr_b16 a[78:79], v10 offset:17632
    v_mfma_f32_16x16x32_bf16 v[124:127], a[92:95], a[232:235], v[124:127]
    buffer_load_dwordx4 v4, s[28:31], s57 offen offset:2112 nt lds
    v_mfma_f32_16x16x32_bf16 v[156:159], a[92:95], a[236:239], v[156:159]
    v_mfma_f32_16x16x32_bf16 v[188:191], a[92:95], a[240:243], v[188:191]
    buffer_load_dwordx4 a[200:203], v5, s[40:43], s58 offen offset:2048 sc1
    v_mfma_f32_16x16x32_bf16 v[220:223], a[92:95], a[244:247], v[220:223]
    s_add_u32 s58, s82, 20480
    v_mfma_f32_16x16x32_bf16 v[252:255], a[92:95], a[248:251], v[252:255]
    buffer_load_dwordx4 v5, s[28:31], s57 offen offset:3168 nt lds
    v_mfma_f32_16x16x32_bf16 a[28:31], a[92:95], a[252:255], a[28:31]
    s_add_u32 s66, s66, 8192
    v_mfma_f32_16x16x32_bf16 v[32:35], a[96:99], a[220:223], v[32:35]
    s_and_b32 s66, s66, 0x3ffff
    buffer_load_dwordx4 a[204:207], v5, s[40:43], s58 offen offset:2048 sc1
    v_mfma_f32_16x16x32_bf16 v[64:67], a[96:99], a[224:227], v[64:67]
    s_add_u32 s63, s64, s66
    v_mfma_f32_16x16x32_bf16 v[96:99], a[96:99], a[228:231], v[96:99]
    s_add_u32 m0, s60, 8448
    v_mfma_f32_16x16x32_bf16 v[128:131], a[96:99], a[232:235], v[128:131]
    s_add_u32 s57, s63, 0
    buffer_load_dwordx4 v2, s[24:27], s57 offen offset:0 nt lds
    v_mfma_f32_16x16x32_bf16 v[160:163], a[96:99], a[236:239], v[160:163]
    s_add_u32 s58, s82, 24576
    v_mfma_f32_16x16x32_bf16 v[192:195], a[96:99], a[240:243], v[192:195]
    buffer_load_dwordx4 v3, s[24:27], s57 offen offset:1056 nt lds
    v_mfma_f32_16x16x32_bf16 v[224:227], a[96:99], a[244:247], v[224:227]
    v_mfma_f32_16x16x32_bf16 a[0:3], a[96:99], a[248:251], a[0:3]
    buffer_load_dwordx4 v4, s[24:27], s57 offen offset:2112 nt lds
    v_mfma_f32_16x16x32_bf16 a[32:35], a[96:99], a[252:255], a[32:35]
    v_mfma_f32_16x16x32_bf16 v[36:39], a[100:103], a[220:223], v[36:39]
    buffer_load_dwordx4 v5, s[24:27], s57 offen offset:3168 nt lds
    v_mfma_f32_16x16x32_bf16 v[68:71], a[100:103], a[224:227], v[68:71]
    s_mov_b32 m0, 71808
    v_mfma_f32_16x16x32_bf16 v[100:103], a[100:103], a[228:231], v[100:103]
    s_add_u32 s57, s78, 4096
    buffer_load_dwordx4 v6, s[36:39], s57 offen offset:0 lds
    v_mfma_f32_16x16x32_bf16 v[132:135], a[100:103], a[232:235], v[132:135]
    v_mfma_f32_16x16x32_bf16 v[164:167], a[100:103], a[236:239], v[164:167]
    buffer_load_dwordx4 v7, s[36:39], s57 offen offset:1056 lds
    v_mfma_f32_16x16x32_bf16 v[196:199], a[100:103], a[240:243], v[196:199]
    v_mfma_f32_16x16x32_bf16 v[228:231], a[100:103], a[244:247], v[228:231]
    buffer_load_dwordx4 a[208:211], v5, s[40:43], s58 offen offset:2048 sc1
    v_mfma_f32_16x16x32_bf16 a[4:7], a[100:103], a[248:251], a[4:7]
    s_add_u32 s58, s82, 28672
    v_mfma_f32_16x16x32_bf16 a[36:39], a[100:103], a[252:255], a[36:39]
    buffer_load_dwordx4 v8, s[36:39], s57 offen offset:2112 lds
    v_mfma_f32_16x16x32_bf16 v[40:43], a[104:107], a[220:223], v[40:43]
    v_mfma_f32_16x16x32_bf16 v[72:75], a[104:107], a[224:227], v[72:75]
    buffer_load_dwordx4 a[212:215], v5, s[40:43], s58 offen offset:2048 sc1
    v_mfma_f32_16x16x32_bf16 v[104:107], a[104:107], a[228:231], v[104:107]
    s_add_u32 s58, s82, 32768
    v_mfma_f32_16x16x32_bf16 v[136:139], a[104:107], a[232:235], v[136:139]
    buffer_load_dwordx4 v9, s[36:39], s57 offen offset:3168 lds
    v_mfma_f32_16x16x32_bf16 v[168:171], a[104:107], a[236:239], v[168:171]
    s_add_u32 m0, s60, 12672
    v_mfma_f32_16x16x32_bf16 v[200:203], a[104:107], a[240:243], v[200:203]
    s_add_u32 s57, s63, 4096
    buffer_load_dwordx4 v2, s[24:27], s57 offen offset:0 nt lds
    v_mfma_f32_16x16x32_bf16 v[232:235], a[104:107], a[244:247], v[232:235]
    v_mfma_f32_16x16x32_bf16 a[8:11], a[104:107], a[248:251], a[8:11]
    buffer_load_dwordx4 v3, s[24:27], s57 offen offset:1056 nt lds
    v_mfma_f32_16x16x32_bf16 a[40:43], a[104:107], a[252:255], a[40:43]
    v_mfma_f32_16x16x32_bf16 v[44:47], a[108:111], a[220:223], v[44:47]
    buffer_load_dwordx4 a[216:219], v5, s[40:43], s58 offen offset:2048 sc1
    v_mfma_f32_16x16x32_bf16 v[76:79], a[108:111], a[224:227], v[76:79]
    v_mfma_f32_16x16x32_bf16 v[108:111], a[108:111], a[228:231], v[108:111]
    buffer_load_dwordx4 v4, s[24:27], s57 offen offset:2112 nt lds
    v_mfma_f32_16x16x32_bf16 v[140:143], a[108:111], a[232:235], v[140:143]
    v_mfma_f32_16x16x32_bf16 v[172:175], a[108:111], a[236:239], v[172:175]
    buffer_load_dwordx4 v5, s[24:27], s57 offen offset:3168 nt lds
    v_mfma_f32_16x16x32_bf16 v[204:207], a[108:111], a[240:243], v[204:207]
    s_add_u32 s60, s60, 16896
    v_mfma_f32_16x16x32_bf16 v[236:239], a[108:111], a[244:247], v[236:239]
    s_cmp_ge_u32 s60, s61
    v_mfma_f32_16x16x32_bf16 a[12:15], a[108:111], a[248:251], a[12:15]
    s_cselect_b32 s60, 0, s60
    v_mfma_f32_16x16x32_bf16 a[44:47], a[108:111], a[252:255], a[44:47]
    s_waitcnt vmcnt(63)
    s_barrier
    s_waitcnt lgkmcnt(0)
    v_mfma_f32_16x16x32_bf16 v[16:19], a[48:51], a[112:115], v[16:19]
    ds_read_b64_tr_b16 a[80:81], v10 offset:25344
    v_mfma_f32_16x16x32_bf16 v[48:51], a[48:51], a[116:119], v[48:51]
    s_add_u32 m0, s60, 0
    ds_read_b64_tr_b16 a[82:83], v10 offset:25856
    v_mfma_f32_16x16x32_bf16 v[80:83], a[48:51], a[120:123], v[80:83]
    s_add_u32 s57, s63, 0
    buffer_load_dwordx4 v2, s[28:31], s57 offen offset:0 nt lds
    v_mfma_f32_16x16x32_bf16 v[112:115], a[48:51], a[124:127], v[112:115]
    s_add_u32 s58, s82, 0
    ds_read_b64_tr_b16 a[84:85], v10 offset:25376
    v_mfma_f32_16x16x32_bf16 v[144:147], a[48:51], a[128:131], v[144:147]
    buffer_load_dwordx4 a[220:223], v5, s[40:43], s58 offen offset:3072 sc1
    v_mfma_f32_16x16x32_bf16 v[176:179], a[48:51], a[132:135], v[176:179]
    s_add_u32 s58, s82, 4096
    ds_read_b64_tr_b16 a[86:87], v10 offset:25888
    v_mfma_f32_16x16x32_bf16 v[208:211], a[48:51], a[136:139], v[208:211]
    buffer_load_dwordx4 v3, s[28:31], s57 offen offset:1056 nt lds
    v_mfma_f32_16x16x32_bf16 v[240:243], a[48:51], a[140:143], v[240:243]
    ds_read_b64_tr_b16 a[88:89], v10 offset:25408
    v_mfma_f32_16x16x32_bf16 a[16:19], a[48:51], a[144:147], a[16:19]
    buffer_load_dwordx4 v4, s[28:31], s57 offen offset:2112 nt lds
    v_mfma_f32_16x16x32_bf16 v[20:23], a[52:55], a[112:115], v[20:23]
    ds_read_b64_tr_b16 a[90:91], v10 offset:25920
    v_mfma_f32_16x16x32_bf16 v[52:55], a[52:55], a[116:119], v[52:55]
    buffer_load_dwordx4 v5, s[28:31], s57 offen offset:3168 nt lds
    v_mfma_f32_16x16x32_bf16 v[84:87], a[52:55], a[120:123], v[84:87]
    s_mov_b32 m0, 76032
    ds_read_b64_tr_b16 a[92:93], v10 offset:25440
    v_mfma_f32_16x16x32_bf16 v[116:119], a[52:55], a[124:127], v[116:119]
    s_add_u32 s57, s78, 32768
    buffer_load_dwordx4 v6, s[36:39], s57 offen offset:0 lds
    v_mfma_f32_16x16x32_bf16 v[148:151], a[52:55], a[128:131], v[148:151]
    ds_read_b64_tr_b16 a[94:95], v10 offset:25952
    v_mfma_f32_16x16x32_bf16 v[180:183], a[52:55], a[132:135], v[180:183]
    buffer_load_dwordx4 v7, s[36:39], s57 offen offset:1056 lds
    v_mfma_f32_16x16x32_bf16 v[212:215], a[52:55], a[136:139], v[212:215]
    ds_read_b64_tr_b16 a[96:97], v10 offset:25472
    v_mfma_f32_16x16x32_bf16 v[244:247], a[52:55], a[140:143], v[244:247]
    buffer_load_dwordx4 a[224:227], v5, s[40:43], s58 offen offset:3072 sc1
    v_mfma_f32_16x16x32_bf16 a[20:23], a[52:55], a[144:147], a[20:23]
    s_add_u32 s58, s82, 8192
    ds_read_b64_tr_b16 a[98:99], v10 offset:25984
    v_mfma_f32_16x16x32_bf16 v[24:27], a[56:59], a[112:115], v[24:27]
    buffer_load_dwordx4 v8, s[36:39], s57 offen offset:2112 lds
    v_mfma_f32_16x16x32_bf16 v[56:59], a[56:59], a[116:119], v[56:59]
    ds_read_b64_tr_b16 a[100:101], v10 offset:25504
    v_mfma_f32_16x16x32_bf16 v[88:91], a[56:59], a[120:123], v[88:91]
    buffer_load_dwordx4 a[228:231], v5, s[40:43], s58 offen offset:3072 sc1
    v_mfma_f32_16x16x32_bf16 v[120:123], a[56:59], a[124:127], v[120:123]
    s_add_u32 s58, s82, 12288
    ds_read_b64_tr_b16 a[102:103], v10 offset:26016
    v_mfma_f32_16x16x32_bf16 v[152:155], a[56:59], a[128:131], v[152:155]
    buffer_load_dwordx4 v9, s[36:39], s57 offen offset:3168 lds
    v_mfma_f32_16x16x32_bf16 v[184:187], a[56:59], a[132:135], v[184:187]
    s_add_u32 m0, s60, 4224
    ds_read_b64_tr_b16 a[104:105], v10 offset:25536
    v_mfma_f32_16x16x32_bf16 v[216:219], a[56:59], a[136:139], v[216:219]
    s_add_u32 s57, s63, 4096
    buffer_load_dwordx4 v2, s[28:31], s57 offen offset:0 nt lds
    v_mfma_f32_16x16x32_bf16 v[248:251], a[56:59], a[140:143], v[248:251]
    ds_read_b64_tr_b16 a[106:107], v10 offset:26048
    v_mfma_f32_16x16x32_bf16 a[24:27], a[56:59], a[144:147], a[24:27]
    buffer_load_dwordx4 v3, s[28:31], s57 offen offset:1056 nt lds
    v_mfma_f32_16x16x32_bf16 v[28:31], a[60:63], a[112:115], v[28:31]
    ds_read_b64_tr_b16 a[108:109], v10 offset:25568
    v_mfma_f32_16x16x32_bf16 v[60:63], a[60:63], a[116:119], v[60:63]
    buffer_load_dwordx4 a[232:235], v5, s[40:43], s58 offen offset:3072 sc1
    v_mfma_f32_16x16x32_bf16 v[92:95], a[60:63], a[120:123], v[92:95]
    s_add_u32 s58, s82, 16384
    ds_read_b64_tr_b16 a[110:111], v10 offset:26080
    v_mfma_f32_16x16x32_bf16 v[124:127], a[60:63], a[124:127], v[124:127]
    buffer_load_dwordx4 v4, s[28:31], s57 offen offset:2112 nt lds
    v_mfma_f32_16x16x32_bf16 v[156:159], a[60:63], a[128:131], v[156:159]
    v_mfma_f32_16x16x32_bf16 v[188:191], a[60:63], a[132:135], v[188:191]
    buffer_load_dwordx4 a[236:239], v5, s[40:43], s58 offen offset:3072 sc1
    v_mfma_f32_16x16x32_bf16 v[220:223], a[60:63], a[136:139], v[220:223]
    s_add_u32 s58, s82, 20480
    v_mfma_f32_16x16x32_bf16 v[252:255], a[60:63], a[140:143], v[252:255]
    buffer_load_dwordx4 v5, s[28:31], s57 offen offset:3168 nt lds
    v_mfma_f32_16x16x32_bf16 a[28:31], a[60:63], a[144:147], a[28:31]
    s_mov_b32 m0, 80256
    v_mfma_f32_16x16x32_bf16 v[32:35], a[64:67], a[112:115], v[32:35]
    s_add_u32 s57, s78, 36864
    buffer_load_dwordx4 v6, s[36:39], s57 offen offset:0 lds
    v_mfma_f32_16x16x32_bf16 v[64:67], a[64:67], a[116:119], v[64:67]
    v_mfma_f32_16x16x32_bf16 v[96:99], a[64:67], a[120:123], v[96:99]
    buffer_load_dwordx4 v7, s[36:39], s57 offen offset:1056 lds
    v_mfma_f32_16x16x32_bf16 v[128:131], a[64:67], a[124:127], v[128:131]
    v_mfma_f32_16x16x32_bf16 v[160:163], a[64:67], a[128:131], v[160:163]
    buffer_load_dwordx4 a[240:243], v5, s[40:43], s58 offen offset:3072 sc1
    v_mfma_f32_16x16x32_bf16 v[192:195], a[64:67], a[132:135], v[192:195]
    s_add_u32 s58, s82, 24576
    v_mfma_f32_16x16x32_bf16 v[224:227], a[64:67], a[136:139], v[224:227]
    buffer_load_dwordx4 v8, s[36:39], s57 offen offset:2112 lds
    v_mfma_f32_16x16x32_bf16 a[0:3], a[64:67], a[140:143], a[0:3]
    v_mfma_f32_16x16x32_bf16 a[32:35], a[64:67], a[144:147], a[32:35]
    buffer_load_dwordx4 v9, s[36:39], s57 offen offset:3168 lds
    v_mfma_f32_16x16x32_bf16 v[36:39], a[68:71], a[112:115], v[36:39]
    s_add_u32 s66, s66, 8192
    v_mfma_f32_16x16x32_bf16 v[68:71], a[68:71], a[116:119], v[68:71]
    s_and_b32 s66, s66, 0x3ffff
    buffer_load_dwordx4 a[244:247], v5, s[40:43], s58 offen offset:3072 sc1
    v_mfma_f32_16x16x32_bf16 v[100:103], a[68:71], a[120:123], v[100:103]
    s_add_u32 s63, s64, s66
    v_mfma_f32_16x16x32_bf16 v[132:135], a[68:71], a[124:127], v[132:135]
    s_add_u32 m0, s60, 8448
    v_mfma_f32_16x16x32_bf16 v[164:167], a[68:71], a[128:131], v[164:167]
    s_add_u32 s57, s63, 0
    buffer_load_dwordx4 v2, s[24:27], s57 offen offset:0 nt lds
    v_mfma_f32_16x16x32_bf16 v[196:199], a[68:71], a[132:135], v[196:199]
    s_add_u32 s58, s82, 28672
    buffer_load_dwordx4 v3, s[24:27], s57 offen offset:1056 nt lds
    v_mfma_f32_16x16x32_bf16 v[228:231], a[68:71], a[136:139], v[228:231]
    v_mfma_f32_16x16x32_bf16 a[4:7], a[68:71], a[140:143], a[4:7]
    buffer_load_dwordx4 v4, s[24:27], s57 offen offset:2112 nt lds
    v_mfma_f32_16x16x32_bf16 a[36:39], a[68:71], a[144:147], a[36:39]
    v_mfma_f32_16x16x32_bf16 v[40:43], a[72:75], a[112:115], v[40:43]
    buffer_load_dwordx4 v5, s[24:27], s57 offen offset:3168 nt lds
    v_mfma_f32_16x16x32_bf16 v[72:75], a[72:75], a[116:119], v[72:75]
    s_add_u32 m0, s60, 12672
    v_mfma_f32_16x16x32_bf16 v[104:107], a[72:75], a[120:123], v[104:107]
    s_add_u32 s57, s63, 4096
    buffer_load_dwordx4 v2, s[24:27], s57 offen offset:0 nt lds
    v_mfma_f32_16x16x32_bf16 v[136:139], a[72:75], a[124:127], v[136:139]
    v_mfma_f32_16x16x32_bf16 v[168:171], a[72:75], a[128:131], v[168:171]
    buffer_load_dwordx4 a[248:251], v5, s[40:43], s58 offen offset:3072 sc1
    v_mfma_f32_16x16x32_bf16 v[200:203], a[72:75], a[132:135], v[200:203]
    s_add_u32 s58, s82, 32768
    v_mfma_f32_16x16x32_bf16 v[232:235], a[72:75], a[136:139], v[232:235]
    buffer_load_dwordx4 v3, s[24:27], s57 offen offset:1056 nt lds
    v_mfma_f32_16x16x32_bf16 a[8:11], a[72:75], a[140:143], a[8:11]
    v_mfma_f32_16x16x32_bf16 a[40:43], a[72:75], a[144:147], a[40:43]
    buffer_load_dwordx4 a[252:255], v5, s[40:43], s58 offen offset:3072 sc1
    v_mfma_f32_16x16x32_bf16 v[44:47], a[76:79], a[112:115], v[44:47]
    v_mfma_f32_16x16x32_bf16 v[76:79], a[76:79], a[116:119], v[76:79]
    buffer_load_dwordx4 v4, s[24:27], s57 offen offset:2112 nt lds
    v_mfma_f32_16x16x32_bf16 v[108:111], a[76:79], a[120:123], v[108:111]
    v_mfma_f32_16x16x32_bf16 v[140:143], a[76:79], a[124:127], v[140:143]
    buffer_load_dwordx4 v5, s[24:27], s57 offen offset:3168 nt lds
    v_mfma_f32_16x16x32_bf16 v[172:175], a[76:79], a[128:131], v[172:175]
    s_add_u32 s60, s60, 16896
    v_mfma_f32_16x16x32_bf16 v[204:207], a[76:79], a[132:135], v[204:207]
    s_cmp_ge_u32 s60, s61
    v_mfma_f32_16x16x32_bf16 v[236:239], a[76:79], a[136:139], v[236:239]
    s_cselect_b32 s60, 0, s60
    v_mfma_f32_16x16x32_bf16 a[12:15], a[76:79], a[140:143], a[12:15]
    v_mfma_f32_16x16x32_bf16 a[44:47], a[76:79], a[144:147], a[44:47]
    s_waitcnt vmcnt(63)
    s_barrier
    s_waitcnt lgkmcnt(0)
    v_cmp_eq_u32 vcc, 1, v14
    s_nop 1
    s_and_b32 s56, vcc_lo, 7
    s_cmp_eq_u32 s56, 7
    s_cbranch_scc1 L_hf3_ok
    s_mov_b32 s72, 131072
L_hf3_lp:
    s_mov_b64 exec, 7
    buffer_load_dword v14, v5, s[40:43], s89 offen sc1
    s_mov_b64 exec, -1
    s_waitcnt vmcnt(0)
    v_cmp_eq_u32 vcc, 1, v14
    s_nop 1
    s_and_b32 s56, vcc_lo, 7
    s_cmp_eq_u32 s56, 7
    s_cbranch_scc1 L_hf3_ok
    s_sub_u32 s72, s72, 1
    s_cmp_lg_u32 s72, 0
    s_cbranch_scc1 L_hf3_lp
L_hf3_ok:
    v_mfma_f32_16x16x32_bf16 v[16:19], a[80:83], a[148:151], v[16:19]
    ds_read_b64_tr_b16 a[48:49], v10 offset:33792
    v_mfma_f32_16x16x32_bf16 v[48:51], a[80:83], a[152:155], v[48:51]
    s_add_u32 m0, s60, 0
    ds_read_b64_tr_b16 a[50:51], v10 offset:34304
    v_mfma_f32_16x16x32_bf16 v[80:83], a[80:83], a[156:159], v[80:83]
    s_add_u32 s57, s63, 0
    buffer_load_dwordx4 v2, s[28:31], s57 offen offset:0 nt lds
    v_mfma_f32_16x16x32_bf16 v[112:115], a[80:83], a[160:163], v[112:115]
    s_add_u32 s58, s83, 0
    ds_read_b64_tr_b16 a[52:53], v10 offset:33824
    v_mfma_f32_16x16x32_bf16 v[144:147], a[80:83], a[164:167], v[144:147]
    buffer_load_dwordx4 a[112:115], v5, s[40:43], s58 offen offset:0 sc1
    v_mfma_f32_16x16x32_bf16 v[176:179], a[80:83], a[168:171], v[176:179]
    s_add_u32 s58, s83, 4096
    ds_read_b64_tr_b16 a[54:55], v10 offset:34336
    v_mfma_f32_16x16x32_bf16 v[208:211], a[80:83], a[172:175], v[208:211]
    buffer_load_dwordx4 v3, s[28:31], s57 offen offset:1056 nt lds
    v_mfma_f32_16x16x32_bf16 v[240:243], a[80:83], a[176:179], v[240:243]
    ds_read_b64_tr_b16 a[56:57], v10 offset:33856
    v_mfma_f32_16x16x32_bf16 a[16:19], a[80:83], a[180:183], a[16:19]
    buffer_load_dwordx4 v4, s[28:31], s57 offen offset:2112 nt lds
    v_mfma_f32_16x16x32_bf16 v[20:23], a[84:87], a[148:151], v[20:23]
    ds_read_b64_tr_b16 a[58:59], v10 offset:34368
    v_mfma_f32_16x16x32_bf16 v[52:55], a[84:87], a[152:155], v[52:55]
    buffer_load_dwordx4 v5, s[28:31], s57 offen offset:3168 nt lds
    v_mfma_f32_16x16x32_bf16 v[84:87], a[84:87], a[156:159], v[84:87]
    s_mov_b32 m0, 84480
    ds_read_b64_tr_b16 a[60:61], v10 offset:33888
    v_mfma_f32_16x16x32_bf16 v[116:119], a[84:87], a[160:163], v[116:119]
    s_add_u32 s57, s78, 65536
    buffer_load_dwordx4 v6, s[36:39], s57 offen offset:0 lds
    v_mfma_f32_16x16x32_bf16 v[148:151], a[84:87], a[164:167], v[148:151]
    ds_read_b64_tr_b16 a[62:63], v10 offset:34400
    v_mfma_f32_16x16x32_bf16 v[180:183], a[84:87], a[168:171], v[180:183]
    buffer_load_dwordx4 a[116:119], v5, s[40:43], s58 offen offset:0 sc1
    v_mfma_f32_16x16x32_bf16 v[212:215], a[84:87], a[172:175], v[212:215]
    s_add_u32 s58, s83, 8192
    ds_read_b64_tr_b16 a[64:65], v10 offset:33920
    v_mfma_f32_16x16x32_bf16 v[244:247], a[84:87], a[176:179], v[244:247]
    buffer_load_dwordx4 v7, s[36:39], s57 offen offset:1056 lds
    v_mfma_f32_16x16x32_bf16 a[20:23], a[84:87], a[180:183], a[20:23]
    ds_read_b64_tr_b16 a[66:67], v10 offset:34432
    v_mfma_f32_16x16x32_bf16 v[24:27], a[88:91], a[148:151], v[24:27]
    buffer_load_dwordx4 a[120:123], v5, s[40:43], s58 offen offset:0 sc1
    v_mfma_f32_16x16x32_bf16 v[56:59], a[88:91], a[152:155], v[56:59]
    s_add_u32 s58, s83, 12288
    ds_read_b64_tr_b16 a[68:69], v10 offset:33952
    v_mfma_f32_16x16x32_bf16 v[88:91], a[88:91], a[156:159], v[88:91]
    buffer_load_dwordx4 v8, s[36:39], s57 offen offset:2112 lds
    v_mfma_f32_16x16x32_bf16 v[120:123], a[88:91], a[160:163], v[120:123]
    ds_read_b64_tr_b16 a[70:71], v10 offset:34464
    v_mfma_f32_16x16x32_bf16 v[152:155], a[88:91], a[164:167], v[152:155]
    buffer_load_dwordx4 v9, s[36:39], s57 offen offset:3168 lds
    v_mfma_f32_16x16x32_bf16 v[184:187], a[88:91], a[168:171], v[184:187]
    s_add_u32 m0, s60, 4224
    ds_read_b64_tr_b16 a[72:73], v10 offset:33984
    v_mfma_f32_16x16x32_bf16 v[216:219], a[88:91], a[172:175], v[216:219]
    s_add_u32 s57, s63, 4096
    buffer_load_dwordx4 v2, s[28:31], s57 offen offset:0 nt lds
    v_mfma_f32_16x16x32_bf16 v[248:251], a[88:91], a[176:179], v[248:251]
    ds_read_b64_tr_b16 a[74:75], v10 offset:34496
    v_mfma_f32_16x16x32_bf16 a[24:27], a[88:91], a[180:183], a[24:27]
    buffer_load_dwordx4 v3, s[28:31], s57 offen offset:1056 nt lds
    v_mfma_f32_16x16x32_bf16 v[28:31], a[92:95], a[148:151], v[28:31]
    ds_read_b64_tr_b16 a[76:77], v10 offset:34016
    v_mfma_f32_16x16x32_bf16 v[60:63], a[92:95], a[152:155], v[60:63]
    buffer_load_dwordx4 a[124:127], v5, s[40:43], s58 offen offset:0 sc1
    v_mfma_f32_16x16x32_bf16 v[92:95], a[92:95], a[156:159], v[92:95]
    s_add_u32 s58, s83, 16384
    ds_read_b64_tr_b16 a[78:79], v10 offset:34528
    v_mfma_f32_16x16x32_bf16 v[124:127], a[92:95], a[160:163], v[124:127]
    buffer_load_dwordx4 v4, s[28:31], s57 offen offset:2112 nt lds
    v_mfma_f32_16x16x32_bf16 v[156:159], a[92:95], a[164:167], v[156:159]
    v_mfma_f32_16x16x32_bf16 v[188:191], a[92:95], a[168:171], v[188:191]
    buffer_load_dwordx4 a[128:131], v5, s[40:43], s58 offen offset:0 sc1
    v_mfma_f32_16x16x32_bf16 v[220:223], a[92:95], a[172:175], v[220:223]
    s_add_u32 s58, s83, 20480
    v_mfma_f32_16x16x32_bf16 v[252:255], a[92:95], a[176:179], v[252:255]
    buffer_load_dwordx4 v5, s[28:31], s57 offen offset:3168 nt lds
    v_mfma_f32_16x16x32_bf16 a[28:31], a[92:95], a[180:183], a[28:31]
    s_add_u32 s66, s66, 8192
    v_mfma_f32_16x16x32_bf16 v[32:35], a[96:99], a[148:151], v[32:35]
    s_and_b32 s66, s66, 0x3ffff
    buffer_load_dwordx4 a[132:135], v5, s[40:43], s58 offen offset:0 sc1
    v_mfma_f32_16x16x32_bf16 v[64:67], a[96:99], a[152:155], v[64:67]
    s_add_u32 s63, s64, s66
    v_mfma_f32_16x16x32_bf16 v[96:99], a[96:99], a[156:159], v[96:99]
    s_add_u32 m0, s60, 8448
    v_mfma_f32_16x16x32_bf16 v[128:131], a[96:99], a[160:163], v[128:131]
    s_add_u32 s57, s63, 0
    buffer_load_dwordx4 v2, s[24:27], s57 offen offset:0 nt lds
    v_mfma_f32_16x16x32_bf16 v[160:163], a[96:99], a[164:167], v[160:163]
    s_add_u32 s58, s83, 24576
    v_mfma_f32_16x16x32_bf16 v[192:195], a[96:99], a[168:171], v[192:195]
    buffer_load_dwordx4 v3, s[24:27], s57 offen offset:1056 nt lds
    v_mfma_f32_16x16x32_bf16 v[224:227], a[96:99], a[172:175], v[224:227]
    v_mfma_f32_16x16x32_bf16 a[0:3], a[96:99], a[176:179], a[0:3]
    buffer_load_dwordx4 v4, s[24:27], s57 offen offset:2112 nt lds
    v_mfma_f32_16x16x32_bf16 a[32:35], a[96:99], a[180:183], a[32:35]
    v_mfma_f32_16x16x32_bf16 v[36:39], a[100:103], a[148:151], v[36:39]
    buffer_load_dwordx4 v5, s[24:27], s57 offen offset:3168 nt lds
    v_mfma_f32_16x16x32_bf16 v[68:71], a[100:103], a[152:155], v[68:71]
    s_mov_b32 m0, 88704
    v_mfma_f32_16x16x32_bf16 v[100:103], a[100:103], a[156:159], v[100:103]
    s_add_u32 s57, s78, 69632
    buffer_load_dwordx4 v6, s[36:39], s57 offen offset:0 lds
    v_mfma_f32_16x16x32_bf16 v[132:135], a[100:103], a[160:163], v[132:135]
    v_mfma_f32_16x16x32_bf16 v[164:167], a[100:103], a[164:167], v[164:167]
    buffer_load_dwordx4 v7, s[36:39], s57 offen offset:1056 lds
    v_mfma_f32_16x16x32_bf16 v[196:199], a[100:103], a[168:171], v[196:199]
    v_mfma_f32_16x16x32_bf16 v[228:231], a[100:103], a[172:175], v[228:231]
    buffer_load_dwordx4 a[136:139], v5, s[40:43], s58 offen offset:0 sc1
    v_mfma_f32_16x16x32_bf16 a[4:7], a[100:103], a[176:179], a[4:7]
    s_add_u32 s58, s83, 28672
    v_mfma_f32_16x16x32_bf16 a[36:39], a[100:103], a[180:183], a[36:39]
    buffer_load_dwordx4 v8, s[36:39], s57 offen offset:2112 lds
    v_mfma_f32_16x16x32_bf16 v[40:43], a[104:107], a[148:151], v[40:43]
    v_mfma_f32_16x16x32_bf16 v[72:75], a[104:107], a[152:155], v[72:75]
    buffer_load_dwordx4 a[140:143], v5, s[40:43], s58 offen offset:0 sc1
    v_mfma_f32_16x16x32_bf16 v[104:107], a[104:107], a[156:159], v[104:107]
    s_add_u32 s58, s83, 32768
    v_mfma_f32_16x16x32_bf16 v[136:139], a[104:107], a[160:163], v[136:139]
    buffer_load_dwordx4 v9, s[36:39], s57 offen offset:3168 lds
    v_mfma_f32_16x16x32_bf16 v[168:171], a[104:107], a[164:167], v[168:171]
    s_add_u32 m0, s60, 12672
    v_mfma_f32_16x16x32_bf16 v[200:203], a[104:107], a[168:171], v[200:203]
    s_add_u32 s57, s63, 4096
    buffer_load_dwordx4 v2, s[24:27], s57 offen offset:0 nt lds
    v_mfma_f32_16x16x32_bf16 v[232:235], a[104:107], a[172:175], v[232:235]
    v_mfma_f32_16x16x32_bf16 a[8:11], a[104:107], a[176:179], a[8:11]
    buffer_load_dwordx4 v3, s[24:27], s57 offen offset:1056 nt lds
    v_mfma_f32_16x16x32_bf16 a[40:43], a[104:107], a[180:183], a[40:43]
    v_mfma_f32_16x16x32_bf16 v[44:47], a[108:111], a[148:151], v[44:47]
    buffer_load_dwordx4 a[144:147], v5, s[40:43], s58 offen offset:0 sc1
    v_mfma_f32_16x16x32_bf16 v[76:79], a[108:111], a[152:155], v[76:79]
    v_mfma_f32_16x16x32_bf16 v[108:111], a[108:111], a[156:159], v[108:111]
    buffer_load_dwordx4 v4, s[24:27], s57 offen offset:2112 nt lds
    v_mfma_f32_16x16x32_bf16 v[140:143], a[108:111], a[160:163], v[140:143]
    v_mfma_f32_16x16x32_bf16 v[172:175], a[108:111], a[164:167], v[172:175]
    buffer_load_dwordx4 v5, s[24:27], s57 offen offset:3168 nt lds
    v_mfma_f32_16x16x32_bf16 v[204:207], a[108:111], a[168:171], v[204:207]
    s_add_u32 s60, s60, 16896
    v_mfma_f32_16x16x32_bf16 v[236:239], a[108:111], a[172:175], v[236:239]
    s_cmp_ge_u32 s60, s61
    v_mfma_f32_16x16x32_bf16 a[12:15], a[108:111], a[176:179], a[12:15]
    s_cselect_b32 s60, 0, s60
    v_mfma_f32_16x16x32_bf16 a[44:47], a[108:111], a[180:183], a[44:47]
    s_waitcnt vmcnt(63)
    s_barrier
    s_waitcnt lgkmcnt(0)
    s_lshr_b32 s56, s2, 3
    v_mul_u32_u24 v14, 4096, v0
    s_lshl_b32 s56, s56, 7
    s_add_u32 s56, s56, L_tail-standalone__gqa_block_cached__near_ridge_kernel
    v_add_u32 v14, s56, v14
    v_min_u32 v14, L_done-standalone__gqa_block_cached__near_ridge_kernel, v14
    v_mov_b32 v15, s97
    v_add_co_u32 v14, vcc, s96, v14
    s_nop 1
    v_addc_co_u32 v15, vcc, 0, v15, vcc
    global_load_dword v1, v[14:15], off
    v_mfma_f32_16x16x32_bf16 v[16:19], a[48:51], a[184:187], v[16:19]
    ds_read_b64_tr_b16 a[80:81], v10 offset:42240
    v_mfma_f32_16x16x32_bf16 v[48:51], a[48:51], a[188:191], v[48:51]
    s_add_u32 m0, s60, 0
    ds_read_b64_tr_b16 a[82:83], v10 offset:42752
    v_mfma_f32_16x16x32_bf16 v[80:83], a[48:51], a[192:195], v[80:83]
    s_add_u32 s57, s63, 0
    buffer_load_dwordx4 v2, s[28:31], s57 offen offset:0 nt lds
    v_mfma_f32_16x16x32_bf16 v[112:115], a[48:51], a[196:199], v[112:115]
    s_add_u32 s58, s83, 0
    ds_read_b64_tr_b16 a[84:85], v10 offset:42272
    v_mfma_f32_16x16x32_bf16 v[144:147], a[48:51], a[200:203], v[144:147]
    buffer_load_dwordx4 a[148:151], v5, s[40:43], s58 offen offset:1024 sc1
    v_mfma_f32_16x16x32_bf16 v[176:179], a[48:51], a[204:207], v[176:179]
    s_add_u32 s58, s83, 4096
    ds_read_b64_tr_b16 a[86:87], v10 offset:42784
    v_mfma_f32_16x16x32_bf16 v[208:211], a[48:51], a[208:211], v[208:211]
    buffer_load_dwordx4 v3, s[28:31], s57 offen offset:1056 nt lds
    v_mfma_f32_16x16x32_bf16 v[240:243], a[48:51], a[212:215], v[240:243]
    ds_read_b64_tr_b16 a[88:89], v10 offset:42304
    v_mfma_f32_16x16x32_bf16 a[16:19], a[48:51], a[216:219], a[16:19]
    buffer_load_dwordx4 v4, s[28:31], s57 offen offset:2112 nt lds
    v_mfma_f32_16x16x32_bf16 v[20:23], a[52:55], a[184:187], v[20:23]
    ds_read_b64_tr_b16 a[90:91], v10 offset:42816
    v_mfma_f32_16x16x32_bf16 v[52:55], a[52:55], a[188:191], v[52:55]
    buffer_load_dwordx4 v5, s[28:31], s57 offen offset:3168 nt lds
    v_mfma_f32_16x16x32_bf16 v[84:87], a[52:55], a[192:195], v[84:87]
    s_mov_b32 m0, 92928
    ds_read_b64_tr_b16 a[92:93], v10 offset:42336
    v_mfma_f32_16x16x32_bf16 v[116:119], a[52:55], a[196:199], v[116:119]
    s_add_u32 s57, s78, 98304
    buffer_load_dwordx4 v6, s[36:39], s57 offen offset:0 lds
    v_mfma_f32_16x16x32_bf16 v[148:151], a[52:55], a[200:203], v[148:151]
    ds_read_b64_tr_b16 a[94:95], v10 offset:42848
    v_mfma_f32_16x16x32_bf16 v[180:183], a[52:55], a[204:207], v[180:183]
    buffer_load_dwordx4 v7, s[36:39], s57 offen offset:1056 lds
    v_mfma_f32_16x16x32_bf16 v[212:215], a[52:55], a[208:211], v[212:215]
    ds_read_b64_tr_b16 a[96:97], v10 offset:42368
    v_mfma_f32_16x16x32_bf16 v[244:247], a[52:55], a[212:215], v[244:247]
    buffer_load_dwordx4 a[152:155], v5, s[40:43], s58 offen offset:1024 sc1
    v_mfma_f32_16x16x32_bf16 a[20:23], a[52:55], a[216:219], a[20:23]
    s_add_u32 s58, s83, 8192
    ds_read_b64_tr_b16 a[98:99], v10 offset:42880
    v_mfma_f32_16x16x32_bf16 v[24:27], a[56:59], a[184:187], v[24:27]
    buffer_load_dwordx4 v8, s[36:39], s57 offen offset:2112 lds
    v_mfma_f32_16x16x32_bf16 v[56:59], a[56:59], a[188:191], v[56:59]
    ds_read_b64_tr_b16 a[100:101], v10 offset:42400
    v_mfma_f32_16x16x32_bf16 v[88:91], a[56:59], a[192:195], v[88:91]
    buffer_load_dwordx4 a[156:159], v5, s[40:43], s58 offen offset:1024 sc1
    v_mfma_f32_16x16x32_bf16 v[120:123], a[56:59], a[196:199], v[120:123]
    s_add_u32 s58, s83, 12288
    ds_read_b64_tr_b16 a[102:103], v10 offset:42912
    v_mfma_f32_16x16x32_bf16 v[152:155], a[56:59], a[200:203], v[152:155]
    buffer_load_dwordx4 v9, s[36:39], s57 offen offset:3168 lds
    v_mfma_f32_16x16x32_bf16 v[184:187], a[56:59], a[204:207], v[184:187]
    s_add_u32 m0, s60, 4224
    ds_read_b64_tr_b16 a[104:105], v10 offset:42432
    v_mfma_f32_16x16x32_bf16 v[216:219], a[56:59], a[208:211], v[216:219]
    s_add_u32 s57, s63, 4096
    buffer_load_dwordx4 v2, s[28:31], s57 offen offset:0 nt lds
    v_mfma_f32_16x16x32_bf16 v[248:251], a[56:59], a[212:215], v[248:251]
    ds_read_b64_tr_b16 a[106:107], v10 offset:42944
    v_mfma_f32_16x16x32_bf16 a[24:27], a[56:59], a[216:219], a[24:27]
    buffer_load_dwordx4 v3, s[28:31], s57 offen offset:1056 nt lds
    v_mfma_f32_16x16x32_bf16 v[28:31], a[60:63], a[184:187], v[28:31]
    ds_read_b64_tr_b16 a[108:109], v10 offset:42464
    v_mfma_f32_16x16x32_bf16 v[60:63], a[60:63], a[188:191], v[60:63]
    buffer_load_dwordx4 a[160:163], v5, s[40:43], s58 offen offset:1024 sc1
    v_mfma_f32_16x16x32_bf16 v[92:95], a[60:63], a[192:195], v[92:95]
    s_add_u32 s58, s83, 16384
    ds_read_b64_tr_b16 a[110:111], v10 offset:42976
    v_mfma_f32_16x16x32_bf16 v[124:127], a[60:63], a[196:199], v[124:127]
    buffer_load_dwordx4 v4, s[28:31], s57 offen offset:2112 nt lds
    v_mfma_f32_16x16x32_bf16 v[156:159], a[60:63], a[200:203], v[156:159]
    v_mfma_f32_16x16x32_bf16 v[188:191], a[60:63], a[204:207], v[188:191]
    buffer_load_dwordx4 a[164:167], v5, s[40:43], s58 offen offset:1024 sc1
    v_mfma_f32_16x16x32_bf16 v[220:223], a[60:63], a[208:211], v[220:223]
    s_add_u32 s58, s83, 20480
    v_mfma_f32_16x16x32_bf16 v[252:255], a[60:63], a[212:215], v[252:255]
    buffer_load_dwordx4 v5, s[28:31], s57 offen offset:3168 nt lds
    v_mfma_f32_16x16x32_bf16 a[28:31], a[60:63], a[216:219], a[28:31]
    s_mov_b32 m0, 97152
    v_mfma_f32_16x16x32_bf16 v[32:35], a[64:67], a[184:187], v[32:35]
    s_add_u32 s57, s78, 102400
    buffer_load_dwordx4 v6, s[36:39], s57 offen offset:0 lds
    v_mfma_f32_16x16x32_bf16 v[64:67], a[64:67], a[188:191], v[64:67]
    v_mfma_f32_16x16x32_bf16 v[96:99], a[64:67], a[192:195], v[96:99]
    buffer_load_dwordx4 v7, s[36:39], s57 offen offset:1056 lds
    v_mfma_f32_16x16x32_bf16 v[128:131], a[64:67], a[196:199], v[128:131]
    v_mfma_f32_16x16x32_bf16 v[160:163], a[64:67], a[200:203], v[160:163]
    buffer_load_dwordx4 a[168:171], v5, s[40:43], s58 offen offset:1024 sc1
    v_mfma_f32_16x16x32_bf16 v[192:195], a[64:67], a[204:207], v[192:195]
    s_add_u32 s58, s83, 24576
    v_mfma_f32_16x16x32_bf16 v[224:227], a[64:67], a[208:211], v[224:227]
    buffer_load_dwordx4 v8, s[36:39], s57 offen offset:2112 lds
    v_mfma_f32_16x16x32_bf16 a[0:3], a[64:67], a[212:215], a[0:3]
    v_mfma_f32_16x16x32_bf16 a[32:35], a[64:67], a[216:219], a[32:35]
    buffer_load_dwordx4 v9, s[36:39], s57 offen offset:3168 lds
    v_mfma_f32_16x16x32_bf16 v[36:39], a[68:71], a[184:187], v[36:39]
    s_add_u32 s66, s66, 8192
    v_mfma_f32_16x16x32_bf16 v[68:71], a[68:71], a[188:191], v[68:71]
    s_and_b32 s66, s66, 0x3ffff
    buffer_load_dwordx4 a[172:175], v5, s[40:43], s58 offen offset:1024 sc1
    v_mfma_f32_16x16x32_bf16 v[100:103], a[68:71], a[192:195], v[100:103]
    s_add_u32 s63, s64, s66
    v_mfma_f32_16x16x32_bf16 v[132:135], a[68:71], a[196:199], v[132:135]
    s_add_u32 m0, s60, 8448
    v_mfma_f32_16x16x32_bf16 v[164:167], a[68:71], a[200:203], v[164:167]
    s_add_u32 s57, s63, 0
    buffer_load_dwordx4 v2, s[24:27], s57 offen offset:0 nt lds
    v_mfma_f32_16x16x32_bf16 v[196:199], a[68:71], a[204:207], v[196:199]
    s_add_u32 s58, s83, 28672
    buffer_load_dwordx4 v3, s[24:27], s57 offen offset:1056 nt lds
    v_mfma_f32_16x16x32_bf16 v[228:231], a[68:71], a[208:211], v[228:231]
    v_mfma_f32_16x16x32_bf16 a[4:7], a[68:71], a[212:215], a[4:7]
    buffer_load_dwordx4 v4, s[24:27], s57 offen offset:2112 nt lds
    v_mfma_f32_16x16x32_bf16 a[36:39], a[68:71], a[216:219], a[36:39]
    v_mfma_f32_16x16x32_bf16 v[40:43], a[72:75], a[184:187], v[40:43]
    buffer_load_dwordx4 v5, s[24:27], s57 offen offset:3168 nt lds
    v_mfma_f32_16x16x32_bf16 v[72:75], a[72:75], a[188:191], v[72:75]
    s_add_u32 m0, s60, 12672
    v_mfma_f32_16x16x32_bf16 v[104:107], a[72:75], a[192:195], v[104:107]
    s_add_u32 s57, s63, 4096
    buffer_load_dwordx4 v2, s[24:27], s57 offen offset:0 nt lds
    v_mfma_f32_16x16x32_bf16 v[136:139], a[72:75], a[196:199], v[136:139]
    v_mfma_f32_16x16x32_bf16 v[168:171], a[72:75], a[200:203], v[168:171]
    buffer_load_dwordx4 a[176:179], v5, s[40:43], s58 offen offset:1024 sc1
    v_mfma_f32_16x16x32_bf16 v[200:203], a[72:75], a[204:207], v[200:203]
    s_add_u32 s58, s83, 32768
    v_mfma_f32_16x16x32_bf16 v[232:235], a[72:75], a[208:211], v[232:235]
    buffer_load_dwordx4 v3, s[24:27], s57 offen offset:1056 nt lds
    v_mfma_f32_16x16x32_bf16 a[8:11], a[72:75], a[212:215], a[8:11]
    v_mfma_f32_16x16x32_bf16 a[40:43], a[72:75], a[216:219], a[40:43]
    buffer_load_dwordx4 a[180:183], v5, s[40:43], s58 offen offset:1024 sc1
    v_mfma_f32_16x16x32_bf16 v[44:47], a[76:79], a[184:187], v[44:47]
    v_mfma_f32_16x16x32_bf16 v[76:79], a[76:79], a[188:191], v[76:79]
    buffer_load_dwordx4 v4, s[24:27], s57 offen offset:2112 nt lds
    v_mfma_f32_16x16x32_bf16 v[108:111], a[76:79], a[192:195], v[108:111]
    v_mfma_f32_16x16x32_bf16 v[140:143], a[76:79], a[196:199], v[140:143]
    buffer_load_dwordx4 v5, s[24:27], s57 offen offset:3168 nt lds
    v_mfma_f32_16x16x32_bf16 v[172:175], a[76:79], a[200:203], v[172:175]
    s_add_u32 s60, s60, 16896
    v_mfma_f32_16x16x32_bf16 v[204:207], a[76:79], a[204:207], v[204:207]
    s_cmp_ge_u32 s60, s61
    v_mfma_f32_16x16x32_bf16 v[236:239], a[76:79], a[208:211], v[236:239]
    s_cselect_b32 s60, 0, s60
    v_mfma_f32_16x16x32_bf16 a[12:15], a[76:79], a[212:215], a[12:15]
    v_mfma_f32_16x16x32_bf16 a[44:47], a[76:79], a[216:219], a[44:47]
    s_waitcnt vmcnt(63)
    s_barrier
    s_waitcnt lgkmcnt(0)
    v_mfma_f32_16x16x32_bf16 v[16:19], a[80:83], a[220:223], v[16:19]
    ds_read_b64_tr_b16 a[48:49], v10 offset:0
    v_mfma_f32_16x16x32_bf16 v[48:51], a[80:83], a[224:227], v[48:51]
    s_add_u32 m0, s60, 0
    ds_read_b64_tr_b16 a[50:51], v10 offset:512
    v_mfma_f32_16x16x32_bf16 v[80:83], a[80:83], a[228:231], v[80:83]
    s_add_u32 s57, s63, 0
    buffer_load_dwordx4 v2, s[28:31], s57 offen offset:0 nt lds
    v_mfma_f32_16x16x32_bf16 v[112:115], a[80:83], a[232:235], v[112:115]
    s_add_u32 s58, s83, 0
    ds_read_b64_tr_b16 a[52:53], v10 offset:32
    v_mfma_f32_16x16x32_bf16 v[144:147], a[80:83], a[236:239], v[144:147]
    buffer_load_dwordx4 a[184:187], v5, s[40:43], s58 offen offset:2048 sc1
    v_mfma_f32_16x16x32_bf16 v[176:179], a[80:83], a[240:243], v[176:179]
    s_add_u32 s58, s83, 4096
    ds_read_b64_tr_b16 a[54:55], v10 offset:544
    v_mfma_f32_16x16x32_bf16 v[208:211], a[80:83], a[244:247], v[208:211]
    buffer_load_dwordx4 v3, s[28:31], s57 offen offset:1056 nt lds
    v_mfma_f32_16x16x32_bf16 v[240:243], a[80:83], a[248:251], v[240:243]
    ds_read_b64_tr_b16 a[56:57], v10 offset:64
    v_mfma_f32_16x16x32_bf16 a[16:19], a[80:83], a[252:255], a[16:19]
    buffer_load_dwordx4 a[188:191], v5, s[40:43], s58 offen offset:2048 sc1
    v_mfma_f32_16x16x32_bf16 v[20:23], a[84:87], a[220:223], v[20:23]
    s_add_u32 s58, s83, 8192
    ds_read_b64_tr_b16 a[58:59], v10 offset:576
    v_mfma_f32_16x16x32_bf16 v[52:55], a[84:87], a[224:227], v[52:55]
    buffer_load_dwordx4 v4, s[28:31], s57 offen offset:2112 nt lds
    v_mfma_f32_16x16x32_bf16 v[84:87], a[84:87], a[228:231], v[84:87]
    ds_read_b64_tr_b16 a[60:61], v10 offset:96
    v_mfma_f32_16x16x32_bf16 v[116:119], a[84:87], a[232:235], v[116:119]
    ds_read_b64_tr_b16 a[62:63], v10 offset:608
    v_mfma_f32_16x16x32_bf16 v[148:151], a[84:87], a[236:239], v[148:151]
    buffer_load_dwordx4 v5, s[28:31], s57 offen offset:3168 nt lds
    v_mfma_f32_16x16x32_bf16 v[180:183], a[84:87], a[240:243], v[180:183]
    s_add_u32 m0, s60, 4224
    ds_read_b64_tr_b16 a[64:65], v10 offset:128
    v_mfma_f32_16x16x32_bf16 v[212:215], a[84:87], a[244:247], v[212:215]
    s_add_u32 s57, s63, 4096
    buffer_load_dwordx4 a[192:195], v5, s[40:43], s58 offen offset:2048 sc1
    v_mfma_f32_16x16x32_bf16 v[244:247], a[84:87], a[248:251], v[244:247]
    s_add_u32 s58, s83, 12288
    ds_read_b64_tr_b16 a[66:67], v10 offset:640
    v_mfma_f32_16x16x32_bf16 a[20:23], a[84:87], a[252:255], a[20:23]
    buffer_load_dwordx4 v2, s[28:31], s57 offen offset:0 nt lds
    v_mfma_f32_16x16x32_bf16 v[24:27], a[88:91], a[220:223], v[24:27]
    ds_read_b64_tr_b16 a[68:69], v10 offset:160
    v_mfma_f32_16x16x32_bf16 v[56:59], a[88:91], a[224:227], v[56:59]
    ds_read_b64_tr_b16 a[70:71], v10 offset:672
    v_mfma_f32_16x16x32_bf16 v[88:91], a[88:91], a[228:231], v[88:91]
    ds_read_b64_tr_b16 a[72:73], v10 offset:192
    v_mfma_f32_16x16x32_bf16 v[120:123], a[88:91], a[232:235], v[120:123]
    buffer_load_dwordx4 a[196:199], v5, s[40:43], s58 offen offset:2048 sc1
    v_mfma_f32_16x16x32_bf16 v[152:155], a[88:91], a[236:239], v[152:155]
    s_add_u32 s58, s83, 16384
    ds_read_b64_tr_b16 a[74:75], v10 offset:704
    v_mfma_f32_16x16x32_bf16 v[184:187], a[88:91], a[240:243], v[184:187]
    buffer_load_dwordx4 v3, s[28:31], s57 offen offset:1056 nt lds
    v_mfma_f32_16x16x32_bf16 v[216:219], a[88:91], a[244:247], v[216:219]
    ds_read_b64_tr_b16 a[76:77], v10 offset:224
    v_mfma_f32_16x16x32_bf16 v[248:251], a[88:91], a[248:251], v[248:251]
    ds_read_b64_tr_b16 a[78:79], v10 offset:736
    v_mfma_f32_16x16x32_bf16 a[24:27], a[88:91], a[252:255], a[24:27]
    buffer_load_dwordx4 v4, s[28:31], s57 offen offset:2112 nt lds
    v_mfma_f32_16x16x32_bf16 v[28:31], a[92:95], a[220:223], v[28:31]
    v_mfma_f32_16x16x32_bf16 v[60:63], a[92:95], a[224:227], v[60:63]
    buffer_load_dwordx4 a[200:203], v5, s[40:43], s58 offen offset:2048 sc1
    v_mfma_f32_16x16x32_bf16 v[92:95], a[92:95], a[228:231], v[92:95]
    s_add_u32 s58, s83, 20480
    v_mfma_f32_16x16x32_bf16 v[124:127], a[92:95], a[232:235], v[124:127]
    buffer_load_dwordx4 v5, s[28:31], s57 offen offset:3168 nt lds
    v_mfma_f32_16x16x32_bf16 v[156:159], a[92:95], a[236:239], v[156:159]
    s_add_u32 s66, s66, 8192
    v_mfma_f32_16x16x32_bf16 v[188:191], a[92:95], a[240:243], v[188:191]
    s_and_b32 s66, s66, 0x3ffff
    v_mfma_f32_16x16x32_bf16 v[220:223], a[92:95], a[244:247], v[220:223]
    s_add_u32 s63, s64, s66
    v_mfma_f32_16x16x32_bf16 v[252:255], a[92:95], a[248:251], v[252:255]
    s_add_u32 m0, s60, 8448
    v_mfma_f32_16x16x32_bf16 a[28:31], a[92:95], a[252:255], a[28:31]
    s_add_u32 s57, s63, 0
    buffer_load_dwordx4 v2, s[24:27], s57 offen offset:0 nt lds
    v_mfma_f32_16x16x32_bf16 v[32:35], a[96:99], a[220:223], v[32:35]
    v_mfma_f32_16x16x32_bf16 v[64:67], a[96:99], a[224:227], v[64:67]
    buffer_load_dwordx4 a[204:207], v5, s[40:43], s58 offen offset:2048 sc1
    v_mfma_f32_16x16x32_bf16 v[96:99], a[96:99], a[228:231], v[96:99]
    s_add_u32 s58, s83, 24576
    v_mfma_f32_16x16x32_bf16 v[128:131], a[96:99], a[232:235], v[128:131]
    buffer_load_dwordx4 v3, s[24:27], s57 offen offset:1056 nt lds
    v_mfma_f32_16x16x32_bf16 v[160:163], a[96:99], a[236:239], v[160:163]
    v_mfma_f32_16x16x32_bf16 v[192:195], a[96:99], a[240:243], v[192:195]
    v_mfma_f32_16x16x32_bf16 v[224:227], a[96:99], a[244:247], v[224:227]
    buffer_load_dwordx4 a[208:211], v5, s[40:43], s58 offen offset:2048 sc1
    v_mfma_f32_16x16x32_bf16 a[0:3], a[96:99], a[248:251], a[0:3]
    s_add_u32 s58, s83, 28672
    v_mfma_f32_16x16x32_bf16 a[32:35], a[96:99], a[252:255], a[32:35]
    buffer_load_dwordx4 v4, s[24:27], s57 offen offset:2112 nt lds
    v_mfma_f32_16x16x32_bf16 v[36:39], a[100:103], a[220:223], v[36:39]
    v_mfma_f32_16x16x32_bf16 v[68:71], a[100:103], a[224:227], v[68:71]
    v_mfma_f32_16x16x32_bf16 v[100:103], a[100:103], a[228:231], v[100:103]
    v_mfma_f32_16x16x32_bf16 v[132:135], a[100:103], a[232:235], v[132:135]
    buffer_load_dwordx4 v5, s[24:27], s57 offen offset:3168 nt lds
    v_mfma_f32_16x16x32_bf16 v[164:167], a[100:103], a[236:239], v[164:167]
    s_add_u32 m0, s60, 12672
    v_mfma_f32_16x16x32_bf16 v[196:199], a[100:103], a[240:243], v[196:199]
    s_add_u32 s57, s63, 4096
    buffer_load_dwordx4 a[212:215], v5, s[40:43], s58 offen offset:2048 sc1
    v_mfma_f32_16x16x32_bf16 v[228:231], a[100:103], a[244:247], v[228:231]
    s_add_u32 s58, s83, 32768
    v_mfma_f32_16x16x32_bf16 a[4:7], a[100:103], a[248:251], a[4:7]
    buffer_load_dwordx4 v2, s[24:27], s57 offen offset:0 nt lds
    v_mfma_f32_16x16x32_bf16 a[36:39], a[100:103], a[252:255], a[36:39]
    v_mfma_f32_16x16x32_bf16 v[40:43], a[104:107], a[220:223], v[40:43]
    v_mfma_f32_16x16x32_bf16 v[72:75], a[104:107], a[224:227], v[72:75]
    v_mfma_f32_16x16x32_bf16 v[104:107], a[104:107], a[228:231], v[104:107]
    buffer_load_dwordx4 v3, s[24:27], s57 offen offset:1056 nt lds
    v_mfma_f32_16x16x32_bf16 v[136:139], a[104:107], a[232:235], v[136:139]
    v_mfma_f32_16x16x32_bf16 v[168:171], a[104:107], a[236:239], v[168:171]
    buffer_load_dwordx4 a[216:219], v5, s[40:43], s58 offen offset:2048 sc1
    v_mfma_f32_16x16x32_bf16 v[200:203], a[104:107], a[240:243], v[200:203]
    v_mfma_f32_16x16x32_bf16 v[232:235], a[104:107], a[244:247], v[232:235]
    v_mfma_f32_16x16x32_bf16 a[8:11], a[104:107], a[248:251], a[8:11]
    buffer_load_dwordx4 v4, s[24:27], s57 offen offset:2112 nt lds
    v_mfma_f32_16x16x32_bf16 a[40:43], a[104:107], a[252:255], a[40:43]
    v_mfma_f32_16x16x32_bf16 v[44:47], a[108:111], a[220:223], v[44:47]
    v_mfma_f32_16x16x32_bf16 v[76:79], a[108:111], a[224:227], v[76:79]
    v_mfma_f32_16x16x32_bf16 v[108:111], a[108:111], a[228:231], v[108:111]
    buffer_load_dwordx4 v5, s[24:27], s57 offen offset:3168 nt lds
    v_mfma_f32_16x16x32_bf16 v[140:143], a[108:111], a[232:235], v[140:143]
    s_add_u32 s60, s60, 16896
    v_mfma_f32_16x16x32_bf16 v[172:175], a[108:111], a[236:239], v[172:175]
    s_cmp_ge_u32 s60, s61
    v_mfma_f32_16x16x32_bf16 v[204:207], a[108:111], a[240:243], v[204:207]
    s_cselect_b32 s60, 0, s60
    v_mfma_f32_16x16x32_bf16 v[236:239], a[108:111], a[244:247], v[236:239]
    v_mfma_f32_16x16x32_bf16 a[12:15], a[108:111], a[248:251], a[12:15]
    v_mfma_f32_16x16x32_bf16 a[44:47], a[108:111], a[252:255], a[44:47]
    s_waitcnt vmcnt(59)
    s_barrier
    s_waitcnt lgkmcnt(0)
    v_mfma_f32_16x16x32_bf16 v[16:19], a[48:51], a[112:115], v[16:19]
    ds_read_b64_tr_b16 a[80:81], v10 offset:8448
    v_mfma_f32_16x16x32_bf16 v[48:51], a[48:51], a[116:119], v[48:51]
    s_add_u32 m0, s60, 0
    ds_read_b64_tr_b16 a[82:83], v10 offset:8960
    v_mfma_f32_16x16x32_bf16 v[80:83], a[48:51], a[120:123], v[80:83]
    s_add_u32 s57, s63, 0
    buffer_load_dwordx4 v2, s[28:31], s57 offen offset:0 nt lds
    v_mfma_f32_16x16x32_bf16 v[112:115], a[48:51], a[124:127], v[112:115]
    s_add_u32 s58, s83, 0
    ds_read_b64_tr_b16 a[84:85], v10 offset:8480
    v_mfma_f32_16x16x32_bf16 v[144:147], a[48:51], a[128:131], v[144:147]
    buffer_load_dwordx4 a[220:223], v5, s[40:43], s58 offen offset:3072 sc1
    v_mfma_f32_16x16x32_bf16 v[176:179], a[48:51], a[132:135], v[176:179]
    s_add_u32 s58, s83, 4096
    ds_read_b64_tr_b16 a[86:87], v10 offset:8992
    v_mfma_f32_16x16x32_bf16 v[208:211], a[48:51], a[136:139], v[208:211]
    buffer_load_dwordx4 v3, s[28:31], s57 offen offset:1056 nt lds
    v_mfma_f32_16x16x32_bf16 v[240:243], a[48:51], a[140:143], v[240:243]
    ds_read_b64_tr_b16 a[88:89], v10 offset:8512
    v_mfma_f32_16x16x32_bf16 a[16:19], a[48:51], a[144:147], a[16:19]
    buffer_load_dwordx4 a[224:227], v5, s[40:43], s58 offen offset:3072 sc1
    v_mfma_f32_16x16x32_bf16 v[20:23], a[52:55], a[112:115], v[20:23]
    s_add_u32 s58, s83, 8192
    ds_read_b64_tr_b16 a[90:91], v10 offset:9024
    v_mfma_f32_16x16x32_bf16 v[52:55], a[52:55], a[116:119], v[52:55]
    buffer_load_dwordx4 v4, s[28:31], s57 offen offset:2112 nt lds
    v_mfma_f32_16x16x32_bf16 v[84:87], a[52:55], a[120:123], v[84:87]
    ds_read_b64_tr_b16 a[92:93], v10 offset:8544
    v_mfma_f32_16x16x32_bf16 v[116:119], a[52:55], a[124:127], v[116:119]
    ds_read_b64_tr_b16 a[94:95], v10 offset:9056
    v_mfma_f32_16x16x32_bf16 v[148:151], a[52:55], a[128:131], v[148:151]
    buffer_load_dwordx4 v5, s[28:31], s57 offen offset:3168 nt lds
    v_mfma_f32_16x16x32_bf16 v[180:183], a[52:55], a[132:135], v[180:183]
    s_add_u32 m0, s60, 4224
    ds_read_b64_tr_b16 a[96:97], v10 offset:8576
    v_mfma_f32_16x16x32_bf16 v[212:215], a[52:55], a[136:139], v[212:215]
    s_add_u32 s57, s63, 4096
    buffer_load_dwordx4 a[228:231], v5, s[40:43], s58 offen offset:3072 sc1
    v_mfma_f32_16x16x32_bf16 v[244:247], a[52:55], a[140:143], v[244:247]
    s_add_u32 s58, s83, 12288
    ds_read_b64_tr_b16 a[98:99], v10 offset:9088
    v_mfma_f32_16x16x32_bf16 a[20:23], a[52:55], a[144:147], a[20:23]
    buffer_load_dwordx4 v2, s[28:31], s57 offen offset:0 nt lds
    v_mfma_f32_16x16x32_bf16 v[24:27], a[56:59], a[112:115], v[24:27]
    ds_read_b64_tr_b16 a[100:101], v10 offset:8608
    v_mfma_f32_16x16x32_bf16 v[56:59], a[56:59], a[116:119], v[56:59]
    ds_read_b64_tr_b16 a[102:103], v10 offset:9120
    v_mfma_f32_16x16x32_bf16 v[88:91], a[56:59], a[120:123], v[88:91]
    ds_read_b64_tr_b16 a[104:105], v10 offset:8640
    v_mfma_f32_16x16x32_bf16 v[120:123], a[56:59], a[124:127], v[120:123]
    buffer_load_dwordx4 a[232:235], v5, s[40:43], s58 offen offset:3072 sc1
    v_mfma_f32_16x16x32_bf16 v[152:155], a[56:59], a[128:131], v[152:155]
    s_add_u32 s58, s83, 16384
    ds_read_b64_tr_b16 a[106:107], v10 offset:9152
    v_mfma_f32_16x16x32_bf16 v[184:187], a[56:59], a[132:135], v[184:187]
    buffer_load_dwordx4 v3, s[28:31], s57 offen offset:1056 nt lds
    v_mfma_f32_16x16x32_bf16 v[216:219], a[56:59], a[136:139], v[216:219]
    ds_read_b64_tr_b16 a[108:109], v10 offset:8672
    v_mfma_f32_16x16x32_bf16 v[248:251], a[56:59], a[140:143], v[248:251]
    ds_read_b64_tr_b16 a[110:111], v10 offset:9184
    v_mfma_f32_16x16x32_bf16 a[24:27], a[56:59], a[144:147], a[24:27]
    buffer_load_dwordx4 v4, s[28:31], s57 offen offset:2112 nt lds
    v_mfma_f32_16x16x32_bf16 v[28:31], a[60:63], a[112:115], v[28:31]
    v_mfma_f32_16x16x32_bf16 v[60:63], a[60:63], a[116:119], v[60:63]
    buffer_load_dwordx4 a[236:239], v5, s[40:43], s58 offen offset:3072 sc1
    v_mfma_f32_16x16x32_bf16 v[92:95], a[60:63], a[120:123], v[92:95]
    s_add_u32 s58, s83, 20480
    v_mfma_f32_16x16x32_bf16 v[124:127], a[60:63], a[124:127], v[124:127]
    buffer_load_dwordx4 v5, s[28:31], s57 offen offset:3168 nt lds
    v_mfma_f32_16x16x32_bf16 v[156:159], a[60:63], a[128:131], v[156:159]
    s_add_u32 s66, s66, 8192
    v_mfma_f32_16x16x32_bf16 v[188:191], a[60:63], a[132:135], v[188:191]
    s_and_b32 s66, s66, 0x3ffff
    v_mfma_f32_16x16x32_bf16 v[220:223], a[60:63], a[136:139], v[220:223]
    s_add_u32 s63, s64, s66
    v_mfma_f32_16x16x32_bf16 v[252:255], a[60:63], a[140:143], v[252:255]
    s_add_u32 m0, s60, 8448
    v_mfma_f32_16x16x32_bf16 a[28:31], a[60:63], a[144:147], a[28:31]
    s_add_u32 s57, s63, 0
    buffer_load_dwordx4 v2, s[24:27], s57 offen offset:0 nt lds
    v_mfma_f32_16x16x32_bf16 v[32:35], a[64:67], a[112:115], v[32:35]
    v_mfma_f32_16x16x32_bf16 v[64:67], a[64:67], a[116:119], v[64:67]
    buffer_load_dwordx4 a[240:243], v5, s[40:43], s58 offen offset:3072 sc1
    v_mfma_f32_16x16x32_bf16 v[96:99], a[64:67], a[120:123], v[96:99]
    s_add_u32 s58, s83, 24576
    v_mfma_f32_16x16x32_bf16 v[128:131], a[64:67], a[124:127], v[128:131]
    buffer_load_dwordx4 v3, s[24:27], s57 offen offset:1056 nt lds
    v_mfma_f32_16x16x32_bf16 v[160:163], a[64:67], a[128:131], v[160:163]
    v_mfma_f32_16x16x32_bf16 v[192:195], a[64:67], a[132:135], v[192:195]
    v_mfma_f32_16x16x32_bf16 v[224:227], a[64:67], a[136:139], v[224:227]
    buffer_load_dwordx4 a[244:247], v5, s[40:43], s58 offen offset:3072 sc1
    v_mfma_f32_16x16x32_bf16 a[0:3], a[64:67], a[140:143], a[0:3]
    s_add_u32 s58, s83, 28672
    v_mfma_f32_16x16x32_bf16 a[32:35], a[64:67], a[144:147], a[32:35]
    buffer_load_dwordx4 v4, s[24:27], s57 offen offset:2112 nt lds
    v_mfma_f32_16x16x32_bf16 v[36:39], a[68:71], a[112:115], v[36:39]
    v_mfma_f32_16x16x32_bf16 v[68:71], a[68:71], a[116:119], v[68:71]
    v_mfma_f32_16x16x32_bf16 v[100:103], a[68:71], a[120:123], v[100:103]
    v_mfma_f32_16x16x32_bf16 v[132:135], a[68:71], a[124:127], v[132:135]
    buffer_load_dwordx4 v5, s[24:27], s57 offen offset:3168 nt lds
    v_mfma_f32_16x16x32_bf16 v[164:167], a[68:71], a[128:131], v[164:167]
    s_add_u32 m0, s60, 12672
    v_mfma_f32_16x16x32_bf16 v[196:199], a[68:71], a[132:135], v[196:199]
    s_add_u32 s57, s63, 4096
    buffer_load_dwordx4 a[248:251], v5, s[40:43], s58 offen offset:3072 sc1
    v_mfma_f32_16x16x32_bf16 v[228:231], a[68:71], a[136:139], v[228:231]
    s_add_u32 s58, s83, 32768
    v_mfma_f32_16x16x32_bf16 a[4:7], a[68:71], a[140:143], a[4:7]
    buffer_load_dwordx4 v2, s[24:27], s57 offen offset:0 nt lds
    v_mfma_f32_16x16x32_bf16 a[36:39], a[68:71], a[144:147], a[36:39]
    v_mfma_f32_16x16x32_bf16 v[40:43], a[72:75], a[112:115], v[40:43]
    v_mfma_f32_16x16x32_bf16 v[72:75], a[72:75], a[116:119], v[72:75]
    v_mfma_f32_16x16x32_bf16 v[104:107], a[72:75], a[120:123], v[104:107]
    buffer_load_dwordx4 v3, s[24:27], s57 offen offset:1056 nt lds
    v_mfma_f32_16x16x32_bf16 v[136:139], a[72:75], a[124:127], v[136:139]
    v_mfma_f32_16x16x32_bf16 v[168:171], a[72:75], a[128:131], v[168:171]
    buffer_load_dwordx4 a[252:255], v5, s[40:43], s58 offen offset:3072 sc1
    v_mfma_f32_16x16x32_bf16 v[200:203], a[72:75], a[132:135], v[200:203]
    v_mfma_f32_16x16x32_bf16 v[232:235], a[72:75], a[136:139], v[232:235]
    v_mfma_f32_16x16x32_bf16 a[8:11], a[72:75], a[140:143], a[8:11]
    buffer_load_dwordx4 v4, s[24:27], s57 offen offset:2112 nt lds
    v_mfma_f32_16x16x32_bf16 a[40:43], a[72:75], a[144:147], a[40:43]
    v_mfma_f32_16x16x32_bf16 v[44:47], a[76:79], a[112:115], v[44:47]
    v_mfma_f32_16x16x32_bf16 v[76:79], a[76:79], a[116:119], v[76:79]
    v_mfma_f32_16x16x32_bf16 v[108:111], a[76:79], a[120:123], v[108:111]
    buffer_load_dwordx4 v5, s[24:27], s57 offen offset:3168 nt lds
    v_mfma_f32_16x16x32_bf16 v[140:143], a[76:79], a[124:127], v[140:143]
    s_add_u32 s60, s60, 16896
    v_mfma_f32_16x16x32_bf16 v[172:175], a[76:79], a[128:131], v[172:175]
    s_cmp_ge_u32 s60, s61
    v_mfma_f32_16x16x32_bf16 v[204:207], a[76:79], a[132:135], v[204:207]
    s_cselect_b32 s60, 0, s60
    v_mfma_f32_16x16x32_bf16 v[236:239], a[76:79], a[136:139], v[236:239]
    v_mfma_f32_16x16x32_bf16 a[12:15], a[76:79], a[140:143], a[12:15]
    v_mfma_f32_16x16x32_bf16 a[44:47], a[76:79], a[144:147], a[44:47]
    s_waitcnt vmcnt(50)
    s_barrier
    s_waitcnt lgkmcnt(0)
    v_mfma_f32_16x16x32_bf16 v[16:19], a[80:83], a[148:151], v[16:19]
    ds_read_b64_tr_b16 a[48:49], v10 offset:16896
    v_mfma_f32_16x16x32_bf16 v[48:51], a[80:83], a[152:155], v[48:51]
    s_add_u32 m0, s60, 0
    ds_read_b64_tr_b16 a[50:51], v10 offset:17408
    v_mfma_f32_16x16x32_bf16 v[80:83], a[80:83], a[156:159], v[80:83]
    s_add_u32 s57, s63, 0
    buffer_load_dwordx4 v2, s[28:31], s57 offen offset:0 nt lds
    v_mfma_f32_16x16x32_bf16 v[112:115], a[80:83], a[160:163], v[112:115]
    ds_read_b64_tr_b16 a[52:53], v10 offset:16928
    v_mfma_f32_16x16x32_bf16 v[144:147], a[80:83], a[164:167], v[144:147]
    buffer_load_dwordx4 v3, s[28:31], s57 offen offset:1056 nt lds
    v_mfma_f32_16x16x32_bf16 v[176:179], a[80:83], a[168:171], v[176:179]
    ds_read_b64_tr_b16 a[54:55], v10 offset:17440
    v_mfma_f32_16x16x32_bf16 v[208:211], a[80:83], a[172:175], v[208:211]
    ds_read_b64_tr_b16 a[56:57], v10 offset:16960
    v_mfma_f32_16x16x32_bf16 v[240:243], a[80:83], a[176:179], v[240:243]
    ds_read_b64_tr_b16 a[58:59], v10 offset:17472
    v_mfma_f32_16x16x32_bf16 a[16:19], a[80:83], a[180:183], a[16:19]
    buffer_load_dwordx4 v4, s[28:31], s57 offen offset:2112 nt lds
    v_mfma_f32_16x16x32_bf16 v[20:23], a[84:87], a[148:151], v[20:23]
    ds_read_b64_tr_b16 a[60:61], v10 offset:16992
    v_mfma_f32_16x16x32_bf16 v[52:55], a[84:87], a[152:155], v[52:55]
    ds_read_b64_tr_b16 a[62:63], v10 offset:17504
    v_mfma_f32_16x16x32_bf16 v[84:87], a[84:87], a[156:159], v[84:87]
    ds_read_b64_tr_b16 a[64:65], v10 offset:17024
    v_mfma_f32_16x16x32_bf16 v[116:119], a[84:87], a[160:163], v[116:119]
    ds_read_b64_tr_b16 a[66:67], v10 offset:17536
    v_mfma_f32_16x16x32_bf16 v[148:151], a[84:87], a[164:167], v[148:151]
    buffer_load_dwordx4 v5, s[28:31], s57 offen offset:3168 nt lds
    v_mfma_f32_16x16x32_bf16 v[180:183], a[84:87], a[168:171], v[180:183]
    s_add_u32 m0, s60, 4224
    ds_read_b64_tr_b16 a[68:69], v10 offset:17056
    v_mfma_f32_16x16x32_bf16 v[212:215], a[84:87], a[172:175], v[212:215]
    s_add_u32 s57, s63, 4096
    ds_read_b64_tr_b16 a[70:71], v10 offset:17568
    v_mfma_f32_16x16x32_bf16 v[244:247], a[84:87], a[176:179], v[244:247]
    ds_read_b64_tr_b16 a[72:73], v10 offset:17088
    v_mfma_f32_16x16x32_bf16 a[20:23], a[84:87], a[180:183], a[20:23]
    buffer_load_dwordx4 v2, s[28:31], s57 offen offset:0 nt lds
    v_mfma_f32_16x16x32_bf16 v[24:27], a[88:91], a[148:151], v[24:27]
    ds_read_b64_tr_b16 a[74:75], v10 offset:17600
    v_mfma_f32_16x16x32_bf16 v[56:59], a[88:91], a[152:155], v[56:59]
    ds_read_b64_tr_b16 a[76:77], v10 offset:17120
    v_mfma_f32_16x16x32_bf16 v[88:91], a[88:91], a[156:159], v[88:91]
    ds_read_b64_tr_b16 a[78:79], v10 offset:17632
    v_mfma_f32_16x16x32_bf16 v[120:123], a[88:91], a[160:163], v[120:123]
    buffer_load_dwordx4 v3, s[28:31], s57 offen offset:1056 nt lds
    v_mfma_f32_16x16x32_bf16 v[152:155], a[88:91], a[164:167], v[152:155]
    v_mfma_f32_16x16x32_bf16 v[184:187], a[88:91], a[168:171], v[184:187]
    v_mfma_f32_16x16x32_bf16 v[216:219], a[88:91], a[172:175], v[216:219]
    v_mfma_f32_16x16x32_bf16 v[248:251], a[88:91], a[176:179], v[248:251]
    v_mfma_f32_16x16x32_bf16 a[24:27], a[88:91], a[180:183], a[24:27]
    buffer_load_dwordx4 v4, s[28:31], s57 offen offset:2112 nt lds
    v_mfma_f32_16x16x32_bf16 v[28:31], a[92:95], a[148:151], v[28:31]
    v_mfma_f32_16x16x32_bf16 v[60:63], a[92:95], a[152:155], v[60:63]
    v_mfma_f32_16x16x32_bf16 v[92:95], a[92:95], a[156:159], v[92:95]
    v_mfma_f32_16x16x32_bf16 v[124:127], a[92:95], a[160:163], v[124:127]
    buffer_load_dwordx4 v5, s[28:31], s57 offen offset:3168 nt lds
    v_mfma_f32_16x16x32_bf16 v[156:159], a[92:95], a[164:167], v[156:159]
    s_add_u32 s66, s66, 8192
    v_mfma_f32_16x16x32_bf16 v[188:191], a[92:95], a[168:171], v[188:191]
    s_and_b32 s66, s66, 0x3ffff
    v_mfma_f32_16x16x32_bf16 v[220:223], a[92:95], a[172:175], v[220:223]
    s_add_u32 s63, s64, s66
    v_mfma_f32_16x16x32_bf16 v[252:255], a[92:95], a[176:179], v[252:255]
    s_add_u32 m0, s60, 8448
    v_mfma_f32_16x16x32_bf16 a[28:31], a[92:95], a[180:183], a[28:31]
    s_add_u32 s57, s63, 0
    buffer_load_dwordx4 v2, s[24:27], s57 offen offset:0 nt lds
    v_mfma_f32_16x16x32_bf16 v[32:35], a[96:99], a[148:151], v[32:35]
    v_mfma_f32_16x16x32_bf16 v[64:67], a[96:99], a[152:155], v[64:67]
    v_mfma_f32_16x16x32_bf16 v[96:99], a[96:99], a[156:159], v[96:99]
    v_mfma_f32_16x16x32_bf16 v[128:131], a[96:99], a[160:163], v[128:131]
    buffer_load_dwordx4 v3, s[24:27], s57 offen offset:1056 nt lds
    v_mfma_f32_16x16x32_bf16 v[160:163], a[96:99], a[164:167], v[160:163]
    v_mfma_f32_16x16x32_bf16 v[192:195], a[96:99], a[168:171], v[192:195]
    v_mfma_f32_16x16x32_bf16 v[224:227], a[96:99], a[172:175], v[224:227]
    v_mfma_f32_16x16x32_bf16 a[0:3], a[96:99], a[176:179], a[0:3]
    buffer_load_dwordx4 v4, s[24:27], s57 offen offset:2112 nt lds
    v_mfma_f32_16x16x32_bf16 a[32:35], a[96:99], a[180:183], a[32:35]
    v_mfma_f32_16x16x32_bf16 v[36:39], a[100:103], a[148:151], v[36:39]
    v_mfma_f32_16x16x32_bf16 v[68:71], a[100:103], a[152:155], v[68:71]
    v_mfma_f32_16x16x32_bf16 v[100:103], a[100:103], a[156:159], v[100:103]
    v_mfma_f32_16x16x32_bf16 v[132:135], a[100:103], a[160:163], v[132:135]
    buffer_load_dwordx4 v5, s[24:27], s57 offen offset:3168 nt lds
    v_mfma_f32_16x16x32_bf16 v[164:167], a[100:103], a[164:167], v[164:167]
    s_add_u32 m0, s60, 12672
    v_mfma_f32_16x16x32_bf16 v[196:199], a[100:103], a[168:171], v[196:199]
    s_add_u32 s57, s63, 4096
    v_mfma_f32_16x16x32_bf16 v[228:231], a[100:103], a[172:175], v[228:231]
    v_mfma_f32_16x16x32_bf16 a[4:7], a[100:103], a[176:179], a[4:7]
    buffer_load_dwordx4 v2, s[24:27], s57 offen offset:0 nt lds
    v_mfma_f32_16x16x32_bf16 a[36:39], a[100:103], a[180:183], a[36:39]
    v_mfma_f32_16x16x32_bf16 v[40:43], a[104:107], a[148:151], v[40:43]
    v_mfma_f32_16x16x32_bf16 v[72:75], a[104:107], a[152:155], v[72:75]
    v_mfma_f32_16x16x32_bf16 v[104:107], a[104:107], a[156:159], v[104:107]
    buffer_load_dwordx4 v3, s[24:27], s57 offen offset:1056 nt lds
    v_mfma_f32_16x16x32_bf16 v[136:139], a[104:107], a[160:163], v[136:139]
    v_mfma_f32_16x16x32_bf16 v[168:171], a[104:107], a[164:167], v[168:171]
    v_mfma_f32_16x16x32_bf16 v[200:203], a[104:107], a[168:171], v[200:203]
    v_mfma_f32_16x16x32_bf16 v[232:235], a[104:107], a[172:175], v[232:235]
    v_mfma_f32_16x16x32_bf16 a[8:11], a[104:107], a[176:179], a[8:11]
    buffer_load_dwordx4 v4, s[24:27], s57 offen offset:2112 nt lds
    v_mfma_f32_16x16x32_bf16 a[40:43], a[104:107], a[180:183], a[40:43]
    v_mfma_f32_16x16x32_bf16 v[44:47], a[108:111], a[148:151], v[44:47]
    v_mfma_f32_16x16x32_bf16 v[76:79], a[108:111], a[152:155], v[76:79]
    v_mfma_f32_16x16x32_bf16 v[108:111], a[108:111], a[156:159], v[108:111]
    buffer_load_dwordx4 v5, s[24:27], s57 offen offset:3168 nt lds
    v_mfma_f32_16x16x32_bf16 v[140:143], a[108:111], a[160:163], v[140:143]
    s_add_u32 s60, s60, 16896
    v_mfma_f32_16x16x32_bf16 v[172:175], a[108:111], a[164:167], v[172:175]
    s_cmp_ge_u32 s60, s61
    v_mfma_f32_16x16x32_bf16 v[204:207], a[108:111], a[168:171], v[204:207]
    s_cselect_b32 s60, 0, s60
    v_mfma_f32_16x16x32_bf16 v[236:239], a[108:111], a[172:175], v[236:239]
    v_mfma_f32_16x16x32_bf16 a[12:15], a[108:111], a[176:179], a[12:15]
    v_mfma_f32_16x16x32_bf16 a[44:47], a[108:111], a[180:183], a[44:47]
    s_waitcnt vmcnt(41)
    s_barrier
    s_waitcnt lgkmcnt(0)
    v_mfma_f32_16x16x32_bf16 v[16:19], a[48:51], a[184:187], v[16:19]
    ds_read_b64_tr_b16 a[80:81], v10 offset:25344
    v_mfma_f32_16x16x32_bf16 v[48:51], a[48:51], a[188:191], v[48:51]
    s_add_u32 m0, s60, 0
    ds_read_b64_tr_b16 a[82:83], v10 offset:25856
    v_mfma_f32_16x16x32_bf16 v[80:83], a[48:51], a[192:195], v[80:83]
    s_add_u32 s57, s63, 0
    buffer_load_dwordx4 v2, s[28:31], s57 offen offset:0 nt lds
    v_mfma_f32_16x16x32_bf16 v[112:115], a[48:51], a[196:199], v[112:115]
    ds_read_b64_tr_b16 a[84:85], v10 offset:25376
    v_mfma_f32_16x16x32_bf16 v[144:147], a[48:51], a[200:203], v[144:147]
    buffer_load_dwordx4 v3, s[28:31], s57 offen offset:1056 nt lds
    v_mfma_f32_16x16x32_bf16 v[176:179], a[48:51], a[204:207], v[176:179]
    ds_read_b64_tr_b16 a[86:87], v10 offset:25888
    v_mfma_f32_16x16x32_bf16 v[208:211], a[48:51], a[208:211], v[208:211]
    ds_read_b64_tr_b16 a[88:89], v10 offset:25408
    v_mfma_f32_16x16x32_bf16 v[240:243], a[48:51], a[212:215], v[240:243]
    ds_read_b64_tr_b16 a[90:91], v10 offset:25920
    v_mfma_f32_16x16x32_bf16 a[16:19], a[48:51], a[216:219], a[16:19]
    buffer_load_dwordx4 v4, s[28:31], s57 offen offset:2112 nt lds
    v_mfma_f32_16x16x32_bf16 v[20:23], a[52:55], a[184:187], v[20:23]
    ds_read_b64_tr_b16 a[92:93], v10 offset:25440
    v_mfma_f32_16x16x32_bf16 v[52:55], a[52:55], a[188:191], v[52:55]
    ds_read_b64_tr_b16 a[94:95], v10 offset:25952
    v_mfma_f32_16x16x32_bf16 v[84:87], a[52:55], a[192:195], v[84:87]
    ds_read_b64_tr_b16 a[96:97], v10 offset:25472
    v_mfma_f32_16x16x32_bf16 v[116:119], a[52:55], a[196:199], v[116:119]
    ds_read_b64_tr_b16 a[98:99], v10 offset:25984
    v_mfma_f32_16x16x32_bf16 v[148:151], a[52:55], a[200:203], v[148:151]
    buffer_load_dwordx4 v5, s[28:31], s57 offen offset:3168 nt lds
    v_mfma_f32_16x16x32_bf16 v[180:183], a[52:55], a[204:207], v[180:183]
    s_add_u32 m0, s60, 4224
    ds_read_b64_tr_b16 a[100:101], v10 offset:25504
    v_mfma_f32_16x16x32_bf16 v[212:215], a[52:55], a[208:211], v[212:215]
    s_add_u32 s57, s63, 4096
    ds_read_b64_tr_b16 a[102:103], v10 offset:26016
    v_mfma_f32_16x16x32_bf16 v[244:247], a[52:55], a[212:215], v[244:247]
    ds_read_b64_tr_b16 a[104:105], v10 offset:25536
    v_mfma_f32_16x16x32_bf16 a[20:23], a[52:55], a[216:219], a[20:23]
    buffer_load_dwordx4 v2, s[28:31], s57 offen offset:0 nt lds
    v_mfma_f32_16x16x32_bf16 v[24:27], a[56:59], a[184:187], v[24:27]
    ds_read_b64_tr_b16 a[106:107], v10 offset:26048
    v_mfma_f32_16x16x32_bf16 v[56:59], a[56:59], a[188:191], v[56:59]
    ds_read_b64_tr_b16 a[108:109], v10 offset:25568
    v_mfma_f32_16x16x32_bf16 v[88:91], a[56:59], a[192:195], v[88:91]
    ds_read_b64_tr_b16 a[110:111], v10 offset:26080
    v_mfma_f32_16x16x32_bf16 v[120:123], a[56:59], a[196:199], v[120:123]
    buffer_load_dwordx4 v3, s[28:31], s57 offen offset:1056 nt lds
    v_mfma_f32_16x16x32_bf16 v[152:155], a[56:59], a[200:203], v[152:155]
    v_mfma_f32_16x16x32_bf16 v[184:187], a[56:59], a[204:207], v[184:187]
    v_mfma_f32_16x16x32_bf16 v[216:219], a[56:59], a[208:211], v[216:219]
    v_mfma_f32_16x16x32_bf16 v[248:251], a[56:59], a[212:215], v[248:251]
    v_mfma_f32_16x16x32_bf16 a[24:27], a[56:59], a[216:219], a[24:27]
    buffer_load_dwordx4 v4, s[28:31], s57 offen offset:2112 nt lds
    v_mfma_f32_16x16x32_bf16 v[28:31], a[60:63], a[184:187], v[28:31]
    v_mfma_f32_16x16x32_bf16 v[60:63], a[60:63], a[188:191], v[60:63]
    v_mfma_f32_16x16x32_bf16 v[92:95], a[60:63], a[192:195], v[92:95]
    v_mfma_f32_16x16x32_bf16 v[124:127], a[60:63], a[196:199], v[124:127]
    buffer_load_dwordx4 v5, s[28:31], s57 offen offset:3168 nt lds
    v_mfma_f32_16x16x32_bf16 v[156:159], a[60:63], a[200:203], v[156:159]
    s_add_u32 s66, s66, 8192
    v_mfma_f32_16x16x32_bf16 v[188:191], a[60:63], a[204:207], v[188:191]
    s_and_b32 s66, s66, 0x3ffff
    v_mfma_f32_16x16x32_bf16 v[220:223], a[60:63], a[208:211], v[220:223]
    s_add_u32 s63, s64, s66
    v_mfma_f32_16x16x32_bf16 v[252:255], a[60:63], a[212:215], v[252:255]
    s_add_u32 m0, s60, 8448
    v_mfma_f32_16x16x32_bf16 a[28:31], a[60:63], a[216:219], a[28:31]
    s_add_u32 s57, s63, 0
    buffer_load_dwordx4 v2, s[24:27], s57 offen offset:0 nt lds
    v_mfma_f32_16x16x32_bf16 v[32:35], a[64:67], a[184:187], v[32:35]
    v_mfma_f32_16x16x32_bf16 v[64:67], a[64:67], a[188:191], v[64:67]
    v_mfma_f32_16x16x32_bf16 v[96:99], a[64:67], a[192:195], v[96:99]
    v_mfma_f32_16x16x32_bf16 v[128:131], a[64:67], a[196:199], v[128:131]
    buffer_load_dwordx4 v3, s[24:27], s57 offen offset:1056 nt lds
    v_mfma_f32_16x16x32_bf16 v[160:163], a[64:67], a[200:203], v[160:163]
    v_mfma_f32_16x16x32_bf16 v[192:195], a[64:67], a[204:207], v[192:195]
    v_mfma_f32_16x16x32_bf16 v[224:227], a[64:67], a[208:211], v[224:227]
    v_mfma_f32_16x16x32_bf16 a[0:3], a[64:67], a[212:215], a[0:3]
    buffer_load_dwordx4 v4, s[24:27], s57 offen offset:2112 nt lds
    v_mfma_f32_16x16x32_bf16 a[32:35], a[64:67], a[216:219], a[32:35]
    v_mfma_f32_16x16x32_bf16 v[36:39], a[68:71], a[184:187], v[36:39]
    v_mfma_f32_16x16x32_bf16 v[68:71], a[68:71], a[188:191], v[68:71]
    v_mfma_f32_16x16x32_bf16 v[100:103], a[68:71], a[192:195], v[100:103]
    v_mfma_f32_16x16x32_bf16 v[132:135], a[68:71], a[196:199], v[132:135]
    buffer_load_dwordx4 v5, s[24:27], s57 offen offset:3168 nt lds
    v_mfma_f32_16x16x32_bf16 v[164:167], a[68:71], a[200:203], v[164:167]
    s_add_u32 m0, s60, 12672
    v_mfma_f32_16x16x32_bf16 v[196:199], a[68:71], a[204:207], v[196:199]
    s_add_u32 s57, s63, 4096
    v_mfma_f32_16x16x32_bf16 v[228:231], a[68:71], a[208:211], v[228:231]
    v_mfma_f32_16x16x32_bf16 a[4:7], a[68:71], a[212:215], a[4:7]
    buffer_load_dwordx4 v2, s[24:27], s57 offen offset:0 nt lds
    v_mfma_f32_16x16x32_bf16 a[36:39], a[68:71], a[216:219], a[36:39]
    v_mfma_f32_16x16x32_bf16 v[40:43], a[72:75], a[184:187], v[40:43]
    v_mfma_f32_16x16x32_bf16 v[72:75], a[72:75], a[188:191], v[72:75]
    v_mfma_f32_16x16x32_bf16 v[104:107], a[72:75], a[192:195], v[104:107]
    buffer_load_dwordx4 v3, s[24:27], s57 offen offset:1056 nt lds
    v_mfma_f32_16x16x32_bf16 v[136:139], a[72:75], a[196:199], v[136:139]
    v_mfma_f32_16x16x32_bf16 v[168:171], a[72:75], a[200:203], v[168:171]
    v_mfma_f32_16x16x32_bf16 v[200:203], a[72:75], a[204:207], v[200:203]
    v_mfma_f32_16x16x32_bf16 v[232:235], a[72:75], a[208:211], v[232:235]
    v_mfma_f32_16x16x32_bf16 a[8:11], a[72:75], a[212:215], a[8:11]
    buffer_load_dwordx4 v4, s[24:27], s57 offen offset:2112 nt lds
    v_mfma_f32_16x16x32_bf16 a[40:43], a[72:75], a[216:219], a[40:43]
    v_mfma_f32_16x16x32_bf16 v[44:47], a[76:79], a[184:187], v[44:47]
    v_mfma_f32_16x16x32_bf16 v[76:79], a[76:79], a[188:191], v[76:79]
    v_mfma_f32_16x16x32_bf16 v[108:111], a[76:79], a[192:195], v[108:111]
    buffer_load_dwordx4 v5, s[24:27], s57 offen offset:3168 nt lds
    v_mfma_f32_16x16x32_bf16 v[140:143], a[76:79], a[196:199], v[140:143]
    s_add_u32 s60, s60, 16896
    v_mfma_f32_16x16x32_bf16 v[172:175], a[76:79], a[200:203], v[172:175]
    s_cmp_ge_u32 s60, s61
    v_mfma_f32_16x16x32_bf16 v[204:207], a[76:79], a[204:207], v[204:207]
    s_cselect_b32 s60, 0, s60
    v_mfma_f32_16x16x32_bf16 v[236:239], a[76:79], a[208:211], v[236:239]
    v_mfma_f32_16x16x32_bf16 a[12:15], a[76:79], a[212:215], a[12:15]
    v_mfma_f32_16x16x32_bf16 a[44:47], a[76:79], a[216:219], a[44:47]
    s_waitcnt vmcnt(32)
    s_barrier
    s_waitcnt lgkmcnt(0)
    v_mfma_f32_16x16x32_bf16 v[16:19], a[80:83], a[220:223], v[16:19]
    s_add_u32 m0, s60, 0
    v_mfma_f32_16x16x32_bf16 v[48:51], a[80:83], a[224:227], v[48:51]
    s_add_u32 s57, s63, 0
    buffer_load_dwordx4 v2, s[28:31], s57 offen offset:0 nt lds
    v_mfma_f32_16x16x32_bf16 v[80:83], a[80:83], a[228:231], v[80:83]
    v_mfma_f32_16x16x32_bf16 v[112:115], a[80:83], a[232:235], v[112:115]
    v_mfma_f32_16x16x32_bf16 v[144:147], a[80:83], a[236:239], v[144:147]
    buffer_load_dwordx4 v3, s[28:31], s57 offen offset:1056 nt lds
    v_mfma_f32_16x16x32_bf16 v[176:179], a[80:83], a[240:243], v[176:179]
    v_mfma_f32_16x16x32_bf16 v[208:211], a[80:83], a[244:247], v[208:211]
    v_mfma_f32_16x16x32_bf16 v[240:243], a[80:83], a[248:251], v[240:243]
    v_mfma_f32_16x16x32_bf16 a[16:19], a[80:83], a[252:255], a[16:19]
    buffer_load_dwordx4 v4, s[28:31], s57 offen offset:2112 nt lds
    v_mfma_f32_16x16x32_bf16 v[20:23], a[84:87], a[220:223], v[20:23]
    v_mfma_f32_16x16x32_bf16 v[52:55], a[84:87], a[224:227], v[52:55]
    v_mfma_f32_16x16x32_bf16 v[84:87], a[84:87], a[228:231], v[84:87]
    v_mfma_f32_16x16x32_bf16 v[116:119], a[84:87], a[232:235], v[116:119]
    v_mfma_f32_16x16x32_bf16 v[148:151], a[84:87], a[236:239], v[148:151]
    buffer_load_dwordx4 v5, s[28:31], s57 offen offset:3168 nt lds
    v_mfma_f32_16x16x32_bf16 v[180:183], a[84:87], a[240:243], v[180:183]
    s_add_u32 m0, s60, 4224
    v_mfma_f32_16x16x32_bf16 v[212:215], a[84:87], a[244:247], v[212:215]
    s_add_u32 s57, s63, 4096
    v_mfma_f32_16x16x32_bf16 v[244:247], a[84:87], a[248:251], v[244:247]
    v_mfma_f32_16x16x32_bf16 a[20:23], a[84:87], a[252:255], a[20:23]
    buffer_load_dwordx4 v2, s[28:31], s57 offen offset:0 nt lds
    v_mfma_f32_16x16x32_bf16 v[24:27], a[88:91], a[220:223], v[24:27]
    v_mfma_f32_16x16x32_bf16 v[56:59], a[88:91], a[224:227], v[56:59]
    v_mfma_f32_16x16x32_bf16 v[88:91], a[88:91], a[228:231], v[88:91]
    v_mfma_f32_16x16x32_bf16 v[120:123], a[88:91], a[232:235], v[120:123]
    buffer_load_dwordx4 v3, s[28:31], s57 offen offset:1056 nt lds
    v_mfma_f32_16x16x32_bf16 v[152:155], a[88:91], a[236:239], v[152:155]
    v_mfma_f32_16x16x32_bf16 v[184:187], a[88:91], a[240:243], v[184:187]
    v_mfma_f32_16x16x32_bf16 v[216:219], a[88:91], a[244:247], v[216:219]
    v_mfma_f32_16x16x32_bf16 v[248:251], a[88:91], a[248:251], v[248:251]
    v_mfma_f32_16x16x32_bf16 a[24:27], a[88:91], a[252:255], a[24:27]
    buffer_load_dwordx4 v4, s[28:31], s57 offen offset:2112 nt lds
    v_mfma_f32_16x16x32_bf16 v[28:31], a[92:95], a[220:223], v[28:31]
    v_mfma_f32_16x16x32_bf16 v[60:63], a[92:95], a[224:227], v[60:63]
    v_mfma_f32_16x16x32_bf16 v[92:95], a[92:95], a[228:231], v[92:95]
    v_mfma_f32_16x16x32_bf16 v[124:127], a[92:95], a[232:235], v[124:127]
    buffer_load_dwordx4 v5, s[28:31], s57 offen offset:3168 nt lds
    v_mfma_f32_16x16x32_bf16 v[156:159], a[92:95], a[236:239], v[156:159]
    s_add_u32 s66, s66, 8192
    v_mfma_f32_16x16x32_bf16 v[188:191], a[92:95], a[240:243], v[188:191]
    s_and_b32 s66, s66, 0x3ffff
    v_mfma_f32_16x16x32_bf16 v[220:223], a[92:95], a[244:247], v[220:223]
    s_add_u32 s63, s64, s66
    v_mfma_f32_16x16x32_bf16 v[252:255], a[92:95], a[248:251], v[252:255]
    s_add_u32 m0, s60, 8448
    v_mfma_f32_16x16x32_bf16 a[28:31], a[92:95], a[252:255], a[28:31]
    s_add_u32 s57, s63, 0
    buffer_load_dwordx4 v2, s[24:27], s57 offen offset:0 nt lds
    v_mfma_f32_16x16x32_bf16 v[32:35], a[96:99], a[220:223], v[32:35]
    v_mfma_f32_16x16x32_bf16 v[64:67], a[96:99], a[224:227], v[64:67]
    v_mfma_f32_16x16x32_bf16 v[96:99], a[96:99], a[228:231], v[96:99]
    v_mfma_f32_16x16x32_bf16 v[128:131], a[96:99], a[232:235], v[128:131]
    buffer_load_dwordx4 v3, s[24:27], s57 offen offset:1056 nt lds
    v_mfma_f32_16x16x32_bf16 v[160:163], a[96:99], a[236:239], v[160:163]
    v_mfma_f32_16x16x32_bf16 v[192:195], a[96:99], a[240:243], v[192:195]
    v_mfma_f32_16x16x32_bf16 v[224:227], a[96:99], a[244:247], v[224:227]
    v_mfma_f32_16x16x32_bf16 a[0:3], a[96:99], a[248:251], a[0:3]
    buffer_load_dwordx4 v4, s[24:27], s57 offen offset:2112 nt lds
    v_mfma_f32_16x16x32_bf16 a[32:35], a[96:99], a[252:255], a[32:35]
    v_mfma_f32_16x16x32_bf16 v[36:39], a[100:103], a[220:223], v[36:39]
    v_mfma_f32_16x16x32_bf16 v[68:71], a[100:103], a[224:227], v[68:71]
    v_mfma_f32_16x16x32_bf16 v[100:103], a[100:103], a[228:231], v[100:103]
    v_mfma_f32_16x16x32_bf16 v[132:135], a[100:103], a[232:235], v[132:135]
    buffer_load_dwordx4 v5, s[24:27], s57 offen offset:3168 nt lds
    v_mfma_f32_16x16x32_bf16 v[164:167], a[100:103], a[236:239], v[164:167]
    s_add_u32 m0, s60, 12672
    v_mfma_f32_16x16x32_bf16 v[196:199], a[100:103], a[240:243], v[196:199]
    s_add_u32 s57, s63, 4096
    v_mfma_f32_16x16x32_bf16 v[228:231], a[100:103], a[244:247], v[228:231]
    v_mfma_f32_16x16x32_bf16 a[4:7], a[100:103], a[248:251], a[4:7]
    buffer_load_dwordx4 v2, s[24:27], s57 offen offset:0 nt lds
    v_mfma_f32_16x16x32_bf16 a[36:39], a[100:103], a[252:255], a[36:39]
    v_mfma_f32_16x16x32_bf16 v[40:43], a[104:107], a[220:223], v[40:43]
    v_mfma_f32_16x16x32_bf16 v[72:75], a[104:107], a[224:227], v[72:75]
    v_mfma_f32_16x16x32_bf16 v[104:107], a[104:107], a[228:231], v[104:107]
    buffer_load_dwordx4 v3, s[24:27], s57 offen offset:1056 nt lds
    v_mfma_f32_16x16x32_bf16 v[136:139], a[104:107], a[232:235], v[136:139]
    v_mfma_f32_16x16x32_bf16 v[168:171], a[104:107], a[236:239], v[168:171]
    v_mfma_f32_16x16x32_bf16 v[200:203], a[104:107], a[240:243], v[200:203]
    v_mfma_f32_16x16x32_bf16 v[232:235], a[104:107], a[244:247], v[232:235]
    v_mfma_f32_16x16x32_bf16 a[8:11], a[104:107], a[248:251], a[8:11]
    buffer_load_dwordx4 v4, s[24:27], s57 offen offset:2112 nt lds
    v_mfma_f32_16x16x32_bf16 a[40:43], a[104:107], a[252:255], a[40:43]
    v_mfma_f32_16x16x32_bf16 v[44:47], a[108:111], a[220:223], v[44:47]
    v_mfma_f32_16x16x32_bf16 v[76:79], a[108:111], a[224:227], v[76:79]
    v_mfma_f32_16x16x32_bf16 v[108:111], a[108:111], a[228:231], v[108:111]
    buffer_load_dwordx4 v5, s[24:27], s57 offen offset:3168 nt lds
    v_mfma_f32_16x16x32_bf16 v[140:143], a[108:111], a[232:235], v[140:143]
    s_add_u32 s60, s60, 16896
    v_mfma_f32_16x16x32_bf16 v[172:175], a[108:111], a[236:239], v[172:175]
    s_cmp_ge_u32 s60, s61
    v_mfma_f32_16x16x32_bf16 v[204:207], a[108:111], a[240:243], v[204:207]
    s_cselect_b32 s60, 0, s60
    v_mfma_f32_16x16x32_bf16 v[236:239], a[108:111], a[244:247], v[236:239]
    v_mfma_f32_16x16x32_bf16 a[12:15], a[108:111], a[248:251], a[12:15]
    v_mfma_f32_16x16x32_bf16 a[44:47], a[108:111], a[252:255], a[44:47]
    v_add_u32 v11, 67584, v5
    v_add_u32 v10, 129024, v5
    s_waitcnt vmcnt(32)
    s_barrier
    s_add_u32 m0, s60, 0
    s_add_u32 s57, s63, 0
    buffer_load_dwordx4 v2, s[28:31], s57 offen offset:0 nt lds
    ds_write_b128 v11, v[16:19] offset:0
    buffer_load_dwordx4 v3, s[28:31], s57 offen offset:1056 nt lds
    ds_write_b128 v11, v[48:51] offset:8192
    ds_write_b128 v11, v[80:83] offset:16384
    buffer_load_dwordx4 v4, s[28:31], s57 offen offset:2112 nt lds
    ds_write_b128 v11, v[112:115] offset:24576
    ds_write_b128 v11, v[144:147] offset:32768
    buffer_load_dwordx4 v5, s[28:31], s57 offen offset:3168 nt lds
    ds_write_b128 v11, v[176:179] offset:40960
    s_add_u32 m0, s60, 4224
    s_add_u32 s57, s63, 4096
    buffer_load_dwordx4 v2, s[28:31], s57 offen offset:0 nt lds
    ds_write_b128 v11, v[208:211] offset:49152
    ds_write_b128 v11, v[240:243] offset:57344
    buffer_load_dwordx4 v3, s[28:31], s57 offen offset:1056 nt lds
    ds_write_b128 v10, a[16:19] offset:4096
    ds_write_b128 v11, v[20:23] offset:1024
    buffer_load_dwordx4 v4, s[28:31], s57 offen offset:2112 nt lds
    ds_write_b128 v11, v[52:55] offset:9216
    buffer_load_dwordx4 v5, s[28:31], s57 offen offset:3168 nt lds
    ds_write_b128 v11, v[84:87] offset:17408
    ds_write_b128 v11, v[116:119] offset:25600
    s_add_u32 s66, s66, 8192
    s_and_b32 s66, s66, 0x3ffff
    s_add_u32 s63, s64, s66
    s_add_u32 m0, s60, 8448
    s_add_u32 s57, s63, 0
    buffer_load_dwordx4 v2, s[24:27], s57 offen offset:0 nt lds
    ds_write_b128 v11, v[148:151] offset:33792
    ds_write_b128 v11, v[180:183] offset:41984
    buffer_load_dwordx4 v3, s[24:27], s57 offen offset:1056 nt lds
    ds_write_b128 v11, v[212:215] offset:50176
    buffer_load_dwordx4 v4, s[24:27], s57 offen offset:2112 nt lds
    ds_write_b128 v11, v[244:247] offset:58368
    ds_write_b128 v10, a[20:23] offset:5120
    buffer_load_dwordx4 v5, s[24:27], s57 offen offset:3168 nt lds
    ds_write_b128 v11, v[24:27] offset:2048
    ds_write_b128 v11, v[56:59] offset:10240
    s_add_u32 m0, s60, 12672
    s_add_u32 s57, s63, 4096
    buffer_load_dwordx4 v2, s[24:27], s57 offen offset:0 nt lds
    ds_write_b128 v11, v[88:91] offset:18432
    buffer_load_dwordx4 v3, s[24:27], s57 offen offset:1056 nt lds
    ds_write_b128 v11, v[120:123] offset:26624
    ds_write_b128 v11, v[152:155] offset:34816
    buffer_load_dwordx4 v4, s[24:27], s57 offen offset:2112 nt lds
    ds_write_b128 v11, v[184:187] offset:43008
    ds_write_b128 v11, v[216:219] offset:51200
    buffer_load_dwordx4 v5, s[24:27], s57 offen offset:3168 nt lds
    ds_write_b128 v11, v[248:251] offset:59392
    ds_write_b128 v10, a[24:27] offset:6144
    s_add_u32 s60, s60, 16896
    s_cmp_ge_u32 s60, s61
    s_cselect_b32 s60, 0, s60
    s_waitcnt lgkmcnt(0)
    s_waitcnt vmcnt(32)
    s_barrier
    s_add_u32 m0, s60, 0
    s_add_u32 s57, s63, 0
    buffer_load_dwordx4 v2, s[28:31], s57 offen offset:0 nt lds
    ds_write_b128 v11, v[28:31] offset:3072
    buffer_load_dwordx4 v3, s[28:31], s57 offen offset:1056 nt lds
    ds_write_b128 v11, v[60:63] offset:11264
    ds_write_b128 v11, v[92:95] offset:19456
    buffer_load_dwordx4 v4, s[28:31], s57 offen offset:2112 nt lds
    ds_write_b128 v11, v[124:127] offset:27648
    ds_write_b128 v11, v[156:159] offset:35840
    buffer_load_dwordx4 v5, s[28:31], s57 offen offset:3168 nt lds
    ds_write_b128 v11, v[188:191] offset:44032
    s_add_u32 m0, s60, 4224
    s_add_u32 s57, s63, 4096
    buffer_load_dwordx4 v2, s[28:31], s57 offen offset:0 nt lds
    ds_write_b128 v11, v[220:223] offset:52224
    ds_write_b128 v11, v[252:255] offset:60416
    buffer_load_dwordx4 v3, s[28:31], s57 offen offset:1056 nt lds
    ds_write_b128 v10, a[28:31] offset:7168
    ds_write_b128 v11, v[32:35] offset:4096
    buffer_load_dwordx4 v4, s[28:31], s57 offen offset:2112 nt lds
    ds_write_b128 v11, v[64:67] offset:12288
    buffer_load_dwordx4 v5, s[28:31], s57 offen offset:3168 nt lds
    ds_write_b128 v11, v[96:99] offset:20480
    ds_write_b128 v11, v[128:131] offset:28672
    s_add_u32 s66, s66, 8192
    s_and_b32 s66, s66, 0x3ffff
    s_add_u32 s63, s64, s66
    s_add_u32 m0, s60, 8448
    s_add_u32 s57, s63, 0
    buffer_load_dwordx4 v2, s[24:27], s57 offen offset:0 nt lds
    ds_write_b128 v11, v[160:163] offset:36864
    ds_write_b128 v11, v[192:195] offset:45056
    buffer_load_dwordx4 v3, s[24:27], s57 offen offset:1056 nt lds
    ds_write_b128 v11, v[224:227] offset:53248
    buffer_load_dwordx4 v4, s[24:27], s57 offen offset:2112 nt lds
    ds_write_b128 v10, a[0:3] offset:0
    ds_write_b128 v10, a[32:35] offset:8192
    buffer_load_dwordx4 v5, s[24:27], s57 offen offset:3168 nt lds
    ds_write_b128 v11, v[36:39] offset:5120
    ds_write_b128 v11, v[68:71] offset:13312
    s_add_u32 m0, s60, 12672
    s_add_u32 s57, s63, 4096
    buffer_load_dwordx4 v2, s[24:27], s57 offen offset:0 nt lds
    ds_write_b128 v11, v[100:103] offset:21504
    buffer_load_dwordx4 v3, s[24:27], s57 offen offset:1056 nt lds
    ds_write_b128 v11, v[132:135] offset:29696
    ds_write_b128 v11, v[164:167] offset:37888
    buffer_load_dwordx4 v4, s[24:27], s57 offen offset:2112 nt lds
    ds_write_b128 v11, v[196:199] offset:46080
    ds_write_b128 v11, v[228:231] offset:54272
    buffer_load_dwordx4 v5, s[24:27], s57 offen offset:3168 nt lds
    ds_write_b128 v10, a[4:7] offset:1024
    ds_write_b128 v10, a[36:39] offset:9216
    s_add_u32 s60, s60, 16896
    s_cmp_ge_u32 s60, s61
    s_cselect_b32 s60, 0, s60
    s_waitcnt lgkmcnt(0)
    s_waitcnt vmcnt(32)
    s_barrier
    s_add_u32 m0, s60, 0
    s_add_u32 s57, s63, 0
    buffer_load_dwordx4 v2, s[28:31], s57 offen offset:0 nt lds
    ds_write_b128 v11, v[40:43] offset:6144
    buffer_load_dwordx4 v3, s[28:31], s57 offen offset:1056 nt lds
    ds_write_b128 v11, v[72:75] offset:14336
    buffer_load_dwordx4 v4, s[28:31], s57 offen offset:2112 nt lds
    ds_write_b128 v11, v[104:107] offset:22528
    buffer_load_dwordx4 v5, s[28:31], s57 offen offset:3168 nt lds
    ds_write_b128 v11, v[136:139] offset:30720
    s_add_u32 m0, s60, 4224
    s_add_u32 s57, s63, 4096
    buffer_load_dwordx4 v2, s[28:31], s57 offen offset:0 nt lds
    ds_write_b128 v11, v[168:171] offset:38912
    buffer_load_dwordx4 v3, s[28:31], s57 offen offset:1056 nt lds
    ds_write_b128 v11, v[200:203] offset:47104
    buffer_load_dwordx4 v4, s[28:31], s57 offen offset:2112 nt lds
    ds_write_b128 v11, v[232:235] offset:55296
    buffer_load_dwordx4 v5, s[28:31], s57 offen offset:3168 nt lds
    ds_write_b128 v10, a[8:11] offset:2048
    ds_write_b128 v10, a[40:43] offset:10240
    s_add_u32 s66, s66, 8192
    s_and_b32 s66, s66, 0x3ffff
    s_add_u32 s63, s64, s66
    s_add_u32 m0, s60, 8448
    s_add_u32 s57, s63, 0
    buffer_load_dwordx4 v2, s[24:27], s57 offen offset:0 nt lds
    ds_write_b128 v11, v[44:47] offset:7168
    buffer_load_dwordx4 v3, s[24:27], s57 offen offset:1056 nt lds
    ds_write_b128 v11, v[76:79] offset:15360
    buffer_load_dwordx4 v4, s[24:27], s57 offen offset:2112 nt lds
    ds_write_b128 v11, v[108:111] offset:23552
    buffer_load_dwordx4 v5, s[24:27], s57 offen offset:3168 nt lds
    ds_write_b128 v11, v[140:143] offset:31744
    s_add_u32 m0, s60, 12672
    s_add_u32 s57, s63, 4096
    buffer_load_dwordx4 v2, s[24:27], s57 offen offset:0 nt lds
    ds_write_b128 v11, v[172:175] offset:39936
    buffer_load_dwordx4 v3, s[24:27], s57 offen offset:1056 nt lds
    ds_write_b128 v11, v[204:207] offset:48128
    buffer_load_dwordx4 v4, s[24:27], s57 offen offset:2112 nt lds
    ds_write_b128 v11, v[236:239] offset:56320
    buffer_load_dwordx4 v5, s[24:27], s57 offen offset:3168 nt lds
    ds_write_b128 v10, a[12:15] offset:3072
    ds_write_b128 v10, a[44:47] offset:11264
    s_add_u32 s60, s60, 16896
    s_cmp_ge_u32 s60, s61
    s_cselect_b32 s60, 0, s60
    s_waitcnt lgkmcnt(0)
    s_waitcnt vmcnt(32)
    s_barrier
    s_add_u32 m0, s60, 0
    s_add_u32 s57, s63, 0
    buffer_load_dwordx4 v2, s[28:31], s57 offen offset:0 nt lds
    buffer_load_dwordx4 v3, s[28:31], s57 offen offset:1056 nt lds
    buffer_load_dwordx4 v4, s[28:31], s57 offen offset:2112 nt lds
    buffer_load_dwordx4 v5, s[28:31], s57 offen offset:3168 nt lds
    s_add_u32 m0, s60, 4224
    s_add_u32 s57, s63, 4096
    buffer_load_dwordx4 v2, s[28:31], s57 offen offset:0 nt lds
    buffer_load_dwordx4 v3, s[28:31], s57 offen offset:1056 nt lds
    buffer_load_dwordx4 v4, s[28:31], s57 offen offset:2112 nt lds
    buffer_load_dwordx4 v5, s[28:31], s57 offen offset:3168 nt lds
    s_add_u32 s66, s66, 8192
    s_and_b32 s66, s66, 0x3ffff
    s_add_u32 s63, s64, s66
    s_add_u32 m0, s60, 8448
    s_add_u32 s57, s63, 0
    buffer_load_dwordx4 v2, s[24:27], s57 offen offset:0 nt lds
    buffer_load_dwordx4 v3, s[24:27], s57 offen offset:1056 nt lds
    buffer_load_dwordx4 v4, s[24:27], s57 offen offset:2112 nt lds
    buffer_load_dwordx4 v5, s[24:27], s57 offen offset:3168 nt lds
    s_add_u32 m0, s60, 12672
    s_add_u32 s57, s63, 4096
    buffer_load_dwordx4 v2, s[24:27], s57 offen offset:0 nt lds
    buffer_load_dwordx4 v3, s[24:27], s57 offen offset:1056 nt lds
    buffer_load_dwordx4 v4, s[24:27], s57 offen offset:2112 nt lds
    buffer_load_dwordx4 v5, s[24:27], s57 offen offset:3168 nt lds
    s_add_u32 s60, s60, 16896
    s_cmp_ge_u32 s60, s61
    s_cselect_b32 s60, 0, s60
    s_waitcnt vmcnt(32)
    s_barrier
    s_add_u32 m0, s60, 0
    s_add_u32 s57, s63, 0
    buffer_load_dwordx4 v2, s[28:31], s57 offen offset:0 nt lds
    buffer_load_dwordx4 v3, s[28:31], s57 offen offset:1056 nt lds
    buffer_load_dwordx4 v4, s[28:31], s57 offen offset:2112 nt lds
    buffer_load_dwordx4 v5, s[28:31], s57 offen offset:3168 nt lds
    s_add_u32 m0, s60, 4224
    s_add_u32 s57, s63, 4096
    buffer_load_dwordx4 v2, s[28:31], s57 offen offset:0 nt lds
    buffer_load_dwordx4 v3, s[28:31], s57 offen offset:1056 nt lds
    buffer_load_dwordx4 v4, s[28:31], s57 offen offset:2112 nt lds
    buffer_load_dwordx4 v5, s[28:31], s57 offen offset:3168 nt lds
    s_add_u32 s66, s66, 8192
    s_and_b32 s66, s66, 0x3ffff
    s_add_u32 s63, s64, s66
    s_add_u32 m0, s60, 8448
    s_add_u32 s57, s63, 0
    buffer_load_dwordx4 v2, s[24:27], s57 offen offset:0 nt lds
    buffer_load_dwordx4 v3, s[24:27], s57 offen offset:1056 nt lds
    buffer_load_dwordx4 v4, s[24:27], s57 offen offset:2112 nt lds
    buffer_load_dwordx4 v5, s[24:27], s57 offen offset:3168 nt lds
    s_add_u32 m0, s60, 12672
    s_add_u32 s57, s63, 4096
    buffer_load_dwordx4 v2, s[24:27], s57 offen offset:0 nt lds
    buffer_load_dwordx4 v3, s[24:27], s57 offen offset:1056 nt lds
    buffer_load_dwordx4 v4, s[24:27], s57 offen offset:2112 nt lds
    buffer_load_dwordx4 v5, s[24:27], s57 offen offset:3168 nt lds
    s_add_u32 s60, s60, 16896
    s_cmp_ge_u32 s60, s61
    s_cselect_b32 s60, 0, s60
    s_waitcnt vmcnt(32)
    s_barrier
    s_add_u32 m0, s60, 0
    s_add_u32 s57, s63, 0
    buffer_load_dwordx4 v2, s[28:31], s57 offen offset:0 nt lds
    buffer_load_dwordx4 v3, s[28:31], s57 offen offset:1056 nt lds
    buffer_load_dwordx4 v4, s[28:31], s57 offen offset:2112 nt lds
    buffer_load_dwordx4 v5, s[28:31], s57 offen offset:3168 nt lds
    s_add_u32 m0, s60, 4224
    s_add_u32 s57, s63, 4096
    buffer_load_dwordx4 v2, s[28:31], s57 offen offset:0 nt lds
    buffer_load_dwordx4 v3, s[28:31], s57 offen offset:1056 nt lds
    buffer_load_dwordx4 v4, s[28:31], s57 offen offset:2112 nt lds
    buffer_load_dwordx4 v5, s[28:31], s57 offen offset:3168 nt lds
    s_add_u32 s66, s66, 8192
    s_and_b32 s66, s66, 0x3ffff
    s_add_u32 s63, s64, s66
    s_add_u32 m0, s60, 8448
    s_add_u32 s57, s63, 0
    buffer_load_dwordx4 v2, s[24:27], s57 offen offset:0 nt lds
    buffer_load_dwordx4 v3, s[24:27], s57 offen offset:1056 nt lds
    buffer_load_dwordx4 v4, s[24:27], s57 offen offset:2112 nt lds
    buffer_load_dwordx4 v5, s[24:27], s57 offen offset:3168 nt lds
    s_add_u32 m0, s60, 12672
    s_add_u32 s57, s63, 4096
    buffer_load_dwordx4 v2, s[24:27], s57 offen offset:0 nt lds
    buffer_load_dwordx4 v3, s[24:27], s57 offen offset:1056 nt lds
    buffer_load_dwordx4 v4, s[24:27], s57 offen offset:2112 nt lds
    buffer_load_dwordx4 v5, s[24:27], s57 offen offset:3168 nt lds
    s_add_u32 s60, s60, 16896
    s_cmp_ge_u32 s60, s61
    s_cselect_b32 s60, 0, s60
    s_waitcnt vmcnt(32)
    s_barrier
    s_add_u32 m0, s60, 0
    s_add_u32 s57, s63, 0
    buffer_load_dwordx4 v2, s[28:31], s57 offen offset:0 nt lds
    buffer_load_dwordx4 v3, s[28:31], s57 offen offset:1056 nt lds
    buffer_load_dwordx4 v4, s[28:31], s57 offen offset:2112 nt lds
    buffer_load_dwordx4 v5, s[28:31], s57 offen offset:3168 nt lds
    s_add_u32 m0, s60, 4224
    s_add_u32 s57, s63, 4096
    buffer_load_dwordx4 v2, s[28:31], s57 offen offset:0 nt lds
    buffer_load_dwordx4 v3, s[28:31], s57 offen offset:1056 nt lds
    buffer_load_dwordx4 v4, s[28:31], s57 offen offset:2112 nt lds
    buffer_load_dwordx4 v5, s[28:31], s57 offen offset:3168 nt lds
    s_add_u32 s66, s66, 8192
    s_and_b32 s66, s66, 0x3ffff
    s_add_u32 s63, s64, s66
    s_add_u32 m0, s60, 8448
    s_add_u32 s57, s63, 0
    buffer_load_dwordx4 v2, s[24:27], s57 offen offset:0 nt lds
    buffer_load_dwordx4 v3, s[24:27], s57 offen offset:1056 nt lds
    buffer_load_dwordx4 v4, s[24:27], s57 offen offset:2112 nt lds
    buffer_load_dwordx4 v5, s[24:27], s57 offen offset:3168 nt lds
    s_add_u32 m0, s60, 12672
    s_add_u32 s57, s63, 4096
    buffer_load_dwordx4 v2, s[24:27], s57 offen offset:0 nt lds
    buffer_load_dwordx4 v3, s[24:27], s57 offen offset:1056 nt lds
    buffer_load_dwordx4 v4, s[24:27], s57 offen offset:2112 nt lds
    buffer_load_dwordx4 v5, s[24:27], s57 offen offset:3168 nt lds
    s_add_u32 s60, s60, 16896
    s_cmp_ge_u32 s60, s61
    s_cselect_b32 s60, 0, s60
    s_waitcnt vmcnt(32)
    s_barrier
    s_add_u32 m0, s60, 0
    s_add_u32 s57, s63, 0
    buffer_load_dwordx4 v2, s[28:31], s57 offen offset:0 nt lds
    buffer_load_dwordx4 v3, s[28:31], s57 offen offset:1056 nt lds
    buffer_load_dwordx4 v4, s[28:31], s57 offen offset:2112 nt lds
    buffer_load_dwordx4 v5, s[28:31], s57 offen offset:3168 nt lds
    s_add_u32 m0, s60, 4224
    s_add_u32 s57, s63, 4096
    buffer_load_dwordx4 v2, s[28:31], s57 offen offset:0 nt lds
    buffer_load_dwordx4 v3, s[28:31], s57 offen offset:1056 nt lds
    buffer_load_dwordx4 v4, s[28:31], s57 offen offset:2112 nt lds
    buffer_load_dwordx4 v5, s[28:31], s57 offen offset:3168 nt lds
    s_add_u32 s60, s60, 16896
    s_cmp_ge_u32 s60, s61
    s_cselect_b32 s60, 0, s60
    s_mov_b32 m0, 141312
    s_add_u32 s57, s75, 524288
    buffer_load_dwordx4 v6, s[36:39], s57 offen offset:0 lds
    buffer_load_dwordx4 v7, s[36:39], s57 offen offset:1056 lds
    buffer_load_dwordx4 v8, s[36:39], s57 offen offset:2112 lds
    buffer_load_dwordx4 v9, s[36:39], s57 offen offset:3168 lds
    s_mov_b32 m0, 145536
    s_add_u32 s57, s75, 528384
    buffer_load_dwordx4 v6, s[36:39], s57 offen offset:0 lds
    buffer_load_dwordx4 v7, s[36:39], s57 offen offset:1056 lds
    buffer_load_dwordx4 v8, s[36:39], s57 offen offset:2112 lds
    buffer_load_dwordx4 v9, s[36:39], s57 offen offset:3168 lds
    s_mov_b32 m0, 149760
    s_add_u32 s57, s75, 557056
    buffer_load_dwordx4 v6, s[36:39], s57 offen offset:0 lds
    buffer_load_dwordx4 v7, s[36:39], s57 offen offset:1056 lds
    buffer_load_dwordx4 v8, s[36:39], s57 offen offset:2112 lds
    buffer_load_dwordx4 v9, s[36:39], s57 offen offset:3168 lds
    s_mov_b32 m0, 153984
    s_add_u32 s57, s75, 561152
    buffer_load_dwordx4 v6, s[36:39], s57 offen offset:0 lds
    buffer_load_dwordx4 v7, s[36:39], s57 offen offset:1056 lds
    buffer_load_dwordx4 v8, s[36:39], s57 offen offset:2112 lds
    buffer_load_dwordx4 v9, s[36:39], s57 offen offset:3168 lds
    s_waitcnt vmcnt(40)
    s_barrier
    s_mov_b32 m0, 16896
    s_add_u32 s57, s75, 589824
    buffer_load_dwordx4 v6, s[36:39], s57 offen offset:0 lds
    buffer_load_dwordx4 v7, s[36:39], s57 offen offset:1056 lds
    buffer_load_dwordx4 v8, s[36:39], s57 offen offset:2112 lds
    buffer_load_dwordx4 v9, s[36:39], s57 offen offset:3168 lds
    s_mov_b32 m0, 21120
    s_add_u32 s57, s75, 593920
    buffer_load_dwordx4 v6, s[36:39], s57 offen offset:0 lds
    buffer_load_dwordx4 v7, s[36:39], s57 offen offset:1056 lds
    buffer_load_dwordx4 v8, s[36:39], s57 offen offset:2112 lds
    buffer_load_dwordx4 v9, s[36:39], s57 offen offset:3168 lds
    s_mov_b32 m0, 25344
    s_add_u32 s57, s75, 622592
    buffer_load_dwordx4 v6, s[36:39], s57 offen offset:0 lds
    buffer_load_dwordx4 v7, s[36:39], s57 offen offset:1056 lds
    buffer_load_dwordx4 v8, s[36:39], s57 offen offset:2112 lds
    buffer_load_dwordx4 v9, s[36:39], s57 offen offset:3168 lds
    s_mov_b32 m0, 29568
    s_add_u32 s57, s75, 626688
    buffer_load_dwordx4 v6, s[36:39], s57 offen offset:0 lds
    buffer_load_dwordx4 v7, s[36:39], s57 offen offset:1056 lds
    buffer_load_dwordx4 v8, s[36:39], s57 offen offset:2112 lds
    buffer_load_dwordx4 v9, s[36:39], s57 offen offset:3168 lds
    s_mov_b32 m0, 67584
    s_add_u32 s57, s77, 524288
    buffer_load_dwordx4 v6, s[36:39], s57 offen offset:0 lds
    buffer_load_dwordx4 v7, s[36:39], s57 offen offset:1056 lds
    buffer_load_dwordx4 v8, s[36:39], s57 offen offset:2112 lds
    buffer_load_dwordx4 v9, s[36:39], s57 offen offset:3168 lds
    s_mov_b32 m0, 71808
    s_add_u32 s57, s77, 528384
    buffer_load_dwordx4 v6, s[36:39], s57 offen offset:0 lds
    buffer_load_dwordx4 v7, s[36:39], s57 offen offset:1056 lds
    buffer_load_dwordx4 v8, s[36:39], s57 offen offset:2112 lds
    buffer_load_dwordx4 v9, s[36:39], s57 offen offset:3168 lds
    s_mov_b32 m0, 76032
    s_add_u32 s57, s77, 557056
    buffer_load_dwordx4 v6, s[36:39], s57 offen offset:0 lds
    buffer_load_dwordx4 v7, s[36:39], s57 offen offset:1056 lds
    buffer_load_dwordx4 v8, s[36:39], s57 offen offset:2112 lds
    buffer_load_dwordx4 v9, s[36:39], s57 offen offset:3168 lds
    s_mov_b32 m0, 80256
    s_add_u32 s57, s77, 561152
    buffer_load_dwordx4 v6, s[36:39], s57 offen offset:0 lds
    buffer_load_dwordx4 v7, s[36:39], s57 offen offset:1056 lds
    buffer_load_dwordx4 v8, s[36:39], s57 offen offset:2112 lds
    buffer_load_dwordx4 v9, s[36:39], s57 offen offset:3168 lds
    s_mov_b32 m0, 84480
    s_add_u32 s57, s77, 589824
    buffer_load_dwordx4 v6, s[36:39], s57 offen offset:0 lds
    buffer_load_dwordx4 v7, s[36:39], s57 offen offset:1056 lds
    buffer_load_dwordx4 v8, s[36:39], s57 offen offset:2112 lds
    buffer_load_dwordx4 v9, s[36:39], s57 offen offset:3168 lds
    s_mov_b32 m0, 88704
    s_add_u32 s57, s77, 593920
    buffer_load_dwordx4 v6, s[36:39], s57 offen offset:0 lds
    buffer_load_dwordx4 v7, s[36:39], s57 offen offset:1056 lds
    buffer_load_dwordx4 v8, s[36:39], s57 offen offset:2112 lds
    buffer_load_dwordx4 v9, s[36:39], s57 offen offset:3168 lds
    s_mov_b32 m0, 92928
    s_add_u32 s57, s77, 622592
    buffer_load_dwordx4 v6, s[36:39], s57 offen offset:0 lds
    buffer_load_dwordx4 v7, s[36:39], s57 offen offset:1056 lds
    buffer_load_dwordx4 v8, s[36:39], s57 offen offset:2112 lds
    buffer_load_dwordx4 v9, s[36:39], s57 offen offset:3168 lds
    s_mov_b32 m0, 97152
    s_add_u32 s57, s77, 626688
    buffer_load_dwordx4 v6, s[36:39], s57 offen offset:0 lds
    buffer_load_dwordx4 v7, s[36:39], s57 offen offset:1056 lds
    buffer_load_dwordx4 v8, s[36:39], s57 offen offset:2112 lds
    buffer_load_dwordx4 v9, s[36:39], s57 offen offset:3168 lds
    s_waitcnt vmcnt(63)
    s_barrier
    s_mov_b32 m0, 101376
    s_add_u32 s57, s78, 524288
    buffer_load_dwordx4 v6, s[36:39], s57 offen offset:0 lds
    buffer_load_dwordx4 v7, s[36:39], s57 offen offset:1056 lds
    buffer_load_dwordx4 v8, s[36:39], s57 offen offset:2112 lds
    buffer_load_dwordx4 v9, s[36:39], s57 offen offset:3168 lds
    s_mov_b32 m0, 105600
    s_add_u32 s57, s78, 528384
    buffer_load_dwordx4 v6, s[36:39], s57 offen offset:0 lds
    buffer_load_dwordx4 v7, s[36:39], s57 offen offset:1056 lds
    buffer_load_dwordx4 v8, s[36:39], s57 offen offset:2112 lds
    buffer_load_dwordx4 v9, s[36:39], s57 offen offset:3168 lds
    s_mov_b32 m0, 109824
    s_add_u32 s57, s78, 557056
    buffer_load_dwordx4 v6, s[36:39], s57 offen offset:0 lds
    buffer_load_dwordx4 v7, s[36:39], s57 offen offset:1056 lds
    buffer_load_dwordx4 v8, s[36:39], s57 offen offset:2112 lds
    buffer_load_dwordx4 v9, s[36:39], s57 offen offset:3168 lds
    s_mov_b32 m0, 114048
    s_add_u32 s57, s78, 561152
    buffer_load_dwordx4 v6, s[36:39], s57 offen offset:0 lds
    buffer_load_dwordx4 v7, s[36:39], s57 offen offset:1056 lds
    buffer_load_dwordx4 v8, s[36:39], s57 offen offset:2112 lds
    buffer_load_dwordx4 v9, s[36:39], s57 offen offset:3168 lds
    s_mov_b32 m0, 118272
    s_add_u32 s57, s78, 589824
    buffer_load_dwordx4 v6, s[36:39], s57 offen offset:0 lds
    buffer_load_dwordx4 v7, s[36:39], s57 offen offset:1056 lds
    buffer_load_dwordx4 v8, s[36:39], s57 offen offset:2112 lds
    buffer_load_dwordx4 v9, s[36:39], s57 offen offset:3168 lds
    s_mov_b32 m0, 122496
    s_add_u32 s57, s78, 593920
    buffer_load_dwordx4 v6, s[36:39], s57 offen offset:0 lds
    buffer_load_dwordx4 v7, s[36:39], s57 offen offset:1056 lds
    buffer_load_dwordx4 v8, s[36:39], s57 offen offset:2112 lds
    buffer_load_dwordx4 v9, s[36:39], s57 offen offset:3168 lds
    s_mov_b32 m0, 126720
    s_add_u32 s57, s78, 622592
    buffer_load_dwordx4 v6, s[36:39], s57 offen offset:0 lds
    buffer_load_dwordx4 v7, s[36:39], s57 offen offset:1056 lds
    buffer_load_dwordx4 v8, s[36:39], s57 offen offset:2112 lds
    buffer_load_dwordx4 v9, s[36:39], s57 offen offset:3168 lds
    s_mov_b32 m0, 130944
    s_add_u32 s57, s78, 626688
    buffer_load_dwordx4 v6, s[36:39], s57 offen offset:0 lds
    buffer_load_dwordx4 v7, s[36:39], s57 offen offset:1056 lds
    buffer_load_dwordx4 v8, s[36:39], s57 offen offset:2112 lds
    buffer_load_dwordx4 v9, s[36:39], s57 offen offset:3168 lds
    s_mov_b32 m0, 33792
    s_add_u32 s57, s76, 524288
    buffer_load_dwordx4 v6, s[36:39], s57 offen offset:0 lds
    buffer_load_dwordx4 v7, s[36:39], s57 offen offset:1056 lds
    buffer_load_dwordx4 v8, s[36:39], s57 offen offset:2112 lds
    buffer_load_dwordx4 v9, s[36:39], s57 offen offset:3168 lds
    s_mov_b32 m0, 38016
    s_add_u32 s57, s76, 528384
    buffer_load_dwordx4 v6, s[36:39], s57 offen offset:0 lds
    buffer_load_dwordx4 v7, s[36:39], s57 offen offset:1056 lds
    buffer_load_dwordx4 v8, s[36:39], s57 offen offset:2112 lds
    buffer_load_dwordx4 v9, s[36:39], s57 offen offset:3168 lds
    s_mov_b32 m0, 42240
    s_add_u32 s57, s76, 557056
    buffer_load_dwordx4 v6, s[36:39], s57 offen offset:0 lds
    buffer_load_dwordx4 v7, s[36:39], s57 offen offset:1056 lds
    buffer_load_dwordx4 v8, s[36:39], s57 offen offset:2112 lds
    buffer_load_dwordx4 v9, s[36:39], s57 offen offset:3168 lds
    s_mov_b32 m0, 46464
    s_add_u32 s57, s76, 561152
    buffer_load_dwordx4 v6, s[36:39], s57 offen offset:0 lds
    buffer_load_dwordx4 v7, s[36:39], s57 offen offset:1056 lds
    buffer_load_dwordx4 v8, s[36:39], s57 offen offset:2112 lds
    buffer_load_dwordx4 v9, s[36:39], s57 offen offset:3168 lds
    s_barrier
    s_mov_b32 m0, 50688
    s_add_u32 s57, s76, 589824
    buffer_load_dwordx4 v6, s[36:39], s57 offen offset:0 lds
    buffer_load_dwordx4 v7, s[36:39], s57 offen offset:1056 lds
    buffer_load_dwordx4 v8, s[36:39], s57 offen offset:2112 lds
    buffer_load_dwordx4 v9, s[36:39], s57 offen offset:3168 lds
    s_mov_b32 m0, 54912
    s_add_u32 s57, s76, 593920
    buffer_load_dwordx4 v6, s[36:39], s57 offen offset:0 lds
    buffer_load_dwordx4 v7, s[36:39], s57 offen offset:1056 lds
    buffer_load_dwordx4 v8, s[36:39], s57 offen offset:2112 lds
    buffer_load_dwordx4 v9, s[36:39], s57 offen offset:3168 lds
    s_mov_b32 m0, 59136
    s_add_u32 s57, s76, 622592
    buffer_load_dwordx4 v6, s[36:39], s57 offen offset:0 lds
    buffer_load_dwordx4 v7, s[36:39], s57 offen offset:1056 lds
    buffer_load_dwordx4 v8, s[36:39], s57 offen offset:2112 lds
    buffer_load_dwordx4 v9, s[36:39], s57 offen offset:3168 lds
    s_mov_b32 m0, 63360
    s_add_u32 s57, s76, 626688
    buffer_load_dwordx4 v6, s[36:39], s57 offen offset:0 lds
    buffer_load_dwordx4 v7, s[36:39], s57 offen offset:1056 lds
    buffer_load_dwordx4 v8, s[36:39], s57 offen offset:2112 lds
    buffer_load_dwordx4 v9, s[36:39], s57 offen offset:3168 lds
    s_waitcnt vmcnt(63)
    s_barrier
    s_waitcnt vmcnt(0)
    s_barrier
    s_endpgm
L_done:
    s_endpgm
.section .rodata,"a"
.p2align 6
.amdhsa_kernel standalone__gqa_block_cached__near_ridge_kernel
  .amdhsa_next_free_vgpr 512
  .amdhsa_next_free_sgpr 100
  .amdhsa_accum_offset 256
  .amdhsa_group_segment_fixed_size 0
  .amdhsa_kernarg_size 64
  .amdhsa_user_sgpr_count 2
  .amdhsa_user_sgpr_kernarg_segment_ptr 1
  .amdhsa_system_sgpr_workgroup_id_x 1
.end_amdhsa_kernel
```
